```python
import torch

def _softmax(x, axis=-1):
    return torch.softmax(x, dim=axis)
def _gelu(x):
    return torch.nn.functional.gelu(x, approximate="tanh")
def _silu(x):
    return torch.nn.functional.silu(x)
def _sigmoid(x):
    return torch.sigmoid(x)
def _layernorm(x, axis=-1, eps=1e-5):
    m = x.mean(dim=axis, keepdim=True)
    v = x.var(dim=axis, keepdim=True, unbiased=False)
    return (x - m) / torch.sqrt(v + eps)
def _scatter_add(tgt, idx, src, axis=0):
    return tgt.clone().index_add_(axis, idx, src)
def _segment_sum(src, seg, n):
    out = torch.zeros((n,) + src.shape[1:], dtype=src.dtype)
    return out.index_add_(0, seg, src)
def _pad(x, pw):
    flat = tuple(v for pair in reversed(pw) for v in pair)
    return torch.nn.functional.pad(x, flat)

kernel_name = 'recurrent_scan__sliding_local_dilated__dense_activation_silu__prompt'

def setup_inputs():

    _w = (lambda a: (lambda t: t.to(torch.bfloat16) if t.is_floating_point() else t)(torch.as_tensor(a)))
    def _A_setup():
        B, S, D = 1, 2048, 576
        return {
            "x": _w((lambda *s: torch.randn(*s, dtype=torch.bfloat16) * 0.05)(B, S, D)),
            "wqkv": _w((lambda *s: torch.randn(*s, dtype=torch.bfloat16) * 0.2)(D, 3 * D)),
            "wo": _w((lambda *s: torch.randn(*s, dtype=torch.bfloat16) * 0.2)(D, D)),
        }
    _A_in = _A_setup()

    def _B_setup():
        B, S, D, F = 1, 2048, 576, 4608
        return {
            "x": _w((lambda *s: torch.randn(*s, dtype=torch.bfloat16) * 0.05)(B, S, D)),
            "w1": _w((lambda *s: torch.randn(*s, dtype=torch.bfloat16) * 1.6)(D, F) * (D ** -0.5)),
            "w2": _w((lambda *s: torch.randn(*s, dtype=torch.bfloat16) * 0.1)(F, D) * (F ** -0.5)),
        }
    _B_in = _B_setup()

    return {
        "A_x": _A_in["x"],
        "A_wqkv": _A_in["wqkv"],
        "A_wo": _A_in["wo"],
        "B_x": _B_in["x"],
        "B_w1": _B_in["w1"],
        "B_w2": _B_in["w2"],
    }

def reference(A_x, A_wqkv, A_wo, B_x, B_w1, B_w2):
    def _A_ref(x, wqkv, wo):
        B, S, D = x.shape
        H = 32; Dh = D // H
        W, dil = 8, 2
        qkv = (lambda x, *d: x.permute(*d))((x @ wqkv).reshape(B, S, 3, H, Dh), 2, 0, 3, 1, 4)
        q, k, v = qkv[0], qkv[1], qkv[2]
        scale = Dh ** -0.5
        pos = torch.arange(S)
        off = torch.arange(W) * dil
        idx = pos[:, None] - off[None, :]
        mask = idx >= 0
        idx_c = torch.where(mask, idx, 0).reshape(-1)
        kg = k[:, :, idx_c, :].reshape(B, H, S, W, Dh)
        vg = v[:, :, idx_c, :].reshape(B, H, S, W, Dh)
        logits = torch.einsum("bhsd,bhswd->bhsw", q, kg) * scale
        logits = torch.where(mask[None, None, :, :], logits, -1e9)
        attn = _softmax(logits, axis=-1)
        o = torch.einsum("bhsw,bhswd->bhsd", attn, vg)
        return (lambda x, *d: x.permute(*d))(o, 0, 2, 1, 3).reshape(B, S, D) @ wo

    def _B_ref(x, w1, w2):
        h = torch.einsum("bsd,df->bsf", x, w1)
        h = _silu(h)
        out = torch.einsum("bsf,fd->bsd", h, w2)
        return out

    x = A_x
    xn = _layernorm(x, axis=-1)
    s = _A_ref(xn, A_wqkv, A_wo)
    g = _silu(_B_ref(xn, B_w1, B_w2))
    return x + s * g
```

```asm
; @launch grid=(256,1,1) block=(256,1,1) lds=155648
.amdgcn_target "amdgcn-amd-amdhsa--gfx950"
.text
.globl recurrent_scan__sliding_local_dilated__dense_activation_silu__prompt_kernel
.p2align 8
.type recurrent_scan__sliding_local_dilated__dense_activation_silu__prompt_kernel,@function
recurrent_scan__sliding_local_dilated__dense_activation_silu__prompt_kernel:
L_main_start:
s_cmp_ge_u32 s2, 256
s_cbranch_scc1 L_exit
s_load_dwordx4 s[4:7], s[0:1], 0
s_load_dwordx2 s[8:9], s[0:1], 16
s_load_dwordx4 s[40:43], s[0:1], 32
s_load_dwordx4 s[44:47], s[0:1], 56
v_lshrrev_b32 v1, 6, v0
v_lshlrev_b32 v46, 7, v0
v_readfirstlane_b32 s34, v1
v_and_b32 v0, 63, v0
s_getpc_b64 s[48:49]
s_bfe_u32 s58, s2, 0x20003
s_lshl_b32 s58, s58, 15
v_add_u32 v46, s58, v46
v_min_u32 v46, 84284, v46
global_load_dword v47, v46, s[48:49]
s_and_b32 s37, s2, 1
s_lshl_b32 s37, s37, 3
s_bfe_u32 s38, s2, 0x20001
s_lshr_b32 s39, s2, 3
s_and_b32 s36, s39, 7
s_add_u32 s32, s37, s36
s_lshl_b32 s51, s38, 1
s_add_u32 s51, s51, s37
s_lshr_b32 s52, s39, 2
s_add_u32 s51, s51, s52
s_lshl_b32 s52, s39, 1
s_and_b32 s52, s52, 6
s_add_u32 s52, s52, s51
s_mul_i32 s53, s52, 57
s_lshr_b32 s53, s53, 9
s_mul_i32 s53, s53, 9
s_sub_u32 s52, s52, s53
s_lshr_b32 s35, s39, 3
s_sub_u32 s35, s35, 1
s_mul_i32 s50, s35, 3
s_cmp_lt_u32 s39, 8
s_cselect_b32 s50, s52, s50
s_cselect_b32 s32, s51, s32
s_lshl_b32 s53, s32, 7
s_lshl_b32 s54, s34, 5
s_add_u32 s53, s53, s54
s_mul_i32 s53, s53, 1152
v_lshrrev_b32 v2, 3, v0
v_mul_u32_u24 v2, 2304, v2
v_lshrrev_b32 v3, 4, v0
v_and_b32 v44, 7, v0
v_xor_b32 v3, v3, v44
v_lshlrev_b32 v3, 4, v3
v_add_u32 v44, v2, v3
v_add_u32 v44, s53, v44
v_xor_b32_e64 v45, 64, v44
v_add_u32 v45, 17408, v45
s_lshl_b32 s55, s50, 7
s_mul_i32 s54, s34, 12288
s_waitcnt lgkmcnt(0)
s_mov_b32 s12, s4
s_mov_b32 s13, s5
s_mov_b32 s14, 2359296
s_mov_b32 s15, 0x20000
s_add_u32 m0, s54, 0
s_add_u32 s56, s55, 1152
buffer_load_dwordx4 v44, s[12:15], s55 offen lds
buffer_load_dwordx4 v45, s[12:15], s55 offen offset:1024 lds
s_add_u32 m0, m0, 2048
s_add_u32 s55, s55, 128
buffer_load_dwordx4 v44, s[12:15], s56 offen lds
buffer_load_dwordx4 v45, s[12:15], s56 offen offset:1024 lds
s_cmp_eq_u32 s55, 1152
s_cselect_b32 s55, 0, s55
s_add_u32 m0, s54, 4096
s_add_u32 s56, s55, 1152
buffer_load_dwordx4 v44, s[12:15], s55 offen lds
buffer_load_dwordx4 v45, s[12:15], s55 offen offset:1024 lds
s_add_u32 m0, m0, 2048
s_add_u32 s55, s55, 128
buffer_load_dwordx4 v44, s[12:15], s56 offen lds
buffer_load_dwordx4 v45, s[12:15], s56 offen offset:1024 lds
s_cmp_eq_u32 s55, 1152
s_cselect_b32 s55, 0, s55
s_add_u32 m0, s54, 8192
s_add_u32 s56, s55, 1152
buffer_load_dwordx4 v44, s[12:15], s55 offen lds
buffer_load_dwordx4 v45, s[12:15], s55 offen offset:1024 lds
s_add_u32 m0, m0, 2048
s_add_u32 s55, s55, 128
buffer_load_dwordx4 v44, s[12:15], s56 offen lds
buffer_load_dwordx4 v45, s[12:15], s56 offen offset:1024 lds
s_cmp_eq_u32 s55, 1152
s_cselect_b32 s55, 0, s55
s_mul_i32 s24, s32, 1917952
s_add_u32 s24, s24, s46
s_addc_u32 s25, s47, 0
s_mov_b32 s26, 100663296
s_mov_b32 s27, 0x20000
s_mov_b32 s28, s44
s_mov_b32 s29, s45
s_mov_b32 s30, 256
s_mov_b32 s31, 0x20000
s_cmp_lt_u32 s39, 8
s_cbranch_scc1 L_attn
s_mov_b32 s50, s35
s_add_u32 s51, s50, 1
s_cmp_ge_u32 s51, 3
s_cselect_b32 s51, 0, s51
s_add_u32 s52, s51, 1
s_cmp_ge_u32 s52, 3
s_cselect_b32 s52, 0, s52
s_mul_i32 s33, s38, 3
s_add_u32 s33, s33, s35
s_mov_b32 s16, s40
s_mov_b32 s17, s41
s_mov_b32 s18, 5308416
s_mov_b32 s19, 0x20000
s_mov_b32 s20, s42
s_mov_b32 s21, s43
s_mov_b32 s22, 5308416
s_mov_b32 s23, 0x20000
s_mul_i32 s59, s33, 768
s_mul_i32 s63, s33, 442368
s_mul_i32 s64, s34, 6144
s_lshl_b32 s33, s35, 2
s_add_u32 s33, s33, s38
s_load_dwordx2 s[72:73], s[0:1], 48
s_lshl_b32 s66, s34, 11
s_lshl_b32 s67, s33, 7
s_add_u32 s66, s66, s67
s_add_u32 s66, s66, 3687424
v_lshrrev_b32 v14, 5, v0
v_lshlrev_b32 v14, 30, v14
v_lshl_add_u32 v14, v0, 2, v14
v_add_u32 v39, s66, v14
v_mov_b32 v14, 0
s_mov_b32 s37, 8192
s_lshl_b32 s66, s32, 2
s_and_b32 s67, s33, 3
s_add_u32 s66, s66, s67
s_lshl_b32 s66, s66, 2
s_lshl_b32 s67, s34, 8
s_add_u32 s66, s66, s67
v_lshlrev_b32 v10, 8, v0
v_add_u32 v10, s66, v10
s_getreg_b32 s66, hwreg(HW_REG_XCC_ID)
s_and_b32 s66, s66, 15
s_and_b32 s67, s33, 12
s_add_u32 s67, s67, 12
s_lshl_b32 s66, s66, s67
s_add_u32 s66, s66, 1
v_mov_b32 v11, s66
v_lshrrev_b32 v2, 3, v0
v_and_b32 v3, 7, v0
s_mul_i32 s58, s34, 48
v_add_u32_e64 v4, s58, v2
v_bfe_u32 v5, v0, 4, 1
v_lshlrev_b32 v5, 2, v5
v_xor_b32 v5, v5, v3
v_lshlrev_b32_e64 v5, 4, v5
v_mul_u32_u24 v6, 9216, v4
v_add_u32_e64 v28, v6, v5
v_add_u32 v29, 72704, v28
v_add_u32 v30, 145408, v28
v_add_u32 v31, 218112, v28
v_bfe_u32 v5, v0, 4, 2
v_lshlrev_b32 v5, 1, v5
v_xor_b32 v5, v5, v3
v_lshlrev_b32_e64 v5, 4, v5
v_mul_u32_u24 v6, 1152, v4
v_add_u32_e64 v32, v6, v5
v_add_u32 v33, 8192, v32
v_add_u32 v34, 16384, v32
v_add_u32 v35, 24576, v32
s_and_b32 s35, s36, 1
s_mul_i32 s39, s35, 384
s_add_u32 s59, s59, s39
s_lshl_b32 s39, s39, 1
s_mul_i32 s60, s50, 1769472
s_add_u32 s60, s60, s59
s_mul_i32 s61, s51, 1769472
s_add_u32 s61, s61, s59
s_mul_i32 s62, s52, 1769472
s_add_u32 s62, s62, s59
v_lshrrev_b32 v2, 5, v0
v_lshlrev_b32 v2, 12, v2
v_bfe_u32 v3, v0, 2, 2
v_lshlrev_b32 v3, 7, v3
v_add_u32 v2, v2, v3
v_bfe_u32 v3, v0, 4, 1
v_lshlrev_b32 v3, 5, v3
v_add_u32 v2, v2, v3
v_and_b32 v3, 3, v0
v_lshlrev_b32 v3, 3, v3
v_add_u32_e64 v2, v2, v3
v_bfe_u32 v3, v0, 3, 1
v_lshlrev_b32 v3, 6, v3
v_add_u32 v16, v2, v3
v_xor_b32 v19, 64, v16
v_lshrrev_b32 v2, 2, v0
v_lshlrev_b32 v2, 7, v2
v_and_b32 v3, 3, v0
v_lshlrev_b32 v3, 3, v3
v_add_u32 v2, v2, v3
s_and_b32 s69, s34, 1
s_lshl_b32 s69, s69, 1
v_bfe_u32 v3, v0, 3, 2
v_xor_b32 v3, s69, v3
v_lshlrev_b32 v3, 5, v3
v_add_u32 v22, v2, v3
v_xor_b32 v25, 32, v22
v_add_u32 v17, 49152, v16
v_add_u32 v18, 98304, v16
v_add_u32 v20, 49152, v19
v_add_u32 v21, 98304, v19
v_add_u32 v23, 49152, v22
v_add_u32 v24, 98304, v22
v_add_u32 v26, 49152, v25
v_add_u32 v27, 98304, v25
v_bfe_u32 v2, v0, 4, 1
v_lshlrev_b32 v2, 10, v2
v_lshrrev_b32 v3, 5, v0
v_lshlrev_b32 v3, 8, v3
v_add_u32 v2, v2, v3
v_and_b32 v3, 15, v0
v_lshlrev_b32 v3, 4, v3
v_add_u32 v2, v2, v3
s_lshl_b32 s69, s34, 11
s_add_u32 s69, s69, 122880
v_add_u32 v36, s69, v2
s_and_b32 s69, s33, 3
s_lshl_b32 s69, s69, 10
v_xor_b32 v36, s69, v36
v_lshlrev_b32_e64 v38, 4, v0
s_lshr_b32 s69, s34, 1
s_lshl_b32 s69, s69, 12
s_add_u32 s69, s69, 122880
v_add_u32 v37, s69, v38
s_lshl_b32 s70, s38, 1
s_lshr_b32 s69, s34, 1
s_add_u32 s70, s70, s69
s_mul_i32 s70, s70, 18
s_and_b32 s69, s34, 1
s_add_u32 s70, s70, s69
s_lshl_b32 s70, s70, 12
s_add_u32 s70, s70, 1917952
s_lshr_b32 s66, s33, 2
s_mul_i32 s67, s32, 43
s_lshr_b32 s67, s67, 7
s_mul_i32 s68, s67, 3
s_sub_u32 s68, s32, s68
s_add_u32 s68, s68, s66
s_add_u32 s68, s68, 1
s_cmp_ge_u32 s68, 3
s_cselect_b32 s69, 3, 0
s_sub_u32 s68, s68, s69
s_cmp_ge_u32 s67, 3
s_cselect_b32 s69, 3, 0
s_sub_u32 s67, s67, s69
s_mul_i32 s69, s68, 3
s_add_u32 s69, s69, s67
s_lshl_b32 s40, s69, 7
s_add_u32 s40, s40, s63
s_lshl_b32 s3, s69, 13
s_add_u32 s3, s3, s70
s_add_u32 s67, s67, 1
s_cmp_eq_u32 s67, 3
s_cselect_b32 s67, 0, s67
s_mul_i32 s69, s68, 3
s_add_u32 s69, s69, s67
s_lshl_b32 s41, s69, 7
s_add_u32 s41, s41, s63
s_lshl_b32 s4, s69, 13
s_add_u32 s4, s4, s70
s_add_u32 s67, s67, 1
s_cmp_eq_u32 s67, 3
s_cselect_b32 s67, 0, s67
s_mul_i32 s69, s68, 3
s_add_u32 s69, s69, s67
s_lshl_b32 s42, s69, 7
s_add_u32 s42, s42, s63
s_lshl_b32 s5, s69, 13
s_add_u32 s5, s5, s70
s_add_u32 s67, s67, 1
s_cmp_eq_u32 s67, 3
s_cselect_b32 s67, 0, s67
s_add_u32 s68, s68, 1
s_cmp_eq_u32 s68, 3
s_cselect_b32 s68, 0, s68
s_mul_i32 s69, s68, 3
s_add_u32 s69, s69, s67
s_lshl_b32 s43, s69, 7
s_add_u32 s43, s43, s63
s_lshl_b32 s6, s69, 13
s_add_u32 s6, s6, s70
s_add_u32 s67, s67, 1
s_cmp_eq_u32 s67, 3
s_cselect_b32 s67, 0, s67
s_mul_i32 s69, s68, 3
s_add_u32 s69, s69, s67
s_lshl_b32 s44, s69, 7
s_add_u32 s44, s44, s63
s_lshl_b32 s7, s69, 13
s_add_u32 s7, s7, s70
s_add_u32 s67, s67, 1
s_cmp_eq_u32 s67, 3
s_cselect_b32 s67, 0, s67
s_mul_i32 s69, s68, 3
s_add_u32 s69, s69, s67
s_lshl_b32 s45, s69, 7
s_add_u32 s45, s45, s63
s_lshl_b32 s8, s69, 13
s_add_u32 s8, s8, s70
s_add_u32 s67, s67, 1
s_cmp_eq_u32 s67, 3
s_cselect_b32 s67, 0, s67
s_add_u32 s68, s68, 1
s_cmp_eq_u32 s68, 3
s_cselect_b32 s68, 0, s68
s_mul_i32 s69, s68, 3
s_add_u32 s69, s69, s67
s_lshl_b32 s46, s69, 7
s_add_u32 s46, s46, s63
s_lshl_b32 s9, s69, 13
s_add_u32 s9, s9, s70
s_add_u32 s67, s67, 1
s_cmp_eq_u32 s67, 3
s_cselect_b32 s67, 0, s67
s_mul_i32 s69, s68, 3
s_add_u32 s69, s69, s67
s_lshl_b32 s47, s69, 7
s_add_u32 s47, s47, s63
s_lshl_b32 s10, s69, 13
s_add_u32 s10, s10, s70
s_add_u32 s67, s67, 1
s_cmp_eq_u32 s67, 3
s_cselect_b32 s67, 0, s67
s_mul_i32 s69, s68, 3
s_add_u32 s69, s69, s67
s_lshl_b32 s48, s69, 7
s_add_u32 s48, s48, s63
s_lshl_b32 s11, s69, 13
s_add_u32 s11, s11, s70
s_add_u32 s67, s67, 1
s_cmp_eq_u32 s67, 3
s_cselect_b32 s67, 0, s67
s_and_b32 s67, s33, 3
s_xor_b32 s96, s67, 0
s_mul_i32 s96, s96, 147456
s_add_u32 s96, s96, 0
s_xor_b32 s97, s67, 1
s_mul_i32 s97, s97, 147456
s_add_u32 s97, s97, 1024
s_xor_b32 s98, s67, 2
s_mul_i32 s98, s98, 147456
s_add_u32 s98, s98, 2048
s_xor_b32 s99, s67, 3
s_mul_i32 s99, s99, 147456
s_add_u32 s99, s99, 3072
s_and_b32 s68, s34, 2
s_lshl_b32 s68, s68, 1
s_add_u32 s50, s67, s68
s_mul_i32 s50, s50, 18
s_and_b32 s68, s34, 1
s_add_u32 s50, s50, s68
s_lshl_b32 s50, s50, 10
s_add_u32 s50, s50, 3097600
s_mul_i32 s101, s66, 589824
s_add_u32 s101, s101, 33733632
s_add_u32 s68, s66, 1
s_cmp_ge_u32 s68, 3
s_cselect_b32 s68, 0, s68
s_lshl_b32 s69, s68, 2
s_add_u32 s51, s69, s67
s_mul_i32 s100, s68, 589824
s_add_u32 s100, s100, 33733632
s_mul_i32 s49, s67, -147456
s_lshl_b32 s68, s66, 2
s_lshl_b32 s53, 15, s68
s_lshl_b32 s68, 1, s33
s_andn2_b32 s53, s53, s68
s_mov_b32 s52, 0xf000
v_and_b32 v2, 31, v0
v_lshlrev_b32 v2, 7, v2
v_add_u32_e64 v2, s54, v2
v_bfe_u32 v3, v0, 1, 3
v_lshrrev_b32 v4, 5, v0
v_lshlrev_b32 v4, 2, v4
v_xor_b32 v3, v3, v4
v_lshlrev_b32 v3, 4, v3
v_add_u32 v80, v2, v3
v_xor_b32 v81, 16, v80
v_xor_b32 v82, 32, v80
v_xor_b32 v83, 48, v80
v_add_u32 v84, 98304, v80
v_add_u32 v85, 98304, v81
v_add_u32 v86, 98304, v82
v_add_u32 v87, 98304, v83
v_and_b32 v2, 1, v0
v_lshlrev_b32 v2, 4, v2
v_mov_b32 v3, 0x3f80
v_lshlrev_b32_e64 v2, v2, v3
v_bfe_u32 v3, v0, 2, 1
v_lshlrev_b32 v3, 1, v3
v_lshrrev_b32 v4, 4, v0
v_cmp_eq_u32 vcc, v3, v4
s_nop 1
v_cndmask_b32_e64 v2, 0, v2, vcc
v_bfe_u32 v3, v0, 3, 1
v_lshlrev_b32_e64 v3, 1, v3
v_bfe_u32 v4, v0, 1, 1
v_add_u32 v3, v3, v4
v_cmp_eq_u32 vcc, 0, v3
s_nop 1
v_cndmask_b32 v40, 0, v2, vcc
v_cmp_eq_u32 vcc, 1, v3
s_nop 1
v_cndmask_b32 v41, 0, v2, vcc
v_cmp_eq_u32 vcc, 2, v3
s_nop 1
v_cndmask_b32 v42, 0, v2, vcc
v_cmp_eq_u32 vcc, 3, v3
s_nop 1
v_cndmask_b32 v43, 0, v2, vcc
v_mov_b32 v8, 0
v_mov_b32 v9, 0
v_mov_b32 v12, 0
v_mov_b32_e64 v13, 0
s_mov_b32 s57, 0x3f803f80
s_waitcnt lgkmcnt(0)
s_mul_i32 s0, s35, 221184
s_sub_u32 s1, 221184, s0
s_mov_b32 s74, 2359296
s_mov_b32 s75, 0x20000
s_add_u32 m0, s54, 49152
s_add_u32 s56, s55, 1152
buffer_load_dwordx4 v44, s[12:15], s55 offen lds
buffer_load_dwordx4 v45, s[12:15], s55 offen offset:1024 lds
s_add_u32 m0, m0, 2048
s_add_u32 s55, s55, 128
buffer_load_dwordx4 v44, s[12:15], s56 offen lds
buffer_load_dwordx4 v45, s[12:15], s56 offen offset:1024 lds
s_cmp_eq_u32 s55, 1152
s_cselect_b32 s55, 0, s55
s_waitcnt vmcnt(12)
ds_read_b128 v[112:115], v80 offset:0
ds_read_b128 v[116:119], v81 offset:0
ds_read_b128 v[120:123], v82 offset:0
ds_read_b128 v[124:127], v83 offset:0
s_add_u32 m0, s54, 53248
s_add_u32 s56, s55, 1152
buffer_load_dwordx4 v44, s[12:15], s55 offen lds
buffer_load_dwordx4 v45, s[12:15], s55 offen offset:1024 lds
s_add_u32 m0, m0, 2048
s_add_u32 s55, s55, 128
buffer_load_dwordx4 v44, s[12:15], s56 offen lds
buffer_load_dwordx4 v45, s[12:15], s56 offen offset:1024 lds
s_cmp_eq_u32 s55, 1152
s_cselect_b32 s55, 0, s55
s_waitcnt vmcnt(12)
ds_read_b128 v[128:131], v80 offset:4096
ds_read_b128 v[132:135], v81 offset:4096
ds_read_b128 v[136:139], v82 offset:4096
ds_read_b128 v[140:143], v83 offset:4096
s_waitcnt lgkmcnt(4)
v_dot2c_f32_bf16 v8, s57, v112
v_dot2c_f32_bf16 v12, v112, v112
v_dot2c_f32_bf16 v9, s57, v113
v_dot2c_f32_bf16 v13, v113, v113
v_dot2c_f32_bf16 v8, s57, v114
v_dot2c_f32_bf16 v12, v114, v114
s_add_u32 m0, s54, 57344
s_add_u32 s56, s55, 1152
buffer_load_dwordx4 v44, s[12:15], s55 offen lds
v_dot2c_f32_bf16 v9, s57, v115
v_dot2c_f32_bf16 v13, v115, v115
v_dot2c_f32_bf16 v8, s57, v116
v_dot2c_f32_bf16 v12, v116, v116
v_dot2c_f32_bf16 v9, s57, v117
v_dot2c_f32_bf16 v13, v117, v117
buffer_load_dwordx4 v45, s[12:15], s55 offen offset:1024 lds
v_dot2c_f32_bf16 v8, s57, v118
v_dot2c_f32_bf16 v12, v118, v118
v_dot2c_f32_bf16 v9, s57, v119
v_dot2c_f32_bf16 v13, v119, v119
v_dot2c_f32_bf16 v8, s57, v120
v_dot2c_f32_bf16 v12, v120, v120
s_add_u32 m0, m0, 2048
s_add_u32 s55, s55, 128
buffer_load_dwordx4 v44, s[12:15], s56 offen lds
v_dot2c_f32_bf16 v9, s57, v121
v_dot2c_f32_bf16 v13, v121, v121
v_dot2c_f32_bf16 v8, s57, v122
v_dot2c_f32_bf16 v12, v122, v122
v_dot2c_f32_bf16 v9, s57, v123
v_dot2c_f32_bf16 v13, v123, v123
buffer_load_dwordx4 v45, s[12:15], s56 offen offset:1024 lds
s_cmp_eq_u32 s55, 1152
s_cselect_b32 s55, 0, s55
v_dot2c_f32_bf16 v8, s57, v124
v_dot2c_f32_bf16 v12, v124, v124
v_dot2c_f32_bf16 v9, s57, v125
v_dot2c_f32_bf16 v13, v125, v125
v_dot2c_f32_bf16 v8, s57, v126
v_dot2c_f32_bf16 v12, v126, v126
v_dot2c_f32_bf16 v9, s57, v127
v_dot2c_f32_bf16 v13, v127, v127
s_waitcnt vmcnt(12)
ds_read_b128 v[144:147], v80 offset:8192
ds_read_b128 v[148:151], v81 offset:8192
ds_read_b128 v[152:155], v82 offset:8192
ds_read_b128 v[156:159], v83 offset:8192
s_waitcnt lgkmcnt(4)
v_dot2c_f32_bf16 v8, s57, v128
v_dot2c_f32_bf16 v12, v128, v128
v_dot2c_f32_bf16 v9, s57, v129
v_dot2c_f32_bf16 v13, v129, v129
v_dot2c_f32_bf16 v8, s57, v130
v_dot2c_f32_bf16 v12, v130, v130
s_add_u32 m0, s54, 98304
s_add_u32 s56, s55, 1152
buffer_load_dwordx4 v44, s[12:15], s55 offen lds
v_dot2c_f32_bf16 v9, s57, v131
v_dot2c_f32_bf16 v13, v131, v131
v_dot2c_f32_bf16 v8, s57, v132
v_dot2c_f32_bf16 v12, v132, v132
v_dot2c_f32_bf16 v9, s57, v133
v_dot2c_f32_bf16 v13, v133, v133
buffer_load_dwordx4 v45, s[12:15], s55 offen offset:1024 lds
v_dot2c_f32_bf16 v8, s57, v134
v_dot2c_f32_bf16 v12, v134, v134
v_dot2c_f32_bf16 v9, s57, v135
v_dot2c_f32_bf16 v13, v135, v135
v_dot2c_f32_bf16 v8, s57, v136
v_dot2c_f32_bf16 v12, v136, v136
s_add_u32 m0, m0, 2048
s_add_u32 s55, s55, 128
buffer_load_dwordx4 v44, s[12:15], s56 offen lds
v_dot2c_f32_bf16 v9, s57, v137
v_dot2c_f32_bf16 v13, v137, v137
v_dot2c_f32_bf16 v8, s57, v138
v_dot2c_f32_bf16 v12, v138, v138
v_dot2c_f32_bf16 v9, s57, v139
v_dot2c_f32_bf16 v13, v139, v139
buffer_load_dwordx4 v45, s[12:15], s56 offen offset:1024 lds
s_cmp_eq_u32 s55, 1152
s_cselect_b32 s55, 0, s55
v_dot2c_f32_bf16 v8, s57, v140
v_dot2c_f32_bf16 v12, v140, v140
v_dot2c_f32_bf16 v9, s57, v141
v_dot2c_f32_bf16 v13, v141, v141
v_dot2c_f32_bf16 v8, s57, v142
v_dot2c_f32_bf16 v12, v142, v142
v_dot2c_f32_bf16 v9, s57, v143
v_dot2c_f32_bf16 v13, v143, v143
s_waitcnt vmcnt(12)
ds_read_b128 v[160:163], v80 offset:49152
ds_read_b128 v[164:167], v81 offset:49152
ds_read_b128 v[168:171], v82 offset:49152
ds_read_b128 v[172:175], v83 offset:49152
s_waitcnt lgkmcnt(4)
s_barrier
v_dot2c_f32_bf16 v8, s57, v144
v_dot2c_f32_bf16 v12, v144, v144
v_dot2c_f32_bf16 v9, s57, v145
v_dot2c_f32_bf16 v13, v145, v145
v_dot2c_f32_bf16 v8, s57, v146
v_dot2c_f32_bf16 v12, v146, v146
s_add_u32 m0, s54, 102400
s_add_u32 s56, s55, 1152
buffer_load_dwordx4 v44, s[12:15], s55 offen lds
v_dot2c_f32_bf16 v9, s57, v147
v_dot2c_f32_bf16 v13, v147, v147
v_dot2c_f32_bf16 v8, s57, v148
v_dot2c_f32_bf16 v12, v148, v148
v_dot2c_f32_bf16 v9, s57, v149
v_dot2c_f32_bf16 v13, v149, v149
buffer_load_dwordx4 v45, s[12:15], s55 offen offset:1024 lds
v_dot2c_f32_bf16 v8, s57, v150
v_dot2c_f32_bf16 v12, v150, v150
v_dot2c_f32_bf16 v9, s57, v151
v_dot2c_f32_bf16 v13, v151, v151
v_dot2c_f32_bf16 v8, s57, v152
v_dot2c_f32_bf16 v12, v152, v152
s_add_u32 m0, m0, 2048
s_add_u32 s55, s55, 128
buffer_load_dwordx4 v44, s[12:15], s56 offen lds
v_dot2c_f32_bf16 v9, s57, v153
v_dot2c_f32_bf16 v13, v153, v153
v_dot2c_f32_bf16 v8, s57, v154
v_dot2c_f32_bf16 v12, v154, v154
v_dot2c_f32_bf16 v9, s57, v155
v_dot2c_f32_bf16 v13, v155, v155
buffer_load_dwordx4 v45, s[12:15], s56 offen offset:1024 lds
s_cmp_eq_u32 s55, 1152
s_cselect_b32 s55, 0, s55
v_dot2c_f32_bf16 v8, s57, v156
v_dot2c_f32_bf16 v12, v156, v156
v_dot2c_f32_bf16 v9, s57, v157
v_dot2c_f32_bf16 v13, v157, v157
v_dot2c_f32_bf16 v8, s57, v158
v_dot2c_f32_bf16 v12, v158, v158
v_dot2c_f32_bf16 v9, s57, v159
v_dot2c_f32_bf16 v13, v159, v159
s_waitcnt vmcnt(12)
ds_read_b128 v[176:179], v80 offset:53248
ds_read_b128 v[180:183], v81 offset:53248
ds_read_b128 v[184:187], v82 offset:53248
ds_read_b128 v[188:191], v83 offset:53248
s_waitcnt lgkmcnt(4)
v_dot2c_f32_bf16 v8, s57, v160
v_dot2c_f32_bf16 v12, v160, v160
v_dot2c_f32_bf16 v9, s57, v161
v_dot2c_f32_bf16 v13, v161, v161
v_dot2c_f32_bf16 v8, s57, v162
v_dot2c_f32_bf16 v12, v162, v162
s_add_u32 m0, s54, 106496
s_add_u32 s56, s55, 1152
buffer_load_dwordx4 v44, s[12:15], s55 offen lds
v_dot2c_f32_bf16 v9, s57, v163
v_dot2c_f32_bf16 v13, v163, v163
v_dot2c_f32_bf16 v8, s57, v164
v_dot2c_f32_bf16 v12, v164, v164
v_dot2c_f32_bf16 v9, s57, v165
v_dot2c_f32_bf16 v13, v165, v165
buffer_load_dwordx4 v45, s[12:15], s55 offen offset:1024 lds
v_dot2c_f32_bf16 v8, s57, v166
v_dot2c_f32_bf16 v12, v166, v166
v_dot2c_f32_bf16 v9, s57, v167
v_dot2c_f32_bf16 v13, v167, v167
v_dot2c_f32_bf16 v8, s57, v168
v_dot2c_f32_bf16 v12, v168, v168
s_add_u32 m0, m0, 2048
s_add_u32 s55, s55, 128
buffer_load_dwordx4 v44, s[12:15], s56 offen lds
v_dot2c_f32_bf16 v9, s57, v169
v_dot2c_f32_bf16 v13, v169, v169
v_dot2c_f32_bf16 v8, s57, v170
v_dot2c_f32_bf16 v12, v170, v170
v_dot2c_f32_bf16 v9, s57, v171
v_dot2c_f32_bf16 v13, v171, v171
buffer_load_dwordx4 v45, s[12:15], s56 offen offset:1024 lds
s_cmp_eq_u32 s55, 1152
s_cselect_b32 s55, 0, s55
v_dot2c_f32_bf16 v8, s57, v172
v_dot2c_f32_bf16 v12, v172, v172
v_dot2c_f32_bf16 v9, s57, v173
v_dot2c_f32_bf16 v13, v173, v173
v_dot2c_f32_bf16 v8, s57, v174
v_dot2c_f32_bf16 v12, v174, v174
v_dot2c_f32_bf16 v9, s57, v175
v_dot2c_f32_bf16 v13, v175, v175
s_waitcnt vmcnt(12)
ds_read_b128 v[192:195], v80 offset:57344
ds_read_b128 v[196:199], v81 offset:57344
ds_read_b128 v[200:203], v82 offset:57344
ds_read_b128 v[204:207], v83 offset:57344
s_waitcnt lgkmcnt(4)
v_dot2c_f32_bf16 v8, s57, v176
v_dot2c_f32_bf16 v12, v176, v176
v_dot2c_f32_bf16 v9, s57, v177
v_dot2c_f32_bf16 v13, v177, v177
v_dot2c_f32_bf16 v8, s57, v178
v_dot2c_f32_bf16 v12, v178, v178
s_add_u32 m0, s64, 0
s_add_u32 s65, s60, 0
buffer_load_dwordx4 v28, s[16:19], s65 offen offset:0 lds
v_dot2c_f32_bf16 v9, s57, v179
v_dot2c_f32_bf16 v13, v179, v179
v_dot2c_f32_bf16 v8, s57, v180
v_dot2c_f32_bf16 v12, v180, v180
v_dot2c_f32_bf16 v9, s57, v181
v_dot2c_f32_bf16 v13, v181, v181
buffer_load_dwordx4 v29, s[16:19], s65 offen offset:1024 lds
v_dot2c_f32_bf16 v8, s57, v182
v_dot2c_f32_bf16 v12, v182, v182
v_dot2c_f32_bf16 v9, s57, v183
v_dot2c_f32_bf16 v13, v183, v183
v_dot2c_f32_bf16 v8, s57, v184
v_dot2c_f32_bf16 v12, v184, v184
buffer_load_dwordx4 v30, s[16:19], s65 offen offset:2048 lds
v_dot2c_f32_bf16 v9, s57, v185
v_dot2c_f32_bf16 v13, v185, v185
v_dot2c_f32_bf16 v8, s57, v186
v_dot2c_f32_bf16 v12, v186, v186
v_dot2c_f32_bf16 v9, s57, v187
v_dot2c_f32_bf16 v13, v187, v187
buffer_load_dwordx4 v31, s[16:19], s65 offen offset:3072 lds
v_dot2c_f32_bf16 v8, s57, v188
v_dot2c_f32_bf16 v12, v188, v188
v_dot2c_f32_bf16 v9, s57, v189
v_dot2c_f32_bf16 v13, v189, v189
v_dot2c_f32_bf16 v8, s57, v190
v_dot2c_f32_bf16 v12, v190, v190
v_dot2c_f32_bf16 v9, s57, v191
v_dot2c_f32_bf16 v13, v191, v191
s_waitcnt vmcnt(12)
ds_read_b128 v[208:211], v84 offset:0
ds_read_b128 v[212:215], v85 offset:0
ds_read_b128 v[216:219], v86 offset:0
ds_read_b128 v[220:223], v87 offset:0
s_waitcnt lgkmcnt(4)
s_barrier
v_dot2c_f32_bf16 v8, s57, v192
v_dot2c_f32_bf16 v12, v192, v192
v_dot2c_f32_bf16 v9, s57, v193
v_dot2c_f32_bf16 v13, v193, v193
v_dot2c_f32_bf16 v8, s57, v194
v_dot2c_f32_bf16 v12, v194, v194
v_dot2c_f32_bf16 v9, s57, v195
v_dot2c_f32_bf16 v13, v195, v195
v_dot2c_f32_bf16 v8, s57, v196
v_dot2c_f32_bf16 v12, v196, v196
s_add_u32 m0, s64, 4096
s_add_u32 s65, s65, 294912
buffer_load_dwordx4 v28, s[16:19], s65 offen offset:0 lds
v_dot2c_f32_bf16 v9, s57, v197
v_dot2c_f32_bf16 v13, v197, v197
v_dot2c_f32_bf16 v8, s57, v198
v_dot2c_f32_bf16 v12, v198, v198
v_dot2c_f32_bf16 v9, s57, v199
v_dot2c_f32_bf16 v13, v199, v199
v_dot2c_f32_bf16 v8, s57, v200
v_dot2c_f32_bf16 v12, v200, v200
v_dot2c_f32_bf16 v9, s57, v201
v_dot2c_f32_bf16 v13, v201, v201
buffer_load_dwordx4 v29, s[16:19], s65 offen offset:1024 lds
v_dot2c_f32_bf16 v8, s57, v202
v_dot2c_f32_bf16 v12, v202, v202
v_dot2c_f32_bf16 v9, s57, v203
v_dot2c_f32_bf16 v13, v203, v203
v_dot2c_f32_bf16 v8, s57, v204
v_dot2c_f32_bf16 v12, v204, v204
v_dot2c_f32_bf16 v9, s57, v205
v_dot2c_f32_bf16 v13, v205, v205
v_dot2c_f32_bf16 v8, s57, v206
v_dot2c_f32_bf16 v12, v206, v206
v_dot2c_f32_bf16 v9, s57, v207
v_dot2c_f32_bf16 v13, v207, v207
s_waitcnt vmcnt(10)
ds_read_b128 v[224:227], v84 offset:4096
ds_read_b128 v[228:231], v85 offset:4096
ds_read_b128 v[232:235], v86 offset:4096
ds_read_b128 v[236:239], v87 offset:4096
s_waitcnt lgkmcnt(4)
v_dot2c_f32_bf16 v8, s57, v208
v_dot2c_f32_bf16 v12, v208, v208
v_dot2c_f32_bf16 v9, s57, v209
v_dot2c_f32_bf16 v13, v209, v209
v_dot2c_f32_bf16 v8, s57, v210
v_dot2c_f32_bf16 v12, v210, v210
s_add_u32 m0, s64, 24576
s_add_u32 s65, s61, 0
buffer_load_dwordx4 v28, s[16:19], s65 offen offset:0 lds
v_dot2c_f32_bf16 v9, s57, v211
v_dot2c_f32_bf16 v13, v211, v211
v_dot2c_f32_bf16 v8, s57, v212
v_dot2c_f32_bf16 v12, v212, v212
v_dot2c_f32_bf16 v9, s57, v213
v_dot2c_f32_bf16 v13, v213, v213
buffer_load_dwordx4 v29, s[16:19], s65 offen offset:1024 lds
v_dot2c_f32_bf16 v8, s57, v214
v_dot2c_f32_bf16 v12, v214, v214
v_dot2c_f32_bf16 v9, s57, v215
v_dot2c_f32_bf16 v13, v215, v215
v_dot2c_f32_bf16 v8, s57, v216
v_dot2c_f32_bf16 v12, v216, v216
buffer_load_dwordx4 v30, s[16:19], s65 offen offset:2048 lds
v_dot2c_f32_bf16 v9, s57, v217
v_dot2c_f32_bf16 v13, v217, v217
v_dot2c_f32_bf16 v8, s57, v218
v_dot2c_f32_bf16 v12, v218, v218
v_dot2c_f32_bf16 v9, s57, v219
v_dot2c_f32_bf16 v13, v219, v219
buffer_load_dwordx4 v31, s[16:19], s65 offen offset:3072 lds
v_dot2c_f32_bf16 v8, s57, v220
v_dot2c_f32_bf16 v12, v220, v220
v_dot2c_f32_bf16 v9, s57, v221
v_dot2c_f32_bf16 v13, v221, v221
v_dot2c_f32_bf16 v8, s57, v222
v_dot2c_f32_bf16 v12, v222, v222
v_dot2c_f32_bf16 v9, s57, v223
v_dot2c_f32_bf16 v13, v223, v223
s_waitcnt vmcnt(10)
ds_read_b128 v[240:243], v84 offset:8192
ds_read_b128 v[244:247], v85 offset:8192
ds_read_b128 v[248:251], v86 offset:8192
ds_read_b128 v[252:255], v87 offset:8192
s_waitcnt lgkmcnt(4)
v_dot2c_f32_bf16 v8, s57, v224
v_dot2c_f32_bf16 v12, v224, v224
v_dot2c_f32_bf16 v9, s57, v225
v_dot2c_f32_bf16 v13, v225, v225
v_dot2c_f32_bf16 v8, s57, v226
v_dot2c_f32_bf16 v12, v226, v226
v_dot2c_f32_bf16 v9, s57, v227
v_dot2c_f32_bf16 v13, v227, v227
v_dot2c_f32_bf16 v8, s57, v228
v_dot2c_f32_bf16 v12, v228, v228
s_add_u32 m0, s64, 28672
s_add_u32 s65, s65, 294912
buffer_load_dwordx4 v28, s[16:19], s65 offen offset:0 lds
v_dot2c_f32_bf16 v9, s57, v229
v_dot2c_f32_bf16 v13, v229, v229
v_dot2c_f32_bf16 v8, s57, v230
v_dot2c_f32_bf16 v12, v230, v230
v_dot2c_f32_bf16 v9, s57, v231
v_dot2c_f32_bf16 v13, v231, v231
v_dot2c_f32_bf16 v8, s57, v232
v_dot2c_f32_bf16 v12, v232, v232
v_dot2c_f32_bf16 v9, s57, v233
v_dot2c_f32_bf16 v13, v233, v233
buffer_load_dwordx4 v29, s[16:19], s65 offen offset:1024 lds
v_dot2c_f32_bf16 v8, s57, v234
v_dot2c_f32_bf16 v12, v234, v234
v_dot2c_f32_bf16 v9, s57, v235
v_dot2c_f32_bf16 v13, v235, v235
v_dot2c_f32_bf16 v8, s57, v236
v_dot2c_f32_bf16 v12, v236, v236
v_dot2c_f32_bf16 v9, s57, v237
v_dot2c_f32_bf16 v13, v237, v237
v_dot2c_f32_bf16 v8, s57, v238
v_dot2c_f32_bf16 v12, v238, v238
v_dot2c_f32_bf16 v9, s57, v239
v_dot2c_f32_bf16 v13, v239, v239
s_waitcnt lgkmcnt(0)
v_dot2c_f32_bf16 v8, s57, v240
v_dot2c_f32_bf16 v12, v240, v240
v_dot2c_f32_bf16 v9, s57, v241
v_dot2c_f32_bf16 v13, v241, v241
v_dot2c_f32_bf16 v8, s57, v242
v_dot2c_f32_bf16 v12, v242, v242
v_dot2c_f32_bf16 v9, s57, v243
v_dot2c_f32_bf16 v13, v243, v243
v_dot2c_f32_bf16 v8, s57, v244
v_dot2c_f32_bf16 v12, v244, v244
buffer_store_dword v14, v39, s[24:27], 0 offen sc1
v_dot2c_f32_bf16 v9, s57, v245
v_dot2c_f32_bf16 v13, v245, v245
v_dot2c_f32_bf16 v8, s57, v246
v_dot2c_f32_bf16 v12, v246, v246
v_dot2c_f32_bf16 v9, s57, v247
v_dot2c_f32_bf16 v13, v247, v247
v_dot2c_f32_bf16 v8, s57, v248
v_dot2c_f32_bf16 v12, v248, v248
v_dot2c_f32_bf16 v9, s57, v249
v_dot2c_f32_bf16 v13, v249, v249
buffer_store_dword v14, v39, s[24:27], s37 offen sc1
v_dot2c_f32_bf16 v8, s57, v250
v_dot2c_f32_bf16 v12, v250, v250
v_dot2c_f32_bf16 v9, s57, v251
v_dot2c_f32_bf16 v13, v251, v251
v_dot2c_f32_bf16 v8, s57, v252
v_dot2c_f32_bf16 v12, v252, v252
v_dot2c_f32_bf16 v9, s57, v253
v_dot2c_f32_bf16 v13, v253, v253
v_dot2c_f32_bf16 v8, s57, v254
v_dot2c_f32_bf16 v12, v254, v254
v_dot2c_f32_bf16 v9, s57, v255
v_dot2c_f32_bf16 v13, v255, v255
s_nop 1
v_add_f32 v8, v8, v9
v_add_f32 v12, v12, v13
v_mov_b32 v9, v8
v_mov_b32 v13, v12
s_nop 0
v_permlane32_swap_b32 v8, v9
v_permlane32_swap_b32 v12, v13
v_add_f32 v8, v8, v9
v_add_f32 v12, v12, v13
v_mfma_f32_32x32x16_bf16 v[80:95], v[40:43], v[112:115], 0
v_mfma_f32_32x32x16_bf16 v[96:111], v[40:43], v[116:119], 0
v_mul_f32 v8, 0x3ae38e39, v8
v_mul_f32 v12, 0x3ae38e39, v12
v_fma_f32 v12, -v8, v8, v12
v_max_f32_e64 v12, 0, v12
v_cvt_pk_bf16_f32 v4, v8, v8
v_and_b32 v4, 0xffff0000, v4
v_xor_b32 v4, 0x80000000, v4
v_cvt_pk_bf16_f32 v12, v12, v12
v_and_b32 v12, 0xffff0000, v12
v_add_f32 v12, 0x3727c5ac, v12
v_cvt_pk_bf16_f32 v12, v12, v12
v_and_b32 v12, 0xffff0000, v12
v_sqrt_f32 v12, v12
s_nop 0
v_cvt_pk_bf16_f32 v12, v12, v12
v_and_b32 v12, 0xffff0000, v12
v_rcp_f32 v2, v12
s_nop 0
v_mul_f32 v2, 0x3fb8aa3b, v2
v_mul_f32_e64 v3, v4, v2
s_waitcnt vmcnt(8)
s_barrier
ds_read_b64_tr_b16 a[192:193], v16 offset:0
ds_read_b64_tr_b16 a[194:195], v16 offset:512
ds_read_b64_tr_b16 a[196:197], v19 offset:0
ds_read_b64_tr_b16 a[198:199], v19 offset:512
ds_read_b64_tr_b16 a[200:201], v16 offset:1024
ds_read_b64_tr_b16 a[202:203], v16 offset:1536
ds_read_b64_tr_b16 a[204:205], v19 offset:1024
ds_read_b64_tr_b16 a[206:207], v19 offset:1536
ds_read_b64_tr_b16 a[208:209], v16 offset:2048
ds_read_b64_tr_b16 a[210:211], v16 offset:2560
ds_read_b64_tr_b16 a[212:213], v19 offset:2048
ds_read_b64_tr_b16 a[214:215], v19 offset:2560
ds_read_b64_tr_b16 a[216:217], v16 offset:3072
ds_read_b64_tr_b16 a[218:219], v16 offset:3584
v_fma_f32 v80, v80, v2, v3
v_fma_f32 v81, v81, v2, v3
v_fma_f32 v82, v82, v2, v3
v_fma_f32 v83, v83, v2, v3
v_fma_f32 v84, v84, v2, v3
v_fma_f32 v85, v85, v2, v3
v_fma_f32 v86, v86, v2, v3
v_fma_f32 v87, v87, v2, v3
v_cvt_pk_bf16_f32 v112, v80, v81
v_cvt_pk_bf16_f32 v113, v82, v83
v_cvt_pk_bf16_f32 v114, v84, v85
v_cvt_pk_bf16_f32 v115, v86, v87
s_waitcnt lgkmcnt(6)
v_mfma_f32_32x32x16_bf16 v[80:95], v[40:43], v[120:123], 0
s_add_u32 m0, s64, 49152
s_add_u32 s65, s62, 0
v_fma_f32 v96, v96, v2, v3
v_fma_f32 v97, v97, v2, v3
v_fma_f32 v98, v98, v2, v3
v_fma_f32 v99, v99, v2, v3
v_mfma_f32_32x32x16_bf16 v[48:63], a[192:195], v[112:115], 0
ds_read_b64_tr_b16 a[220:221], v19 offset:3072
ds_read_b64_tr_b16 a[222:223], v19 offset:3584
buffer_load_dwordx4 v28, s[16:19], s65 offen offset:0 lds
v_fma_f32 v100, v100, v2, v3
v_fma_f32 v101, v101, v2, v3
v_fma_f32 v102, v102, v2, v3
v_mfma_f32_32x32x16_bf16 v[64:79], a[196:199], v[112:115], 0
ds_read_b64_tr_b16 a[224:225], v16 offset:8192
ds_read_b64_tr_b16 a[226:227], v16 offset:8704
v_fma_f32 v103, v103, v2, v3
v_cvt_pk_bf16_f32 v116, v96, v97
v_cvt_pk_bf16_f32 v117, v98, v99
v_cvt_pk_bf16_f32 v118, v100, v101
v_cvt_pk_bf16_f32 v119, v102, v103
v_mfma_f32_32x32x16_bf16 v[96:111], v[40:43], v[124:127], 0
buffer_load_dwordx4 v29, s[16:19], s65 offen offset:1024 lds
v_fma_f32 v80, v80, v2, v3
v_fma_f32 v81, v81, v2, v3
v_fma_f32 v82, v82, v2, v3
v_fma_f32 v83, v83, v2, v3
v_fma_f32 v84, v84, v2, v3
v_mfma_f32_32x32x16_bf16 v[48:63], a[200:203], v[116:119], v[48:63]
ds_read_b64_tr_b16 a[228:229], v19 offset:8192
ds_read_b64_tr_b16 a[230:231], v19 offset:8704
buffer_load_dwordx4 v30, s[16:19], s65 offen offset:2048 lds
v_fma_f32 v85, v85, v2, v3
v_fma_f32 v86, v86, v2, v3
v_fma_f32 v87, v87, v2, v3
v_mfma_f32_32x32x16_bf16 v[64:79], a[204:207], v[116:119], v[64:79]
ds_read_b64_tr_b16 a[232:233], v16 offset:9216
ds_read_b64_tr_b16 a[234:235], v16 offset:9728
v_cvt_pk_bf16_f32 v120, v80, v81
v_cvt_pk_bf16_f32 v121, v82, v83
v_cvt_pk_bf16_f32 v122, v84, v85
v_cvt_pk_bf16_f32 v123, v86, v87
s_waitcnt lgkmcnt(6)
v_mfma_f32_32x32x16_bf16 v[80:95], v[40:43], v[128:131], 0
buffer_load_dwordx4 v31, s[16:19], s65 offen offset:3072 lds
v_fma_f32 v96, v96, v2, v3
v_fma_f32 v97, v97, v2, v3
v_fma_f32 v98, v98, v2, v3
v_fma_f32 v99, v99, v2, v3
v_mfma_f32_32x32x16_bf16 v[48:63], a[208:211], v[120:123], v[48:63]
ds_read_b64_tr_b16 a[236:237], v19 offset:9216
ds_read_b64_tr_b16 a[238:239], v19 offset:9728
v_fma_f32 v100, v100, v2, v3
v_fma_f32 v101, v101, v2, v3
v_fma_f32 v102, v102, v2, v3
v_fma_f32 v103, v103, v2, v3
v_cvt_pk_bf16_f32 v124, v96, v97
v_mfma_f32_32x32x16_bf16 v[64:79], a[212:215], v[120:123], v[64:79]
ds_read_b64_tr_b16 a[240:241], v16 offset:10240
ds_read_b64_tr_b16 a[242:243], v16 offset:10752
s_add_u32 m0, s64, 53248
s_add_u32 s65, s65, 294912
v_cvt_pk_bf16_f32 v125, v98, v99
v_cvt_pk_bf16_f32 v126, v100, v101
v_cvt_pk_bf16_f32 v127, v102, v103
v_mfma_f32_32x32x16_bf16 v[96:111], v[40:43], v[132:135], 0
buffer_load_dwordx4 v28, s[16:19], s65 offen offset:0 lds
v_fma_f32 v80, v80, v2, v3
v_fma_f32 v81, v81, v2, v3
v_fma_f32 v82, v82, v2, v3
v_fma_f32 v83, v83, v2, v3
v_fma_f32 v84, v84, v2, v3
v_mfma_f32_32x32x16_bf16 v[48:63], a[216:219], v[124:127], v[48:63]
ds_read_b64_tr_b16 a[244:245], v19 offset:10240
ds_read_b64_tr_b16 a[246:247], v19 offset:10752
v_fma_f32 v85, v85, v2, v3
v_fma_f32 v86, v86, v2, v3
v_fma_f32 v87, v87, v2, v3
v_cvt_pk_bf16_f32 v128, v80, v81
v_cvt_pk_bf16_f32 v129, v82, v83
v_mfma_f32_32x32x16_bf16 v[64:79], a[220:223], v[124:127], v[64:79]
ds_read_b64_tr_b16 a[248:249], v16 offset:11264
ds_read_b64_tr_b16 a[250:251], v16 offset:11776
buffer_load_dwordx4 v29, s[16:19], s65 offen offset:1024 lds
v_cvt_pk_bf16_f32 v130, v84, v85
v_cvt_pk_bf16_f32 v131, v86, v87
s_waitcnt lgkmcnt(6)
v_mfma_f32_32x32x16_bf16 v[80:95], v[40:43], v[136:139], 0
v_fma_f32 v96, v96, v2, v3
v_fma_f32 v97, v97, v2, v3
v_fma_f32 v98, v98, v2, v3
v_fma_f32 v99, v99, v2, v3
v_fma_f32 v100, v100, v2, v3
v_fma_f32 v101, v101, v2, v3
v_mfma_f32_32x32x16_bf16 v[48:63], a[224:227], v[128:131], v[48:63]
ds_read_b64_tr_b16 a[252:253], v19 offset:11264
ds_read_b64_tr_b16 a[254:255], v19 offset:11776
s_add_u32 m0, s64, 73728
s_add_u32 s65, s60, 128
v_fma_f32 v102, v102, v2, v3
v_fma_f32 v103, v103, v2, v3
v_cvt_pk_bf16_f32 v132, v96, v97
v_mfma_f32_32x32x16_bf16 v[64:79], a[228:231], v[128:131], v[64:79]
ds_read_b64_tr_b16 a[192:193], v16 offset:16384
ds_read_b64_tr_b16 a[194:195], v16 offset:16896
buffer_load_dwordx4 v28, s[16:19], s65 offen offset:0 lds
v_cvt_pk_bf16_f32 v133, v98, v99
v_cvt_pk_bf16_f32 v134, v100, v101
v_cvt_pk_bf16_f32 v135, v102, v103
v_mfma_f32_32x32x16_bf16 v[96:111], v[40:43], v[140:143], 0
v_fma_f32 v80, v80, v2, v3
v_fma_f32 v81, v81, v2, v3
v_fma_f32 v82, v82, v2, v3
v_fma_f32 v83, v83, v2, v3
v_fma_f32 v84, v84, v2, v3
v_fma_f32 v85, v85, v2, v3
v_fma_f32 v86, v86, v2, v3
v_mfma_f32_32x32x16_bf16 v[48:63], a[232:235], v[132:135], v[48:63]
ds_read_b64_tr_b16 a[196:197], v19 offset:16384
ds_read_b64_tr_b16 a[198:199], v19 offset:16896
buffer_load_dwordx4 v29, s[16:19], s65 offen offset:1024 lds
v_fma_f32 v87, v87, v2, v3
v_cvt_pk_bf16_f32 v136, v80, v81
v_cvt_pk_bf16_f32 v137, v82, v83
v_mfma_f32_32x32x16_bf16 v[64:79], a[236:239], v[132:135], v[64:79]
ds_read_b64_tr_b16 a[200:201], v16 offset:17408
ds_read_b64_tr_b16 a[202:203], v16 offset:17920
buffer_load_dwordx4 v30, s[16:19], s65 offen offset:2048 lds
v_cvt_pk_bf16_f32 v138, v84, v85
v_cvt_pk_bf16_f32 v139, v86, v87
s_waitcnt lgkmcnt(6)
v_mfma_f32_32x32x16_bf16 v[80:95], v[40:43], v[144:147], 0
v_fma_f32 v96, v96, v2, v3
v_fma_f32 v97, v97, v2, v3
v_fma_f32 v98, v98, v2, v3
v_fma_f32 v99, v99, v2, v3
v_fma_f32 v100, v100, v2, v3
v_fma_f32 v101, v101, v2, v3
v_mfma_f32_32x32x16_bf16 v[48:63], a[240:243], v[136:139], v[48:63]
ds_read_b64_tr_b16 a[204:205], v19 offset:17408
ds_read_b64_tr_b16 a[206:207], v19 offset:17920
buffer_load_dwordx4 v31, s[16:19], s65 offen offset:3072 lds
v_fma_f32 v102, v102, v2, v3
v_fma_f32 v103, v103, v2, v3
v_mfma_f32_32x32x16_bf16 v[64:79], a[244:247], v[136:139], v[64:79]
ds_read_b64_tr_b16 a[208:209], v16 offset:18432
ds_read_b64_tr_b16 a[210:211], v16 offset:18944
v_cvt_pk_bf16_f32 v140, v96, v97
v_cvt_pk_bf16_f32 v141, v98, v99
v_cvt_pk_bf16_f32 v142, v100, v101
v_cvt_pk_bf16_f32 v143, v102, v103
v_mfma_f32_32x32x16_bf16 v[96:111], v[40:43], v[148:151], 0
s_add_u32 m0, s64, 77824
s_add_u32 s65, s65, 294912
v_fma_f32 v80, v80, v2, v3
v_fma_f32 v81, v81, v2, v3
v_fma_f32 v82, v82, v2, v3
v_fma_f32 v83, v83, v2, v3
v_fma_f32 v84, v84, v2, v3
v_mfma_f32_32x32x16_bf16 v[48:63], a[248:251], v[140:143], v[48:63]
ds_read_b64_tr_b16 a[212:213], v19 offset:18432
ds_read_b64_tr_b16 a[214:215], v19 offset:18944
buffer_load_dwordx4 v28, s[16:19], s65 offen offset:0 lds
v_fma_f32 v85, v85, v2, v3
v_fma_f32 v86, v86, v2, v3
v_fma_f32 v87, v87, v2, v3
v_mfma_f32_32x32x16_bf16 v[64:79], a[252:255], v[140:143], v[64:79]
ds_read_b64_tr_b16 a[216:217], v16 offset:19456
ds_read_b64_tr_b16 a[218:219], v16 offset:19968
v_cvt_pk_bf16_f32 v144, v80, v81
v_cvt_pk_bf16_f32 v145, v82, v83
v_cvt_pk_bf16_f32 v146, v84, v85
v_cvt_pk_bf16_f32 v147, v86, v87
s_waitcnt lgkmcnt(6)
v_mfma_f32_32x32x16_bf16 v[80:95], v[40:43], v[152:155], 0
buffer_load_dwordx4 v29, s[16:19], s65 offen offset:1024 lds
v_fma_f32 v96, v96, v2, v3
v_fma_f32 v97, v97, v2, v3
v_fma_f32 v98, v98, v2, v3
v_fma_f32 v99, v99, v2, v3
v_mfma_f32_32x32x16_bf16 v[48:63], a[192:195], v[144:147], v[48:63]
ds_read_b64_tr_b16 a[220:221], v19 offset:19456
ds_read_b64_tr_b16 a[222:223], v19 offset:19968
v_fma_f32 v100, v100, v2, v3
v_fma_f32 v101, v101, v2, v3
v_fma_f32 v102, v102, v2, v3
v_fma_f32 v103, v103, v2, v3
v_cvt_pk_bf16_f32 v148, v96, v97
v_mfma_f32_32x32x16_bf16 v[64:79], a[196:199], v[144:147], v[64:79]
s_waitcnt vmcnt(14)
s_barrier
ds_read_b64_tr_b16 a[224:225], v16 offset:24576
ds_read_b64_tr_b16 a[226:227], v16 offset:25088
v_cvt_pk_bf16_f32 v149, v98, v99
v_cvt_pk_bf16_f32 v150, v100, v101
v_cvt_pk_bf16_f32 v151, v102, v103
v_mfma_f32_32x32x16_bf16 v[96:111], v[40:43], v[156:159], 0
s_add_u32 m0, s64, 98304
v_fma_f32 v80, v80, v2, v3
v_fma_f32 v81, v81, v2, v3
v_fma_f32 v82, v82, v2, v3
v_fma_f32 v83, v83, v2, v3
v_fma_f32 v84, v84, v2, v3
v_mfma_f32_32x32x16_bf16 v[48:63], a[200:203], v[148:151], v[48:63]
ds_read_b64_tr_b16 a[228:229], v19 offset:24576
ds_read_b64_tr_b16 a[230:231], v19 offset:25088
v_fma_f32 v85, v85, v2, v3
v_fma_f32 v86, v86, v2, v3
v_fma_f32 v87, v87, v2, v3
v_cvt_pk_bf16_f32 v152, v80, v81
v_mfma_f32_32x32x16_bf16 v[64:79], a[204:207], v[148:151], v[64:79]
ds_read_b64_tr_b16 a[232:233], v16 offset:25600
ds_read_b64_tr_b16 a[234:235], v16 offset:26112
s_add_u32 s65, s61, 128
v_cvt_pk_bf16_f32 v153, v82, v83
v_cvt_pk_bf16_f32 v154, v84, v85
v_cvt_pk_bf16_f32 v155, v86, v87
s_waitcnt lgkmcnt(6)
v_mfma_f32_32x32x16_bf16 v[80:95], v[40:43], v[160:163], 0
v_fma_f32 v96, v96, v2, v3
v_fma_f32 v97, v97, v2, v3
v_fma_f32 v98, v98, v2, v3
v_fma_f32 v99, v99, v2, v3
v_fma_f32 v100, v100, v2, v3
v_fma_f32 v101, v101, v2, v3
v_mfma_f32_32x32x16_bf16 v[48:63], a[208:211], v[152:155], v[48:63]
ds_read_b64_tr_b16 a[236:237], v19 offset:25600
ds_read_b64_tr_b16 a[238:239], v19 offset:26112
buffer_load_dwordx4 v28, s[16:19], s65 offen offset:0 lds
v_fma_f32 v102, v102, v2, v3
v_fma_f32 v103, v103, v2, v3
v_mfma_f32_32x32x16_bf16 v[64:79], a[212:215], v[152:155], v[64:79]
ds_read_b64_tr_b16 a[240:241], v16 offset:26624
ds_read_b64_tr_b16 a[242:243], v16 offset:27136
v_cvt_pk_bf16_f32 v156, v96, v97
v_cvt_pk_bf16_f32 v157, v98, v99
v_cvt_pk_bf16_f32 v158, v100, v101
v_cvt_pk_bf16_f32 v159, v102, v103
v_mfma_f32_32x32x16_bf16 v[96:111], v[40:43], v[164:167], 0
v_fma_f32 v80, v80, v2, v3
v_fma_f32 v81, v81, v2, v3
v_fma_f32 v82, v82, v2, v3
v_fma_f32 v83, v83, v2, v3
v_fma_f32 v84, v84, v2, v3
v_fma_f32 v85, v85, v2, v3
v_mfma_f32_32x32x16_bf16 v[48:63], a[216:219], v[156:159], v[48:63]
ds_read_b64_tr_b16 a[244:245], v19 offset:26624
ds_read_b64_tr_b16 a[246:247], v19 offset:27136
v_fma_f32 v86, v86, v2, v3
v_fma_f32 v87, v87, v2, v3
v_cvt_pk_bf16_f32 v160, v80, v81
v_cvt_pk_bf16_f32 v161, v82, v83
v_mfma_f32_32x32x16_bf16 v[64:79], a[220:223], v[156:159], v[64:79]
ds_read_b64_tr_b16 a[248:249], v16 offset:27648
ds_read_b64_tr_b16 a[250:251], v16 offset:28160
buffer_load_dwordx4 v29, s[16:19], s65 offen offset:1024 lds
v_cvt_pk_bf16_f32 v162, v84, v85
v_cvt_pk_bf16_f32 v163, v86, v87
s_waitcnt lgkmcnt(6)
v_mfma_f32_32x32x16_bf16 v[80:95], v[40:43], v[168:171], 0
v_fma_f32 v96, v96, v2, v3
v_fma_f32 v97, v97, v2, v3
v_fma_f32 v98, v98, v2, v3
v_fma_f32 v99, v99, v2, v3
v_fma_f32 v100, v100, v2, v3
v_fma_f32 v101, v101, v2, v3
v_mfma_f32_32x32x16_bf16 v[48:63], a[224:227], v[160:163], v[48:63]
ds_read_b64_tr_b16 a[252:253], v19 offset:27648
ds_read_b64_tr_b16 a[254:255], v19 offset:28160
v_fma_f32 v102, v102, v2, v3
v_fma_f32 v103, v103, v2, v3
v_cvt_pk_bf16_f32 v164, v96, v97
v_cvt_pk_bf16_f32 v165, v98, v99
v_mfma_f32_32x32x16_bf16 v[64:79], a[228:231], v[160:163], v[64:79]
ds_read_b64_tr_b16 a[192:193], v16 offset:32768
ds_read_b64_tr_b16 a[194:195], v16 offset:33280
v_cvt_pk_bf16_f32 v166, v100, v101
v_cvt_pk_bf16_f32 v167, v102, v103
v_mfma_f32_32x32x16_bf16 v[96:111], v[40:43], v[172:175], 0
v_fma_f32 v80, v80, v2, v3
v_fma_f32 v81, v81, v2, v3
v_fma_f32 v82, v82, v2, v3
v_fma_f32 v83, v83, v2, v3
v_fma_f32 v84, v84, v2, v3
v_fma_f32 v85, v85, v2, v3
v_mfma_f32_32x32x16_bf16 v[48:63], a[232:235], v[164:167], v[48:63]
ds_read_b64_tr_b16 a[196:197], v19 offset:32768
ds_read_b64_tr_b16 a[198:199], v19 offset:33280
buffer_load_dwordx4 v30, s[16:19], s65 offen offset:2048 lds
v_fma_f32 v86, v86, v2, v3
v_fma_f32 v87, v87, v2, v3
v_mfma_f32_32x32x16_bf16 v[64:79], a[236:239], v[164:167], v[64:79]
ds_read_b64_tr_b16 a[200:201], v16 offset:33792
ds_read_b64_tr_b16 a[202:203], v16 offset:34304
v_cvt_pk_bf16_f32 v168, v80, v81
v_cvt_pk_bf16_f32 v169, v82, v83
v_cvt_pk_bf16_f32 v170, v84, v85
v_cvt_pk_bf16_f32 v171, v86, v87
s_waitcnt lgkmcnt(6)
v_mfma_f32_32x32x16_bf16 v[80:95], v[40:43], v[176:179], 0
v_fma_f32 v96, v96, v2, v3
v_fma_f32 v97, v97, v2, v3
v_fma_f32 v98, v98, v2, v3
v_fma_f32 v99, v99, v2, v3
v_fma_f32 v100, v100, v2, v3
v_fma_f32 v101, v101, v2, v3
v_mfma_f32_32x32x16_bf16 v[48:63], a[240:243], v[168:171], v[48:63]
ds_read_b64_tr_b16 a[204:205], v19 offset:33792
ds_read_b64_tr_b16 a[206:207], v19 offset:34304
v_fma_f32 v102, v102, v2, v3
v_fma_f32 v103, v103, v2, v3
v_cvt_pk_bf16_f32 v172, v96, v97
v_cvt_pk_bf16_f32 v173, v98, v99
v_mfma_f32_32x32x16_bf16 v[64:79], a[244:247], v[168:171], v[64:79]
ds_read_b64_tr_b16 a[208:209], v16 offset:34816
ds_read_b64_tr_b16 a[210:211], v16 offset:35328
buffer_load_dwordx4 v31, s[16:19], s65 offen offset:3072 lds
v_cvt_pk_bf16_f32 v174, v100, v101
v_cvt_pk_bf16_f32 v175, v102, v103
v_mfma_f32_32x32x16_bf16 v[96:111], v[40:43], v[180:183], 0
v_fma_f32 v80, v80, v2, v3
v_fma_f32 v81, v81, v2, v3
v_fma_f32 v82, v82, v2, v3
v_fma_f32 v83, v83, v2, v3
v_fma_f32 v84, v84, v2, v3
v_fma_f32 v85, v85, v2, v3
v_mfma_f32_32x32x16_bf16 v[48:63], a[248:251], v[172:175], v[48:63]
ds_read_b64_tr_b16 a[212:213], v19 offset:34816
ds_read_b64_tr_b16 a[214:215], v19 offset:35328
v_fma_f32 v86, v86, v2, v3
v_fma_f32 v87, v87, v2, v3
v_cvt_pk_bf16_f32 v176, v80, v81
v_cvt_pk_bf16_f32 v177, v82, v83
v_mfma_f32_32x32x16_bf16 v[64:79], a[252:255], v[172:175], v[64:79]
ds_read_b64_tr_b16 a[216:217], v16 offset:35840
ds_read_b64_tr_b16 a[218:219], v16 offset:36352
v_cvt_pk_bf16_f32 v178, v84, v85
v_cvt_pk_bf16_f32 v179, v86, v87
s_waitcnt lgkmcnt(6)
v_mfma_f32_32x32x16_bf16 v[80:95], v[40:43], v[184:187], 0
s_add_u32 m0, s64, 102400
v_fma_f32 v96, v96, v2, v3
v_fma_f32 v97, v97, v2, v3
v_fma_f32 v98, v98, v2, v3
v_fma_f32 v99, v99, v2, v3
v_fma_f32 v100, v100, v2, v3
v_mfma_f32_32x32x16_bf16 v[48:63], a[192:195], v[176:179], v[48:63]
ds_read_b64_tr_b16 a[220:221], v19 offset:35840
ds_read_b64_tr_b16 a[222:223], v19 offset:36352
v_fma_f32 v101, v101, v2, v3
v_fma_f32 v102, v102, v2, v3
v_fma_f32 v103, v103, v2, v3
v_cvt_pk_bf16_f32 v180, v96, v97
v_mfma_f32_32x32x16_bf16 v[64:79], a[196:199], v[176:179], v[64:79]
ds_read_b64_tr_b16 a[224:225], v16 offset:40960
ds_read_b64_tr_b16 a[226:227], v16 offset:41472
v_cvt_pk_bf16_f32 v181, v98, v99
v_cvt_pk_bf16_f32 v182, v100, v101
v_cvt_pk_bf16_f32 v183, v102, v103
v_mfma_f32_32x32x16_bf16 v[96:111], v[40:43], v[188:191], 0
s_add_u32 s65, s65, 294912
v_fma_f32 v80, v80, v2, v3
v_fma_f32 v81, v81, v2, v3
v_fma_f32 v82, v82, v2, v3
v_fma_f32 v83, v83, v2, v3
v_fma_f32 v84, v84, v2, v3
v_mfma_f32_32x32x16_bf16 v[48:63], a[200:203], v[180:183], v[48:63]
ds_read_b64_tr_b16 a[228:229], v19 offset:40960
ds_read_b64_tr_b16 a[230:231], v19 offset:41472
v_fma_f32 v85, v85, v2, v3
v_fma_f32 v86, v86, v2, v3
v_fma_f32 v87, v87, v2, v3
v_cvt_pk_bf16_f32 v184, v80, v81
v_cvt_pk_bf16_f32 v185, v82, v83
v_mfma_f32_32x32x16_bf16 v[64:79], a[204:207], v[180:183], v[64:79]
ds_read_b64_tr_b16 a[232:233], v16 offset:41984
ds_read_b64_tr_b16 a[234:235], v16 offset:42496
buffer_load_dwordx4 v28, s[16:19], s65 offen offset:0 lds
v_cvt_pk_bf16_f32 v186, v84, v85
v_cvt_pk_bf16_f32 v187, v86, v87
s_waitcnt lgkmcnt(6)
v_mfma_f32_32x32x16_bf16 v[80:95], v[40:43], v[192:195], 0
v_fma_f32 v96, v96, v2, v3
v_fma_f32 v97, v97, v2, v3
v_fma_f32 v98, v98, v2, v3
v_fma_f32 v99, v99, v2, v3
v_fma_f32 v100, v100, v2, v3
v_fma_f32 v101, v101, v2, v3
v_mfma_f32_32x32x16_bf16 v[48:63], a[208:211], v[184:187], v[48:63]
ds_read_b64_tr_b16 a[236:237], v19 offset:41984
ds_read_b64_tr_b16 a[238:239], v19 offset:42496
v_fma_f32 v102, v102, v2, v3
v_fma_f32 v103, v103, v2, v3
v_cvt_pk_bf16_f32 v188, v96, v97
v_cvt_pk_bf16_f32 v189, v98, v99
v_mfma_f32_32x32x16_bf16 v[64:79], a[212:215], v[184:187], v[64:79]
ds_read_b64_tr_b16 a[240:241], v16 offset:43008
ds_read_b64_tr_b16 a[242:243], v16 offset:43520
v_cvt_pk_bf16_f32 v190, v100, v101
v_cvt_pk_bf16_f32 v191, v102, v103
v_mfma_f32_32x32x16_bf16 v[96:111], v[40:43], v[196:199], 0
buffer_load_dwordx4 v29, s[16:19], s65 offen offset:1024 lds
v_fma_f32 v80, v80, v2, v3
v_fma_f32 v81, v81, v2, v3
v_fma_f32 v82, v82, v2, v3
v_fma_f32 v83, v83, v2, v3
v_mfma_f32_32x32x16_bf16 v[48:63], a[216:219], v[188:191], v[48:63]
ds_read_b64_tr_b16 a[244:245], v19 offset:43008
ds_read_b64_tr_b16 a[246:247], v19 offset:43520
v_fma_f32 v84, v84, v2, v3
v_fma_f32 v85, v85, v2, v3
v_fma_f32 v86, v86, v2, v3
v_fma_f32 v87, v87, v2, v3
v_mfma_f32_32x32x16_bf16 v[64:79], a[220:223], v[188:191], v[64:79]
ds_read_b64_tr_b16 a[248:249], v16 offset:44032
ds_read_b64_tr_b16 a[250:251], v16 offset:44544
v_cvt_pk_bf16_f32 v192, v80, v81
v_cvt_pk_bf16_f32 v193, v82, v83
v_cvt_pk_bf16_f32 v194, v84, v85
v_cvt_pk_bf16_f32 v195, v86, v87
s_waitcnt lgkmcnt(6)
v_mfma_f32_32x32x16_bf16 v[80:95], v[40:43], v[200:203], 0
v_fma_f32 v96, v96, v2, v3
v_fma_f32 v97, v97, v2, v3
v_fma_f32 v98, v98, v2, v3
v_fma_f32 v99, v99, v2, v3
v_fma_f32 v100, v100, v2, v3
v_fma_f32 v101, v101, v2, v3
v_mfma_f32_32x32x16_bf16 v[48:63], a[224:227], v[192:195], v[48:63]
ds_read_b64_tr_b16 a[252:253], v19 offset:44032
ds_read_b64_tr_b16 a[254:255], v19 offset:44544
v_fma_f32 v102, v102, v2, v3
v_fma_f32 v103, v103, v2, v3
v_cvt_pk_bf16_f32 v196, v96, v97
v_cvt_pk_bf16_f32 v197, v98, v99
v_mfma_f32_32x32x16_bf16 v[64:79], a[228:231], v[192:195], v[64:79]
s_waitcnt vmcnt(12)
s_barrier
ds_read_b64_tr_b16 a[192:193], v17 offset:0
ds_read_b64_tr_b16 a[194:195], v17 offset:512
v_cvt_pk_bf16_f32 v198, v100, v101
v_cvt_pk_bf16_f32 v199, v102, v103
v_mfma_f32_32x32x16_bf16 v[96:111], v[40:43], v[204:207], 0
s_add_u32 m0, s64, 0
v_fma_f32 v80, v80, v2, v3
v_fma_f32 v81, v81, v2, v3
v_fma_f32 v82, v82, v2, v3
v_fma_f32 v83, v83, v2, v3
v_fma_f32 v84, v84, v2, v3
v_mfma_f32_32x32x16_bf16 v[48:63], a[232:235], v[196:199], v[48:63]
ds_read_b64_tr_b16 a[196:197], v20 offset:0
ds_read_b64_tr_b16 a[198:199], v20 offset:512
v_fma_f32 v85, v85, v2, v3
v_fma_f32 v86, v86, v2, v3
v_fma_f32 v87, v87, v2, v3
v_cvt_pk_bf16_f32 v200, v80, v81
v_mfma_f32_32x32x16_bf16 v[64:79], a[236:239], v[196:199], v[64:79]
ds_read_b64_tr_b16 a[200:201], v17 offset:1024
ds_read_b64_tr_b16 a[202:203], v17 offset:1536
s_add_u32 s65, s62, 128
v_cvt_pk_bf16_f32 v201, v82, v83
v_cvt_pk_bf16_f32 v202, v84, v85
v_cvt_pk_bf16_f32 v203, v86, v87
s_waitcnt lgkmcnt(6)
v_mfma_f32_32x32x16_bf16 v[80:95], v[40:43], v[208:211], 0
v_fma_f32 v96, v96, v2, v3
v_fma_f32 v97, v97, v2, v3
v_fma_f32 v98, v98, v2, v3
v_fma_f32 v99, v99, v2, v3
v_fma_f32 v100, v100, v2, v3
v_fma_f32 v101, v101, v2, v3
v_mfma_f32_32x32x16_bf16 v[48:63], a[240:243], v[200:203], v[48:63]
ds_read_b64_tr_b16 a[204:205], v20 offset:1024
ds_read_b64_tr_b16 a[206:207], v20 offset:1536
buffer_load_dwordx4 v28, s[16:19], s65 offen offset:0 lds
v_fma_f32 v102, v102, v2, v3
v_fma_f32 v103, v103, v2, v3
v_mfma_f32_32x32x16_bf16 v[64:79], a[244:247], v[200:203], v[64:79]
ds_read_b64_tr_b16 a[208:209], v17 offset:2048
ds_read_b64_tr_b16 a[210:211], v17 offset:2560
v_cvt_pk_bf16_f32 v204, v96, v97
v_cvt_pk_bf16_f32 v205, v98, v99
v_cvt_pk_bf16_f32 v206, v100, v101
v_cvt_pk_bf16_f32 v207, v102, v103
v_mfma_f32_32x32x16_bf16 v[96:111], v[40:43], v[212:215], 0
v_fma_f32 v80, v80, v2, v3
v_fma_f32 v81, v81, v2, v3
v_fma_f32 v82, v82, v2, v3
v_fma_f32 v83, v83, v2, v3
v_fma_f32 v84, v84, v2, v3
v_fma_f32 v85, v85, v2, v3
v_mfma_f32_32x32x16_bf16 v[48:63], a[248:251], v[204:207], v[48:63]
ds_read_b64_tr_b16 a[212:213], v20 offset:2048
ds_read_b64_tr_b16 a[214:215], v20 offset:2560
v_fma_f32 v86, v86, v2, v3
v_fma_f32 v87, v87, v2, v3
v_cvt_pk_bf16_f32 v208, v80, v81
v_cvt_pk_bf16_f32 v209, v82, v83
v_mfma_f32_32x32x16_bf16 v[64:79], a[252:255], v[204:207], v[64:79]
ds_read_b64_tr_b16 a[216:217], v17 offset:3072
ds_read_b64_tr_b16 a[218:219], v17 offset:3584
buffer_load_dwordx4 v29, s[16:19], s65 offen offset:1024 lds
v_cvt_pk_bf16_f32 v210, v84, v85
v_cvt_pk_bf16_f32 v211, v86, v87
s_waitcnt lgkmcnt(6)
v_mfma_f32_32x32x16_bf16 v[80:95], v[40:43], v[216:219], 0
v_fma_f32 v96, v96, v2, v3
v_fma_f32 v97, v97, v2, v3
v_fma_f32 v98, v98, v2, v3
v_fma_f32 v99, v99, v2, v3
v_fma_f32 v100, v100, v2, v3
v_fma_f32 v101, v101, v2, v3
v_mfma_f32_32x32x16_bf16 v[48:63], a[192:195], v[208:211], v[48:63]
ds_read_b64_tr_b16 a[220:221], v20 offset:3072
ds_read_b64_tr_b16 a[222:223], v20 offset:3584
v_fma_f32 v102, v102, v2, v3
v_fma_f32 v103, v103, v2, v3
v_cvt_pk_bf16_f32 v212, v96, v97
v_cvt_pk_bf16_f32 v213, v98, v99
v_mfma_f32_32x32x16_bf16 v[64:79], a[196:199], v[208:211], v[64:79]
ds_read_b64_tr_b16 a[224:225], v17 offset:8192
ds_read_b64_tr_b16 a[226:227], v17 offset:8704
v_cvt_pk_bf16_f32 v214, v100, v101
v_cvt_pk_bf16_f32 v215, v102, v103
v_mfma_f32_32x32x16_bf16 v[96:111], v[40:43], v[220:223], 0
v_fma_f32 v80, v80, v2, v3
v_fma_f32 v81, v81, v2, v3
v_fma_f32 v82, v82, v2, v3
v_fma_f32 v83, v83, v2, v3
v_fma_f32 v84, v84, v2, v3
v_fma_f32 v85, v85, v2, v3
v_mfma_f32_32x32x16_bf16 v[48:63], a[200:203], v[212:215], v[48:63]
ds_read_b64_tr_b16 a[228:229], v20 offset:8192
ds_read_b64_tr_b16 a[230:231], v20 offset:8704
buffer_load_dwordx4 v30, s[16:19], s65 offen offset:2048 lds
v_fma_f32 v86, v86, v2, v3
v_fma_f32 v87, v87, v2, v3
v_mfma_f32_32x32x16_bf16 v[64:79], a[204:207], v[212:215], v[64:79]
ds_read_b64_tr_b16 a[232:233], v17 offset:9216
ds_read_b64_tr_b16 a[234:235], v17 offset:9728
v_cvt_pk_bf16_f32 v216, v80, v81
v_cvt_pk_bf16_f32 v217, v82, v83
v_cvt_pk_bf16_f32 v218, v84, v85
v_cvt_pk_bf16_f32 v219, v86, v87
s_waitcnt lgkmcnt(6)
v_mfma_f32_32x32x16_bf16 v[80:95], v[40:43], v[224:227], 0
v_fma_f32 v96, v96, v2, v3
v_fma_f32 v97, v97, v2, v3
v_fma_f32 v98, v98, v2, v3
v_fma_f32 v99, v99, v2, v3
v_fma_f32 v100, v100, v2, v3
v_fma_f32 v101, v101, v2, v3
v_mfma_f32_32x32x16_bf16 v[48:63], a[208:211], v[216:219], v[48:63]
ds_read_b64_tr_b16 a[236:237], v20 offset:9216
ds_read_b64_tr_b16 a[238:239], v20 offset:9728
v_fma_f32 v102, v102, v2, v3
v_fma_f32 v103, v103, v2, v3
v_cvt_pk_bf16_f32 v220, v96, v97
v_cvt_pk_bf16_f32 v221, v98, v99
v_mfma_f32_32x32x16_bf16 v[64:79], a[212:215], v[216:219], v[64:79]
ds_read_b64_tr_b16 a[240:241], v17 offset:10240
ds_read_b64_tr_b16 a[242:243], v17 offset:10752
buffer_load_dwordx4 v31, s[16:19], s65 offen offset:3072 lds
v_cvt_pk_bf16_f32 v222, v100, v101
v_cvt_pk_bf16_f32 v223, v102, v103
v_mfma_f32_32x32x16_bf16 v[96:111], v[40:43], v[228:231], 0
v_fma_f32 v80, v80, v2, v3
v_fma_f32 v81, v81, v2, v3
v_fma_f32 v82, v82, v2, v3
v_fma_f32 v83, v83, v2, v3
v_fma_f32 v84, v84, v2, v3
v_fma_f32 v85, v85, v2, v3
v_mfma_f32_32x32x16_bf16 v[48:63], a[216:219], v[220:223], v[48:63]
ds_read_b64_tr_b16 a[244:245], v20 offset:10240
ds_read_b64_tr_b16 a[246:247], v20 offset:10752
v_fma_f32 v86, v86, v2, v3
v_fma_f32 v87, v87, v2, v3
v_cvt_pk_bf16_f32 v224, v80, v81
v_cvt_pk_bf16_f32 v225, v82, v83
v_mfma_f32_32x32x16_bf16 v[64:79], a[220:223], v[220:223], v[64:79]
ds_read_b64_tr_b16 a[248:249], v17 offset:11264
ds_read_b64_tr_b16 a[250:251], v17 offset:11776
v_cvt_pk_bf16_f32 v226, v84, v85
v_cvt_pk_bf16_f32 v227, v86, v87
s_waitcnt lgkmcnt(6)
v_mfma_f32_32x32x16_bf16 v[80:95], v[40:43], v[232:235], 0
s_add_u32 m0, s64, 4096
v_fma_f32 v96, v96, v2, v3
v_fma_f32 v97, v97, v2, v3
v_fma_f32 v98, v98, v2, v3
v_fma_f32 v99, v99, v2, v3
v_fma_f32 v100, v100, v2, v3
v_mfma_f32_32x32x16_bf16 v[48:63], a[224:227], v[224:227], v[48:63]
ds_read_b64_tr_b16 a[252:253], v20 offset:11264
ds_read_b64_tr_b16 a[254:255], v20 offset:11776
v_fma_f32 v101, v101, v2, v3
v_fma_f32 v102, v102, v2, v3
v_fma_f32 v103, v103, v2, v3
v_cvt_pk_bf16_f32 v228, v96, v97
v_mfma_f32_32x32x16_bf16 v[64:79], a[228:231], v[224:227], v[64:79]
ds_read_b64_tr_b16 a[192:193], v17 offset:16384
ds_read_b64_tr_b16 a[194:195], v17 offset:16896
v_cvt_pk_bf16_f32 v229, v98, v99
v_cvt_pk_bf16_f32 v230, v100, v101
v_cvt_pk_bf16_f32 v231, v102, v103
v_mfma_f32_32x32x16_bf16 v[96:111], v[40:43], v[236:239], 0
s_add_u32 s65, s65, 294912
v_fma_f32 v80, v80, v2, v3
v_fma_f32 v81, v81, v2, v3
v_fma_f32 v82, v82, v2, v3
v_fma_f32 v83, v83, v2, v3
v_fma_f32 v84, v84, v2, v3
v_mfma_f32_32x32x16_bf16 v[48:63], a[232:235], v[228:231], v[48:63]
ds_read_b64_tr_b16 a[196:197], v20 offset:16384
ds_read_b64_tr_b16 a[198:199], v20 offset:16896
v_fma_f32 v85, v85, v2, v3
v_fma_f32 v86, v86, v2, v3
v_fma_f32 v87, v87, v2, v3
v_cvt_pk_bf16_f32 v232, v80, v81
v_cvt_pk_bf16_f32 v233, v82, v83
v_mfma_f32_32x32x16_bf16 v[64:79], a[236:239], v[228:231], v[64:79]
ds_read_b64_tr_b16 a[200:201], v17 offset:17408
ds_read_b64_tr_b16 a[202:203], v17 offset:17920
buffer_load_dwordx4 v28, s[16:19], s65 offen offset:0 lds
v_cvt_pk_bf16_f32 v234, v84, v85
v_cvt_pk_bf16_f32 v235, v86, v87
s_waitcnt lgkmcnt(6)
v_mfma_f32_32x32x16_bf16 v[80:95], v[40:43], v[240:243], 0
v_fma_f32 v96, v96, v2, v3
v_fma_f32 v97, v97, v2, v3
v_fma_f32 v98, v98, v2, v3
v_fma_f32 v99, v99, v2, v3
v_fma_f32 v100, v100, v2, v3
v_fma_f32 v101, v101, v2, v3
v_mfma_f32_32x32x16_bf16 v[48:63], a[240:243], v[232:235], v[48:63]
ds_read_b64_tr_b16 a[204:205], v20 offset:17408
ds_read_b64_tr_b16 a[206:207], v20 offset:17920
v_fma_f32 v102, v102, v2, v3
v_fma_f32 v103, v103, v2, v3
v_cvt_pk_bf16_f32 v236, v96, v97
v_cvt_pk_bf16_f32 v237, v98, v99
v_mfma_f32_32x32x16_bf16 v[64:79], a[244:247], v[232:235], v[64:79]
ds_read_b64_tr_b16 a[208:209], v17 offset:18432
ds_read_b64_tr_b16 a[210:211], v17 offset:18944
v_cvt_pk_bf16_f32 v238, v100, v101
v_cvt_pk_bf16_f32 v239, v102, v103
v_mfma_f32_32x32x16_bf16 v[96:111], v[40:43], v[244:247], 0
buffer_load_dwordx4 v29, s[16:19], s65 offen offset:1024 lds
v_fma_f32 v80, v80, v2, v3
v_fma_f32 v81, v81, v2, v3
v_fma_f32 v82, v82, v2, v3
v_fma_f32 v83, v83, v2, v3
v_mfma_f32_32x32x16_bf16 v[48:63], a[248:251], v[236:239], v[48:63]
ds_read_b64_tr_b16 a[212:213], v20 offset:18432
ds_read_b64_tr_b16 a[214:215], v20 offset:18944
v_fma_f32 v84, v84, v2, v3
v_fma_f32 v85, v85, v2, v3
v_fma_f32 v86, v86, v2, v3
v_fma_f32 v87, v87, v2, v3
v_mfma_f32_32x32x16_bf16 v[64:79], a[252:255], v[236:239], v[64:79]
ds_read_b64_tr_b16 a[216:217], v17 offset:19456
ds_read_b64_tr_b16 a[218:219], v17 offset:19968
v_cvt_pk_bf16_f32 v240, v80, v81
v_cvt_pk_bf16_f32 v241, v82, v83
v_cvt_pk_bf16_f32 v242, v84, v85
v_cvt_pk_bf16_f32 v243, v86, v87
s_waitcnt lgkmcnt(6)
v_mfma_f32_32x32x16_bf16 v[80:95], v[40:43], v[248:251], 0
v_fma_f32 v96, v96, v2, v3
v_fma_f32 v97, v97, v2, v3
v_fma_f32 v98, v98, v2, v3
v_fma_f32 v99, v99, v2, v3
v_fma_f32 v100, v100, v2, v3
v_fma_f32 v101, v101, v2, v3
v_mfma_f32_32x32x16_bf16 v[48:63], a[192:195], v[240:243], v[48:63]
ds_read_b64_tr_b16 a[220:221], v20 offset:19456
ds_read_b64_tr_b16 a[222:223], v20 offset:19968
v_fma_f32 v102, v102, v2, v3
v_fma_f32 v103, v103, v2, v3
v_cvt_pk_bf16_f32 v244, v96, v97
v_cvt_pk_bf16_f32 v245, v98, v99
v_mfma_f32_32x32x16_bf16 v[64:79], a[196:199], v[240:243], v[64:79]
s_waitcnt vmcnt(12)
s_barrier
ds_read_b64_tr_b16 a[224:225], v17 offset:24576
ds_read_b64_tr_b16 a[226:227], v17 offset:25088
v_cvt_pk_bf16_f32 v246, v100, v101
v_cvt_pk_bf16_f32 v247, v102, v103
v_mfma_f32_32x32x16_bf16 v[96:111], v[40:43], v[252:255], 0
s_add_u32 m0, s64, 24576
v_fma_f32 v80, v80, v2, v3
v_fma_f32 v81, v81, v2, v3
v_fma_f32 v82, v82, v2, v3
v_fma_f32 v83, v83, v2, v3
v_fma_f32 v84, v84, v2, v3
v_mfma_f32_32x32x16_bf16 v[48:63], a[200:203], v[244:247], v[48:63]
ds_read_b64_tr_b16 a[228:229], v20 offset:24576
ds_read_b64_tr_b16 a[230:231], v20 offset:25088
s_add_u32 s65, s60, 256
v_fma_f32 v85, v85, v2, v3
v_fma_f32 v86, v86, v2, v3
v_fma_f32 v87, v87, v2, v3
v_mfma_f32_32x32x16_bf16 v[64:79], a[204:207], v[244:247], v[64:79]
ds_read_b64_tr_b16 a[232:233], v17 offset:25600
ds_read_b64_tr_b16 a[234:235], v17 offset:26112
v_cvt_pk_bf16_f32 v248, v80, v81
v_cvt_pk_bf16_f32 v249, v82, v83
v_cvt_pk_bf16_f32 v250, v84, v85
v_cvt_pk_bf16_f32 v251, v86, v87
s_waitcnt lgkmcnt(6)
s_nop 0
v_mfma_f32_32x32x16_bf16 v[48:63], a[208:211], v[248:251], v[48:63]
ds_read_b64_tr_b16 a[236:237], v20 offset:25600
ds_read_b64_tr_b16 a[238:239], v20 offset:26112
buffer_load_dwordx4 v28, s[16:19], s65 offen offset:0 lds
v_fma_f32 v96, v96, v2, v3
v_fma_f32 v97, v97, v2, v3
v_fma_f32 v98, v98, v2, v3
v_fma_f32 v99, v99, v2, v3
v_fma_f32 v100, v100, v2, v3
v_fma_f32 v101, v101, v2, v3
v_fma_f32 v102, v102, v2, v3
v_mfma_f32_32x32x16_bf16 v[64:79], a[212:215], v[248:251], v[64:79]
ds_read_b64_tr_b16 a[240:241], v17 offset:26624
ds_read_b64_tr_b16 a[242:243], v17 offset:27136
buffer_atomic_add v11, v10, s[28:31], 0 offen sc1
v_add_u32 v42, 294912, v28
v_add_u32 v43, 294912, v29
v_fma_f32 v103, v103, v2, v3
v_cvt_pk_bf16_f32 v252, v96, v97
v_cvt_pk_bf16_f32 v253, v98, v99
v_cvt_pk_bf16_f32 v254, v100, v101
v_cvt_pk_bf16_f32 v255, v102, v103
s_nop 1
v_mfma_f32_32x32x16_bf16 v[48:63], a[216:219], v[252:255], v[48:63]
ds_read_b64_tr_b16 a[244:245], v20 offset:26624
ds_read_b64_tr_b16 a[246:247], v20 offset:27136
v_mfma_f32_32x32x16_bf16 v[64:79], a[220:223], v[252:255], v[64:79]
ds_read_b64_tr_b16 a[248:249], v17 offset:27648
ds_read_b64_tr_b16 a[250:251], v17 offset:28160
buffer_load_dwordx4 v29, s[16:19], s65 offen offset:1024 lds
s_waitcnt lgkmcnt(6)
v_mfma_f32_32x32x16_bf16 v[80:95], a[224:227], v[112:115], 0
ds_read_b64_tr_b16 a[252:253], v20 offset:27648
ds_read_b64_tr_b16 a[254:255], v20 offset:28160
v_mfma_f32_32x32x16_bf16 v[96:111], a[228:231], v[112:115], 0
ds_read_b64_tr_b16 a[192:193], v17 offset:32768
ds_read_b64_tr_b16 a[194:195], v17 offset:33280
v_mfma_f32_32x32x16_bf16 v[80:95], a[232:235], v[116:119], v[80:95]
ds_read_b64_tr_b16 a[196:197], v20 offset:32768
ds_read_b64_tr_b16 a[198:199], v20 offset:33280
buffer_load_dwordx4 v30, s[16:19], s65 offen offset:2048 lds
v_exp_f32_e64 v1, -v48
v_mfma_f32_32x32x16_bf16 v[96:111], a[236:239], v[116:119], v[96:111]
ds_read_b64_tr_b16 a[200:201], v17 offset:33792
ds_read_b64_tr_b16 a[202:203], v17 offset:34304
v_exp_f32_e64 v2, -v49
v_exp_f32_e64 v3, -v50
s_waitcnt lgkmcnt(6)
v_mfma_f32_32x32x16_bf16 v[80:95], a[240:243], v[120:123], v[80:95]
ds_read_b64_tr_b16 a[204:205], v20 offset:33792
ds_read_b64_tr_b16 a[206:207], v20 offset:34304
v_add_f32 v1, 1.0, v1
v_add_f32 v2, 1.0, v2
v_exp_f32_e64 v4, -v51
v_mfma_f32_32x32x16_bf16 v[96:111], a[244:247], v[120:123], v[96:111]
ds_read_b64_tr_b16 a[208:209], v17 offset:34816
ds_read_b64_tr_b16 a[210:211], v17 offset:35328
buffer_load_dwordx4 v31, s[16:19], s65 offen offset:3072 lds
v_add_f32 v3, 1.0, v3
v_rcp_f32 v1, v1
v_mfma_f32_32x32x16_bf16 v[80:95], a[248:251], v[124:127], v[80:95]
ds_read_b64_tr_b16 a[212:213], v20 offset:34816
ds_read_b64_tr_b16 a[214:215], v20 offset:35328
v_add_f32 v4, 1.0, v4
v_rcp_f32 v2, v2
v_mul_f32_e64 v1, v48, v1
v_mfma_f32_32x32x16_bf16 v[96:111], a[252:255], v[124:127], v[96:111]
ds_read_b64_tr_b16 a[216:217], v17 offset:35840
ds_read_b64_tr_b16 a[218:219], v17 offset:36352
v_rcp_f32 v3, v3
v_mul_f32_e64 v2, v49, v2
s_waitcnt lgkmcnt(6)
v_mfma_f32_32x32x16_bf16 v[80:95], a[192:195], v[128:131], v[80:95]
ds_read_b64_tr_b16 a[220:221], v20 offset:35840
ds_read_b64_tr_b16 a[222:223], v20 offset:36352
v_rcp_f32 v4, v4
v_mul_f32 v3, v50, v3
v_cvt_pk_bf16_f32 v8, v1, v2
v_mfma_f32_32x32x16_bf16 v[96:111], a[196:199], v[128:131], v[96:111]
ds_read_b64_tr_b16 a[224:225], v17 offset:40960
ds_read_b64_tr_b16 a[226:227], v17 offset:41472
s_add_u32 m0, s64, 28672
v_mul_f32_e64 v4, v51, v4
v_cvt_pk_bf16_f32 v9, v3, v4
v_exp_f32_e64 v5, -v52
v_mfma_f32_32x32x16_bf16 v[80:95], a[200:203], v[132:135], v[80:95]
ds_read_b64_tr_b16 a[228:229], v20 offset:40960
ds_read_b64_tr_b16 a[230:231], v20 offset:41472
buffer_load_dwordx4 v42, s[16:19], s65 offen offset:0 lds
v_exp_f32_e64 v6, -v53
v_mfma_f32_32x32x16_bf16 v[96:111], a[204:207], v[132:135], v[96:111]
ds_read_b64_tr_b16 a[232:233], v17 offset:41984
ds_read_b64_tr_b16 a[234:235], v17 offset:42496
v_exp_f32_e64 v7, -v54
v_add_f32 v5, 1.0, v5
v_add_f32_e64 v6, 1.0, v6
s_waitcnt lgkmcnt(6)
v_mfma_f32_32x32x16_bf16 v[80:95], a[208:211], v[136:139], v[80:95]
ds_read_b64_tr_b16 a[236:237], v20 offset:41984
ds_read_b64_tr_b16 a[238:239], v20 offset:42496
v_exp_f32_e64 v46, -v55
v_add_f32_e64 v7, 1.0, v7
v_mfma_f32_32x32x16_bf16 v[96:111], a[212:215], v[136:139], v[96:111]
ds_read_b64_tr_b16 a[240:241], v17 offset:43008
ds_read_b64_tr_b16 a[242:243], v17 offset:43520
buffer_load_dwordx4 v43, s[16:19], s65 offen offset:1024 lds
v_rcp_f32 v5, v5
v_add_f32 v46, 1.0, v46
v_mfma_f32_32x32x16_bf16 v[80:95], a[216:219], v[140:143], v[80:95]
ds_read_b64_tr_b16 a[244:245], v20 offset:43008
ds_read_b64_tr_b16 a[246:247], v20 offset:43520
v_rcp_f32 v6, v6
v_mul_f32 v5, v52, v5
v_rcp_f32_e64 v7, v7
v_mfma_f32_32x32x16_bf16 v[96:111], a[220:223], v[140:143], v[96:111]
ds_read_b64_tr_b16 a[248:249], v17 offset:44032
ds_read_b64_tr_b16 a[250:251], v17 offset:44544
v_mul_f32 v6, v53, v6
v_rcp_f32_e64 v46, v46
s_waitcnt lgkmcnt(6)
v_mfma_f32_32x32x16_bf16 v[80:95], a[224:227], v[144:147], v[80:95]
ds_read_b64_tr_b16 a[252:253], v20 offset:44032
ds_read_b64_tr_b16 a[254:255], v20 offset:44544
v_mul_f32_e64 v7, v54, v7
v_cvt_pk_bf16_f32 v12, v5, v6
v_mul_f32_e64 v46, v55, v46
v_cvt_pk_bf16_f32 v13, v7, v46
v_mfma_f32_32x32x16_bf16 v[96:111], a[228:231], v[144:147], v[96:111]
s_waitcnt vmcnt(13)
s_barrier
ds_read_b64_tr_b16 a[192:193], v18 offset:0
ds_read_b64_tr_b16 a[194:195], v18 offset:512
v_exp_f32_e64 v1, -v56
v_mfma_f32_32x32x16_bf16 v[80:95], a[232:235], v[148:151], v[80:95]
ds_read_b64_tr_b16 a[196:197], v21 offset:0
ds_read_b64_tr_b16 a[198:199], v21 offset:512
s_add_u32 m0, s64, 49152
v_exp_f32_e64 v2, -v57
v_exp_f32_e64 v3, -v58
v_mfma_f32_32x32x16_bf16 v[96:111], a[236:239], v[148:151], v[96:111]
ds_read_b64_tr_b16 a[200:201], v18 offset:1024
ds_read_b64_tr_b16 a[202:203], v18 offset:1536
s_add_u32 s65, s61, 256
v_add_f32 v1, 1.0, v1
v_add_f32_e64 v2, 1.0, v2
s_waitcnt lgkmcnt(6)
v_mfma_f32_32x32x16_bf16 v[80:95], a[240:243], v[152:155], v[80:95]
ds_read_b64_tr_b16 a[204:205], v21 offset:1024
ds_read_b64_tr_b16 a[206:207], v21 offset:1536
v_exp_f32_e64 v4, -v59
v_add_f32 v3, 1.0, v3
v_rcp_f32 v1, v1
v_mfma_f32_32x32x16_bf16 v[96:111], a[244:247], v[152:155], v[96:111]
ds_read_b64_tr_b16 a[208:209], v18 offset:2048
ds_read_b64_tr_b16 a[210:211], v18 offset:2560
buffer_load_dwordx4 v28, s[16:19], s65 offen offset:0 lds
v_add_f32_e64 v4, 1.0, v4
v_mfma_f32_32x32x16_bf16 v[80:95], a[248:251], v[156:159], v[80:95]
ds_read_b64_tr_b16 a[212:213], v21 offset:2048
ds_read_b64_tr_b16 a[214:215], v21 offset:2560
v_rcp_f32 v2, v2
v_mul_f32 v1, v56, v1
v_rcp_f32_e64 v3, v3
v_mfma_f32_32x32x16_bf16 v[96:111], a[252:255], v[156:159], v[96:111]
ds_read_b64_tr_b16 a[216:217], v18 offset:3072
ds_read_b64_tr_b16 a[218:219], v18 offset:3584
v_mul_f32 v2, v57, v2
v_rcp_f32_e64 v4, v4
s_waitcnt lgkmcnt(6)
v_mfma_f32_32x32x16_bf16 v[80:95], a[192:195], v[160:163], v[80:95]
ds_read_b64_tr_b16 a[220:221], v21 offset:3072
ds_read_b64_tr_b16 a[222:223], v21 offset:3584
buffer_load_dwordx4 v29, s[16:19], s65 offen offset:1024 lds
v_mul_f32_e64 v3, v58, v3
v_cvt_pk_bf16_f32 v10, v1, v2
v_mul_f32_e64 v4, v59, v4
v_mfma_f32_32x32x16_bf16 v[96:111], a[196:199], v[160:163], v[96:111]
ds_read_b64_tr_b16 a[224:225], v18 offset:8192
ds_read_b64_tr_b16 a[226:227], v18 offset:8704
v_cvt_pk_bf16_f32 v11, v3, v4
ds_write_b128 v36, v[8:11] offset:0
v_mfma_f32_32x32x16_bf16 v[80:95], a[200:203], v[164:167], v[80:95]
ds_read_b64_tr_b16 a[228:229], v21 offset:8192
ds_read_b64_tr_b16 a[230:231], v21 offset:8704
v_exp_f32_e64 v5, -v60
v_exp_f32_e64 v6, -v61
v_mfma_f32_32x32x16_bf16 v[96:111], a[204:207], v[164:167], v[96:111]
ds_read_b64_tr_b16 a[232:233], v18 offset:9216
ds_read_b64_tr_b16 a[234:235], v18 offset:9728
buffer_load_dwordx4 v30, s[16:19], s65 offen offset:2048 lds
v_exp_f32_e64 v7, -v62
s_waitcnt lgkmcnt(7)
v_mfma_f32_32x32x16_bf16 v[80:95], a[208:211], v[168:171], v[80:95]
ds_read_b64_tr_b16 a[236:237], v21 offset:9216
ds_read_b64_tr_b16 a[238:239], v21 offset:9728
v_add_f32 v5, 1.0, v5
v_add_f32_e64 v6, 1.0, v6
v_exp_f32_e64 v46, -v63
v_mfma_f32_32x32x16_bf16 v[96:111], a[212:215], v[168:171], v[96:111]
ds_read_b64_tr_b16 a[240:241], v18 offset:10240
ds_read_b64_tr_b16 a[242:243], v18 offset:10752
v_add_f32 v7, 1.0, v7
v_rcp_f32 v5, v5
v_add_f32_e64 v46, 1.0, v46
v_mfma_f32_32x32x16_bf16 v[80:95], a[216:219], v[172:175], v[80:95]
ds_read_b64_tr_b16 a[244:245], v21 offset:10240
ds_read_b64_tr_b16 a[246:247], v21 offset:10752
buffer_load_dwordx4 v31, s[16:19], s65 offen offset:3072 lds
v_rcp_f32_e64 v6, v6
v_mfma_f32_32x32x16_bf16 v[96:111], a[220:223], v[172:175], v[96:111]
ds_read_b64_tr_b16 a[248:249], v18 offset:11264
ds_read_b64_tr_b16 a[250:251], v18 offset:11776
v_mul_f32 v5, v60, v5
v_rcp_f32 v7, v7
v_mul_f32 v6, v61, v6
s_waitcnt lgkmcnt(6)
v_mfma_f32_32x32x16_bf16 v[80:95], a[224:227], v[176:179], v[80:95]
ds_read_b64_tr_b16 a[252:253], v21 offset:11264
ds_read_b64_tr_b16 a[254:255], v21 offset:11776
v_rcp_f32 v46, v46
v_mul_f32 v7, v62, v7
v_cvt_pk_bf16_f32 v14, v5, v6
v_mfma_f32_32x32x16_bf16 v[96:111], a[228:231], v[176:179], v[96:111]
ds_read_b64_tr_b16 a[192:193], v18 offset:16384
ds_read_b64_tr_b16 a[194:195], v18 offset:16896
s_add_u32 m0, s64, 53248
v_mul_f32_e64 v46, v63, v46
v_cvt_pk_bf16_f32 v15, v7, v46
v_mfma_f32_32x32x16_bf16 v[80:95], a[232:235], v[180:183], v[80:95]
ds_read_b64_tr_b16 a[196:197], v21 offset:16384
ds_read_b64_tr_b16 a[198:199], v21 offset:16896
buffer_load_dwordx4 v42, s[16:19], s65 offen offset:0 lds
v_mfma_f32_32x32x16_bf16 v[96:111], a[236:239], v[180:183], v[96:111]
ds_read_b64_tr_b16 a[200:201], v18 offset:17408
ds_read_b64_tr_b16 a[202:203], v18 offset:17920
ds_write_b128 v36, v[12:15] offset:512
s_waitcnt lgkmcnt(7)
v_mfma_f32_32x32x16_bf16 v[80:95], a[240:243], v[184:187], v[80:95]
ds_read_b64_tr_b16 a[204:205], v21 offset:17408
ds_read_b64_tr_b16 a[206:207], v21 offset:17920
v_exp_f32_e64 v1, -v64
v_exp_f32_e64 v2, -v65
v_mfma_f32_32x32x16_bf16 v[96:111], a[244:247], v[184:187], v[96:111]
ds_read_b64_tr_b16 a[208:209], v18 offset:18432
ds_read_b64_tr_b16 a[210:211], v18 offset:18944
buffer_load_dwordx4 v43, s[16:19], s65 offen offset:1024 lds
v_exp_f32_e64 v3, -v66
v_mfma_f32_32x32x16_bf16 v[80:95], a[248:251], v[188:191], v[80:95]
ds_read_b64_tr_b16 a[212:213], v21 offset:18432
ds_read_b64_tr_b16 a[214:215], v21 offset:18944
v_add_f32 v1, 1.0, v1
v_add_f32_e64 v2, 1.0, v2
v_exp_f32_e64 v4, -v67
v_add_f32_e64 v3, 1.0, v3
v_mfma_f32_32x32x16_bf16 v[96:111], a[252:255], v[188:191], v[96:111]
ds_read_b64_tr_b16 a[216:217], v18 offset:19456
ds_read_b64_tr_b16 a[218:219], v18 offset:19968
v_rcp_f32 v1, v1
v_add_f32_e64 v4, 1.0, v4
s_waitcnt lgkmcnt(6)
v_mfma_f32_32x32x16_bf16 v[80:95], a[192:195], v[192:195], v[80:95]
ds_read_b64_tr_b16 a[220:221], v21 offset:19456
ds_read_b64_tr_b16 a[222:223], v21 offset:19968
v_rcp_f32 v2, v2
v_mul_f32 v1, v64, v1
v_rcp_f32_e64 v3, v3
v_mfma_f32_32x32x16_bf16 v[96:111], a[196:199], v[192:195], v[96:111]
s_waitcnt vmcnt(13)
s_barrier
ds_read_b64_tr_b16 a[224:225], v16 offset:0
ds_read_b64_tr_b16 a[226:227], v16 offset:512
v_mul_f32_e64 v2, v65, v2
v_mfma_f32_32x32x16_bf16 v[80:95], a[200:203], v[196:199], v[80:95]
ds_read_b64_tr_b16 a[228:229], v19 offset:0
ds_read_b64_tr_b16 a[230:231], v19 offset:512
s_add_u32 m0, s64, 73728
v_rcp_f32 v4, v4
v_mul_f32 v3, v66, v3
v_cvt_pk_bf16_f32 v8, v1, v2
v_mfma_f32_32x32x16_bf16 v[96:111], a[204:207], v[196:199], v[96:111]
ds_read_b64_tr_b16 a[232:233], v16 offset:1024
ds_read_b64_tr_b16 a[234:235], v16 offset:1536
s_add_u32 s65, s62, 256
v_mul_f32_e64 v4, v67, v4
v_cvt_pk_bf16_f32 v9, v3, v4
s_waitcnt lgkmcnt(6)
v_mfma_f32_32x32x16_bf16 v[80:95], a[208:211], v[200:203], v[80:95]
ds_read_b64_tr_b16 a[236:237], v19 offset:1024
ds_read_b64_tr_b16 a[238:239], v19 offset:1536
v_exp_f32_e64 v5, -v68
v_exp_f32_e64 v6, -v69
v_mfma_f32_32x32x16_bf16 v[96:111], a[212:215], v[200:203], v[96:111]
ds_read_b64_tr_b16 a[240:241], v16 offset:2048
ds_read_b64_tr_b16 a[242:243], v16 offset:2560
buffer_load_dwordx4 v28, s[16:19], s65 offen offset:0 lds
v_exp_f32_e64 v7, -v70
v_mfma_f32_32x32x16_bf16 v[80:95], a[216:219], v[204:207], v[80:95]
ds_read_b64_tr_b16 a[244:245], v19 offset:2048
ds_read_b64_tr_b16 a[246:247], v19 offset:2560
v_add_f32 v5, 1.0, v5
v_add_f32_e64 v6, 1.0, v6
v_exp_f32_e64 v46, -v71
v_add_f32_e64 v7, 1.0, v7
v_mfma_f32_32x32x16_bf16 v[96:111], a[220:223], v[204:207], v[96:111]
ds_read_b64_tr_b16 a[248:249], v16 offset:3072
ds_read_b64_tr_b16 a[250:251], v16 offset:3584
v_rcp_f32 v5, v5
v_add_f32_e64 v46, 1.0, v46
s_waitcnt lgkmcnt(6)
v_mfma_f32_32x32x16_bf16 v[80:95], a[224:227], v[208:211], v[80:95]
ds_read_b64_tr_b16 a[252:253], v19 offset:3072
ds_read_b64_tr_b16 a[254:255], v19 offset:3584
buffer_load_dwordx4 v29, s[16:19], s65 offen offset:1024 lds
v_rcp_f32 v6, v6
v_mul_f32 v5, v68, v5
v_mfma_f32_32x32x16_bf16 v[96:111], a[228:231], v[208:211], v[96:111]
ds_read_b64_tr_b16 a[192:193], v16 offset:8192
ds_read_b64_tr_b16 a[194:195], v16 offset:8704
v_rcp_f32 v7, v7
v_mul_f32 v6, v69, v6
v_rcp_f32_e64 v46, v46
v_mfma_f32_32x32x16_bf16 v[80:95], a[232:235], v[212:215], v[80:95]
ds_read_b64_tr_b16 a[196:197], v19 offset:8192
ds_read_b64_tr_b16 a[198:199], v19 offset:8704
v_mul_f32_e64 v7, v70, v7
v_cvt_pk_bf16_f32 v12, v5, v6
v_mul_f32_e64 v46, v71, v46
v_cvt_pk_bf16_f32 v13, v7, v46
v_mfma_f32_32x32x16_bf16 v[96:111], a[236:239], v[212:215], v[96:111]
ds_read_b64_tr_b16 a[200:201], v16 offset:9216
ds_read_b64_tr_b16 a[202:203], v16 offset:9728
buffer_load_dwordx4 v30, s[16:19], s65 offen offset:2048 lds
v_exp_f32_e64 v1, -v72
s_waitcnt lgkmcnt(6)
v_mfma_f32_32x32x16_bf16 v[80:95], a[240:243], v[216:219], v[80:95]
ds_read_b64_tr_b16 a[204:205], v19 offset:9216
ds_read_b64_tr_b16 a[206:207], v19 offset:9728
v_exp_f32_e64 v2, -v73
v_exp_f32_e64 v3, -v74
v_mfma_f32_32x32x16_bf16 v[96:111], a[244:247], v[216:219], v[96:111]
ds_read_b64_tr_b16 a[208:209], v16 offset:10240
ds_read_b64_tr_b16 a[210:211], v16 offset:10752
v_add_f32 v1, 1.0, v1
v_add_f32_e64 v2, 1.0, v2
v_exp_f32_e64 v4, -v75
v_add_f32_e64 v3, 1.0, v3
v_mfma_f32_32x32x16_bf16 v[80:95], a[248:251], v[220:223], v[80:95]
ds_read_b64_tr_b16 a[212:213], v19 offset:10240
ds_read_b64_tr_b16 a[214:215], v19 offset:10752
buffer_load_dwordx4 v31, s[16:19], s65 offen offset:3072 lds
v_rcp_f32_e64 v1, v1
v_mfma_f32_32x32x16_bf16 v[96:111], a[252:255], v[220:223], v[96:111]
ds_read_b64_tr_b16 a[216:217], v16 offset:11264
ds_read_b64_tr_b16 a[218:219], v16 offset:11776
v_add_f32 v4, 1.0, v4
v_rcp_f32 v2, v2
v_mul_f32 v1, v72, v1
s_waitcnt lgkmcnt(6)
v_mfma_f32_32x32x16_bf16 v[80:95], a[192:195], v[224:227], v[80:95]
ds_read_b64_tr_b16 a[220:221], v19 offset:11264
ds_read_b64_tr_b16 a[222:223], v19 offset:11776
v_rcp_f32 v3, v3
v_mul_f32 v2, v73, v2
v_mfma_f32_32x32x16_bf16 v[96:111], a[196:199], v[224:227], v[96:111]
ds_read_b64_tr_b16 a[224:225], v16 offset:16384
ds_read_b64_tr_b16 a[226:227], v16 offset:16896
s_add_u32 m0, s64, 77824
v_rcp_f32 v4, v4
v_mul_f32 v3, v74, v3
v_cvt_pk_bf16_f32 v10, v1, v2
v_mfma_f32_32x32x16_bf16 v[80:95], a[200:203], v[228:231], v[80:95]
ds_read_b64_tr_b16 a[228:229], v19 offset:16384
ds_read_b64_tr_b16 a[230:231], v19 offset:16896
buffer_load_dwordx4 v42, s[16:19], s65 offen offset:0 lds
v_mul_f32_e64 v4, v75, v4
v_cvt_pk_bf16_f32 v11, v3, v4
v_mfma_f32_32x32x16_bf16 v[96:111], a[204:207], v[228:231], v[96:111]
ds_read_b64_tr_b16 a[232:233], v16 offset:17408
ds_read_b64_tr_b16 a[234:235], v16 offset:17920
ds_write_b128 v36, v[8:11] offset:8192
s_waitcnt lgkmcnt(7)
v_mfma_f32_32x32x16_bf16 v[80:95], a[208:211], v[232:235], v[80:95]
ds_read_b64_tr_b16 a[236:237], v19 offset:17408
ds_read_b64_tr_b16 a[238:239], v19 offset:17920
v_exp_f32_e64 v5, -v76
v_exp_f32_e64 v6, -v77
v_mfma_f32_32x32x16_bf16 v[96:111], a[212:215], v[232:235], v[96:111]
ds_read_b64_tr_b16 a[240:241], v16 offset:18432
ds_read_b64_tr_b16 a[242:243], v16 offset:18944
buffer_load_dwordx4 v43, s[16:19], s65 offen offset:1024 lds
v_exp_f32_e64 v7, -v78
v_mfma_f32_32x32x16_bf16 v[80:95], a[216:219], v[236:239], v[80:95]
ds_read_b64_tr_b16 a[244:245], v19 offset:18432
ds_read_b64_tr_b16 a[246:247], v19 offset:18944
v_add_f32 v5, 1.0, v5
v_add_f32_e64 v6, 1.0, v6
v_exp_f32_e64 v46, -v79
v_add_f32_e64 v7, 1.0, v7
v_mfma_f32_32x32x16_bf16 v[96:111], a[220:223], v[236:239], v[96:111]
ds_read_b64_tr_b16 a[248:249], v16 offset:19456
ds_read_b64_tr_b16 a[250:251], v16 offset:19968
v_rcp_f32 v5, v5
v_add_f32_e64 v46, 1.0, v46
s_waitcnt lgkmcnt(6)
v_mfma_f32_32x32x16_bf16 v[80:95], a[224:227], v[240:243], v[80:95]
ds_read_b64_tr_b16 a[252:253], v19 offset:19456
ds_read_b64_tr_b16 a[254:255], v19 offset:19968
v_rcp_f32 v6, v6
v_mul_f32 v5, v76, v5
v_rcp_f32_e64 v7, v7
v_mfma_f32_32x32x16_bf16 v[96:111], a[228:231], v[240:243], v[96:111]
s_waitcnt vmcnt(12)
s_barrier
ds_read_b64_tr_b16 a[192:193], v16 offset:24576
ds_read_b64_tr_b16 a[194:195], v16 offset:25088
v_mul_f32_e64 v6, v77, v6
v_mfma_f32_32x32x16_bf16 v[80:95], a[232:235], v[244:247], v[80:95]
ds_read_b64_tr_b16 a[196:197], v19 offset:24576
ds_read_b64_tr_b16 a[198:199], v19 offset:25088
s_sub_u32 s60, s60, s39
v_rcp_f32 v46, v46
v_mul_f32_e64 v7, v78, v7
v_cvt_pk_bf16_f32 v14, v5, v6
v_mfma_f32_32x32x16_bf16 v[96:111], a[236:239], v[244:247], v[96:111]
ds_read_b64_tr_b16 a[200:201], v16 offset:25600
ds_read_b64_tr_b16 a[202:203], v16 offset:26112
s_add_u32 m0, s64, 98304
v_mul_f32_e64 v46, v79, v46
v_cvt_pk_bf16_f32 v15, v7, v46
s_waitcnt lgkmcnt(6)
v_mfma_f32_32x32x16_bf16 v[80:95], a[240:243], v[248:251], v[80:95]
ds_read_b64_tr_b16 a[204:205], v19 offset:25600
ds_read_b64_tr_b16 a[206:207], v19 offset:26112
s_add_u32 s65, s60, 384
ds_write_b128 v36, v[12:15] offset:8704
v_mfma_f32_32x32x16_bf16 v[96:111], a[244:247], v[248:251], v[96:111]
ds_read_b64_tr_b16 a[208:209], v16 offset:26624
ds_read_b64_tr_b16 a[210:211], v16 offset:27136
v_mfma_f32_32x32x16_bf16 v[80:95], a[248:251], v[252:255], v[80:95]
ds_read_b64_tr_b16 a[212:213], v19 offset:26624
ds_read_b64_tr_b16 a[214:215], v19 offset:27136
buffer_load_dwordx4 v28, s[16:19], s65 offen offset:0 lds
v_mfma_f32_32x32x16_bf16 v[96:111], a[252:255], v[252:255], v[96:111]
ds_read_b64_tr_b16 a[216:217], v16 offset:27648
ds_read_b64_tr_b16 a[218:219], v16 offset:28160
s_waitcnt lgkmcnt(7)
v_mfma_f32_32x32x16_bf16 v[48:63], a[192:195], v[112:115], 0
ds_read_b64_tr_b16 a[220:221], v19 offset:27648
ds_read_b64_tr_b16 a[222:223], v19 offset:28160
v_mfma_f32_32x32x16_bf16 v[64:79], a[196:199], v[112:115], 0
ds_read_b64_tr_b16 a[224:225], v16 offset:32768
ds_read_b64_tr_b16 a[226:227], v16 offset:33280
buffer_load_dwordx4 v29, s[16:19], s65 offen offset:1024 lds
v_mfma_f32_32x32x16_bf16 v[48:63], a[200:203], v[116:119], v[48:63]
ds_read_b64_tr_b16 a[228:229], v19 offset:32768
ds_read_b64_tr_b16 a[230:231], v19 offset:33280
v_exp_f32_e64 v1, -v80
v_exp_f32_e64 v2, -v81
v_mfma_f32_32x32x16_bf16 v[64:79], a[204:207], v[116:119], v[64:79]
ds_read_b64_tr_b16 a[232:233], v16 offset:33792
ds_read_b64_tr_b16 a[234:235], v16 offset:34304
v_exp_f32_e64 v3, -v82
v_add_f32 v1, 1.0, v1
v_add_f32_e64 v2, 1.0, v2
s_waitcnt lgkmcnt(6)
v_mfma_f32_32x32x16_bf16 v[48:63], a[208:211], v[120:123], v[48:63]
ds_read_b64_tr_b16 a[236:237], v19 offset:33792
ds_read_b64_tr_b16 a[238:239], v19 offset:34304
buffer_load_dwordx4 v30, s[16:19], s65 offen offset:2048 lds
v_exp_f32_e64 v4, -v83
v_mfma_f32_32x32x16_bf16 v[64:79], a[212:215], v[120:123], v[64:79]
ds_read_b64_tr_b16 a[240:241], v16 offset:34816
ds_read_b64_tr_b16 a[242:243], v16 offset:35328
v_add_f32 v3, 1.0, v3
v_rcp_f32 v1, v1
v_add_f32_e64 v4, 1.0, v4
v_mfma_f32_32x32x16_bf16 v[48:63], a[216:219], v[124:127], v[48:63]
ds_read_b64_tr_b16 a[244:245], v19 offset:34816
ds_read_b64_tr_b16 a[246:247], v19 offset:35328
buffer_load_dwordx4 v31, s[16:19], s65 offen offset:3072 lds
v_rcp_f32 v2, v2
v_mul_f32 v1, v80, v1
v_mfma_f32_32x32x16_bf16 v[64:79], a[220:223], v[124:127], v[64:79]
ds_read_b64_tr_b16 a[248:249], v16 offset:35840
ds_read_b64_tr_b16 a[250:251], v16 offset:36352
v_rcp_f32 v3, v3
v_mul_f32_e64 v2, v81, v2
s_waitcnt lgkmcnt(6)
v_mfma_f32_32x32x16_bf16 v[48:63], a[224:227], v[128:131], v[48:63]
ds_read_b64_tr_b16 a[252:253], v19 offset:35840
ds_read_b64_tr_b16 a[254:255], v19 offset:36352
v_rcp_f32 v4, v4
v_mul_f32 v3, v82, v3
v_cvt_pk_bf16_f32 v8, v1, v2
v_mul_f32_e64 v4, v83, v4
v_mfma_f32_32x32x16_bf16 v[64:79], a[228:231], v[128:131], v[64:79]
ds_read_b64_tr_b16 a[192:193], v16 offset:40960
ds_read_b64_tr_b16 a[194:195], v16 offset:41472
s_add_u32 m0, s64, 102400
v_cvt_pk_bf16_f32 v9, v3, v4
v_exp_f32_e64 v5, -v84
v_mfma_f32_32x32x16_bf16 v[48:63], a[232:235], v[132:135], v[48:63]
ds_read_b64_tr_b16 a[196:197], v19 offset:40960
ds_read_b64_tr_b16 a[198:199], v19 offset:41472
v_exp_f32_e64 v6, -v85
v_exp_f32_e64 v7, -v86
v_mfma_f32_32x32x16_bf16 v[64:79], a[236:239], v[132:135], v[64:79]
ds_read_b64_tr_b16 a[200:201], v16 offset:41984
ds_read_b64_tr_b16 a[202:203], v16 offset:42496
buffer_load_dwordx4 v42, s[16:19], s65 offen offset:0 lds
v_add_f32 v5, 1.0, v5
v_add_f32_e64 v6, 1.0, v6
s_waitcnt lgkmcnt(6)
v_mfma_f32_32x32x16_bf16 v[48:63], a[240:243], v[136:139], v[48:63]
ds_read_b64_tr_b16 a[204:205], v19 offset:41984
ds_read_b64_tr_b16 a[206:207], v19 offset:42496
v_exp_f32_e64 v46, -v87
v_add_f32 v7, 1.0, v7
v_rcp_f32 v5, v5
v_mfma_f32_32x32x16_bf16 v[64:79], a[244:247], v[136:139], v[64:79]
ds_read_b64_tr_b16 a[208:209], v16 offset:43008
ds_read_b64_tr_b16 a[210:211], v16 offset:43520
v_add_f32 v46, 1.0, v46
v_rcp_f32 v6, v6
v_mul_f32_e64 v5, v84, v5
v_mfma_f32_32x32x16_bf16 v[48:63], a[248:251], v[140:143], v[48:63]
ds_read_b64_tr_b16 a[212:213], v19 offset:43008
ds_read_b64_tr_b16 a[214:215], v19 offset:43520
buffer_load_dwordx4 v43, s[16:19], s65 offen offset:1024 lds
v_rcp_f32 v7, v7
v_mul_f32 v6, v85, v6
v_mfma_f32_32x32x16_bf16 v[64:79], a[252:255], v[140:143], v[64:79]
ds_read_b64_tr_b16 a[216:217], v16 offset:44032
ds_read_b64_tr_b16 a[218:219], v16 offset:44544
v_rcp_f32 v46, v46
v_mul_f32 v7, v86, v7
v_cvt_pk_bf16_f32 v12, v5, v6
s_waitcnt lgkmcnt(6)
v_mfma_f32_32x32x16_bf16 v[48:63], a[192:195], v[144:147], v[48:63]
ds_read_b64_tr_b16 a[220:221], v19 offset:44032
ds_read_b64_tr_b16 a[222:223], v19 offset:44544
v_mul_f32 v46, v87, v46
v_cvt_pk_bf16_f32 v13, v7, v46
v_exp_f32_e64 v1, -v88
v_mfma_f32_32x32x16_bf16 v[64:79], a[196:199], v[144:147], v[64:79]
s_waitcnt vmcnt(12) lgkmcnt(15)
s_barrier
ds_read_b64_tr_b16 a[224:225], v17 offset:0
ds_read_b64_tr_b16 a[226:227], v17 offset:512
v_exp_f32_e64 v2, -v89
v_mfma_f32_32x32x16_bf16 v[48:63], a[200:203], v[148:151], v[48:63]
ds_read_b64_tr_b16 a[228:229], v20 offset:0
ds_read_b64_tr_b16 a[230:231], v20 offset:512
s_sub_u32 s61, s61, s39
ds_read_b128 a[0:3], v37 offset:0
v_exp_f32_e64 v3, -v90
v_add_f32 v1, 1.0, v1
v_mfma_f32_32x32x16_bf16 v[64:79], a[204:207], v[148:151], v[64:79]
ds_read_b64_tr_b16 a[232:233], v17 offset:1024
ds_read_b64_tr_b16 a[234:235], v17 offset:1536
s_add_u32 m0, s64, 0
v_add_f32_e64 v2, 1.0, v2
s_waitcnt lgkmcnt(7)
v_mfma_f32_32x32x16_bf16 v[48:63], a[208:211], v[152:155], v[48:63]
ds_read_b64_tr_b16 a[236:237], v20 offset:1024
ds_read_b64_tr_b16 a[238:239], v20 offset:1536
s_add_u32 s65, s61, 384
ds_read_b128 a[4:7], v37 offset:1024
v_exp_f32_e64 v4, -v91
v_add_f32_e64 v3, 1.0, v3
v_mfma_f32_32x32x16_bf16 v[64:79], a[212:215], v[152:155], v[64:79]
ds_read_b64_tr_b16 a[240:241], v17 offset:2048
ds_read_b64_tr_b16 a[242:243], v17 offset:2560
v_rcp_f32 v1, v1
v_add_f32 v4, 1.0, v4
v_rcp_f32_e64 v2, v2
v_mfma_f32_32x32x16_bf16 v[48:63], a[216:219], v[156:159], v[48:63]
ds_read_b64_tr_b16 a[244:245], v20 offset:2048
ds_read_b64_tr_b16 a[246:247], v20 offset:2560
buffer_load_dwordx4 v28, s[16:19], s65 offen offset:0 lds
ds_read_b128 a[8:11], v37 offset:2048
v_mul_f32_e64 v1, v88, v1
v_mfma_f32_32x32x16_bf16 v[64:79], a[220:223], v[156:159], v[64:79]
ds_read_b64_tr_b16 a[248:249], v17 offset:3072
ds_read_b64_tr_b16 a[250:251], v17 offset:3584
v_rcp_f32 v3, v3
v_mul_f32_e64 v2, v89, v2
s_waitcnt lgkmcnt(8)
v_mfma_f32_32x32x16_bf16 v[48:63], a[224:227], v[160:163], v[48:63]
ds_read_b64_tr_b16 a[252:253], v20 offset:3072
ds_read_b64_tr_b16 a[254:255], v20 offset:3584
ds_read_b128 a[12:15], v37 offset:3072
v_rcp_f32 v4, v4
v_mul_f32 v3, v90, v3
v_cvt_pk_bf16_f32 v10, v1, v2
v_mfma_f32_32x32x16_bf16 v[64:79], a[228:231], v[160:163], v[64:79]
ds_read_b64_tr_b16 a[192:193], v17 offset:8192
ds_read_b64_tr_b16 a[194:195], v17 offset:8704
buffer_load_dwordx4 v29, s[16:19], s65 offen offset:1024 lds
v_mul_f32_e64 v4, v91, v4
v_cvt_pk_bf16_f32 v11, v3, v4
v_mfma_f32_32x32x16_bf16 v[48:63], a[232:235], v[164:167], v[48:63]
ds_read_b64_tr_b16 a[196:197], v20 offset:8192
ds_read_b64_tr_b16 a[198:199], v20 offset:8704
ds_read_b128 a[16:19], v37 offset:8192
ds_write_b128 v36, v[8:11] offset:16384
v_mfma_f32_32x32x16_bf16 v[64:79], a[236:239], v[164:167], v[64:79]
ds_read_b64_tr_b16 a[200:201], v17 offset:9216
ds_read_b64_tr_b16 a[202:203], v17 offset:9728
v_exp_f32_e64 v5, -v92
v_exp_f32_e64 v6, -v93
s_waitcnt lgkmcnt(9)
v_mfma_f32_32x32x16_bf16 v[48:63], a[240:243], v[168:171], v[48:63]
ds_read_b64_tr_b16 a[204:205], v20 offset:9216
ds_read_b64_tr_b16 a[206:207], v20 offset:9728
buffer_load_dwordx4 v30, s[16:19], s65 offen offset:2048 lds
ds_read_b128 a[20:23], v37 offset:9216
v_mfma_f32_32x32x16_bf16 v[64:79], a[244:247], v[168:171], v[64:79]
ds_read_b64_tr_b16 a[208:209], v17 offset:10240
ds_read_b64_tr_b16 a[210:211], v17 offset:10752
v_exp_f32_e64 v7, -v94
v_add_f32 v5, 1.0, v5
v_add_f32_e64 v6, 1.0, v6
v_mfma_f32_32x32x16_bf16 v[48:63], a[248:251], v[172:175], v[48:63]
ds_read_b64_tr_b16 a[212:213], v20 offset:10240
ds_read_b64_tr_b16 a[214:215], v20 offset:10752
buffer_load_dwordx4 v31, s[16:19], s65 offen offset:3072 lds
ds_read_b128 a[24:27], v37 offset:10240
v_exp_f32_e64 v46, -v95
v_mfma_f32_32x32x16_bf16 v[64:79], a[252:255], v[172:175], v[64:79]
ds_read_b64_tr_b16 a[216:217], v17 offset:11264
ds_read_b64_tr_b16 a[218:219], v17 offset:11776
v_add_f32 v7, 1.0, v7
v_rcp_f32_e64 v5, v5
s_waitcnt lgkmcnt(8)
v_mfma_f32_32x32x16_bf16 v[48:63], a[192:195], v[176:179], v[48:63]
ds_read_b64_tr_b16 a[220:221], v20 offset:11264
ds_read_b64_tr_b16 a[222:223], v20 offset:11776
ds_read_b128 a[28:31], v37 offset:11264
v_add_f32 v46, 1.0, v46
v_rcp_f32 v6, v6
v_mul_f32_e64 v5, v92, v5
v_mfma_f32_32x32x16_bf16 v[64:79], a[196:199], v[176:179], v[64:79]
ds_read_b64_tr_b16 a[224:225], v17 offset:16384
ds_read_b64_tr_b16 a[226:227], v17 offset:16896
s_add_u32 m0, s64, 4096
v_rcp_f32 v7, v7
v_mul_f32 v6, v93, v6
v_mfma_f32_32x32x16_bf16 v[48:63], a[200:203], v[180:183], v[48:63]
ds_read_b64_tr_b16 a[228:229], v20 offset:16384
ds_read_b64_tr_b16 a[230:231], v20 offset:16896
v_rcp_f32 v46, v46
v_mul_f32 v7, v94, v7
v_cvt_pk_bf16_f32 v14, v5, v6
v_mfma_f32_32x32x16_bf16 v[64:79], a[204:207], v[180:183], v[64:79]
ds_read_b64_tr_b16 a[232:233], v17 offset:17408
ds_read_b64_tr_b16 a[234:235], v17 offset:17920
buffer_load_dwordx4 v42, s[16:19], s65 offen offset:0 lds
v_mul_f32_e64 v46, v95, v46
v_cvt_pk_bf16_f32 v15, v7, v46
s_waitcnt lgkmcnt(7)
v_mfma_f32_32x32x16_bf16 v[48:63], a[208:211], v[184:187], v[48:63]
ds_read_b64_tr_b16 a[236:237], v20 offset:17408
ds_read_b64_tr_b16 a[238:239], v20 offset:17920
ds_write_b128 v36, v[12:15] offset:16896
v_mfma_f32_32x32x16_bf16 v[64:79], a[212:215], v[184:187], v[64:79]
ds_read_b64_tr_b16 a[240:241], v17 offset:18432
ds_read_b64_tr_b16 a[242:243], v17 offset:18944
v_exp_f32_e64 v1, -v96
v_exp_f32_e64 v2, -v97
v_mfma_f32_32x32x16_bf16 v[48:63], a[216:219], v[188:191], v[48:63]
ds_read_b64_tr_b16 a[244:245], v20 offset:18432
ds_read_b64_tr_b16 a[246:247], v20 offset:18944
buffer_load_dwordx4 v43, s[16:19], s65 offen offset:1024 lds
v_exp_f32_e64 v3, -v98
v_add_f32 v1, 1.0, v1
v_mfma_f32_32x32x16_bf16 v[64:79], a[220:223], v[188:191], v[64:79]
ds_read_b64_tr_b16 a[248:249], v17 offset:19456
ds_read_b64_tr_b16 a[250:251], v17 offset:19968
v_add_f32_e64 v2, 1.0, v2
v_exp_f32_e64 v4, -v99
s_waitcnt lgkmcnt(7)
v_mfma_f32_32x32x16_bf16 v[48:63], a[224:227], v[192:195], v[48:63]
ds_read_b64_tr_b16 a[252:253], v20 offset:19456
ds_read_b64_tr_b16 a[254:255], v20 offset:19968
v_add_f32 v3, 1.0, v3
v_rcp_f32 v1, v1
v_add_f32 v4, 1.0, v4
v_mfma_f32_32x32x16_bf16 v[64:79], a[228:231], v[192:195], v[64:79]
s_waitcnt vmcnt(12)
s_barrier
ds_read_b64_tr_b16 a[192:193], v17 offset:24576
ds_read_b64_tr_b16 a[194:195], v17 offset:25088
v_rcp_f32 v2, v2
v_mul_f32 v1, v96, v1
v_mfma_f32_32x32x16_bf16 v[48:63], a[232:235], v[196:199], v[48:63]
ds_read_b64_tr_b16 a[196:197], v20 offset:24576
ds_read_b64_tr_b16 a[198:199], v20 offset:25088
s_sub_u32 s62, s62, s39
v_rcp_f32 v3, v3
v_mul_f32_e64 v2, v97, v2
v_mfma_f32_32x32x16_bf16 v[64:79], a[236:239], v[196:199], v[64:79]
ds_read_b64_tr_b16 a[200:201], v17 offset:25600
ds_read_b64_tr_b16 a[202:203], v17 offset:26112
s_add_u32 m0, s64, 24576
v_rcp_f32 v4, v4
v_mul_f32_e64 v3, v98, v3
s_waitcnt lgkmcnt(6)
v_mfma_f32_32x32x16_bf16 v[48:63], a[240:243], v[200:203], v[48:63]
ds_read_b64_tr_b16 a[204:205], v20 offset:25600
ds_read_b64_tr_b16 a[206:207], v20 offset:26112
s_add_u32 s65, s62, 384
v_cvt_pk_bf16_f32 v8, v1, v2
v_mul_f32_e64 v4, v99, v4
v_cvt_pk_bf16_f32 v9, v3, v4
v_mfma_f32_32x32x16_bf16 v[64:79], a[244:247], v[200:203], v[64:79]
ds_read_b64_tr_b16 a[208:209], v17 offset:26624
ds_read_b64_tr_b16 a[210:211], v17 offset:27136
v_exp_f32_e64 v5, -v100
v_exp_f32_e64 v6, -v101
v_mfma_f32_32x32x16_bf16 v[48:63], a[248:251], v[204:207], v[48:63]
ds_read_b64_tr_b16 a[212:213], v20 offset:26624
ds_read_b64_tr_b16 a[214:215], v20 offset:27136
buffer_load_dwordx4 v28, s[16:19], s65 offen offset:0 lds
v_exp_f32_e64 v7, -v102
v_add_f32_e64 v5, 1.0, v5
v_mfma_f32_32x32x16_bf16 v[64:79], a[252:255], v[204:207], v[64:79]
ds_read_b64_tr_b16 a[216:217], v17 offset:27648
ds_read_b64_tr_b16 a[218:219], v17 offset:28160
v_add_f32_e64 v6, 1.0, v6
v_exp_f32_e64 v46, -v103
v_add_f32 v7, 1.0, v7
s_waitcnt lgkmcnt(6)
v_mfma_f32_32x32x16_bf16 v[48:63], a[192:195], v[208:211], v[48:63]
ds_read_b64_tr_b16 a[220:221], v20 offset:27648
ds_read_b64_tr_b16 a[222:223], v20 offset:28160
v_rcp_f32 v5, v5
v_add_f32 v46, 1.0, v46
v_mfma_f32_32x32x16_bf16 v[64:79], a[196:199], v[208:211], v[64:79]
ds_read_b64_tr_b16 a[224:225], v17 offset:32768
ds_read_b64_tr_b16 a[226:227], v17 offset:33280
buffer_load_dwordx4 v29, s[16:19], s65 offen offset:1024 lds
v_rcp_f32 v6, v6
v_mul_f32 v5, v100, v5
v_mfma_f32_32x32x16_bf16 v[48:63], a[200:203], v[212:215], v[48:63]
ds_read_b64_tr_b16 a[228:229], v20 offset:32768
ds_read_b64_tr_b16 a[230:231], v20 offset:33280
v_rcp_f32 v7, v7
v_mul_f32 v6, v101, v6
v_rcp_f32_e64 v46, v46
v_mfma_f32_32x32x16_bf16 v[64:79], a[204:207], v[212:215], v[64:79]
ds_read_b64_tr_b16 a[232:233], v17 offset:33792
ds_read_b64_tr_b16 a[234:235], v17 offset:34304
v_mul_f32_e64 v7, v102, v7
v_cvt_pk_bf16_f32 v12, v5, v6
v_mul_f32 v46, v103, v46
s_waitcnt lgkmcnt(6)
v_mfma_f32_32x32x16_bf16 v[48:63], a[208:211], v[216:219], v[48:63]
ds_read_b64_tr_b16 a[236:237], v20 offset:33792
ds_read_b64_tr_b16 a[238:239], v20 offset:34304
buffer_load_dwordx4 v30, s[16:19], s65 offen offset:2048 lds
v_cvt_pk_bf16_f32 v13, v7, v46
v_exp_f32_e64 v1, -v104
v_mfma_f32_32x32x16_bf16 v[64:79], a[212:215], v[216:219], v[64:79]
ds_read_b64_tr_b16 a[240:241], v17 offset:34816
ds_read_b64_tr_b16 a[242:243], v17 offset:35328
v_exp_f32_e64 v2, -v105
v_exp_f32_e64 v3, -v106
v_add_f32_e64 v1, 1.0, v1
v_mfma_f32_32x32x16_bf16 v[48:63], a[216:219], v[220:223], v[48:63]
ds_read_b64_tr_b16 a[244:245], v20 offset:34816
ds_read_b64_tr_b16 a[246:247], v20 offset:35328
buffer_load_dwordx4 v31, s[16:19], s65 offen offset:3072 lds
v_add_f32_e64 v2, 1.0, v2
v_mfma_f32_32x32x16_bf16 v[64:79], a[220:223], v[220:223], v[64:79]
ds_read_b64_tr_b16 a[248:249], v17 offset:35840
ds_read_b64_tr_b16 a[250:251], v17 offset:36352
v_exp_f32_e64 v4, -v107
v_add_f32 v3, 1.0, v3
s_waitcnt lgkmcnt(6)
v_mfma_f32_32x32x16_bf16 v[48:63], a[224:227], v[224:227], v[48:63]
ds_read_b64_tr_b16 a[252:253], v20 offset:35840
ds_read_b64_tr_b16 a[254:255], v20 offset:36352
v_rcp_f32 v1, v1
v_add_f32 v4, 1.0, v4
v_rcp_f32_e64 v2, v2
v_mfma_f32_32x32x16_bf16 v[64:79], a[228:231], v[224:227], v[64:79]
ds_read_b64_tr_b16 a[192:193], v17 offset:40960
ds_read_b64_tr_b16 a[194:195], v17 offset:41472
s_add_u32 m0, s64, 28672
v_mul_f32 v1, v104, v1
v_rcp_f32 v3, v3
v_mfma_f32_32x32x16_bf16 v[48:63], a[232:235], v[228:231], v[48:63]
ds_read_b64_tr_b16 a[196:197], v20 offset:40960
ds_read_b64_tr_b16 a[198:199], v20 offset:41472
v_mul_f32 v2, v105, v2
v_rcp_f32 v4, v4
v_mul_f32_e64 v3, v106, v3
v_cvt_pk_bf16_f32 v10, v1, v2
v_mfma_f32_32x32x16_bf16 v[64:79], a[236:239], v[228:231], v[64:79]
ds_read_b64_tr_b16 a[200:201], v17 offset:41984
ds_read_b64_tr_b16 a[202:203], v17 offset:42496
buffer_load_dwordx4 v42, s[16:19], s65 offen offset:0 lds
v_mul_f32_e64 v4, v107, v4
v_cvt_pk_bf16_f32 v11, v3, v4
s_waitcnt lgkmcnt(6)
v_mfma_f32_32x32x16_bf16 v[48:63], a[240:243], v[232:235], v[48:63]
ds_read_b64_tr_b16 a[204:205], v20 offset:41984
ds_read_b64_tr_b16 a[206:207], v20 offset:42496
ds_write_b128 v36, v[8:11] offset:24576
v_mfma_f32_32x32x16_bf16 v[64:79], a[244:247], v[232:235], v[64:79]
ds_read_b64_tr_b16 a[208:209], v17 offset:43008
ds_read_b64_tr_b16 a[210:211], v17 offset:43520
buffer_load_dword v47, v39, s[24:27], s37 offen sc1
v_exp_f32_e64 v5, -v108
v_mfma_f32_32x32x16_bf16 v[48:63], a[248:251], v[236:239], v[48:63]
ds_read_b64_tr_b16 a[212:213], v20 offset:43008
ds_read_b64_tr_b16 a[214:215], v20 offset:43520
buffer_load_dwordx4 v43, s[16:19], s65 offen offset:1024 lds
v_exp_f32_e64 v6, -v109
v_mfma_f32_32x32x16_bf16 v[64:79], a[252:255], v[236:239], v[64:79]
ds_read_b64_tr_b16 a[216:217], v17 offset:44032
ds_read_b64_tr_b16 a[218:219], v17 offset:44544
v_exp_f32_e64 v7, -v110
v_add_f32_e64 v5, 1.0, v5
s_waitcnt lgkmcnt(7)
v_mfma_f32_32x32x16_bf16 v[48:63], a[192:195], v[240:243], v[48:63]
ds_read_b64_tr_b16 a[220:221], v20 offset:44032
ds_read_b64_tr_b16 a[222:223], v20 offset:44544
v_add_f32_e64 v6, 1.0, v6
v_exp_f32_e64 v46, -v111
v_add_f32_e64 v7, 1.0, v7
v_mfma_f32_32x32x16_bf16 v[64:79], a[196:199], v[240:243], v[64:79]
s_waitcnt vmcnt(13)
s_barrier
ds_read_b64_tr_b16 a[224:225], v18 offset:0
ds_read_b64_tr_b16 a[226:227], v18 offset:512
v_rcp_f32 v5, v5
v_add_f32 v46, 1.0, v46
v_mfma_f32_32x32x16_bf16 v[48:63], a[200:203], v[244:247], v[48:63]
ds_read_b64_tr_b16 a[228:229], v21 offset:0
ds_read_b64_tr_b16 a[230:231], v21 offset:512
s_add_u32 m0, s64, 49152
v_rcp_f32 v6, v6
v_mul_f32 v5, v108, v5
v_mfma_f32_32x32x16_bf16 v[64:79], a[204:207], v[244:247], v[64:79]
ds_read_b64_tr_b16 a[232:233], v18 offset:1024
ds_read_b64_tr_b16 a[234:235], v18 offset:1536
s_add_u32 s65, s60, 512
v_rcp_f32 v7, v7
v_mul_f32_e64 v6, v109, v6
s_waitcnt lgkmcnt(6)
v_mfma_f32_32x32x16_bf16 v[48:63], a[208:211], v[248:251], v[48:63]
ds_read_b64_tr_b16 a[236:237], v21 offset:1024
ds_read_b64_tr_b16 a[238:239], v21 offset:1536
v_rcp_f32 v46, v46
v_mul_f32 v7, v110, v7
v_cvt_pk_bf16_f32 v14, v5, v6
v_mul_f32_e64 v46, v111, v46
v_mfma_f32_32x32x16_bf16 v[64:79], a[212:215], v[248:251], v[64:79]
ds_read_b64_tr_b16 a[240:241], v18 offset:2048
ds_read_b64_tr_b16 a[242:243], v18 offset:2560
buffer_load_dwordx4 v28, s[16:19], s65 offen offset:0 lds
v_cvt_pk_bf16_f32 v15, v7, v46
v_mfma_f32_32x32x16_bf16 v[48:63], a[216:219], v[252:255], v[48:63]
ds_read_b64_tr_b16 a[244:245], v21 offset:2048
ds_read_b64_tr_b16 a[246:247], v21 offset:2560
ds_write_b128 v36, v[12:15] offset:25088
v_mfma_f32_32x32x16_bf16 v[64:79], a[220:223], v[252:255], v[64:79]
ds_read_b64_tr_b16 a[248:249], v18 offset:3072
ds_read_b64_tr_b16 a[250:251], v18 offset:3584
s_waitcnt lgkmcnt(7)
v_mfma_f32_32x32x16_bf16 v[80:95], a[224:227], v[112:115], 0
ds_read_b64_tr_b16 a[252:253], v21 offset:3072
ds_read_b64_tr_b16 a[254:255], v21 offset:3584
buffer_load_dwordx4 v29, s[16:19], s65 offen offset:1024 lds
v_mfma_f32_32x32x16_bf16 v[96:111], a[228:231], v[112:115], 0
ds_read_b64_tr_b16 a[192:193], v18 offset:8192
ds_read_b64_tr_b16 a[194:195], v18 offset:8704
v_mfma_f32_32x32x16_bf16 v[80:95], a[232:235], v[116:119], v[80:95]
ds_read_b64_tr_b16 a[196:197], v21 offset:8192
ds_read_b64_tr_b16 a[198:199], v21 offset:8704
v_exp_f32_e64 v1, -v48
v_exp_f32_e64 v2, -v49
v_mfma_f32_32x32x16_bf16 v[96:111], a[236:239], v[116:119], v[96:111]
ds_read_b64_tr_b16 a[200:201], v18 offset:9216
ds_read_b64_tr_b16 a[202:203], v18 offset:9728
buffer_load_dwordx4 v30, s[16:19], s65 offen offset:2048 lds
v_exp_f32_e64 v3, -v50
s_waitcnt lgkmcnt(6)
v_mfma_f32_32x32x16_bf16 v[80:95], a[240:243], v[120:123], v[80:95]
ds_read_b64_tr_b16 a[204:205], v21 offset:9216
ds_read_b64_tr_b16 a[206:207], v21 offset:9728
v_add_f32 v1, 1.0, v1
v_add_f32 v2, 1.0, v2
v_exp_f32_e64 v4, -v51
v_mfma_f32_32x32x16_bf16 v[96:111], a[244:247], v[120:123], v[96:111]
ds_read_b64_tr_b16 a[208:209], v18 offset:10240
ds_read_b64_tr_b16 a[210:211], v18 offset:10752
v_add_f32 v3, 1.0, v3
v_rcp_f32 v1, v1
v_add_f32_e64 v4, 1.0, v4
v_mfma_f32_32x32x16_bf16 v[80:95], a[248:251], v[124:127], v[80:95]
ds_read_b64_tr_b16 a[212:213], v21 offset:10240
ds_read_b64_tr_b16 a[214:215], v21 offset:10752
buffer_load_dwordx4 v31, s[16:19], s65 offen offset:3072 lds
v_rcp_f32_e64 v2, v2
v_mfma_f32_32x32x16_bf16 v[96:111], a[252:255], v[124:127], v[96:111]
ds_read_b64_tr_b16 a[216:217], v18 offset:11264
ds_read_b64_tr_b16 a[218:219], v18 offset:11776
v_mul_f32 v1, v48, v1
v_rcp_f32 v3, v3
v_mul_f32 v2, v49, v2
s_waitcnt lgkmcnt(6)
v_mfma_f32_32x32x16_bf16 v[80:95], a[192:195], v[128:131], v[80:95]
ds_read_b64_tr_b16 a[220:221], v21 offset:11264
ds_read_b64_tr_b16 a[222:223], v21 offset:11776
v_rcp_f32 v4, v4
v_mul_f32 v3, v50, v3
v_cvt_pk_bf16_f32 v8, v1, v2
v_mfma_f32_32x32x16_bf16 v[96:111], a[196:199], v[128:131], v[96:111]
ds_read_b64_tr_b16 a[224:225], v18 offset:16384
ds_read_b64_tr_b16 a[226:227], v18 offset:16896
s_add_u32 m0, s64, 53248
v_mul_f32_e64 v4, v51, v4
v_cvt_pk_bf16_f32 v9, v3, v4
v_exp_f32_e64 v5, -v52
v_mfma_f32_32x32x16_bf16 v[80:95], a[200:203], v[132:135], v[80:95]
ds_read_b64_tr_b16 a[228:229], v21 offset:16384
ds_read_b64_tr_b16 a[230:231], v21 offset:16896
buffer_load_dwordx4 v42, s[16:19], s65 offen offset:0 lds
v_exp_f32_e64 v6, -v53
v_mfma_f32_32x32x16_bf16 v[96:111], a[204:207], v[132:135], v[96:111]
ds_read_b64_tr_b16 a[232:233], v18 offset:17408
ds_read_b64_tr_b16 a[234:235], v18 offset:17920
v_exp_f32_e64 v7, -v54
v_add_f32 v5, 1.0, v5
s_waitcnt lgkmcnt(6)
v_mfma_f32_32x32x16_bf16 v[80:95], a[208:211], v[136:139], v[80:95]
ds_read_b64_tr_b16 a[236:237], v21 offset:17408
ds_read_b64_tr_b16 a[238:239], v21 offset:17920
v_add_f32_e64 v6, 1.0, v6
v_exp_f32_e64 v46, -v55
v_add_f32_e64 v7, 1.0, v7
v_mfma_f32_32x32x16_bf16 v[96:111], a[212:215], v[136:139], v[96:111]
ds_read_b64_tr_b16 a[240:241], v18 offset:18432
ds_read_b64_tr_b16 a[242:243], v18 offset:18944
buffer_load_dwordx4 v43, s[16:19], s65 offen offset:1024 lds
v_rcp_f32_e64 v5, v5
v_mfma_f32_32x32x16_bf16 v[80:95], a[216:219], v[140:143], v[80:95]
ds_read_b64_tr_b16 a[244:245], v21 offset:18432
ds_read_b64_tr_b16 a[246:247], v21 offset:18944
v_add_f32 v46, 1.0, v46
v_rcp_f32 v6, v6
v_mul_f32_e64 v5, v52, v5
v_mfma_f32_32x32x16_bf16 v[96:111], a[220:223], v[140:143], v[96:111]
ds_read_b64_tr_b16 a[248:249], v18 offset:19456
ds_read_b64_tr_b16 a[250:251], v18 offset:19968
v_rcp_f32 v7, v7
v_mul_f32_e64 v6, v53, v6
s_waitcnt lgkmcnt(6)
v_mfma_f32_32x32x16_bf16 v[80:95], a[224:227], v[144:147], v[80:95]
ds_read_b64_tr_b16 a[252:253], v21 offset:19456
ds_read_b64_tr_b16 a[254:255], v21 offset:19968
v_rcp_f32 v46, v46
v_mul_f32 v7, v54, v7
v_cvt_pk_bf16_f32 v12, v5, v6
v_mul_f32_e64 v46, v55, v46
v_mfma_f32_32x32x16_bf16 v[96:111], a[228:231], v[144:147], v[96:111]
s_waitcnt vmcnt(13) lgkmcnt(15)
s_barrier
ds_read_b64_tr_b16 a[192:193], v16 offset:0
ds_read_b64_tr_b16 a[194:195], v16 offset:512
v_cvt_pk_bf16_f32 v13, v7, v46
v_mfma_f32_32x32x16_bf16 v[80:95], a[232:235], v[148:151], v[80:95]
ds_read_b64_tr_b16 a[196:197], v19 offset:0
ds_read_b64_tr_b16 a[198:199], v19 offset:512
s_add_u32 m0, s64, 73728
ds_read_b128 a[32:35], v37 offset:16384
v_exp_f32_e64 v1, -v56
v_mfma_f32_32x32x16_bf16 v[96:111], a[236:239], v[148:151], v[96:111]
ds_read_b64_tr_b16 a[200:201], v16 offset:1024
ds_read_b64_tr_b16 a[202:203], v16 offset:1536
s_add_u32 s65, s61, 512
v_exp_f32_e64 v2, -v57
s_waitcnt lgkmcnt(7)
v_mfma_f32_32x32x16_bf16 v[80:95], a[240:243], v[152:155], v[80:95]
ds_read_b64_tr_b16 a[204:205], v19 offset:1024
ds_read_b64_tr_b16 a[206:207], v19 offset:1536
ds_read_b128 a[36:39], v37 offset:17408
v_exp_f32_e64 v3, -v58
v_add_f32 v1, 1.0, v1
v_mfma_f32_32x32x16_bf16 v[96:111], a[244:247], v[152:155], v[96:111]
ds_read_b64_tr_b16 a[208:209], v16 offset:2048
ds_read_b64_tr_b16 a[210:211], v16 offset:2560
buffer_load_dwordx4 v28, s[16:19], s65 offen offset:0 lds
v_add_f32_e64 v2, 1.0, v2
v_exp_f32_e64 v4, -v59
v_mfma_f32_32x32x16_bf16 v[80:95], a[248:251], v[156:159], v[80:95]
ds_read_b64_tr_b16 a[212:213], v19 offset:2048
ds_read_b64_tr_b16 a[214:215], v19 offset:2560
ds_read_b128 a[40:43], v37 offset:18432
v_add_f32 v3, 1.0, v3
v_rcp_f32 v1, v1
v_mfma_f32_32x32x16_bf16 v[96:111], a[252:255], v[156:159], v[96:111]
ds_read_b64_tr_b16 a[216:217], v16 offset:3072
ds_read_b64_tr_b16 a[218:219], v16 offset:3584
v_add_f32 v4, 1.0, v4
v_rcp_f32 v2, v2
v_mul_f32 v1, v56, v1
s_waitcnt lgkmcnt(8)
v_mfma_f32_32x32x16_bf16 v[80:95], a[192:195], v[160:163], v[80:95]
ds_read_b64_tr_b16 a[220:221], v19 offset:3072
ds_read_b64_tr_b16 a[222:223], v19 offset:3584
buffer_load_dwordx4 v29, s[16:19], s65 offen offset:1024 lds
ds_read_b128 a[44:47], v37 offset:19456
v_mfma_f32_32x32x16_bf16 v[96:111], a[196:199], v[160:163], v[96:111]
ds_read_b64_tr_b16 a[224:225], v16 offset:8192
ds_read_b64_tr_b16 a[226:227], v16 offset:8704
v_rcp_f32 v3, v3
v_mul_f32 v2, v57, v2
v_rcp_f32_e64 v4, v4
v_mfma_f32_32x32x16_bf16 v[80:95], a[200:203], v[164:167], v[80:95]
ds_read_b64_tr_b16 a[228:229], v19 offset:8192
ds_read_b64_tr_b16 a[230:231], v19 offset:8704
ds_read_b128 a[48:51], v37 offset:24576
v_mul_f32_e64 v3, v58, v3
v_cvt_pk_bf16_f32 v10, v1, v2
v_mul_f32_e64 v4, v59, v4
v_mfma_f32_32x32x16_bf16 v[96:111], a[204:207], v[164:167], v[96:111]
ds_read_b64_tr_b16 a[232:233], v16 offset:9216
ds_read_b64_tr_b16 a[234:235], v16 offset:9728
buffer_load_dwordx4 v30, s[16:19], s65 offen offset:2048 lds
v_cvt_pk_bf16_f32 v11, v3, v4
s_waitcnt lgkmcnt(8)
v_mfma_f32_32x32x16_bf16 v[80:95], a[208:211], v[168:171], v[80:95]
ds_read_b64_tr_b16 a[236:237], v19 offset:9216
ds_read_b64_tr_b16 a[238:239], v19 offset:9728
ds_read_b128 a[52:55], v37 offset:25600
ds_write_b128 v36, v[8:11] offset:0
v_mfma_f32_32x32x16_bf16 v[96:111], a[212:215], v[168:171], v[96:111]
ds_read_b64_tr_b16 a[240:241], v16 offset:10240
ds_read_b64_tr_b16 a[242:243], v16 offset:10752
v_exp_f32_e64 v5, -v60
v_exp_f32_e64 v6, -v61
v_mfma_f32_32x32x16_bf16 v[80:95], a[216:219], v[172:175], v[80:95]
ds_read_b64_tr_b16 a[244:245], v19 offset:10240
ds_read_b64_tr_b16 a[246:247], v19 offset:10752
buffer_load_dwordx4 v31, s[16:19], s65 offen offset:3072 lds
ds_read_b128 a[56:59], v37 offset:26624
v_exp_f32_e64 v7, -v62
v_mfma_f32_32x32x16_bf16 v[96:111], a[220:223], v[172:175], v[96:111]
ds_read_b64_tr_b16 a[248:249], v16 offset:11264
ds_read_b64_tr_b16 a[250:251], v16 offset:11776
v_add_f32 v5, 1.0, v5
v_add_f32 v6, 1.0, v6
s_waitcnt lgkmcnt(9)
v_mfma_f32_32x32x16_bf16 v[80:95], a[224:227], v[176:179], v[80:95]
ds_read_b64_tr_b16 a[252:253], v19 offset:11264
ds_read_b64_tr_b16 a[254:255], v19 offset:11776
ds_read_b128 a[60:63], v37 offset:27648
v_exp_f32_e64 v46, -v63
v_add_f32_e64 v7, 1.0, v7
v_mfma_f32_32x32x16_bf16 v[96:111], a[228:231], v[176:179], v[96:111]
ds_read_b64_tr_b16 a[192:193], v16 offset:16384
ds_read_b64_tr_b16 a[194:195], v16 offset:16896
s_add_u32 m0, s64, 77824
v_rcp_f32 v5, v5
v_add_f32 v46, 1.0, v46
v_mfma_f32_32x32x16_bf16 v[80:95], a[232:235], v[180:183], v[80:95]
ds_read_b64_tr_b16 a[196:197], v19 offset:16384
ds_read_b64_tr_b16 a[198:199], v19 offset:16896
buffer_load_dwordx4 v42, s[16:19], s65 offen offset:0 lds
v_rcp_f32 v6, v6
v_mul_f32 v5, v60, v5
v_mfma_f32_32x32x16_bf16 v[96:111], a[236:239], v[180:183], v[96:111]
ds_read_b64_tr_b16 a[200:201], v16 offset:17408
ds_read_b64_tr_b16 a[202:203], v16 offset:17920
v_rcp_f32 v7, v7
v_mul_f32_e64 v6, v61, v6
s_waitcnt lgkmcnt(7)
v_mfma_f32_32x32x16_bf16 v[80:95], a[240:243], v[184:187], v[80:95]
ds_read_b64_tr_b16 a[204:205], v19 offset:17408
ds_read_b64_tr_b16 a[206:207], v19 offset:17920
v_rcp_f32 v46, v46
v_mul_f32 v7, v62, v7
v_cvt_pk_bf16_f32 v14, v5, v6
v_mul_f32_e64 v46, v63, v46
v_mfma_f32_32x32x16_bf16 v[96:111], a[244:247], v[184:187], v[96:111]
ds_read_b64_tr_b16 a[208:209], v16 offset:18432
ds_read_b64_tr_b16 a[210:211], v16 offset:18944
buffer_load_dwordx4 v43, s[16:19], s65 offen offset:1024 lds
v_cvt_pk_bf16_f32 v15, v7, v46
v_mfma_f32_32x32x16_bf16 v[80:95], a[248:251], v[188:191], v[80:95]
ds_read_b64_tr_b16 a[212:213], v19 offset:18432
ds_read_b64_tr_b16 a[214:215], v19 offset:18944
ds_write_b128 v36, v[12:15] offset:512
v_mfma_f32_32x32x16_bf16 v[96:111], a[252:255], v[188:191], v[96:111]
ds_read_b64_tr_b16 a[216:217], v16 offset:19456
ds_read_b64_tr_b16 a[218:219], v16 offset:19968
v_exp_f32_e64 v1, -v64
v_exp_f32_e64 v2, -v65
s_waitcnt lgkmcnt(7)
v_mfma_f32_32x32x16_bf16 v[80:95], a[192:195], v[192:195], v[80:95]
ds_read_b64_tr_b16 a[220:221], v19 offset:19456
ds_read_b64_tr_b16 a[222:223], v19 offset:19968
v_exp_f32_e64 v3, -v66
v_add_f32 v1, 1.0, v1
v_add_f32_e64 v2, 1.0, v2
v_mfma_f32_32x32x16_bf16 v[96:111], a[196:199], v[192:195], v[96:111]
s_waitcnt vmcnt(12)
s_barrier
ds_read_b64_tr_b16 a[224:225], v16 offset:24576
ds_read_b64_tr_b16 a[226:227], v16 offset:25088
v_exp_f32_e64 v4, -v67
v_add_f32_e64 v3, 1.0, v3
v_mfma_f32_32x32x16_bf16 v[80:95], a[200:203], v[196:199], v[80:95]
ds_read_b64_tr_b16 a[228:229], v19 offset:24576
ds_read_b64_tr_b16 a[230:231], v19 offset:25088
s_add_u32 m0, s64, 98304
v_rcp_f32 v1, v1
v_add_f32 v4, 1.0, v4
v_mfma_f32_32x32x16_bf16 v[96:111], a[204:207], v[196:199], v[96:111]
ds_read_b64_tr_b16 a[232:233], v16 offset:25600
ds_read_b64_tr_b16 a[234:235], v16 offset:26112
s_add_u32 s65, s62, 512
v_rcp_f32 v2, v2
v_mul_f32_e64 v1, v64, v1
s_waitcnt lgkmcnt(6)
v_mfma_f32_32x32x16_bf16 v[80:95], a[208:211], v[200:203], v[80:95]
ds_read_b64_tr_b16 a[236:237], v19 offset:25600
ds_read_b64_tr_b16 a[238:239], v19 offset:26112
v_rcp_f32 v3, v3
v_mul_f32 v2, v65, v2
v_mfma_f32_32x32x16_bf16 v[96:111], a[212:215], v[200:203], v[96:111]
ds_read_b64_tr_b16 a[240:241], v16 offset:26624
ds_read_b64_tr_b16 a[242:243], v16 offset:27136
buffer_load_dwordx4 v28, s[16:19], s65 offen offset:0 lds
v_rcp_f32 v4, v4
v_mul_f32 v3, v66, v3
v_mfma_f32_32x32x16_bf16 v[80:95], a[216:219], v[204:207], v[80:95]
ds_read_b64_tr_b16 a[244:245], v19 offset:26624
ds_read_b64_tr_b16 a[246:247], v19 offset:27136
v_cvt_pk_bf16_f32 v8, v1, v2
v_mul_f32_e64 v4, v67, v4
v_cvt_pk_bf16_f32 v9, v3, v4
v_exp_f32_e64 v5, -v68
v_mfma_f32_32x32x16_bf16 v[96:111], a[220:223], v[204:207], v[96:111]
ds_read_b64_tr_b16 a[248:249], v16 offset:27648
ds_read_b64_tr_b16 a[250:251], v16 offset:28160
v_exp_f32_e64 v6, -v69
s_waitcnt lgkmcnt(6)
v_mfma_f32_32x32x16_bf16 v[80:95], a[224:227], v[208:211], v[80:95]
ds_read_b64_tr_b16 a[252:253], v19 offset:27648
ds_read_b64_tr_b16 a[254:255], v19 offset:28160
buffer_load_dwordx4 v29, s[16:19], s65 offen offset:1024 lds
v_exp_f32_e64 v7, -v70
v_add_f32 v5, 1.0, v5
v_mfma_f32_32x32x16_bf16 v[96:111], a[228:231], v[208:211], v[96:111]
ds_read_b64_tr_b16 a[192:193], v16 offset:32768
ds_read_b64_tr_b16 a[194:195], v16 offset:33280
v_add_f32_e64 v6, 1.0, v6
v_exp_f32_e64 v46, -v71
v_add_f32_e64 v7, 1.0, v7
v_mfma_f32_32x32x16_bf16 v[80:95], a[232:235], v[212:215], v[80:95]
ds_read_b64_tr_b16 a[196:197], v19 offset:32768
ds_read_b64_tr_b16 a[198:199], v19 offset:33280
v_rcp_f32 v5, v5
v_add_f32 v46, 1.0, v46
v_rcp_f32_e64 v6, v6
v_mfma_f32_32x32x16_bf16 v[96:111], a[236:239], v[212:215], v[96:111]
ds_read_b64_tr_b16 a[200:201], v16 offset:33792
ds_read_b64_tr_b16 a[202:203], v16 offset:34304
buffer_load_dwordx4 v30, s[16:19], s65 offen offset:2048 lds
v_mul_f32 v5, v68, v5
s_waitcnt lgkmcnt(6)
v_mfma_f32_32x32x16_bf16 v[80:95], a[240:243], v[216:219], v[80:95]
ds_read_b64_tr_b16 a[204:205], v19 offset:33792
ds_read_b64_tr_b16 a[206:207], v19 offset:34304
v_rcp_f32 v7, v7
v_mul_f32 v6, v69, v6
v_rcp_f32_e64 v46, v46
v_mfma_f32_32x32x16_bf16 v[96:111], a[244:247], v[216:219], v[96:111]
ds_read_b64_tr_b16 a[208:209], v16 offset:34816
ds_read_b64_tr_b16 a[210:211], v16 offset:35328
v_mul_f32_e64 v7, v70, v7
v_cvt_pk_bf16_f32 v12, v5, v6
v_mul_f32_e64 v46, v71, v46
v_cvt_pk_bf16_f32 v13, v7, v46
v_mfma_f32_32x32x16_bf16 v[80:95], a[248:251], v[220:223], v[80:95]
ds_read_b64_tr_b16 a[212:213], v19 offset:34816
ds_read_b64_tr_b16 a[214:215], v19 offset:35328
buffer_load_dwordx4 v31, s[16:19], s65 offen offset:3072 lds
v_exp_f32_e64 v1, -v72
v_mfma_f32_32x32x16_bf16 v[96:111], a[252:255], v[220:223], v[96:111]
ds_read_b64_tr_b16 a[216:217], v16 offset:35840
ds_read_b64_tr_b16 a[218:219], v16 offset:36352
v_exp_f32_e64 v2, -v73
v_exp_f32_e64 v3, -v74
s_waitcnt lgkmcnt(6)
v_mfma_f32_32x32x16_bf16 v[80:95], a[192:195], v[224:227], v[80:95]
ds_read_b64_tr_b16 a[220:221], v19 offset:35840
ds_read_b64_tr_b16 a[222:223], v19 offset:36352
v_add_f32 v1, 1.0, v1
v_add_f32_e64 v2, 1.0, v2
v_exp_f32_e64 v4, -v75
v_mfma_f32_32x32x16_bf16 v[96:111], a[196:199], v[224:227], v[96:111]
ds_read_b64_tr_b16 a[224:225], v16 offset:40960
ds_read_b64_tr_b16 a[226:227], v16 offset:41472
s_add_u32 m0, s64, 102400
v_add_f32 v3, 1.0, v3
v_rcp_f32 v1, v1
v_add_f32_e64 v4, 1.0, v4
v_mfma_f32_32x32x16_bf16 v[80:95], a[200:203], v[228:231], v[80:95]
ds_read_b64_tr_b16 a[228:229], v19 offset:40960
ds_read_b64_tr_b16 a[230:231], v19 offset:41472
buffer_load_dwordx4 v42, s[16:19], s65 offen offset:0 lds
v_rcp_f32_e64 v2, v2
v_mfma_f32_32x32x16_bf16 v[96:111], a[204:207], v[228:231], v[96:111]
ds_read_b64_tr_b16 a[232:233], v16 offset:41984
ds_read_b64_tr_b16 a[234:235], v16 offset:42496
v_mul_f32 v1, v72, v1
v_rcp_f32 v3, v3
v_mul_f32 v2, v73, v2
s_waitcnt lgkmcnt(6)
v_mfma_f32_32x32x16_bf16 v[80:95], a[208:211], v[232:235], v[80:95]
ds_read_b64_tr_b16 a[236:237], v19 offset:41984
ds_read_b64_tr_b16 a[238:239], v19 offset:42496
v_rcp_f32 v4, v4
v_mul_f32 v3, v74, v3
v_cvt_pk_bf16_f32 v10, v1, v2
v_mfma_f32_32x32x16_bf16 v[96:111], a[212:215], v[232:235], v[96:111]
ds_read_b64_tr_b16 a[240:241], v16 offset:43008
ds_read_b64_tr_b16 a[242:243], v16 offset:43520
buffer_load_dwordx4 v43, s[16:19], s65 offen offset:1024 lds
v_mul_f32_e64 v4, v75, v4
v_cvt_pk_bf16_f32 v11, v3, v4
v_mfma_f32_32x32x16_bf16 v[80:95], a[216:219], v[236:239], v[80:95]
ds_read_b64_tr_b16 a[244:245], v19 offset:43008
ds_read_b64_tr_b16 a[246:247], v19 offset:43520
ds_write_b128 v36, v[8:11] offset:8192
v_mfma_f32_32x32x16_bf16 v[96:111], a[220:223], v[236:239], v[96:111]
ds_read_b64_tr_b16 a[248:249], v16 offset:44032
ds_read_b64_tr_b16 a[250:251], v16 offset:44544
v_exp_f32_e64 v5, -v76
v_exp_f32_e64 v6, -v77
s_waitcnt lgkmcnt(7)
v_mfma_f32_32x32x16_bf16 v[80:95], a[224:227], v[240:243], v[80:95]
ds_read_b64_tr_b16 a[252:253], v19 offset:44032
ds_read_b64_tr_b16 a[254:255], v19 offset:44544
v_exp_f32_e64 v7, -v78
v_add_f32 v5, 1.0, v5
v_add_f32_e64 v6, 1.0, v6
v_mfma_f32_32x32x16_bf16 v[96:111], a[228:231], v[240:243], v[96:111]
s_waitcnt vmcnt(12)
s_barrier
ds_read_b64_tr_b16 a[192:193], v17 offset:0
ds_read_b64_tr_b16 a[194:195], v17 offset:512
v_exp_f32_e64 v46, -v79
v_mfma_f32_32x32x16_bf16 v[80:95], a[232:235], v[244:247], v[80:95]
ds_read_b64_tr_b16 a[196:197], v20 offset:0
ds_read_b64_tr_b16 a[198:199], v20 offset:512
s_add_u32 m0, s64, 0
v_add_f32 v7, 1.0, v7
v_rcp_f32 v5, v5
v_add_f32 v46, 1.0, v46
v_mfma_f32_32x32x16_bf16 v[96:111], a[236:239], v[244:247], v[96:111]
ds_read_b64_tr_b16 a[200:201], v17 offset:1024
ds_read_b64_tr_b16 a[202:203], v17 offset:1536
s_add_u32 s65, s60, 640
v_rcp_f32 v6, v6
s_waitcnt lgkmcnt(6)
v_mfma_f32_32x32x16_bf16 v[80:95], a[240:243], v[248:251], v[80:95]
ds_read_b64_tr_b16 a[204:205], v20 offset:1024
ds_read_b64_tr_b16 a[206:207], v20 offset:1536
v_mul_f32 v5, v76, v5
v_rcp_f32 v7, v7
v_mul_f32_e64 v6, v77, v6
v_mfma_f32_32x32x16_bf16 v[96:111], a[244:247], v[248:251], v[96:111]
ds_read_b64_tr_b16 a[208:209], v17 offset:2048
ds_read_b64_tr_b16 a[210:211], v17 offset:2560
buffer_load_dwordx4 v28, s[16:19], s65 offen offset:0 lds
v_rcp_f32_e64 v46, v46
v_mfma_f32_32x32x16_bf16 v[80:95], a[248:251], v[252:255], v[80:95]
ds_read_b64_tr_b16 a[212:213], v20 offset:2048
ds_read_b64_tr_b16 a[214:215], v20 offset:2560
v_mul_f32_e64 v7, v78, v7
v_cvt_pk_bf16_f32 v14, v5, v6
v_mul_f32_e64 v46, v79, v46
v_cvt_pk_bf16_f32 v15, v7, v46
v_mfma_f32_32x32x16_bf16 v[96:111], a[252:255], v[252:255], v[96:111]
ds_read_b64_tr_b16 a[216:217], v17 offset:3072
ds_read_b64_tr_b16 a[218:219], v17 offset:3584
ds_write_b128 v36, v[12:15] offset:8704
s_waitcnt lgkmcnt(7)
v_mfma_f32_32x32x16_bf16 v[48:63], a[192:195], v[112:115], 0
ds_read_b64_tr_b16 a[220:221], v20 offset:3072
ds_read_b64_tr_b16 a[222:223], v20 offset:3584
buffer_load_dwordx4 v29, s[16:19], s65 offen offset:1024 lds
v_mfma_f32_32x32x16_bf16 v[64:79], a[196:199], v[112:115], 0
ds_read_b64_tr_b16 a[224:225], v17 offset:8192
ds_read_b64_tr_b16 a[226:227], v17 offset:8704
v_mfma_f32_32x32x16_bf16 v[48:63], a[200:203], v[116:119], v[48:63]
ds_read_b64_tr_b16 a[228:229], v20 offset:8192
ds_read_b64_tr_b16 a[230:231], v20 offset:8704
v_exp_f32_e64 v1, -v80
v_exp_f32_e64 v2, -v81
v_mfma_f32_32x32x16_bf16 v[64:79], a[204:207], v[116:119], v[64:79]
ds_read_b64_tr_b16 a[232:233], v17 offset:9216
ds_read_b64_tr_b16 a[234:235], v17 offset:9728
buffer_load_dwordx4 v30, s[16:19], s65 offen offset:2048 lds
v_exp_f32_e64 v3, -v82
s_waitcnt lgkmcnt(6)
v_mfma_f32_32x32x16_bf16 v[48:63], a[208:211], v[120:123], v[48:63]
ds_read_b64_tr_b16 a[236:237], v20 offset:9216
ds_read_b64_tr_b16 a[238:239], v20 offset:9728
v_add_f32 v1, 1.0, v1
v_add_f32 v2, 1.0, v2
v_exp_f32_e64 v4, -v83
v_mfma_f32_32x32x16_bf16 v[64:79], a[212:215], v[120:123], v[64:79]
ds_read_b64_tr_b16 a[240:241], v17 offset:10240
ds_read_b64_tr_b16 a[242:243], v17 offset:10752
v_add_f32 v3, 1.0, v3
v_rcp_f32 v1, v1
v_add_f32_e64 v4, 1.0, v4
v_mfma_f32_32x32x16_bf16 v[48:63], a[216:219], v[124:127], v[48:63]
ds_read_b64_tr_b16 a[244:245], v20 offset:10240
ds_read_b64_tr_b16 a[246:247], v20 offset:10752
buffer_load_dwordx4 v31, s[16:19], s65 offen offset:3072 lds
v_rcp_f32 v2, v2
v_mul_f32 v1, v80, v1
v_mfma_f32_32x32x16_bf16 v[64:79], a[220:223], v[124:127], v[64:79]
ds_read_b64_tr_b16 a[248:249], v17 offset:11264
ds_read_b64_tr_b16 a[250:251], v17 offset:11776
v_rcp_f32 v3, v3
v_mul_f32_e64 v2, v81, v2
s_waitcnt lgkmcnt(6)
v_mfma_f32_32x32x16_bf16 v[48:63], a[224:227], v[128:131], v[48:63]
ds_read_b64_tr_b16 a[252:253], v20 offset:11264
ds_read_b64_tr_b16 a[254:255], v20 offset:11776
v_rcp_f32 v4, v4
v_mul_f32 v3, v82, v3
v_cvt_pk_bf16_f32 v8, v1, v2
v_mul_f32_e64 v4, v83, v4
v_mfma_f32_32x32x16_bf16 v[64:79], a[228:231], v[128:131], v[64:79]
ds_read_b64_tr_b16 a[192:193], v17 offset:16384
ds_read_b64_tr_b16 a[194:195], v17 offset:16896
s_add_u32 m0, s64, 4096
v_cvt_pk_bf16_f32 v9, v3, v4
v_exp_f32_e64 v5, -v84
v_mfma_f32_32x32x16_bf16 v[48:63], a[232:235], v[132:135], v[48:63]
ds_read_b64_tr_b16 a[196:197], v20 offset:16384
ds_read_b64_tr_b16 a[198:199], v20 offset:16896
buffer_load_dwordx4 v42, s[16:19], s65 offen offset:0 lds
v_exp_f32_e64 v6, -v85
v_mfma_f32_32x32x16_bf16 v[64:79], a[236:239], v[132:135], v[64:79]
ds_read_b64_tr_b16 a[200:201], v17 offset:17408
ds_read_b64_tr_b16 a[202:203], v17 offset:17920
v_exp_f32_e64 v7, -v86
v_add_f32 v5, 1.0, v5
v_add_f32_e64 v6, 1.0, v6
s_waitcnt lgkmcnt(6)
v_mfma_f32_32x32x16_bf16 v[48:63], a[240:243], v[136:139], v[48:63]
ds_read_b64_tr_b16 a[204:205], v20 offset:17408
ds_read_b64_tr_b16 a[206:207], v20 offset:17920
v_exp_f32_e64 v46, -v87
v_add_f32 v7, 1.0, v7
v_rcp_f32 v5, v5
v_mfma_f32_32x32x16_bf16 v[64:79], a[244:247], v[136:139], v[64:79]
ds_read_b64_tr_b16 a[208:209], v17 offset:18432
ds_read_b64_tr_b16 a[210:211], v17 offset:18944
buffer_load_dwordx4 v43, s[16:19], s65 offen offset:1024 lds
v_add_f32_e64 v46, 1.0, v46
v_mfma_f32_32x32x16_bf16 v[48:63], a[248:251], v[140:143], v[48:63]
ds_read_b64_tr_b16 a[212:213], v20 offset:18432
ds_read_b64_tr_b16 a[214:215], v20 offset:18944
v_rcp_f32 v6, v6
v_mul_f32 v5, v84, v5
v_rcp_f32_e64 v7, v7
v_mfma_f32_32x32x16_bf16 v[64:79], a[252:255], v[140:143], v[64:79]
ds_read_b64_tr_b16 a[216:217], v17 offset:19456
ds_read_b64_tr_b16 a[218:219], v17 offset:19968
v_mul_f32 v6, v85, v6
v_rcp_f32 v46, v46
v_mul_f32 v7, v86, v7
s_waitcnt lgkmcnt(6)
v_mfma_f32_32x32x16_bf16 v[48:63], a[192:195], v[144:147], v[48:63]
ds_read_b64_tr_b16 a[220:221], v20 offset:19456
ds_read_b64_tr_b16 a[222:223], v20 offset:19968
v_cvt_pk_bf16_f32 v12, v5, v6
v_mul_f32_e64 v46, v87, v46
v_cvt_pk_bf16_f32 v13, v7, v46
v_mfma_f32_32x32x16_bf16 v[64:79], a[196:199], v[144:147], v[64:79]
s_waitcnt vmcnt(12) lgkmcnt(15)
s_barrier
ds_read_b64_tr_b16 a[224:225], v17 offset:24576
ds_read_b64_tr_b16 a[226:227], v17 offset:25088
v_exp_f32_e64 v1, -v88
v_mfma_f32_32x32x16_bf16 v[48:63], a[200:203], v[148:151], v[48:63]
ds_read_b64_tr_b16 a[228:229], v20 offset:24576
ds_read_b64_tr_b16 a[230:231], v20 offset:25088
s_add_u32 m0, s64, 24576
ds_read_b128 a[64:67], v37 offset:0
v_exp_f32_e64 v2, -v89
v_mfma_f32_32x32x16_bf16 v[64:79], a[204:207], v[148:151], v[64:79]
ds_read_b64_tr_b16 a[232:233], v17 offset:25600
ds_read_b64_tr_b16 a[234:235], v17 offset:26112
s_add_u32 s65, s61, 640
v_exp_f32_e64 v3, -v90
s_waitcnt lgkmcnt(7)
v_mfma_f32_32x32x16_bf16 v[48:63], a[208:211], v[152:155], v[48:63]
ds_read_b64_tr_b16 a[236:237], v20 offset:25600
ds_read_b64_tr_b16 a[238:239], v20 offset:26112
ds_read_b128 a[68:71], v37 offset:1024
v_add_f32 v1, 1.0, v1
v_add_f32_e64 v2, 1.0, v2
v_exp_f32_e64 v4, -v91
v_mfma_f32_32x32x16_bf16 v[64:79], a[212:215], v[152:155], v[64:79]
ds_read_b64_tr_b16 a[240:241], v17 offset:26624
ds_read_b64_tr_b16 a[242:243], v17 offset:27136
buffer_load_dwordx4 v28, s[16:19], s65 offen offset:0 lds
v_add_f32 v3, 1.0, v3
v_rcp_f32 v1, v1
v_mfma_f32_32x32x16_bf16 v[48:63], a[216:219], v[156:159], v[48:63]
ds_read_b64_tr_b16 a[244:245], v20 offset:26624
ds_read_b64_tr_b16 a[246:247], v20 offset:27136
ds_read_b128 a[72:75], v37 offset:2048
v_add_f32 v4, 1.0, v4
v_rcp_f32 v2, v2
v_mfma_f32_32x32x16_bf16 v[64:79], a[220:223], v[156:159], v[64:79]
ds_read_b64_tr_b16 a[248:249], v17 offset:27648
ds_read_b64_tr_b16 a[250:251], v17 offset:28160
v_mul_f32 v1, v88, v1
v_rcp_f32 v3, v3
v_mul_f32 v2, v89, v2
s_waitcnt lgkmcnt(8)
v_mfma_f32_32x32x16_bf16 v[48:63], a[224:227], v[160:163], v[48:63]
ds_read_b64_tr_b16 a[252:253], v20 offset:27648
ds_read_b64_tr_b16 a[254:255], v20 offset:28160
buffer_load_dwordx4 v29, s[16:19], s65 offen offset:1024 lds
ds_read_b128 a[76:79], v37 offset:3072
v_rcp_f32_e64 v4, v4
v_mfma_f32_32x32x16_bf16 v[64:79], a[228:231], v[160:163], v[64:79]
ds_read_b64_tr_b16 a[192:193], v17 offset:32768
ds_read_b64_tr_b16 a[194:195], v17 offset:33280
v_mul_f32_e64 v3, v90, v3
v_cvt_pk_bf16_f32 v10, v1, v2
v_mul_f32_e64 v4, v91, v4
v_cvt_pk_bf16_f32 v11, v3, v4
v_mfma_f32_32x32x16_bf16 v[48:63], a[232:235], v[164:167], v[48:63]
ds_read_b64_tr_b16 a[196:197], v20 offset:32768
ds_read_b64_tr_b16 a[198:199], v20 offset:33280
ds_read_b128 a[80:83], v37 offset:8192
ds_write_b128 v36, v[8:11] offset:16384
v_mfma_f32_32x32x16_bf16 v[64:79], a[236:239], v[164:167], v[64:79]
ds_read_b64_tr_b16 a[200:201], v17 offset:33792
ds_read_b64_tr_b16 a[202:203], v17 offset:34304
buffer_load_dwordx4 v30, s[16:19], s65 offen offset:2048 lds
v_exp_f32_e64 v5, -v92
s_waitcnt lgkmcnt(9)
v_mfma_f32_32x32x16_bf16 v[48:63], a[240:243], v[168:171], v[48:63]
ds_read_b64_tr_b16 a[204:205], v20 offset:33792
ds_read_b64_tr_b16 a[206:207], v20 offset:34304
ds_read_b128 a[84:87], v37 offset:9216
v_exp_f32_e64 v6, -v93
v_mfma_f32_32x32x16_bf16 v[64:79], a[244:247], v[168:171], v[64:79]
ds_read_b64_tr_b16 a[208:209], v17 offset:34816
ds_read_b64_tr_b16 a[210:211], v17 offset:35328
v_exp_f32_e64 v7, -v94
v_add_f32 v5, 1.0, v5
v_add_f32_e64 v6, 1.0, v6
v_mfma_f32_32x32x16_bf16 v[48:63], a[248:251], v[172:175], v[48:63]
ds_read_b64_tr_b16 a[212:213], v20 offset:34816
ds_read_b64_tr_b16 a[214:215], v20 offset:35328
buffer_load_dwordx4 v31, s[16:19], s65 offen offset:3072 lds
ds_read_b128 a[88:91], v37 offset:10240
v_exp_f32_e64 v46, -v95
v_mfma_f32_32x32x16_bf16 v[64:79], a[252:255], v[172:175], v[64:79]
ds_read_b64_tr_b16 a[216:217], v17 offset:35840
ds_read_b64_tr_b16 a[218:219], v17 offset:36352
v_add_f32 v7, 1.0, v7
v_rcp_f32_e64 v5, v5
s_waitcnt lgkmcnt(8)
v_mfma_f32_32x32x16_bf16 v[48:63], a[192:195], v[176:179], v[48:63]
ds_read_b64_tr_b16 a[220:221], v20 offset:35840
ds_read_b64_tr_b16 a[222:223], v20 offset:36352
ds_read_b128 a[92:95], v37 offset:11264
v_add_f32 v46, 1.0, v46
v_rcp_f32 v6, v6
v_mul_f32_e64 v5, v92, v5
v_mfma_f32_32x32x16_bf16 v[64:79], a[196:199], v[176:179], v[64:79]
ds_read_b64_tr_b16 a[224:225], v17 offset:40960
ds_read_b64_tr_b16 a[226:227], v17 offset:41472
s_add_u32 m0, s64, 28672
v_rcp_f32 v7, v7
v_mul_f32 v6, v93, v6
v_mfma_f32_32x32x16_bf16 v[48:63], a[200:203], v[180:183], v[48:63]
ds_read_b64_tr_b16 a[228:229], v20 offset:40960
ds_read_b64_tr_b16 a[230:231], v20 offset:41472
buffer_load_dwordx4 v42, s[16:19], s65 offen offset:0 lds
v_rcp_f32_e64 v46, v46
v_mfma_f32_32x32x16_bf16 v[64:79], a[204:207], v[180:183], v[64:79]
ds_read_b64_tr_b16 a[232:233], v17 offset:41984
ds_read_b64_tr_b16 a[234:235], v17 offset:42496
v_mul_f32_e64 v7, v94, v7
v_cvt_pk_bf16_f32 v14, v5, v6
v_mul_f32_e64 v46, v95, v46
v_cvt_pk_bf16_f32 v15, v7, v46
s_waitcnt lgkmcnt(7)
v_mfma_f32_32x32x16_bf16 v[48:63], a[208:211], v[184:187], v[48:63]
ds_read_b64_tr_b16 a[236:237], v20 offset:41984
ds_read_b64_tr_b16 a[238:239], v20 offset:42496
ds_write_b128 v36, v[12:15] offset:16896
v_mfma_f32_32x32x16_bf16 v[64:79], a[212:215], v[184:187], v[64:79]
ds_read_b64_tr_b16 a[240:241], v17 offset:43008
ds_read_b64_tr_b16 a[242:243], v17 offset:43520
buffer_load_dwordx4 v43, s[16:19], s65 offen offset:1024 lds
v_exp_f32_e64 v1, -v96
v_mfma_f32_32x32x16_bf16 v[48:63], a[216:219], v[188:191], v[48:63]
ds_read_b64_tr_b16 a[244:245], v20 offset:43008
ds_read_b64_tr_b16 a[246:247], v20 offset:43520
v_exp_f32_e64 v2, -v97
v_exp_f32_e64 v3, -v98
v_add_f32 v1, 1.0, v1
v_mfma_f32_32x32x16_bf16 v[64:79], a[220:223], v[188:191], v[64:79]
ds_read_b64_tr_b16 a[248:249], v17 offset:44032
ds_read_b64_tr_b16 a[250:251], v17 offset:44544
v_add_f32_e64 v2, 1.0, v2
v_exp_f32_e64 v4, -v99
s_waitcnt lgkmcnt(7)
v_mfma_f32_32x32x16_bf16 v[48:63], a[224:227], v[192:195], v[48:63]
ds_read_b64_tr_b16 a[252:253], v20 offset:44032
ds_read_b64_tr_b16 a[254:255], v20 offset:44544
v_add_f32 v3, 1.0, v3
v_rcp_f32 v1, v1
v_add_f32 v4, 1.0, v4
v_mfma_f32_32x32x16_bf16 v[64:79], a[228:231], v[192:195], v[64:79]
s_waitcnt vmcnt(12)
s_barrier
ds_read_b64_tr_b16 a[192:193], v18 offset:0
ds_read_b64_tr_b16 a[194:195], v18 offset:512
v_rcp_f32 v2, v2
v_mul_f32 v1, v96, v1
v_mfma_f32_32x32x16_bf16 v[48:63], a[232:235], v[196:199], v[48:63]
ds_read_b64_tr_b16 a[196:197], v21 offset:0
ds_read_b64_tr_b16 a[198:199], v21 offset:512
s_add_u32 m0, s64, 49152
v_rcp_f32 v3, v3
v_mul_f32 v2, v97, v2
v_mfma_f32_32x32x16_bf16 v[64:79], a[236:239], v[196:199], v[64:79]
ds_read_b64_tr_b16 a[200:201], v18 offset:1024
ds_read_b64_tr_b16 a[202:203], v18 offset:1536
s_add_u32 s65, s62, 640
v_rcp_f32 v4, v4
v_mul_f32_e64 v3, v98, v3
s_waitcnt lgkmcnt(6)
v_mfma_f32_32x32x16_bf16 v[48:63], a[240:243], v[200:203], v[48:63]
ds_read_b64_tr_b16 a[204:205], v21 offset:1024
ds_read_b64_tr_b16 a[206:207], v21 offset:1536
v_cvt_pk_bf16_f32 v8, v1, v2
v_mul_f32_e64 v4, v99, v4
v_cvt_pk_bf16_f32 v9, v3, v4
v_exp_f32_e64 v5, -v100
v_mfma_f32_32x32x16_bf16 v[64:79], a[244:247], v[200:203], v[64:79]
ds_read_b64_tr_b16 a[208:209], v18 offset:2048
ds_read_b64_tr_b16 a[210:211], v18 offset:2560
buffer_load_dwordx4 v28, s[16:19], s65 offen offset:0 lds
v_exp_f32_e64 v6, -v101
v_mfma_f32_32x32x16_bf16 v[48:63], a[248:251], v[204:207], v[48:63]
ds_read_b64_tr_b16 a[212:213], v21 offset:2048
ds_read_b64_tr_b16 a[214:215], v21 offset:2560
v_exp_f32_e64 v7, -v102
v_add_f32 v5, 1.0, v5
v_add_f32 v6, 1.0, v6
v_mfma_f32_32x32x16_bf16 v[64:79], a[252:255], v[204:207], v[64:79]
ds_read_b64_tr_b16 a[216:217], v18 offset:3072
ds_read_b64_tr_b16 a[218:219], v18 offset:3584
v_exp_f32_e64 v46, -v103
v_add_f32 v7, 1.0, v7
s_waitcnt lgkmcnt(6)
v_mfma_f32_32x32x16_bf16 v[48:63], a[192:195], v[208:211], v[48:63]
ds_read_b64_tr_b16 a[220:221], v21 offset:3072
ds_read_b64_tr_b16 a[222:223], v21 offset:3584
buffer_load_dwordx4 v29, s[16:19], s65 offen offset:1024 lds
v_rcp_f32_e64 v5, v5
v_mfma_f32_32x32x16_bf16 v[64:79], a[196:199], v[208:211], v[64:79]
ds_read_b64_tr_b16 a[224:225], v18 offset:8192
ds_read_b64_tr_b16 a[226:227], v18 offset:8704
v_add_f32 v46, 1.0, v46
v_rcp_f32 v6, v6
v_mul_f32_e64 v5, v100, v5
v_mfma_f32_32x32x16_bf16 v[48:63], a[200:203], v[212:215], v[48:63]
ds_read_b64_tr_b16 a[228:229], v21 offset:8192
ds_read_b64_tr_b16 a[230:231], v21 offset:8704
v_rcp_f32 v7, v7
v_mul_f32 v6, v101, v6
v_rcp_f32_e64 v46, v46
v_mfma_f32_32x32x16_bf16 v[64:79], a[204:207], v[212:215], v[64:79]
ds_read_b64_tr_b16 a[232:233], v18 offset:9216
ds_read_b64_tr_b16 a[234:235], v18 offset:9728
buffer_load_dwordx4 v30, s[16:19], s65 offen offset:2048 lds
v_mul_f32 v7, v102, v7
s_waitcnt lgkmcnt(6)
v_mfma_f32_32x32x16_bf16 v[48:63], a[208:211], v[216:219], v[48:63]
ds_read_b64_tr_b16 a[236:237], v21 offset:9216
ds_read_b64_tr_b16 a[238:239], v21 offset:9728
v_cvt_pk_bf16_f32 v12, v5, v6
v_mul_f32_e64 v46, v103, v46
v_cvt_pk_bf16_f32 v13, v7, v46
v_exp_f32_e64 v1, -v104
v_mfma_f32_32x32x16_bf16 v[64:79], a[212:215], v[216:219], v[64:79]
ds_read_b64_tr_b16 a[240:241], v18 offset:10240
ds_read_b64_tr_b16 a[242:243], v18 offset:10752
v_exp_f32_e64 v2, -v105
v_exp_f32_e64 v3, -v106
v_add_f32_e64 v1, 1.0, v1
v_mfma_f32_32x32x16_bf16 v[48:63], a[216:219], v[220:223], v[48:63]
ds_read_b64_tr_b16 a[244:245], v21 offset:10240
ds_read_b64_tr_b16 a[246:247], v21 offset:10752
buffer_load_dwordx4 v31, s[16:19], s65 offen offset:3072 lds
v_add_f32_e64 v2, 1.0, v2
v_mfma_f32_32x32x16_bf16 v[64:79], a[220:223], v[220:223], v[64:79]
ds_read_b64_tr_b16 a[248:249], v18 offset:11264
ds_read_b64_tr_b16 a[250:251], v18 offset:11776
v_exp_f32_e64 v4, -v107
v_add_f32 v3, 1.0, v3
s_waitcnt lgkmcnt(6)
v_mfma_f32_32x32x16_bf16 v[48:63], a[224:227], v[224:227], v[48:63]
ds_read_b64_tr_b16 a[252:253], v21 offset:11264
ds_read_b64_tr_b16 a[254:255], v21 offset:11776
v_rcp_f32 v1, v1
v_add_f32 v4, 1.0, v4
v_rcp_f32_e64 v2, v2
v_mfma_f32_32x32x16_bf16 v[64:79], a[228:231], v[224:227], v[64:79]
ds_read_b64_tr_b16 a[192:193], v18 offset:16384
ds_read_b64_tr_b16 a[194:195], v18 offset:16896
s_add_u32 m0, s64, 53248
v_mul_f32 v1, v104, v1
v_rcp_f32 v3, v3
v_mfma_f32_32x32x16_bf16 v[48:63], a[232:235], v[228:231], v[48:63]
ds_read_b64_tr_b16 a[196:197], v21 offset:16384
ds_read_b64_tr_b16 a[198:199], v21 offset:16896
buffer_load_dwordx4 v42, s[16:19], s65 offen offset:0 lds
v_mul_f32 v2, v105, v2
v_rcp_f32 v4, v4
v_mfma_f32_32x32x16_bf16 v[64:79], a[236:239], v[228:231], v[64:79]
ds_read_b64_tr_b16 a[200:201], v18 offset:17408
ds_read_b64_tr_b16 a[202:203], v18 offset:17920
v_mul_f32_e64 v3, v106, v3
v_cvt_pk_bf16_f32 v10, v1, v2
v_mul_f32_e64 v4, v107, v4
v_cvt_pk_bf16_f32 v11, v3, v4
s_waitcnt lgkmcnt(6)
v_mfma_f32_32x32x16_bf16 v[48:63], a[240:243], v[232:235], v[48:63]
ds_read_b64_tr_b16 a[204:205], v21 offset:17408
ds_read_b64_tr_b16 a[206:207], v21 offset:17920
ds_write_b128 v36, v[8:11] offset:24576
v_mfma_f32_32x32x16_bf16 v[64:79], a[244:247], v[232:235], v[64:79]
ds_read_b64_tr_b16 a[208:209], v18 offset:18432
ds_read_b64_tr_b16 a[210:211], v18 offset:18944
buffer_load_dwordx4 v43, s[16:19], s65 offen offset:1024 lds
v_exp_f32_e64 v5, -v108
v_mfma_f32_32x32x16_bf16 v[48:63], a[248:251], v[236:239], v[48:63]
ds_read_b64_tr_b16 a[212:213], v21 offset:18432
ds_read_b64_tr_b16 a[214:215], v21 offset:18944
v_exp_f32_e64 v6, -v109
v_exp_f32_e64 v7, -v110
v_add_f32 v5, 1.0, v5
v_mfma_f32_32x32x16_bf16 v[64:79], a[252:255], v[236:239], v[64:79]
ds_read_b64_tr_b16 a[216:217], v18 offset:19456
ds_read_b64_tr_b16 a[218:219], v18 offset:19968
v_add_f32_e64 v6, 1.0, v6
v_exp_f32_e64 v46, -v111
s_waitcnt lgkmcnt(7)
v_mfma_f32_32x32x16_bf16 v[48:63], a[192:195], v[240:243], v[48:63]
ds_read_b64_tr_b16 a[220:221], v21 offset:19456
ds_read_b64_tr_b16 a[222:223], v21 offset:19968
v_add_f32 v7, 1.0, v7
v_rcp_f32 v5, v5
v_add_f32 v46, 1.0, v46
v_mfma_f32_32x32x16_bf16 v[64:79], a[196:199], v[240:243], v[64:79]
s_waitcnt vmcnt(12)
s_barrier
ds_read_b64_tr_b16 a[224:225], v16 offset:0
ds_read_b64_tr_b16 a[226:227], v16 offset:512
v_rcp_f32 v6, v6
v_mul_f32 v5, v108, v5
v_mfma_f32_32x32x16_bf16 v[48:63], a[200:203], v[244:247], v[48:63]
ds_read_b64_tr_b16 a[228:229], v19 offset:0
ds_read_b64_tr_b16 a[230:231], v19 offset:512
s_add_u32 m0, s64, 73728
v_rcp_f32 v7, v7
v_mul_f32 v6, v109, v6
v_mfma_f32_32x32x16_bf16 v[64:79], a[204:207], v[244:247], v[64:79]
ds_read_b64_tr_b16 a[232:233], v16 offset:1024
ds_read_b64_tr_b16 a[234:235], v16 offset:1536
s_add_u32 s65, s40, s0
v_rcp_f32 v46, v46
v_mul_f32 v7, v110, v7
s_waitcnt lgkmcnt(6)
v_mfma_f32_32x32x16_bf16 v[48:63], a[208:211], v[248:251], v[48:63]
ds_read_b64_tr_b16 a[236:237], v19 offset:1024
ds_read_b64_tr_b16 a[238:239], v19 offset:1536
buffer_load_dwordx4 v32, s[20:23], s65 offen offset:0 lds
v_cvt_pk_bf16_f32 v14, v5, v6
v_mul_f32_e64 v46, v111, v46
v_cvt_pk_bf16_f32 v15, v7, v46
v_mfma_f32_32x32x16_bf16 v[64:79], a[212:215], v[248:251], v[64:79]
ds_read_b64_tr_b16 a[240:241], v16 offset:2048
ds_read_b64_tr_b16 a[242:243], v16 offset:2560
ds_write_b128 v36, v[12:15] offset:25088
v_mfma_f32_32x32x16_bf16 v[48:63], a[216:219], v[252:255], v[48:63]
ds_read_b64_tr_b16 a[244:245], v19 offset:2048
ds_read_b64_tr_b16 a[246:247], v19 offset:2560
v_mfma_f32_32x32x16_bf16 v[64:79], a[220:223], v[252:255], v[64:79]
ds_read_b64_tr_b16 a[248:249], v16 offset:3072
ds_read_b64_tr_b16 a[250:251], v16 offset:3584
buffer_load_dwordx4 v33, s[20:23], s65 offen offset:1024 lds
s_waitcnt lgkmcnt(7)
v_mfma_f32_32x32x16_bf16 v[80:95], a[224:227], v[112:115], 0
ds_read_b64_tr_b16 a[252:253], v19 offset:3072
ds_read_b64_tr_b16 a[254:255], v19 offset:3584
v_mfma_f32_32x32x16_bf16 v[96:111], a[228:231], v[112:115], 0
ds_read_b64_tr_b16 a[192:193], v16 offset:8192
ds_read_b64_tr_b16 a[194:195], v16 offset:8704
v_mfma_f32_32x32x16_bf16 v[80:95], a[232:235], v[116:119], v[80:95]
ds_read_b64_tr_b16 a[196:197], v19 offset:8192
ds_read_b64_tr_b16 a[198:199], v19 offset:8704
buffer_load_dwordx4 v34, s[20:23], s65 offen offset:2048 lds
v_exp_f32_e64 v1, -v48
v_mfma_f32_32x32x16_bf16 v[96:111], a[236:239], v[116:119], v[96:111]
ds_read_b64_tr_b16 a[200:201], v16 offset:9216
ds_read_b64_tr_b16 a[202:203], v16 offset:9728
v_exp_f32_e64 v2, -v49
v_exp_f32_e64 v3, -v50
s_waitcnt lgkmcnt(6)
v_mfma_f32_32x32x16_bf16 v[80:95], a[240:243], v[120:123], v[80:95]
ds_read_b64_tr_b16 a[204:205], v19 offset:9216
ds_read_b64_tr_b16 a[206:207], v19 offset:9728
v_add_f32 v1, 1.0, v1
v_add_f32 v2, 1.0, v2
v_exp_f32_e64 v4, -v51
v_mfma_f32_32x32x16_bf16 v[96:111], a[244:247], v[120:123], v[96:111]
ds_read_b64_tr_b16 a[208:209], v16 offset:10240
ds_read_b64_tr_b16 a[210:211], v16 offset:10752
buffer_load_dwordx4 v35, s[20:23], s65 offen offset:3072 lds
v_add_f32 v3, 1.0, v3
v_rcp_f32 v1, v1
v_mfma_f32_32x32x16_bf16 v[80:95], a[248:251], v[124:127], v[80:95]
ds_read_b64_tr_b16 a[212:213], v19 offset:10240
ds_read_b64_tr_b16 a[214:215], v19 offset:10752
v_add_f32 v4, 1.0, v4
v_rcp_f32 v2, v2
v_mul_f32_e64 v1, v48, v1
v_mfma_f32_32x32x16_bf16 v[96:111], a[252:255], v[124:127], v[96:111]
ds_read_b64_tr_b16 a[216:217], v16 offset:11264
ds_read_b64_tr_b16 a[218:219], v16 offset:11776
v_rcp_f32 v3, v3
v_mul_f32_e64 v2, v49, v2
s_waitcnt lgkmcnt(6)
v_mfma_f32_32x32x16_bf16 v[80:95], a[192:195], v[128:131], v[80:95]
ds_read_b64_tr_b16 a[220:221], v19 offset:11264
ds_read_b64_tr_b16 a[222:223], v19 offset:11776
s_add_u32 m0, s64, 77824
v_rcp_f32 v4, v4
v_mul_f32 v3, v50, v3
v_cvt_pk_bf16_f32 v8, v1, v2
v_mfma_f32_32x32x16_bf16 v[96:111], a[196:199], v[128:131], v[96:111]
ds_read_b64_tr_b16 a[224:225], v16 offset:16384
ds_read_b64_tr_b16 a[226:227], v16 offset:16896
s_add_u32 s65, s65, 36864
v_mul_f32_e64 v4, v51, v4
v_cvt_pk_bf16_f32 v9, v3, v4
v_exp_f32_e64 v5, -v52
v_mfma_f32_32x32x16_bf16 v[80:95], a[200:203], v[132:135], v[80:95]
ds_read_b64_tr_b16 a[228:229], v19 offset:16384
ds_read_b64_tr_b16 a[230:231], v19 offset:16896
v_exp_f32_e64 v6, -v53
v_exp_f32_e64 v7, -v54
v_mfma_f32_32x32x16_bf16 v[96:111], a[204:207], v[132:135], v[96:111]
ds_read_b64_tr_b16 a[232:233], v16 offset:17408
ds_read_b64_tr_b16 a[234:235], v16 offset:17920
buffer_load_dwordx4 v32, s[20:23], s65 offen offset:0 lds
v_add_f32 v5, 1.0, v5
v_add_f32_e64 v6, 1.0, v6
s_waitcnt lgkmcnt(6)
v_mfma_f32_32x32x16_bf16 v[80:95], a[208:211], v[136:139], v[80:95]
ds_read_b64_tr_b16 a[236:237], v19 offset:17408
ds_read_b64_tr_b16 a[238:239], v19 offset:17920
v_exp_f32_e64 v46, -v55
v_add_f32 v7, 1.0, v7
v_rcp_f32 v5, v5
v_mfma_f32_32x32x16_bf16 v[96:111], a[212:215], v[136:139], v[96:111]
ds_read_b64_tr_b16 a[240:241], v16 offset:18432
ds_read_b64_tr_b16 a[242:243], v16 offset:18944
v_add_f32 v46, 1.0, v46
v_rcp_f32 v6, v6
v_mul_f32_e64 v5, v52, v5
v_mfma_f32_32x32x16_bf16 v[80:95], a[216:219], v[140:143], v[80:95]
ds_read_b64_tr_b16 a[244:245], v19 offset:18432
ds_read_b64_tr_b16 a[246:247], v19 offset:18944
buffer_load_dwordx4 v33, s[20:23], s65 offen offset:1024 lds
v_rcp_f32 v7, v7
v_mul_f32 v6, v53, v6
v_mfma_f32_32x32x16_bf16 v[96:111], a[220:223], v[140:143], v[96:111]
ds_read_b64_tr_b16 a[248:249], v16 offset:19456
ds_read_b64_tr_b16 a[250:251], v16 offset:19968
v_rcp_f32 v46, v46
v_mul_f32 v7, v54, v7
v_cvt_pk_bf16_f32 v12, v5, v6
s_waitcnt lgkmcnt(6)
v_mfma_f32_32x32x16_bf16 v[80:95], a[224:227], v[144:147], v[80:95]
ds_read_b64_tr_b16 a[252:253], v19 offset:19456
ds_read_b64_tr_b16 a[254:255], v19 offset:19968
v_mul_f32 v46, v55, v46
v_cvt_pk_bf16_f32 v13, v7, v46
v_exp_f32_e64 v1, -v56
v_mfma_f32_32x32x16_bf16 v[96:111], a[228:231], v[144:147], v[96:111]
s_waitcnt vmcnt(12) lgkmcnt(15)
s_barrier
ds_read_b64_tr_b16 a[192:193], v16 offset:24576
ds_read_b64_tr_b16 a[194:195], v16 offset:25088
v_exp_f32_e64 v2, -v57
v_mfma_f32_32x32x16_bf16 v[80:95], a[232:235], v[148:151], v[80:95]
ds_read_b64_tr_b16 a[196:197], v19 offset:24576
ds_read_b64_tr_b16 a[198:199], v19 offset:25088
s_add_u32 m0, s64, 98304
ds_read_b128 a[96:99], v37 offset:16384
v_exp_f32_e64 v3, -v58
v_mfma_f32_32x32x16_bf16 v[96:111], a[236:239], v[148:151], v[96:111]
ds_read_b64_tr_b16 a[200:201], v16 offset:25600
ds_read_b64_tr_b16 a[202:203], v16 offset:26112
s_add_u32 s65, s41, s0
v_add_f32 v1, 1.0, v1
v_add_f32 v2, 1.0, v2
s_waitcnt lgkmcnt(7)
v_mfma_f32_32x32x16_bf16 v[80:95], a[240:243], v[152:155], v[80:95]
ds_read_b64_tr_b16 a[204:205], v19 offset:25600
ds_read_b64_tr_b16 a[206:207], v19 offset:26112
buffer_load_dwordx4 v32, s[20:23], s65 offen offset:0 lds
ds_read_b128 a[100:103], v37 offset:17408
v_exp_f32_e64 v4, -v59
v_mfma_f32_32x32x16_bf16 v[96:111], a[244:247], v[152:155], v[96:111]
ds_read_b64_tr_b16 a[208:209], v16 offset:26624
ds_read_b64_tr_b16 a[210:211], v16 offset:27136
v_add_f32 v3, 1.0, v3
v_rcp_f32 v1, v1
v_add_f32_e64 v4, 1.0, v4
v_mfma_f32_32x32x16_bf16 v[80:95], a[248:251], v[156:159], v[80:95]
ds_read_b64_tr_b16 a[212:213], v19 offset:26624
ds_read_b64_tr_b16 a[214:215], v19 offset:27136
ds_read_b128 a[104:107], v37 offset:18432
v_rcp_f32 v2, v2
v_mul_f32 v1, v56, v1
v_mfma_f32_32x32x16_bf16 v[96:111], a[252:255], v[156:159], v[96:111]
ds_read_b64_tr_b16 a[216:217], v16 offset:27648
ds_read_b64_tr_b16 a[218:219], v16 offset:28160
buffer_load_dwordx4 v33, s[20:23], s65 offen offset:1024 lds
v_rcp_f32 v3, v3
s_waitcnt lgkmcnt(8)
v_mfma_f32_32x32x16_bf16 v[80:95], a[192:195], v[160:163], v[80:95]
ds_read_b64_tr_b16 a[220:221], v19 offset:27648
ds_read_b64_tr_b16 a[222:223], v19 offset:28160
ds_read_b128 a[108:111], v37 offset:19456
v_mul_f32 v2, v57, v2
v_rcp_f32 v4, v4
v_mfma_f32_32x32x16_bf16 v[96:111], a[196:199], v[160:163], v[96:111]
ds_read_b64_tr_b16 a[224:225], v16 offset:32768
ds_read_b64_tr_b16 a[226:227], v16 offset:33280
v_mul_f32_e64 v3, v58, v3
v_cvt_pk_bf16_f32 v10, v1, v2
v_mul_f32_e64 v4, v59, v4
v_cvt_pk_bf16_f32 v11, v3, v4
v_mfma_f32_32x32x16_bf16 v[80:95], a[200:203], v[164:167], v[80:95]
ds_read_b64_tr_b16 a[228:229], v19 offset:32768
ds_read_b64_tr_b16 a[230:231], v19 offset:33280
buffer_load_dwordx4 v34, s[20:23], s65 offen offset:2048 lds
ds_read_b128 a[112:115], v37 offset:24576
v_mfma_f32_32x32x16_bf16 v[96:111], a[204:207], v[164:167], v[96:111]
ds_read_b64_tr_b16 a[232:233], v16 offset:33792
ds_read_b64_tr_b16 a[234:235], v16 offset:34304
s_waitcnt lgkmcnt(8)
v_mfma_f32_32x32x16_bf16 v[80:95], a[208:211], v[168:171], v[80:95]
ds_read_b64_tr_b16 a[236:237], v19 offset:33792
ds_read_b64_tr_b16 a[238:239], v19 offset:34304
ds_read_b128 a[116:119], v37 offset:25600
ds_write_b128 v36, v[8:11] offset:0
v_mfma_f32_32x32x16_bf16 v[96:111], a[212:215], v[168:171], v[96:111]
ds_read_b64_tr_b16 a[240:241], v16 offset:34816
ds_read_b64_tr_b16 a[242:243], v16 offset:35328
buffer_load_dwordx4 v35, s[20:23], s65 offen offset:3072 lds
v_exp_f32_e64 v5, -v60
v_mfma_f32_32x32x16_bf16 v[80:95], a[216:219], v[172:175], v[80:95]
ds_read_b64_tr_b16 a[244:245], v19 offset:34816
ds_read_b64_tr_b16 a[246:247], v19 offset:35328
ds_read_b128 a[120:123], v37 offset:26624
v_exp_f32_e64 v6, -v61
v_mfma_f32_32x32x16_bf16 v[96:111], a[220:223], v[172:175], v[96:111]
ds_read_b64_tr_b16 a[248:249], v16 offset:35840
ds_read_b64_tr_b16 a[250:251], v16 offset:36352
v_exp_f32_e64 v7, -v62
v_add_f32 v5, 1.0, v5
v_add_f32 v6, 1.0, v6
s_waitcnt lgkmcnt(9)
v_mfma_f32_32x32x16_bf16 v[80:95], a[224:227], v[176:179], v[80:95]
ds_read_b64_tr_b16 a[252:253], v19 offset:35840
ds_read_b64_tr_b16 a[254:255], v19 offset:36352
s_add_u32 m0, s64, 102400
ds_read_b128 a[124:127], v37 offset:27648
v_exp_f32_e64 v46, -v63
v_mfma_f32_32x32x16_bf16 v[96:111], a[228:231], v[176:179], v[96:111]
ds_read_b64_tr_b16 a[192:193], v16 offset:40960
ds_read_b64_tr_b16 a[194:195], v16 offset:41472
s_add_u32 s65, s65, 36864
v_add_f32 v7, 1.0, v7
v_rcp_f32 v5, v5
v_add_f32_e64 v46, 1.0, v46
v_mfma_f32_32x32x16_bf16 v[80:95], a[232:235], v[180:183], v[80:95]
ds_read_b64_tr_b16 a[196:197], v19 offset:40960
ds_read_b64_tr_b16 a[198:199], v19 offset:41472
v_rcp_f32 v6, v6
v_mul_f32 v5, v60, v5
v_rcp_f32_e64 v7, v7
v_mfma_f32_32x32x16_bf16 v[96:111], a[236:239], v[180:183], v[96:111]
ds_read_b64_tr_b16 a[200:201], v16 offset:41984
ds_read_b64_tr_b16 a[202:203], v16 offset:42496
buffer_load_dwordx4 v32, s[20:23], s65 offen offset:0 lds
v_mul_f32 v6, v61, v6
s_waitcnt lgkmcnt(7)
v_mfma_f32_32x32x16_bf16 v[80:95], a[240:243], v[184:187], v[80:95]
ds_read_b64_tr_b16 a[204:205], v19 offset:41984
ds_read_b64_tr_b16 a[206:207], v19 offset:42496
v_rcp_f32 v46, v46
v_mul_f32 v7, v62, v7
v_cvt_pk_bf16_f32 v14, v5, v6
v_mul_f32_e64 v46, v63, v46
v_mfma_f32_32x32x16_bf16 v[96:111], a[244:247], v[184:187], v[96:111]
ds_read_b64_tr_b16 a[208:209], v16 offset:43008
ds_read_b64_tr_b16 a[210:211], v16 offset:43520
v_cvt_pk_bf16_f32 v15, v7, v46
ds_write_b128 v36, v[12:15] offset:512
v_mfma_f32_32x32x16_bf16 v[80:95], a[248:251], v[188:191], v[80:95]
ds_read_b64_tr_b16 a[212:213], v19 offset:43008
ds_read_b64_tr_b16 a[214:215], v19 offset:43520
buffer_load_dwordx4 v33, s[20:23], s65 offen offset:1024 lds
v_exp_f32_e64 v1, -v64
v_mfma_f32_32x32x16_bf16 v[96:111], a[252:255], v[188:191], v[96:111]
ds_read_b64_tr_b16 a[216:217], v16 offset:44032
ds_read_b64_tr_b16 a[218:219], v16 offset:44544
v_exp_f32_e64 v2, -v65
v_exp_f32_e64 v3, -v66
s_waitcnt lgkmcnt(7)
v_mfma_f32_32x32x16_bf16 v[80:95], a[192:195], v[192:195], v[80:95]
ds_read_b64_tr_b16 a[220:221], v19 offset:44032
ds_read_b64_tr_b16 a[222:223], v19 offset:44544
v_add_f32 v1, 1.0, v1
v_add_f32_e64 v2, 1.0, v2
v_exp_f32_e64 v4, -v67
v_add_f32_e64 v3, 1.0, v3
v_mfma_f32_32x32x16_bf16 v[96:111], a[196:199], v[192:195], v[96:111]
s_waitcnt vmcnt(12)
s_barrier
ds_read_b64_tr_b16 a[224:225], v17 offset:0
ds_read_b64_tr_b16 a[226:227], v17 offset:512
v_rcp_f32_e64 v1, v1
v_mfma_f32_32x32x16_bf16 v[80:95], a[200:203], v[196:199], v[80:95]
ds_read_b64_tr_b16 a[228:229], v20 offset:0
ds_read_b64_tr_b16 a[230:231], v20 offset:512
s_add_u32 m0, s64, 0
v_add_f32 v4, 1.0, v4
v_rcp_f32 v2, v2
v_mul_f32 v1, v64, v1
v_mfma_f32_32x32x16_bf16 v[96:111], a[204:207], v[196:199], v[96:111]
ds_read_b64_tr_b16 a[232:233], v17 offset:1024
ds_read_b64_tr_b16 a[234:235], v17 offset:1536
s_add_u32 s65, s42, s0
v_rcp_f32 v3, v3
v_mul_f32 v2, v65, v2
s_waitcnt lgkmcnt(6)
v_mfma_f32_32x32x16_bf16 v[80:95], a[208:211], v[200:203], v[80:95]
ds_read_b64_tr_b16 a[236:237], v20 offset:1024
ds_read_b64_tr_b16 a[238:239], v20 offset:1536
v_rcp_f32 v4, v4
v_mul_f32 v3, v66, v3
v_cvt_pk_bf16_f32 v8, v1, v2
v_mfma_f32_32x32x16_bf16 v[96:111], a[212:215], v[200:203], v[96:111]
ds_read_b64_tr_b16 a[240:241], v17 offset:2048
ds_read_b64_tr_b16 a[242:243], v17 offset:2560
buffer_load_dwordx4 v32, s[20:23], s65 offen offset:0 lds
v_mul_f32_e64 v4, v67, v4
v_cvt_pk_bf16_f32 v9, v3, v4
v_mfma_f32_32x32x16_bf16 v[80:95], a[216:219], v[204:207], v[80:95]
ds_read_b64_tr_b16 a[244:245], v20 offset:2048
ds_read_b64_tr_b16 a[246:247], v20 offset:2560
v_exp_f32_e64 v5, -v68
v_exp_f32_e64 v6, -v69
v_mfma_f32_32x32x16_bf16 v[96:111], a[220:223], v[204:207], v[96:111]
ds_read_b64_tr_b16 a[248:249], v17 offset:3072
ds_read_b64_tr_b16 a[250:251], v17 offset:3584
v_exp_f32_e64 v7, -v70
v_add_f32 v5, 1.0, v5
v_add_f32_e64 v6, 1.0, v6
s_waitcnt lgkmcnt(6)
v_mfma_f32_32x32x16_bf16 v[80:95], a[224:227], v[208:211], v[80:95]
ds_read_b64_tr_b16 a[252:253], v20 offset:3072
ds_read_b64_tr_b16 a[254:255], v20 offset:3584
buffer_load_dwordx4 v33, s[20:23], s65 offen offset:1024 lds
v_exp_f32_e64 v46, -v71
v_add_f32_e64 v7, 1.0, v7
v_mfma_f32_32x32x16_bf16 v[96:111], a[228:231], v[208:211], v[96:111]
ds_read_b64_tr_b16 a[192:193], v17 offset:8192
ds_read_b64_tr_b16 a[194:195], v17 offset:8704
v_rcp_f32 v5, v5
v_add_f32 v46, 1.0, v46
v_mfma_f32_32x32x16_bf16 v[80:95], a[232:235], v[212:215], v[80:95]
ds_read_b64_tr_b16 a[196:197], v20 offset:8192
ds_read_b64_tr_b16 a[198:199], v20 offset:8704
v_rcp_f32 v6, v6
v_mul_f32 v5, v68, v5
v_rcp_f32_e64 v7, v7
v_mfma_f32_32x32x16_bf16 v[96:111], a[236:239], v[212:215], v[96:111]
ds_read_b64_tr_b16 a[200:201], v17 offset:9216
ds_read_b64_tr_b16 a[202:203], v17 offset:9728
buffer_load_dwordx4 v34, s[20:23], s65 offen offset:2048 lds
v_mul_f32 v6, v69, v6
s_waitcnt lgkmcnt(6)
v_mfma_f32_32x32x16_bf16 v[80:95], a[240:243], v[216:219], v[80:95]
ds_read_b64_tr_b16 a[204:205], v20 offset:9216
ds_read_b64_tr_b16 a[206:207], v20 offset:9728
v_rcp_f32 v46, v46
v_mul_f32 v7, v70, v7
v_cvt_pk_bf16_f32 v12, v5, v6
v_mfma_f32_32x32x16_bf16 v[96:111], a[244:247], v[216:219], v[96:111]
ds_read_b64_tr_b16 a[208:209], v17 offset:10240
ds_read_b64_tr_b16 a[210:211], v17 offset:10752
v_mul_f32_e64 v46, v71, v46
v_cvt_pk_bf16_f32 v13, v7, v46
v_exp_f32_e64 v1, -v72
v_mfma_f32_32x32x16_bf16 v[80:95], a[248:251], v[220:223], v[80:95]
ds_read_b64_tr_b16 a[212:213], v20 offset:10240
ds_read_b64_tr_b16 a[214:215], v20 offset:10752
buffer_load_dwordx4 v35, s[20:23], s65 offen offset:3072 lds
v_exp_f32_e64 v2, -v73
v_mfma_f32_32x32x16_bf16 v[96:111], a[252:255], v[220:223], v[96:111]
ds_read_b64_tr_b16 a[216:217], v17 offset:11264
ds_read_b64_tr_b16 a[218:219], v17 offset:11776
v_exp_f32_e64 v3, -v74
v_add_f32 v1, 1.0, v1
s_waitcnt lgkmcnt(6)
v_mfma_f32_32x32x16_bf16 v[80:95], a[192:195], v[224:227], v[80:95]
ds_read_b64_tr_b16 a[220:221], v20 offset:11264
ds_read_b64_tr_b16 a[222:223], v20 offset:11776
v_add_f32_e64 v2, 1.0, v2
v_exp_f32_e64 v4, -v75
v_add_f32_e64 v3, 1.0, v3
v_mfma_f32_32x32x16_bf16 v[96:111], a[196:199], v[224:227], v[96:111]
ds_read_b64_tr_b16 a[224:225], v17 offset:16384
ds_read_b64_tr_b16 a[226:227], v17 offset:16896
s_add_u32 m0, s64, 4096
v_rcp_f32 v1, v1
v_add_f32 v4, 1.0, v4
v_mfma_f32_32x32x16_bf16 v[80:95], a[200:203], v[228:231], v[80:95]
ds_read_b64_tr_b16 a[228:229], v20 offset:16384
ds_read_b64_tr_b16 a[230:231], v20 offset:16896
v_rcp_f32 v2, v2
v_mul_f32 v1, v72, v1
v_mfma_f32_32x32x16_bf16 v[96:111], a[204:207], v[228:231], v[96:111]
ds_read_b64_tr_b16 a[232:233], v17 offset:17408
ds_read_b64_tr_b16 a[234:235], v17 offset:17920
s_add_u32 s65, s65, 36864
v_rcp_f32 v3, v3
v_mul_f32_e64 v2, v73, v2
s_waitcnt lgkmcnt(6)
v_mfma_f32_32x32x16_bf16 v[80:95], a[208:211], v[232:235], v[80:95]
ds_read_b64_tr_b16 a[236:237], v20 offset:17408
ds_read_b64_tr_b16 a[238:239], v20 offset:17920
buffer_load_dwordx4 v32, s[20:23], s65 offen offset:0 lds
v_rcp_f32_e64 v4, v4
v_mfma_f32_32x32x16_bf16 v[96:111], a[212:215], v[232:235], v[96:111]
ds_read_b64_tr_b16 a[240:241], v17 offset:18432
ds_read_b64_tr_b16 a[242:243], v17 offset:18944
v_mul_f32_e64 v3, v74, v3
v_cvt_pk_bf16_f32 v10, v1, v2
v_mul_f32_e64 v4, v75, v4
v_cvt_pk_bf16_f32 v11, v3, v4
v_mfma_f32_32x32x16_bf16 v[80:95], a[216:219], v[236:239], v[80:95]
ds_read_b64_tr_b16 a[244:245], v20 offset:18432
ds_read_b64_tr_b16 a[246:247], v20 offset:18944
ds_write_b128 v36, v[8:11] offset:8192
v_mfma_f32_32x32x16_bf16 v[96:111], a[220:223], v[236:239], v[96:111]
ds_read_b64_tr_b16 a[248:249], v17 offset:19456
ds_read_b64_tr_b16 a[250:251], v17 offset:19968
buffer_load_dwordx4 v33, s[20:23], s65 offen offset:1024 lds
s_waitcnt lgkmcnt(7)
v_mfma_f32_32x32x16_bf16 v[80:95], a[224:227], v[240:243], v[80:95]
ds_read_b64_tr_b16 a[252:253], v20 offset:19456
ds_read_b64_tr_b16 a[254:255], v20 offset:19968
v_exp_f32_e64 v5, -v76
v_exp_f32_e64 v6, -v77
v_mfma_f32_32x32x16_bf16 v[96:111], a[228:231], v[240:243], v[96:111]
v_exp_f32_e64 v7, -v78
v_add_f32 v5, 1.0, v5
v_add_f32_e64 v6, 1.0, v6
v_exp_f32_e64 v46, -v79
v_add_f32_e64 v7, 1.0, v7
v_mfma_f32_32x32x16_bf16 v[80:95], a[232:235], v[244:247], v[80:95]
s_lshl_b32 s66, s32, 4
v_and_b32 v40, 3, v0
v_lshl_add_u32 v40, v40, 2, s66
v_rcp_f32 v5, v5
v_add_f32 v46, 1.0, v46
v_mfma_f32_32x32x16_bf16 v[96:111], a[236:239], v[244:247], v[96:111]
s_waitcnt vmcnt(12)
s_barrier
ds_read_b64_tr_b16 a[192:193], v23 offset:24576
ds_read_b64_tr_b16 a[194:195], v23 offset:26624
v_rcp_f32 v6, v6
s_waitcnt lgkmcnt(2)
v_mfma_f32_32x32x16_bf16 v[80:95], a[240:243], v[248:251], v[80:95]
s_add_u32 m0, s64, 24576
v_mul_f32 v5, v76, v5
v_rcp_f32 v7, v7
v_mul_f32 v6, v77, v6
v_rcp_f32 v46, v46
v_mfma_f32_32x32x16_bf16 v[96:111], a[244:247], v[248:251], v[96:111]
ds_read_b64_tr_b16 a[196:197], v26 offset:24576
ds_read_b64_tr_b16 a[198:199], v26 offset:26624
buffer_load_dword v41, v40, s[28:31], 0 offen sc1
v_mul_f32_e64 v7, v78, v7
v_cvt_pk_bf16_f32 v14, v5, v6
v_mfma_f32_32x32x16_bf16 v[80:95], a[248:251], v[252:255], v[80:95]
s_add_u32 s65, s40, s1
v_mul_f32 v46, v79, v46
v_cvt_pk_bf16_f32 v15, v7, v46
ds_write_b128 v36, v[12:15] offset:8704
v_mfma_f32_32x32x16_bf16 v[96:111], a[252:255], v[252:255], v[96:111]
ds_read_b64_tr_b16 a[200:201], v23 offset:28672
ds_read_b64_tr_b16 a[202:203], v23 offset:30720
s_waitcnt lgkmcnt(3)
v_mfma_f32_16x16x32_bf16 v[112:115], a[192:195], a[0:3], 0
ds_read_b64_tr_b16 a[204:205], v26 offset:28672
v_mfma_f32_16x16x32_bf16 v[120:123], a[192:195], a[4:7], 0
buffer_load_dwordx4 v32, s[20:23], s65 offen offset:0 lds
v_mfma_f32_16x16x32_bf16 v[128:131], a[192:195], a[8:11], 0
ds_read_b64_tr_b16 a[206:207], v26 offset:30720
v_mfma_f32_16x16x32_bf16 v[136:139], a[192:195], a[12:15], 0
v_mfma_f32_16x16x32_bf16 v[140:143], a[196:199], a[12:15], 0
ds_read_b64_tr_b16 a[208:209], v23 offset:32768
v_mfma_f32_16x16x32_bf16 v[132:135], a[196:199], a[8:11], 0
v_mfma_f32_16x16x32_bf16 v[124:127], a[196:199], a[4:7], 0
ds_read_b64_tr_b16 a[210:211], v23 offset:34816
v_exp_f32_e64 v1, -v80
v_mfma_f32_16x16x32_bf16 v[116:119], a[196:199], a[0:3], 0
v_exp_f32_e64 v2, -v81
s_waitcnt lgkmcnt(2)
v_mfma_f32_16x16x32_bf16 v[112:115], a[200:203], a[16:19], v[112:115]
ds_read_b64_tr_b16 a[212:213], v26 offset:32768
v_exp_f32_e64 v3, -v82
v_add_f32_e64 v1, 1.0, v1
v_mfma_f32_16x16x32_bf16 v[120:123], a[200:203], a[20:23], v[120:123]
buffer_load_dwordx4 v33, s[20:23], s65 offen offset:1024 lds
v_add_f32_e64 v2, 1.0, v2
v_mfma_f32_16x16x32_bf16 v[128:131], a[200:203], a[24:27], v[128:131]
ds_read_b64_tr_b16 a[214:215], v26 offset:34816
v_exp_f32_e64 v4, -v83
v_add_f32_e64 v3, 1.0, v3
v_mfma_f32_16x16x32_bf16 v[136:139], a[200:203], a[28:31], v[136:139]
buffer_load_dwordx4 v34, s[20:23], s65 offen offset:2048 lds
v_mfma_f32_16x16x32_bf16 v[140:143], a[204:207], a[28:31], v[140:143]
ds_read_b64_tr_b16 a[216:217], v23 offset:36864
v_rcp_f32_e64 v1, v1
v_mfma_f32_16x16x32_bf16 v[132:135], a[204:207], a[24:27], v[132:135]
v_add_f32 v4, 1.0, v4
v_rcp_f32 v2, v2
v_mul_f32_e64 v1, v80, v1
v_mfma_f32_16x16x32_bf16 v[124:127], a[204:207], a[20:23], v[124:127]
ds_read_b64_tr_b16 a[218:219], v23 offset:38912
v_rcp_f32_e64 v3, v3
v_mfma_f32_16x16x32_bf16 v[116:119], a[204:207], a[16:19], v[116:119]
v_mul_f32 v2, v81, v2
v_rcp_f32_e64 v4, v4
s_waitcnt lgkmcnt(2)
v_mfma_f32_16x16x32_bf16 v[112:115], a[208:211], a[32:35], v[112:115]
ds_read_b64_tr_b16 a[220:221], v26 offset:36864
v_mul_f32_e64 v3, v82, v3
v_cvt_pk_bf16_f32 v8, v1, v2
v_mfma_f32_16x16x32_bf16 v[120:123], a[208:211], a[36:39], v[120:123]
buffer_load_dwordx4 v35, s[20:23], s65 offen offset:3072 lds
v_mul_f32_e64 v4, v83, v4
v_mfma_f32_16x16x32_bf16 v[128:131], a[208:211], a[40:43], v[128:131]
ds_read_b64_tr_b16 a[222:223], v26 offset:38912
v_cvt_pk_bf16_f32 v9, v3, v4
v_exp_f32_e64 v5, -v84
v_mfma_f32_16x16x32_bf16 v[136:139], a[208:211], a[44:47], v[136:139]
v_exp_f32_e64 v6, -v85
v_mfma_f32_16x16x32_bf16 v[140:143], a[212:215], a[44:47], v[140:143]
ds_read_b64_tr_b16 a[224:225], v23 offset:40960
v_exp_f32_e64 v7, -v86
v_add_f32_e64 v5, 1.0, v5
v_mfma_f32_16x16x32_bf16 v[132:135], a[212:215], a[40:43], v[132:135]
s_add_u32 m0, s64, 28672
v_add_f32_e64 v6, 1.0, v6
v_mfma_f32_16x16x32_bf16 v[124:127], a[212:215], a[36:39], v[124:127]
ds_read_b64_tr_b16 a[226:227], v23 offset:43008
v_exp_f32_e64 v46, -v87
v_mfma_f32_16x16x32_bf16 v[116:119], a[212:215], a[32:35], v[116:119]
s_add_u32 s65, s65, 36864
v_add_f32 v7, 1.0, v7
s_waitcnt lgkmcnt(2)
v_mfma_f32_16x16x32_bf16 v[112:115], a[216:219], a[48:51], v[112:115]
ds_read_b64_tr_b16 a[228:229], v26 offset:40960
v_rcp_f32_e64 v5, v5
v_mfma_f32_16x16x32_bf16 v[120:123], a[216:219], a[52:55], v[120:123]
v_add_f32 v46, 1.0, v46
v_rcp_f32 v6, v6
v_mul_f32_e64 v5, v84, v5
v_mfma_f32_16x16x32_bf16 v[128:131], a[216:219], a[56:59], v[128:131]
ds_read_b64_tr_b16 a[230:231], v26 offset:43008
v_rcp_f32_e64 v7, v7
v_mfma_f32_16x16x32_bf16 v[136:139], a[216:219], a[60:63], v[136:139]
buffer_load_dwordx4 v32, s[20:23], s65 offen offset:0 lds
v_mul_f32_e64 v6, v85, v6
v_mfma_f32_16x16x32_bf16 v[140:143], a[220:223], a[60:63], v[140:143]
ds_read_b64_tr_b16 a[232:233], v23 offset:45056
v_rcp_f32 v46, v46
v_mul_f32 v7, v86, v7
v_mfma_f32_16x16x32_bf16 v[132:135], a[220:223], a[56:59], v[132:135]
v_cvt_pk_bf16_f32 v12, v5, v6
v_mul_f32_e64 v46, v87, v46
v_cvt_pk_bf16_f32 v13, v7, v46
v_mfma_f32_16x16x32_bf16 v[124:127], a[220:223], a[52:55], v[124:127]
ds_read_b64_tr_b16 a[234:235], v23 offset:47104
v_exp_f32_e64 v1, -v88
v_mfma_f32_16x16x32_bf16 v[116:119], a[220:223], a[48:51], v[116:119]
v_exp_f32_e64 v2, -v89
s_waitcnt lgkmcnt(2)
v_mfma_f32_16x16x32_bf16 v[112:115], a[224:227], a[64:67], v[112:115]
ds_read_b64_tr_b16 a[236:237], v26 offset:45056
v_exp_f32_e64 v3, -v90
v_mfma_f32_16x16x32_bf16 v[120:123], a[224:227], a[68:71], v[120:123]
buffer_load_dwordx4 v33, s[20:23], s65 offen offset:1024 lds
v_add_f32 v1, 1.0, v1
v_add_f32_e64 v2, 1.0, v2
v_mfma_f32_16x16x32_bf16 v[128:131], a[224:227], a[72:75], v[128:131]
ds_read_b64_tr_b16 a[238:239], v26 offset:47104
v_exp_f32_e64 v4, -v91
v_mfma_f32_16x16x32_bf16 v[136:139], a[224:227], a[76:79], v[136:139]
v_add_f32 v3, 1.0, v3
v_rcp_f32 v1, v1
v_add_f32_e64 v4, 1.0, v4
v_mfma_f32_16x16x32_bf16 v[140:143], a[228:231], a[76:79], v[140:143]
s_waitcnt vmcnt(13) lgkmcnt(15)
s_barrier
v_mfma_f32_16x16x32_bf16 v[132:135], a[228:231], a[72:75], v[132:135]
ds_read_b64_tr_b16 a[240:241], v24 offset:0
s_add_u32 m0, s64, 49152
v_mfma_f32_16x16x32_bf16 v[124:127], a[228:231], a[68:71], v[124:127]
ds_read_b64_tr_b16 a[242:243], v24 offset:2048
ds_read_b128 a[128:131], v37 offset:0
v_rcp_f32_e64 v2, v2
v_mfma_f32_16x16x32_bf16 v[116:119], a[228:231], a[64:67], v[116:119]
s_add_u32 s65, s41, s1
v_mul_f32_e64 v1, v88, v1
s_waitcnt lgkmcnt(3)
v_mfma_f32_16x16x32_bf16 v[112:115], a[232:235], a[80:83], v[112:115]
ds_read_b64_tr_b16 a[244:245], v27 offset:0
ds_read_b128 a[132:135], v37 offset:1024
v_rcp_f32_e64 v3, v3
v_mfma_f32_16x16x32_bf16 v[120:123], a[232:235], a[84:87], v[120:123]
ds_read_b128 a[136:139], v37 offset:2048
v_mul_f32_e64 v2, v89, v2
v_mfma_f32_16x16x32_bf16 v[128:131], a[232:235], a[88:91], v[128:131]
ds_read_b64_tr_b16 a[246:247], v27 offset:2048
v_rcp_f32_e64 v4, v4
v_mfma_f32_16x16x32_bf16 v[136:139], a[232:235], a[92:95], v[136:139]
buffer_load_dwordx4 v32, s[20:23], s65 offen offset:0 lds
v_mul_f32_e64 v3, v90, v3
v_cvt_pk_bf16_f32 v10, v1, v2
v_mfma_f32_16x16x32_bf16 v[140:143], a[236:239], a[92:95], v[140:143]
ds_read_b64_tr_b16 a[248:249], v24 offset:4096
ds_read_b128 a[140:143], v37 offset:3072
v_mul_f32_e64 v4, v91, v4
v_mfma_f32_16x16x32_bf16 v[132:135], a[236:239], a[88:91], v[132:135]
ds_read_b128 a[144:147], v37 offset:8192
v_cvt_pk_bf16_f32 v11, v3, v4
v_mfma_f32_16x16x32_bf16 v[124:127], a[236:239], a[84:87], v[124:127]
ds_read_b64_tr_b16 a[250:251], v24 offset:6144
v_mfma_f32_16x16x32_bf16 v[116:119], a[236:239], a[80:83], v[116:119]
ds_read_b128 a[148:151], v37 offset:9216
s_waitcnt lgkmcnt(5)
v_mfma_f32_16x16x32_bf16 v[144:147], a[240:243], a[0:3], 0
ds_read_b64_tr_b16 a[252:253], v27 offset:4096
v_mfma_f32_16x16x32_bf16 v[152:155], a[240:243], a[4:7], 0
buffer_load_dwordx4 v33, s[20:23], s65 offen offset:1024 lds
v_mfma_f32_16x16x32_bf16 v[160:163], a[240:243], a[8:11], 0
ds_read_b64_tr_b16 a[254:255], v27 offset:6144
ds_read_b128 a[152:155], v37 offset:10240
v_mfma_f32_16x16x32_bf16 v[168:171], a[240:243], a[12:15], 0
ds_read_b128 a[156:159], v37 offset:11264
v_mfma_f32_16x16x32_bf16 v[172:175], a[244:247], a[12:15], 0
ds_read_b64_tr_b16 a[192:193], v24 offset:8192
v_mfma_f32_16x16x32_bf16 v[164:167], a[244:247], a[8:11], 0
ds_write_b128 v36, v[8:11] offset:16384
v_mfma_f32_16x16x32_bf16 v[156:159], a[244:247], a[4:7], 0
ds_read_b64_tr_b16 a[194:195], v24 offset:10240
v_exp_f32_e64 v5, -v92
v_mfma_f32_16x16x32_bf16 v[148:151], a[244:247], a[0:3], 0
v_exp_f32_e64 v6, -v93
s_waitcnt lgkmcnt(5)
v_mfma_f32_16x16x32_bf16 v[144:147], a[248:251], a[16:19], v[144:147]
ds_read_b64_tr_b16 a[196:197], v27 offset:8192
v_exp_f32_e64 v7, -v94
v_mfma_f32_16x16x32_bf16 v[152:155], a[248:251], a[20:23], v[152:155]
buffer_load_dwordx4 v34, s[20:23], s65 offen offset:2048 lds
v_add_f32_e64 v5, 1.0, v5
v_mfma_f32_16x16x32_bf16 v[160:163], a[248:251], a[24:27], v[160:163]
ds_read_b64_tr_b16 a[198:199], v27 offset:10240
v_add_f32_e64 v6, 1.0, v6
v_exp_f32_e64 v46, -v95
v_mfma_f32_16x16x32_bf16 v[168:171], a[248:251], a[28:31], v[168:171]
v_add_f32 v7, 1.0, v7
v_rcp_f32 v5, v5
v_mfma_f32_16x16x32_bf16 v[172:175], a[252:255], a[28:31], v[172:175]
ds_read_b64_tr_b16 a[200:201], v24 offset:12288
v_add_f32 v46, 1.0, v46
v_rcp_f32 v6, v6
v_mfma_f32_16x16x32_bf16 v[164:167], a[252:255], a[24:27], v[164:167]
buffer_load_dwordx4 v35, s[20:23], s65 offen offset:3072 lds
v_mul_f32_e64 v5, v92, v5
v_mfma_f32_16x16x32_bf16 v[156:159], a[252:255], a[20:23], v[156:159]
ds_read_b64_tr_b16 a[202:203], v24 offset:14336
v_rcp_f32_e64 v7, v7
v_mfma_f32_16x16x32_bf16 v[148:151], a[252:255], a[16:19], v[148:151]
v_mul_f32 v6, v93, v6
v_rcp_f32_e64 v46, v46
s_waitcnt lgkmcnt(2)
v_mfma_f32_16x16x32_bf16 v[144:147], a[192:195], a[32:35], v[144:147]
ds_read_b64_tr_b16 a[204:205], v27 offset:12288
v_mul_f32_e64 v7, v94, v7
v_cvt_pk_bf16_f32 v14, v5, v6
v_mfma_f32_16x16x32_bf16 v[152:155], a[192:195], a[36:39], v[152:155]
v_mul_f32_e64 v46, v95, v46
v_cvt_pk_bf16_f32 v15, v7, v46
v_mfma_f32_16x16x32_bf16 v[160:163], a[192:195], a[40:43], v[160:163]
ds_read_b64_tr_b16 a[206:207], v27 offset:14336
s_add_u32 m0, s64, 53248
v_mfma_f32_16x16x32_bf16 v[168:171], a[192:195], a[44:47], v[168:171]
ds_write_b128 v36, v[12:15] offset:16896
v_mfma_f32_16x16x32_bf16 v[172:175], a[196:199], a[44:47], v[172:175]
ds_read_b64_tr_b16 a[208:209], v24 offset:16384
v_exp_f32_e64 v1, -v96
v_mfma_f32_16x16x32_bf16 v[164:167], a[196:199], a[40:43], v[164:167]
s_add_u32 s65, s65, 36864
v_exp_f32_e64 v2, -v97
v_mfma_f32_16x16x32_bf16 v[156:159], a[196:199], a[36:39], v[156:159]
ds_read_b64_tr_b16 a[210:211], v24 offset:18432
v_exp_f32_e64 v3, -v98
v_add_f32_e64 v1, 1.0, v1
v_mfma_f32_16x16x32_bf16 v[148:151], a[196:199], a[32:35], v[148:151]
v_add_f32 v2, 1.0, v2
s_waitcnt lgkmcnt(3)
v_mfma_f32_16x16x32_bf16 v[144:147], a[200:203], a[48:51], v[144:147]
ds_read_b64_tr_b16 a[212:213], v27 offset:16384
v_exp_f32_e64 v4, -v99
v_add_f32_e64 v3, 1.0, v3
v_mfma_f32_16x16x32_bf16 v[152:155], a[200:203], a[52:55], v[152:155]
buffer_load_dwordx4 v32, s[20:23], s65 offen offset:0 lds
v_mfma_f32_16x16x32_bf16 v[160:163], a[200:203], a[56:59], v[160:163]
ds_read_b64_tr_b16 a[214:215], v27 offset:18432
v_rcp_f32_e64 v1, v1
v_mfma_f32_16x16x32_bf16 v[168:171], a[200:203], a[60:63], v[168:171]
v_add_f32 v4, 1.0, v4
v_rcp_f32 v2, v2
v_mul_f32_e64 v1, v96, v1
v_mfma_f32_16x16x32_bf16 v[172:175], a[204:207], a[60:63], v[172:175]
ds_read_b64_tr_b16 a[216:217], v24 offset:20480
v_rcp_f32_e64 v3, v3
v_mfma_f32_16x16x32_bf16 v[164:167], a[204:207], a[56:59], v[164:167]
v_mul_f32 v2, v97, v2
v_rcp_f32 v4, v4
v_mul_f32_e64 v3, v98, v3
v_mfma_f32_16x16x32_bf16 v[156:159], a[204:207], a[52:55], v[156:159]
ds_read_b64_tr_b16 a[218:219], v24 offset:22528
v_cvt_pk_bf16_f32 v8, v1, v2
v_mul_f32_e64 v4, v99, v4
v_mfma_f32_16x16x32_bf16 v[148:151], a[204:207], a[48:51], v[148:151]
v_cvt_pk_bf16_f32 v9, v3, v4
s_waitcnt lgkmcnt(2)
v_mfma_f32_16x16x32_bf16 v[144:147], a[208:211], a[64:67], v[144:147]
ds_read_b64_tr_b16 a[220:221], v27 offset:20480
v_exp_f32_e64 v5, -v100
v_mfma_f32_16x16x32_bf16 v[152:155], a[208:211], a[68:71], v[152:155]
buffer_load_dwordx4 v33, s[20:23], s65 offen offset:1024 lds
v_mfma_f32_16x16x32_bf16 v[160:163], a[208:211], a[72:75], v[160:163]
ds_read_b64_tr_b16 a[222:223], v27 offset:22528
v_exp_f32_e64 v6, -v101
v_mfma_f32_16x16x32_bf16 v[168:171], a[208:211], a[76:79], v[168:171]
v_exp_f32_e64 v7, -v102
v_add_f32 v5, 1.0, v5
v_mfma_f32_16x16x32_bf16 v[172:175], a[212:215], a[76:79], v[172:175]
s_waitcnt vmcnt(13)
s_barrier
v_add_f32_e64 v6, 1.0, v6
v_mfma_f32_16x16x32_bf16 v[164:167], a[212:215], a[72:75], v[164:167]
ds_read_b64_tr_b16 a[224:225], v22 offset:0
s_add_u32 m0, s64, 73728
v_exp_f32_e64 v46, -v103
v_mfma_f32_16x16x32_bf16 v[156:159], a[212:215], a[68:71], v[156:159]
ds_read_b64_tr_b16 a[226:227], v22 offset:2048
v_add_f32_e64 v7, 1.0, v7
v_mfma_f32_16x16x32_bf16 v[148:151], a[212:215], a[64:67], v[148:151]
s_add_u32 s65, s42, s1
v_rcp_f32_e64 v5, v5
s_waitcnt lgkmcnt(2)
v_mfma_f32_16x16x32_bf16 v[144:147], a[216:219], a[80:83], v[144:147]
ds_read_b64_tr_b16 a[228:229], v25 offset:0
v_add_f32_e64 v46, 1.0, v46
v_mfma_f32_16x16x32_bf16 v[152:155], a[216:219], a[84:87], v[152:155]
v_rcp_f32 v6, v6
v_mul_f32 v5, v100, v5
v_mfma_f32_16x16x32_bf16 v[160:163], a[216:219], a[88:91], v[160:163]
ds_read_b64_tr_b16 a[230:231], v25 offset:2048
v_rcp_f32 v7, v7
v_mul_f32 v6, v101, v6
v_mfma_f32_16x16x32_bf16 v[168:171], a[216:219], a[92:95], v[168:171]
buffer_load_dwordx4 v32, s[20:23], s65 offen offset:0 lds
v_mfma_f32_16x16x32_bf16 v[172:175], a[220:223], a[92:95], v[172:175]
ds_read_b64_tr_b16 a[232:233], v22 offset:4096
v_rcp_f32 v46, v46
v_mul_f32 v7, v102, v7
v_mfma_f32_16x16x32_bf16 v[164:167], a[220:223], a[88:91], v[164:167]
v_cvt_pk_bf16_f32 v12, v5, v6
v_mul_f32_e64 v46, v103, v46
v_cvt_pk_bf16_f32 v13, v7, v46
v_mfma_f32_16x16x32_bf16 v[156:159], a[220:223], a[84:87], v[156:159]
ds_read_b64_tr_b16 a[234:235], v22 offset:6144
v_exp_f32_e64 v1, -v104
v_mfma_f32_16x16x32_bf16 v[148:151], a[220:223], a[80:83], v[148:151]
v_exp_f32_e64 v2, -v105
s_waitcnt lgkmcnt(2)
v_mfma_f32_16x16x32_bf16 v[176:179], a[224:227], a[0:3], 0
ds_read_b64_tr_b16 a[236:237], v25 offset:4096
v_exp_f32_e64 v3, -v106
v_mfma_f32_16x16x32_bf16 v[184:187], a[224:227], a[4:7], 0
buffer_load_dwordx4 v33, s[20:23], s65 offen offset:1024 lds
v_add_f32 v1, 1.0, v1
v_add_f32_e64 v2, 1.0, v2
v_mfma_f32_16x16x32_bf16 v[192:195], a[224:227], a[8:11], 0
ds_read_b64_tr_b16 a[238:239], v25 offset:6144
v_exp_f32_e64 v4, -v107
v_mfma_f32_16x16x32_bf16 v[200:203], a[224:227], a[12:15], 0
v_add_f32 v3, 1.0, v3
v_rcp_f32 v1, v1
v_mfma_f32_16x16x32_bf16 v[204:207], a[228:231], a[12:15], 0
ds_read_b64_tr_b16 a[240:241], v22 offset:8192
v_add_f32 v4, 1.0, v4
v_rcp_f32 v2, v2
v_mfma_f32_16x16x32_bf16 v[196:199], a[228:231], a[8:11], 0
v_mul_f32 v1, v104, v1
v_rcp_f32 v3, v3
v_mfma_f32_16x16x32_bf16 v[188:191], a[228:231], a[4:7], 0
ds_read_b64_tr_b16 a[242:243], v22 offset:10240
v_mul_f32 v2, v105, v2
v_rcp_f32 v4, v4
v_mfma_f32_16x16x32_bf16 v[180:183], a[228:231], a[0:3], 0
v_mul_f32_e64 v3, v106, v3
v_cvt_pk_bf16_f32 v10, v1, v2
s_waitcnt lgkmcnt(2)
v_mfma_f32_16x16x32_bf16 v[176:179], a[232:235], a[16:19], v[176:179]
ds_read_b64_tr_b16 a[244:245], v25 offset:8192
v_mul_f32 v4, v107, v4
v_cvt_pk_bf16_f32 v11, v3, v4
v_mfma_f32_16x16x32_bf16 v[184:187], a[232:235], a[20:23], v[184:187]
buffer_load_dwordx4 v34, s[20:23], s65 offen offset:2048 lds
v_mfma_f32_16x16x32_bf16 v[192:195], a[232:235], a[24:27], v[192:195]
ds_read_b64_tr_b16 a[246:247], v25 offset:10240
v_mfma_f32_16x16x32_bf16 v[200:203], a[232:235], a[28:31], v[200:203]
ds_write_b128 v36, v[8:11] offset:24576
v_mfma_f32_16x16x32_bf16 v[204:207], a[236:239], a[28:31], v[204:207]
ds_read_b64_tr_b16 a[248:249], v22 offset:12288
v_exp_f32_e64 v5, -v108
v_mfma_f32_16x16x32_bf16 v[196:199], a[236:239], a[24:27], v[196:199]
buffer_load_dwordx4 v35, s[20:23], s65 offen offset:3072 lds
v_mfma_f32_16x16x32_bf16 v[188:191], a[236:239], a[20:23], v[188:191]
ds_read_b64_tr_b16 a[250:251], v22 offset:14336
v_exp_f32_e64 v6, -v109
v_mfma_f32_16x16x32_bf16 v[180:183], a[236:239], a[16:19], v[180:183]
v_exp_f32_e64 v7, -v110
s_waitcnt lgkmcnt(3)
v_mfma_f32_16x16x32_bf16 v[176:179], a[240:243], a[32:35], v[176:179]
ds_read_b64_tr_b16 a[252:253], v25 offset:12288
v_add_f32 v5, 1.0, v5
v_add_f32_e64 v6, 1.0, v6
v_mfma_f32_16x16x32_bf16 v[184:187], a[240:243], a[36:39], v[184:187]
v_exp_f32_e64 v46, -v111
v_add_f32_e64 v7, 1.0, v7
v_mfma_f32_16x16x32_bf16 v[192:195], a[240:243], a[40:43], v[192:195]
ds_read_b64_tr_b16 a[254:255], v25 offset:14336
s_add_u32 m0, s64, 77824
v_mfma_f32_16x16x32_bf16 v[200:203], a[240:243], a[44:47], v[200:203]
v_rcp_f32 v5, v5
v_add_f32 v46, 1.0, v46
v_mfma_f32_16x16x32_bf16 v[204:207], a[244:247], a[44:47], v[204:207]
ds_read_b64_tr_b16 a[192:193], v22 offset:16384
v_rcp_f32_e64 v6, v6
v_mfma_f32_16x16x32_bf16 v[196:199], a[244:247], a[40:43], v[196:199]
s_add_u32 s65, s65, 36864
v_mul_f32 v5, v108, v5
v_rcp_f32 v7, v7
v_mfma_f32_16x16x32_bf16 v[188:191], a[244:247], a[36:39], v[188:191]
ds_read_b64_tr_b16 a[194:195], v22 offset:18432
v_mul_f32_e64 v6, v109, v6
v_mfma_f32_16x16x32_bf16 v[180:183], a[244:247], a[32:35], v[180:183]
v_rcp_f32 v46, v46
s_waitcnt lgkmcnt(2)
v_mfma_f32_16x16x32_bf16 v[176:179], a[248:251], a[48:51], v[176:179]
ds_read_b64_tr_b16 a[196:197], v25 offset:16384
v_mul_f32_e64 v7, v110, v7
v_cvt_pk_bf16_f32 v14, v5, v6
v_mul_f32_e64 v46, v111, v46
v_mfma_f32_16x16x32_bf16 v[184:187], a[248:251], a[52:55], v[184:187]
buffer_load_dwordx4 v32, s[20:23], s65 offen offset:0 lds
v_cvt_pk_bf16_f32 v15, v7, v46
v_mfma_f32_16x16x32_bf16 v[192:195], a[248:251], a[56:59], v[192:195]
ds_read_b64_tr_b16 a[198:199], v25 offset:18432
v_mfma_f32_16x16x32_bf16 v[200:203], a[248:251], a[60:63], v[200:203]
v_mfma_f32_16x16x32_bf16 v[204:207], a[252:255], a[60:63], v[204:207]
ds_read_b64_tr_b16 a[200:201], v22 offset:20480
v_mfma_f32_16x16x32_bf16 v[196:199], a[252:255], a[56:59], v[196:199]
ds_write_b128 v36, v[12:15] offset:25088
v_mfma_f32_16x16x32_bf16 v[188:191], a[252:255], a[52:55], v[188:191]
ds_read_b64_tr_b16 a[202:203], v22 offset:22528
v_mfma_f32_16x16x32_bf16 v[180:183], a[252:255], a[48:51], v[180:183]
s_waitcnt lgkmcnt(3)
v_mfma_f32_16x16x32_bf16 v[176:179], a[192:195], a[64:67], v[176:179]
ds_read_b64_tr_b16 a[204:205], v25 offset:20480
v_mfma_f32_16x16x32_bf16 v[184:187], a[192:195], a[68:71], v[184:187]
buffer_load_dwordx4 v33, s[20:23], s65 offen offset:1024 lds
v_mfma_f32_16x16x32_bf16 v[192:195], a[192:195], a[72:75], v[192:195]
ds_read_b64_tr_b16 a[206:207], v25 offset:22528
v_mfma_f32_16x16x32_bf16 v[200:203], a[192:195], a[76:79], v[200:203]
v_mfma_f32_16x16x32_bf16 v[204:207], a[196:199], a[76:79], v[204:207]
s_waitcnt vmcnt(12) lgkmcnt(3)
s_barrier
v_mfma_f32_16x16x32_bf16 v[196:199], a[196:199], a[72:75], v[196:199]
ds_read_b64_tr_b16 a[208:209], v22 offset:24576
s_add_u32 m0, s64, 98304
v_mfma_f32_16x16x32_bf16 v[188:191], a[196:199], a[68:71], v[188:191]
ds_read_b64_tr_b16 a[210:211], v22 offset:26624
ds_read_b128 a[160:163], v37 offset:16384
v_mfma_f32_16x16x32_bf16 v[180:183], a[196:199], a[64:67], v[180:183]
s_add_u32 s65, s43, s0
s_waitcnt lgkmcnt(3)
v_mfma_f32_16x16x32_bf16 v[176:179], a[200:203], a[80:83], v[176:179]
ds_read_b64_tr_b16 a[212:213], v25 offset:24576
ds_read_b128 a[164:167], v37 offset:17408
v_mfma_f32_16x16x32_bf16 v[184:187], a[200:203], a[84:87], v[184:187]
ds_read_b128 a[168:171], v37 offset:18432
s_waitcnt vmcnt(18)
v_mfma_f32_16x16x32_bf16 v[192:195], a[200:203], a[88:91], v[192:195]
ds_read_b64_tr_b16 a[214:215], v25 offset:26624
v_and_b32 v42, 0xff, v41
v_mfma_f32_16x16x32_bf16 v[200:203], a[200:203], a[92:95], v[200:203]
buffer_load_dwordx4 v32, s[20:23], s65 offen offset:0 lds
v_mfma_f32_16x16x32_bf16 v[204:207], a[204:207], a[92:95], v[204:207]
ds_read_b64_tr_b16 a[216:217], v22 offset:28672
ds_read_b128 a[172:175], v37 offset:19456
v_mfma_f32_16x16x32_bf16 v[196:199], a[204:207], a[88:91], v[196:199]
ds_read_b128 a[176:179], v37 offset:24576
v_cmp_le_u32_e64 vcc, 4, v42
v_mfma_f32_16x16x32_bf16 v[188:191], a[204:207], a[84:87], v[188:191]
ds_read_b64_tr_b16 a[218:219], v22 offset:30720
s_and_b32 s66, vcc_lo, 15
s_cmp_eq_u32 s66, 15
s_cbranch_scc0 L_slowH
L_backH:
v_mfma_f32_16x16x32_bf16 v[180:183], a[204:207], a[80:83], v[180:183]
ds_read_b128 a[180:183], v37 offset:25600
s_waitcnt lgkmcnt(5)
v_mfma_f32_16x16x32_bf16 v[112:115], a[208:211], a[96:99], v[112:115]
ds_read_b64_tr_b16 a[220:221], v25 offset:28672
v_readlane_b32 s66, v41, s38
v_mfma_f32_16x16x32_bf16 v[120:123], a[208:211], a[100:103], v[120:123]
buffer_load_dwordx4 v33, s[20:23], s65 offen offset:1024 lds
v_mfma_f32_16x16x32_bf16 v[128:131], a[208:211], a[104:107], v[128:131]
ds_read_b64_tr_b16 a[222:223], v25 offset:30720
ds_read_b128 a[184:187], v37 offset:26624
v_mfma_f32_16x16x32_bf16 v[136:139], a[208:211], a[108:111], v[136:139]
ds_read_b128 a[188:191], v37 offset:27648
s_lshr_b32 s67, s66, 4
v_mfma_f32_16x16x32_bf16 v[140:143], a[212:215], a[108:111], v[140:143]
ds_read_b64_tr_b16 a[224:225], v22 offset:32768
s_xor_b32 s66, s66, s67
v_mfma_f32_16x16x32_bf16 v[132:135], a[212:215], a[104:107], v[132:135]
s_and_b32 s66, s66, 0xff000
s_cselect_b32 s58, 0, 1
s_cselect_b32 s100, s100, 589824
s_cselect_b32 s101, s101, 589824
s_sub_u32 s59, s100, s101
v_mfma_f32_16x16x32_bf16 v[124:127], a[212:215], a[100:103], v[124:127]
ds_read_b64_tr_b16 a[226:227], v22 offset:34816
s_add_u32 s3, s3, s101
v_mfma_f32_16x16x32_bf16 v[116:119], a[212:215], a[96:99], v[116:119]
s_add_u32 s4, s4, s101
s_waitcnt lgkmcnt(4)
v_mfma_f32_16x16x32_bf16 v[112:115], a[216:219], a[112:115], v[112:115]
ds_read_b64_tr_b16 a[228:229], v25 offset:32768
s_add_u32 s5, s5, s101
v_mfma_f32_16x16x32_bf16 v[120:123], a[216:219], a[116:119], v[120:123]
buffer_load_dwordx4 v34, s[20:23], s65 offen offset:2048 lds
v_mfma_f32_16x16x32_bf16 v[128:131], a[216:219], a[120:123], v[128:131]
ds_read_b64_tr_b16 a[230:231], v25 offset:34816
s_add_u32 s6, s6, s101
v_mfma_f32_16x16x32_bf16 v[136:139], a[216:219], a[124:127], v[136:139]
s_add_u32 s7, s7, s101
s_add_u32 s8, s8, s101
v_mfma_f32_16x16x32_bf16 v[140:143], a[220:223], a[124:127], v[140:143]
ds_read_b64_tr_b16 a[232:233], v22 offset:36864
s_lshl_b32 s66, s32, 7
v_mfma_f32_16x16x32_bf16 v[132:135], a[220:223], a[120:123], v[132:135]
buffer_load_dwordx4 v35, s[20:23], s65 offen offset:3072 lds
v_mfma_f32_16x16x32_bf16 v[124:127], a[220:223], a[116:119], v[124:127]
ds_read_b64_tr_b16 a[234:235], v22 offset:38912
s_and_b32 s67, s34, 2
v_mfma_f32_16x16x32_bf16 v[116:119], a[220:223], a[112:115], v[116:119]
s_lshl_b32 s67, s67, 5
s_waitcnt lgkmcnt(2)
v_mfma_f32_16x16x32_bf16 v[112:115], a[224:227], a[128:131], v[112:115]
ds_read_b64_tr_b16 a[236:237], v25 offset:36864
s_add_u32 s66, s66, s67
v_mfma_f32_16x16x32_bf16 v[120:123], a[224:227], a[132:135], v[120:123]
s_and_b32 s67, s33, 2
s_lshl_b32 s67, s67, 4
v_mfma_f32_16x16x32_bf16 v[128:131], a[224:227], a[136:139], v[128:131]
ds_read_b64_tr_b16 a[238:239], v25 offset:38912
s_add_u32 m0, s64, 102400
v_mfma_f32_16x16x32_bf16 v[136:139], a[224:227], a[140:143], v[136:139]
s_add_u32 s66, s66, s67
s_and_b32 s67, s33, 1
v_mfma_f32_16x16x32_bf16 v[140:143], a[228:231], a[140:143], v[140:143]
ds_read_b64_tr_b16 a[240:241], v22 offset:40960
s_add_u32 s66, s66, s67
v_mfma_f32_16x16x32_bf16 v[132:135], a[228:231], a[136:139], v[132:135]
s_add_u32 s65, s65, 36864
v_lshrrev_b32 v40, 2, v0
v_mfma_f32_16x16x32_bf16 v[124:127], a[228:231], a[132:135], v[124:127]
ds_read_b64_tr_b16 a[242:243], v22 offset:43008
v_lshlrev_b32_e64 v40, 1, v40
v_mfma_f32_16x16x32_bf16 v[116:119], a[228:231], a[128:131], v[116:119]
v_add_u32 v40, s66, v40
s_waitcnt lgkmcnt(2)
v_mfma_f32_16x16x32_bf16 v[112:115], a[232:235], a[144:147], v[112:115]
ds_read_b64_tr_b16 a[244:245], v25 offset:40960
v_mul_u32_u24 v40, 1152, v40
v_mfma_f32_16x16x32_bf16 v[120:123], a[232:235], a[148:151], v[120:123]
buffer_load_dwordx4 v32, s[20:23], s65 offen offset:0 lds
v_mfma_f32_16x16x32_bf16 v[128:131], a[232:235], a[152:155], v[128:131]
ds_read_b64_tr_b16 a[246:247], v25 offset:43008
v_and_b32_e64 v41, 3, v0
v_mfma_f32_16x16x32_bf16 v[136:139], a[232:235], a[156:159], v[136:139]
v_lshlrev_b32 v41, 4, v41
s_and_b32 s67, s34, 1
v_mfma_f32_16x16x32_bf16 v[140:143], a[236:239], a[156:159], v[140:143]
ds_read_b64_tr_b16 a[248:249], v22 offset:45056
s_lshl_b32 s67, s67, 6
v_mfma_f32_16x16x32_bf16 v[132:135], a[236:239], a[152:155], v[132:135]
v_add3_u32 v30, v40, v41, s67
s_lshl_b32 s36, s34, 13
v_mfma_f32_16x16x32_bf16 v[124:127], a[236:239], a[148:151], v[124:127]
ds_read_b64_tr_b16 a[250:251], v22 offset:47104
s_add_u32 s36, s36, 122880
v_mfma_f32_16x16x32_bf16 v[116:119], a[236:239], a[144:147], v[116:119]
v_and_b32 v40, 15, v0
s_waitcnt lgkmcnt(2)
v_mfma_f32_16x16x32_bf16 v[112:115], a[240:243], a[160:163], v[112:115]
ds_read_b64_tr_b16 a[252:253], v25 offset:45056
v_lshrrev_b32_e64 v41, 4, v0
v_mfma_f32_16x16x32_bf16 v[120:123], a[240:243], a[164:167], v[120:123]
buffer_load_dwordx4 v33, s[20:23], s65 offen offset:1024 lds
v_mfma_f32_16x16x32_bf16 v[128:131], a[240:243], a[168:171], v[128:131]
ds_read_b64_tr_b16 a[254:255], v25 offset:47104
v_lshlrev_b32_e64 v41, 3, v41
v_mfma_f32_16x16x32_bf16 v[136:139], a[240:243], a[172:175], v[136:139]
v_add_u32_e64 v41, s36, v41
v_lshl_add_u32 v1, v40, 6, v41
v_mfma_f32_16x16x32_bf16 v[140:143], a[244:247], a[172:175], v[140:143]
s_waitcnt vmcnt(12)
s_barrier
v_mfma_f32_16x16x32_bf16 v[132:135], a[244:247], a[168:171], v[132:135]
ds_read_b64_tr_b16 a[192:193], v23 offset:0
s_add_u32 m0, s64, 0
v_mfma_f32_16x16x32_bf16 v[124:127], a[244:247], a[164:167], v[124:127]
ds_read_b64_tr_b16 a[194:195], v23 offset:2048
v_mul_u32_u24 v40, 80, v40
v_mfma_f32_16x16x32_bf16 v[116:119], a[244:247], a[160:163], v[116:119]
s_add_u32 s65, s43, s1
s_waitcnt lgkmcnt(2)
v_mfma_f32_16x16x32_bf16 v[112:115], a[248:251], a[176:179], v[112:115]
ds_read_b64_tr_b16 a[196:197], v26 offset:0
v_add_u32 v2, v40, v41
v_mfma_f32_16x16x32_bf16 v[120:123], a[248:251], a[180:183], v[120:123]
v_lshrrev_b32_e64 v40, 2, v0
v_mul_u32_u24 v40, 80, v40
v_mfma_f32_16x16x32_bf16 v[128:131], a[248:251], a[184:187], v[128:131]
ds_read_b64_tr_b16 a[198:199], v26 offset:2048
v_and_b32_e64 v41, 3, v0
v_mfma_f32_16x16x32_bf16 v[136:139], a[248:251], a[188:191], v[136:139]
buffer_load_dwordx4 v32, s[20:23], s65 offen offset:0 lds
v_mfma_f32_16x16x32_bf16 v[140:143], a[252:255], a[188:191], v[140:143]
ds_read_b64_tr_b16 a[200:201], v23 offset:4096
v_lshlrev_b32_e64 v41, 4, v41
v_mfma_f32_16x16x32_bf16 v[132:135], a[252:255], a[184:187], v[132:135]
v_add3_u32 v3, v40, v41, s36
s_sub_u32 s60, s46, s63
v_mfma_f32_16x16x32_bf16 v[124:127], a[252:255], a[180:183], v[124:127]
ds_read_b64_tr_b16 a[202:203], v23 offset:6144
s_sub_u32 s61, s47, s63
v_mfma_f32_16x16x32_bf16 v[116:119], a[252:255], a[176:179], v[116:119]
s_sub_u32 s62, s48, s63
s_waitcnt lgkmcnt(2)
v_mfma_f32_16x16x32_bf16 v[144:147], a[192:195], a[96:99], v[144:147]
ds_read_b64_tr_b16 a[204:205], v26 offset:4096
s_lshl_b32 s67, s34, 11
v_mfma_f32_16x16x32_bf16 v[152:155], a[192:195], a[100:103], v[152:155]
buffer_load_dwordx4 v33, s[20:23], s65 offen offset:1024 lds
v_mfma_f32_16x16x32_bf16 v[160:163], a[192:195], a[104:107], v[160:163]
ds_read_b64_tr_b16 a[206:207], v26 offset:6144
s_and_b32 s66, s34, 2
v_mfma_f32_16x16x32_bf16 v[168:171], a[192:195], a[108:111], v[168:171]
s_bfe_u32 s68, s33, 0x10001
s_add_u32 s66, s66, s68
v_mfma_f32_16x16x32_bf16 v[172:175], a[196:199], a[108:111], v[172:175]
ds_read_b64_tr_b16 a[208:209], v23 offset:8192
s_lshl_b32 s66, s66, 11
v_mfma_f32_16x16x32_bf16 v[164:167], a[196:199], a[104:107], v[164:167]
v_cvt_pk_bf16_f32 v240, v112, v113
v_cvt_pk_bf16_f32 v241, v114, v115
v_mfma_f32_16x16x32_bf16 v[156:159], a[196:199], a[100:103], v[156:159]
ds_read_b64_tr_b16 a[210:211], v23 offset:10240
v_cvt_pk_bf16_f32 v242, v116, v117
v_mfma_f32_16x16x32_bf16 v[148:151], a[196:199], a[96:99], v[148:151]
v_cvt_pk_bf16_f32 v243, v118, v119
s_waitcnt lgkmcnt(2)
v_mfma_f32_16x16x32_bf16 v[144:147], a[200:203], a[112:115], v[144:147]
ds_read_b64_tr_b16 a[212:213], v26 offset:8192
s_lshl_b32 s51, s51, 7
v_mfma_f32_16x16x32_bf16 v[152:155], a[200:203], a[116:119], v[152:155]
buffer_load_dwordx4 v34, s[20:23], s65 offen offset:2048 lds
v_mfma_f32_16x16x32_bf16 v[160:163], a[200:203], a[120:123], v[160:163]
ds_read_b64_tr_b16 a[214:215], v26 offset:10240
s_add_u32 s51, s51, s67
v_mfma_f32_16x16x32_bf16 v[168:171], a[200:203], a[124:127], v[168:171]
buffer_store_dwordx4 v[240:243], v38, s[24:27], s3 offen offset:0 sc1
v_mfma_f32_16x16x32_bf16 v[172:175], a[204:207], a[124:127], v[172:175]
ds_read_b64_tr_b16 a[216:217], v23 offset:12288
v_cvt_pk_bf16_f32 v244, v120, v121
v_mfma_f32_16x16x32_bf16 v[164:167], a[204:207], a[120:123], v[164:167]
buffer_load_dwordx4 v35, s[20:23], s65 offen offset:3072 lds
v_mfma_f32_16x16x32_bf16 v[156:159], a[204:207], a[116:119], v[156:159]
ds_read_b64_tr_b16 a[218:219], v23 offset:14336
v_cvt_pk_bf16_f32 v245, v122, v123
v_mfma_f32_16x16x32_bf16 v[148:151], a[204:207], a[112:115], v[148:151]
v_cvt_pk_bf16_f32 v246, v124, v125
s_waitcnt lgkmcnt(2)
v_mfma_f32_16x16x32_bf16 v[144:147], a[208:211], a[128:131], v[144:147]
ds_read_b64_tr_b16 a[220:221], v26 offset:12288
v_cvt_pk_bf16_f32 v247, v126, v127
v_mfma_f32_16x16x32_bf16 v[152:155], a[208:211], a[132:135], v[152:155]
buffer_store_dwordx4 v[244:247], v38, s[24:27], s3 offen offset:1024 sc1
v_mfma_f32_16x16x32_bf16 v[160:163], a[208:211], a[136:139], v[160:163]
ds_read_b64_tr_b16 a[222:223], v26 offset:14336
s_add_u32 m0, s64, 4096
v_mfma_f32_16x16x32_bf16 v[168:171], a[208:211], a[140:143], v[168:171]
v_cvt_pk_bf16_f32 v248, v128, v129
v_cvt_pk_bf16_f32 v249, v130, v131
v_mfma_f32_16x16x32_bf16 v[172:175], a[212:215], a[140:143], v[172:175]
ds_read_b64_tr_b16 a[224:225], v23 offset:16384
v_cvt_pk_bf16_f32 v250, v132, v133
v_mfma_f32_16x16x32_bf16 v[164:167], a[212:215], a[136:139], v[164:167]
s_add_u32 s65, s65, 36864
v_cvt_pk_bf16_f32 v251, v134, v135
v_mfma_f32_16x16x32_bf16 v[156:159], a[212:215], a[132:135], v[156:159]
ds_read_b64_tr_b16 a[226:227], v23 offset:18432
s_add_u32 s51, s51, 3695616
v_mfma_f32_16x16x32_bf16 v[148:151], a[212:215], a[128:131], v[148:151]
v_mov_b32 v43, s51
s_waitcnt lgkmcnt(2)
v_mfma_f32_16x16x32_bf16 v[144:147], a[216:219], a[144:147], v[144:147]
ds_read_b64_tr_b16 a[228:229], v26 offset:16384
v_and_b32_e64 v40, 15, v0
v_mfma_f32_16x16x32_bf16 v[152:155], a[216:219], a[148:151], v[152:155]
buffer_load_dwordx4 v32, s[20:23], s65 offen offset:0 lds
v_mfma_f32_16x16x32_bf16 v[160:163], a[216:219], a[152:155], v[160:163]
ds_read_b64_tr_b16 a[230:231], v26 offset:18432
v_mov_b32_e64 v41, s67
v_mfma_f32_16x16x32_bf16 v[168:171], a[216:219], a[156:159], v[168:171]
buffer_store_dwordx4 v[248:251], v38, s[24:27], s3 offen offset:2048 sc1
v_mfma_f32_16x16x32_bf16 v[172:175], a[220:223], a[156:159], v[172:175]
ds_read_b64_tr_b16 a[232:233], v23 offset:20480
v_cvt_pk_bf16_f32 v252, v136, v137
v_mfma_f32_16x16x32_bf16 v[164:167], a[220:223], a[152:155], v[164:167]
v_cvt_pk_bf16_f32 v253, v138, v139
v_cvt_pk_bf16_f32 v254, v140, v141
v_mfma_f32_16x16x32_bf16 v[156:159], a[220:223], a[148:151], v[156:159]
ds_read_b64_tr_b16 a[234:235], v23 offset:22528
v_cvt_pk_bf16_f32 v255, v142, v143
v_mfma_f32_16x16x32_bf16 v[148:151], a[220:223], a[144:147], v[148:151]
v_mov_b32 v42, s66
s_waitcnt lgkmcnt(2)
v_mfma_f32_16x16x32_bf16 v[144:147], a[224:227], a[160:163], v[144:147]
ds_read_b64_tr_b16 a[236:237], v26 offset:20480
v_cmp_gt_u32_e64 vcc, 12, v40
v_mfma_f32_16x16x32_bf16 v[152:155], a[224:227], a[164:167], v[152:155]
buffer_load_dwordx4 v33, s[20:23], s65 offen offset:1024 lds
v_mfma_f32_16x16x32_bf16 v[160:163], a[224:227], a[168:171], v[160:163]
ds_read_b64_tr_b16 a[238:239], v26 offset:22528
buffer_store_dwordx4 v[252:255], v38, s[24:27], s3 offen offset:3072 sc1
v_mfma_f32_16x16x32_bf16 v[168:171], a[224:227], a[172:175], v[168:171]
v_lshlrev_b32_e64 v40, 7, v40
v_add_u32 v40, 3687424, v40
v_mfma_f32_16x16x32_bf16 v[172:175], a[228:231], a[172:175], v[172:175]
s_waitcnt vmcnt(16)
s_barrier
v_mfma_f32_16x16x32_bf16 v[164:167], a[228:231], a[168:171], v[164:167]
ds_read_b64_tr_b16 a[240:241], v23 offset:24576
s_add_u32 m0, s64, 24576
v_mfma_f32_16x16x32_bf16 v[156:159], a[228:231], a[164:167], v[156:159]
ds_read_b64_tr_b16 a[242:243], v23 offset:26624
v_cndmask_b32_e64 v41, v42, v41, vcc
v_mfma_f32_16x16x32_bf16 v[148:151], a[228:231], a[160:163], v[148:151]
s_add_u32 s65, s44, s0
s_waitcnt lgkmcnt(2)
v_mfma_f32_16x16x32_bf16 v[144:147], a[232:235], a[176:179], v[144:147]
ds_read_b64_tr_b16 a[244:245], v26 offset:24576
v_add_u32_e64 v28, v40, v41
v_mfma_f32_16x16x32_bf16 v[152:155], a[232:235], a[180:183], v[152:155]
s_or_b32 vcc_lo, s52, s53
s_mov_b32 vcc_hi, 0
v_mfma_f32_16x16x32_bf16 v[160:163], a[232:235], a[184:187], v[160:163]
ds_read_b64_tr_b16 a[246:247], v26 offset:26624
v_mov_b32_e64 v40, 2.0
v_mfma_f32_16x16x32_bf16 v[168:171], a[232:235], a[188:191], v[168:171]
buffer_load_dwordx4 v32, s[20:23], s65 offen offset:0 lds
v_mfma_f32_16x16x32_bf16 v[172:175], a[236:239], a[188:191], v[172:175]
ds_read_b64_tr_b16 a[248:249], v23 offset:28672
v_cndmask_b32_e64 v28, v40, v28, vcc
v_mfma_f32_16x16x32_bf16 v[164:167], a[236:239], a[184:187], v[164:167]
v_mov_b32 v16, 0
v_mov_b32 v17, 0
v_mfma_f32_16x16x32_bf16 v[156:159], a[236:239], a[180:183], v[156:159]
ds_read_b64_tr_b16 a[250:251], v23 offset:30720
v_mov_b32_e64 v20, 0
v_mfma_f32_16x16x32_bf16 v[148:151], a[236:239], a[176:179], v[148:151]
v_mov_b32 v21, 0
s_waitcnt lgkmcnt(2)
v_mfma_f32_16x16x32_bf16 v[176:179], a[240:243], a[96:99], v[176:179]
ds_read_b64_tr_b16 a[252:253], v26 offset:28672
v_and_b32_e64 v40, 1, v0
v_mfma_f32_16x16x32_bf16 v[184:187], a[240:243], a[100:103], v[184:187]
buffer_load_dwordx4 v33, s[20:23], s65 offen offset:1024 lds
v_mfma_f32_16x16x32_bf16 v[192:195], a[240:243], a[104:107], v[192:195]
ds_read_b64_tr_b16 a[254:255], v26 offset:30720
v_lshlrev_b32_e64 v40, 4, v40
v_mfma_f32_16x16x32_bf16 v[200:203], a[240:243], a[108:111], v[200:203]
v_mov_b32 v41, 0x3f80
v_lshlrev_b32_e64 v40, v40, v41
v_mfma_f32_16x16x32_bf16 v[204:207], a[244:247], a[108:111], v[204:207]
ds_read_b64_tr_b16 a[192:193], v23 offset:32768
v_bfe_u32 v41, v0, 2, 2
v_mfma_f32_16x16x32_bf16 v[196:199], a[244:247], a[104:107], v[196:199]
v_lshrrev_b32 v42, 4, v0
v_cmp_eq_u32 vcc, v41, v42
v_mfma_f32_16x16x32_bf16 v[188:191], a[244:247], a[100:103], v[188:191]
ds_read_b64_tr_b16 a[194:195], v23 offset:34816
v_cndmask_b32_e64 v40, 0, v40, vcc
v_mfma_f32_16x16x32_bf16 v[180:183], a[244:247], a[96:99], v[180:183]
v_and_b32 v41, 2, v0
s_waitcnt lgkmcnt(2)
v_mfma_f32_16x16x32_bf16 v[176:179], a[248:251], a[112:115], v[176:179]
ds_read_b64_tr_b16 a[196:197], v26 offset:32768
v_cvt_pk_bf16_f32 v240, v144, v145
v_mfma_f32_16x16x32_bf16 v[184:187], a[248:251], a[116:119], v[184:187]
buffer_load_dwordx4 v34, s[20:23], s65 offen offset:2048 lds
v_mfma_f32_16x16x32_bf16 v[192:195], a[248:251], a[120:123], v[192:195]
ds_read_b64_tr_b16 a[198:199], v26 offset:34816
v_cvt_pk_bf16_f32 v241, v146, v147
v_mfma_f32_16x16x32_bf16 v[200:203], a[248:251], a[124:127], v[200:203]
v_cvt_pk_bf16_f32 v242, v148, v149
v_cvt_pk_bf16_f32 v243, v150, v151
v_mfma_f32_16x16x32_bf16 v[204:207], a[252:255], a[124:127], v[204:207]
ds_read_b64_tr_b16 a[200:201], v23 offset:36864
v_cmp_eq_u32_e64 vcc, 0, v41
v_mfma_f32_16x16x32_bf16 v[196:199], a[252:255], a[120:123], v[196:199]
buffer_load_dwordx4 v35, s[20:23], s65 offen offset:3072 lds
v_mfma_f32_16x16x32_bf16 v[188:191], a[252:255], a[116:119], v[188:191]
ds_read_b64_tr_b16 a[202:203], v23 offset:38912
v_cndmask_b32_e64 v18, 0, v40, vcc
v_mfma_f32_16x16x32_bf16 v[180:183], a[252:255], a[112:115], v[180:183]
v_cndmask_b32 v19, v40, v16, vcc
s_waitcnt lgkmcnt(2)
v_mfma_f32_16x16x32_bf16 v[176:179], a[192:195], a[128:131], v[176:179]
ds_read_b64_tr_b16 a[204:205], v26 offset:36864
s_mov_b32 s16, s24
v_mfma_f32_16x16x32_bf16 v[184:187], a[192:195], a[132:135], v[184:187]
buffer_store_dwordx4 v[240:243], v38, s[24:27], s4 offen offset:0 sc1
v_mfma_f32_16x16x32_bf16 v[192:195], a[192:195], a[136:139], v[192:195]
ds_read_b64_tr_b16 a[206:207], v26 offset:38912
s_add_u32 m0, s64, 28672
v_mfma_f32_16x16x32_bf16 v[200:203], a[192:195], a[140:143], v[200:203]
v_cvt_pk_bf16_f32 v244, v152, v153
v_cvt_pk_bf16_f32 v245, v154, v155
v_mfma_f32_16x16x32_bf16 v[204:207], a[196:199], a[140:143], v[204:207]
ds_read_b64_tr_b16 a[208:209], v23 offset:40960
v_cvt_pk_bf16_f32 v246, v156, v157
v_mfma_f32_16x16x32_bf16 v[196:199], a[196:199], a[136:139], v[196:199]
s_add_u32 s65, s65, 36864
v_cvt_pk_bf16_f32 v247, v158, v159
v_mfma_f32_16x16x32_bf16 v[188:191], a[196:199], a[132:135], v[188:191]
ds_read_b64_tr_b16 a[210:211], v23 offset:43008
buffer_store_dwordx4 v[244:247], v38, s[24:27], s4 offen offset:1024 sc1
v_mfma_f32_16x16x32_bf16 v[180:183], a[196:199], a[128:131], v[180:183]
v_cvt_pk_bf16_f32 v248, v160, v161
s_waitcnt lgkmcnt(2)
v_mfma_f32_16x16x32_bf16 v[176:179], a[200:203], a[144:147], v[176:179]
ds_read_b64_tr_b16 a[212:213], v26 offset:40960
v_cvt_pk_bf16_f32 v249, v162, v163
v_mfma_f32_16x16x32_bf16 v[184:187], a[200:203], a[148:151], v[184:187]
buffer_load_dwordx4 v32, s[20:23], s65 offen offset:0 lds
v_mfma_f32_16x16x32_bf16 v[192:195], a[200:203], a[152:155], v[192:195]
ds_read_b64_tr_b16 a[214:215], v26 offset:43008
v_cvt_pk_bf16_f32 v250, v164, v165
v_mfma_f32_16x16x32_bf16 v[200:203], a[200:203], a[156:159], v[200:203]
v_cvt_pk_bf16_f32 v251, v166, v167
s_mov_b32 s17, s25
v_mfma_f32_16x16x32_bf16 v[204:207], a[204:207], a[156:159], v[204:207]
ds_read_b64_tr_b16 a[216:217], v23 offset:45056
s_mov_b32 s57, 0xffff0000
v_mfma_f32_16x16x32_bf16 v[196:199], a[204:207], a[152:155], v[196:199]
buffer_store_dwordx4 v[248:251], v38, s[24:27], s4 offen offset:2048 sc1
v_mfma_f32_16x16x32_bf16 v[188:191], a[204:207], a[148:151], v[188:191]
ds_read_b64_tr_b16 a[218:219], v23 offset:47104
v_cvt_pk_bf16_f32 v252, v168, v169
v_mfma_f32_16x16x32_bf16 v[180:183], a[204:207], a[144:147], v[180:183]
v_cvt_pk_bf16_f32 v253, v170, v171
s_waitcnt lgkmcnt(2)
v_mfma_f32_16x16x32_bf16 v[176:179], a[208:211], a[160:163], v[176:179]
ds_read_b64_tr_b16 a[220:221], v26 offset:45056
v_cvt_pk_bf16_f32 v254, v172, v173
v_mfma_f32_16x16x32_bf16 v[184:187], a[208:211], a[164:167], v[184:187]
buffer_load_dwordx4 v33, s[20:23], s65 offen offset:1024 lds
v_mfma_f32_16x16x32_bf16 v[192:195], a[208:211], a[168:171], v[192:195]
ds_read_b64_tr_b16 a[222:223], v26 offset:47104
v_cvt_pk_bf16_f32 v255, v174, v175
v_mfma_f32_16x16x32_bf16 v[200:203], a[208:211], a[172:175], v[200:203]
buffer_store_dwordx4 v[252:255], v38, s[24:27], s4 offen offset:3072 sc1
v_mfma_f32_16x16x32_bf16 v[204:207], a[212:215], a[172:175], v[204:207]
s_waitcnt vmcnt(20)
s_barrier
v_mfma_f32_16x16x32_bf16 v[196:199], a[212:215], a[168:171], v[196:199]
ds_read_b64_tr_b16 a[224:225], v24 offset:0
s_add_u32 m0, s64, 49152
v_mfma_f32_16x16x32_bf16 v[188:191], a[212:215], a[164:167], v[188:191]
ds_read_b64_tr_b16 a[226:227], v24 offset:2048
v_lshlrev_b32_e64 v41, 3, v0
v_mfma_f32_16x16x32_bf16 v[180:183], a[212:215], a[160:163], v[180:183]
s_add_u32 s65, s44, s1
s_waitcnt lgkmcnt(2)
v_mfma_f32_16x16x32_bf16 v[176:179], a[216:219], a[176:179], v[176:179]
ds_read_b64_tr_b16 a[228:229], v27 offset:0
v_mfma_f32_16x16x32_bf16 v[184:187], a[216:219], a[180:183], v[184:187]
v_mfma_f32_16x16x32_bf16 v[192:195], a[216:219], a[184:187], v[192:195]
ds_read_b64_tr_b16 a[230:231], v27 offset:2048
v_mfma_f32_16x16x32_bf16 v[200:203], a[216:219], a[188:191], v[200:203]
buffer_load_dwordx4 v32, s[20:23], s65 offen offset:0 lds
v_mfma_f32_16x16x32_bf16 v[204:207], a[220:223], a[188:191], v[204:207]
ds_read_b64_tr_b16 a[232:233], v24 offset:4096
v_mfma_f32_16x16x32_bf16 v[196:199], a[220:223], a[184:187], v[196:199]
v_mfma_f32_16x16x32_bf16 v[188:191], a[220:223], a[180:183], v[188:191]
ds_read_b64_tr_b16 a[234:235], v24 offset:6144
v_mfma_f32_16x16x32_bf16 v[180:183], a[220:223], a[176:179], v[180:183]
s_waitcnt lgkmcnt(2)
v_mfma_f32_16x16x32_bf16 v[208:211], a[224:227], a[0:3], 0
ds_read_b64_tr_b16 a[236:237], v27 offset:4096
v_mfma_f32_16x16x32_bf16 v[216:219], a[224:227], a[4:7], 0
buffer_load_dwordx4 v33, s[20:23], s65 offen offset:1024 lds
v_mfma_f32_16x16x32_bf16 v[224:227], a[224:227], a[8:11], 0
ds_read_b64_tr_b16 a[238:239], v27 offset:6144
v_mfma_f32_16x16x32_bf16 v[232:235], a[224:227], a[12:15], 0
v_mfma_f32_16x16x32_bf16 v[236:239], a[228:231], a[12:15], 0
ds_read_b64_tr_b16 a[240:241], v24 offset:8192
v_mfma_f32_16x16x32_bf16 v[228:231], a[228:231], a[8:11], 0
v_mfma_f32_16x16x32_bf16 v[220:223], a[228:231], a[4:7], 0
ds_read_b64_tr_b16 a[242:243], v24 offset:10240
v_mov_b32 v31, 1
v_mfma_f32_16x16x32_bf16 v[212:215], a[228:231], a[0:3], 0
s_waitcnt vmcnt(12)
s_waitcnt lgkmcnt(2)
v_mfma_f32_16x16x32_bf16 v[208:211], a[232:235], a[16:19], v[208:211]
ds_read_b64_tr_b16 a[244:245], v27 offset:8192
s_cmp_eq_u32 s58, 0
s_cbranch_scc1 L_rel0
buffer_store_dword v31, v39, s[24:27], s37 offen
L_relb0:
v_mfma_f32_16x16x32_bf16 v[216:219], a[232:235], a[20:23], v[216:219]
buffer_load_dwordx4 v34, s[20:23], s65 offen offset:2048 lds
v_mfma_f32_16x16x32_bf16 v[224:227], a[232:235], a[24:27], v[224:227]
ds_read_b64_tr_b16 a[246:247], v27 offset:10240
v_mfma_f32_16x16x32_bf16 v[232:235], a[232:235], a[28:31], v[232:235]
v_mfma_f32_16x16x32_bf16 v[236:239], a[236:239], a[28:31], v[236:239]
ds_read_b64_tr_b16 a[248:249], v24 offset:12288
v_mfma_f32_16x16x32_bf16 v[228:231], a[236:239], a[24:27], v[228:231]
buffer_load_dwordx4 v35, s[20:23], s65 offen offset:3072 lds
v_mfma_f32_16x16x32_bf16 v[220:223], a[236:239], a[20:23], v[220:223]
ds_read_b64_tr_b16 a[250:251], v24 offset:14336
v_mfma_f32_16x16x32_bf16 v[212:215], a[236:239], a[16:19], v[212:215]
s_waitcnt lgkmcnt(2)
v_mfma_f32_16x16x32_bf16 v[208:211], a[240:243], a[32:35], v[208:211]
ds_read_b64_tr_b16 a[252:253], v27 offset:12288
v_mfma_f32_16x16x32_bf16 v[216:219], a[240:243], a[36:39], v[216:219]
v_mfma_f32_16x16x32_bf16 v[224:227], a[240:243], a[40:43], v[224:227]
ds_read_b64_tr_b16 a[254:255], v27 offset:14336
s_add_u32 m0, s64, 53248
v_mfma_f32_16x16x32_bf16 v[232:235], a[240:243], a[44:47], v[232:235]
v_mfma_f32_16x16x32_bf16 v[236:239], a[244:247], a[44:47], v[236:239]
ds_read_b64_tr_b16 a[192:193], v24 offset:16384
v_mfma_f32_16x16x32_bf16 v[228:231], a[244:247], a[40:43], v[228:231]
s_add_u32 s65, s65, 36864
v_mfma_f32_16x16x32_bf16 v[220:223], a[244:247], a[36:39], v[220:223]
ds_read_b64_tr_b16 a[194:195], v24 offset:18432
v_mfma_f32_16x16x32_bf16 v[212:215], a[244:247], a[32:35], v[212:215]
s_waitcnt lgkmcnt(2)
v_mfma_f32_16x16x32_bf16 v[208:211], a[248:251], a[48:51], v[208:211]
ds_read_b64_tr_b16 a[196:197], v27 offset:16384
v_mfma_f32_16x16x32_bf16 v[216:219], a[248:251], a[52:55], v[216:219]
buffer_load_dwordx4 v32, s[20:23], s65 offen offset:0 lds
v_mfma_f32_16x16x32_bf16 v[224:227], a[248:251], a[56:59], v[224:227]
ds_read_b64_tr_b16 a[198:199], v27 offset:18432
v_mfma_f32_16x16x32_bf16 v[232:235], a[248:251], a[60:63], v[232:235]
v_mfma_f32_16x16x32_bf16 v[236:239], a[252:255], a[60:63], v[236:239]
ds_read_b64_tr_b16 a[200:201], v24 offset:20480
v_mfma_f32_16x16x32_bf16 v[228:231], a[252:255], a[56:59], v[228:231]
buffer_load_dword v29, v43, s[24:27], 0 offen sc1
v_mfma_f32_16x16x32_bf16 v[220:223], a[252:255], a[52:55], v[220:223]
ds_read_b64_tr_b16 a[202:203], v24 offset:22528
v_mfma_f32_16x16x32_bf16 v[212:215], a[252:255], a[48:51], v[212:215]
s_waitcnt lgkmcnt(2)
v_mfma_f32_16x16x32_bf16 v[208:211], a[192:195], a[64:67], v[208:211]
ds_read_b64_tr_b16 a[204:205], v27 offset:20480
v_mfma_f32_16x16x32_bf16 v[216:219], a[192:195], a[68:71], v[216:219]
buffer_load_dwordx4 v33, s[20:23], s65 offen offset:1024 lds
v_mfma_f32_16x16x32_bf16 v[224:227], a[192:195], a[72:75], v[224:227]
ds_read_b64_tr_b16 a[206:207], v27 offset:22528
v_mfma_f32_16x16x32_bf16 v[232:235], a[192:195], a[76:79], v[232:235]
v_mfma_f32_16x16x32_bf16 v[236:239], a[196:199], a[76:79], v[236:239]
s_waitcnt vmcnt(19)
s_barrier
v_mfma_f32_16x16x32_bf16 v[228:231], a[196:199], a[72:75], v[228:231]
ds_read_b64_tr_b16 a[208:209], v22 offset:0
s_add_u32 m0, s64, 73728
v_mfma_f32_16x16x32_bf16 v[220:223], a[196:199], a[68:71], v[220:223]
ds_read_b64_tr_b16 a[210:211], v22 offset:2048
v_cvt_pk_bf16_f32 v240, v176, v177
v_mfma_f32_16x16x32_bf16 v[212:215], a[196:199], a[64:67], v[212:215]
s_add_u32 s65, s45, s0
s_waitcnt lgkmcnt(2)
v_mfma_f32_16x16x32_bf16 v[208:211], a[200:203], a[80:83], v[208:211]
ds_read_b64_tr_b16 a[212:213], v25 offset:0
v_cvt_pk_bf16_f32 v241, v178, v179
v_mfma_f32_16x16x32_bf16 v[216:219], a[200:203], a[84:87], v[216:219]
v_cvt_pk_bf16_f32 v242, v180, v181
v_cvt_pk_bf16_f32 v243, v182, v183
v_mfma_f32_16x16x32_bf16 v[224:227], a[200:203], a[88:91], v[224:227]
ds_read_b64_tr_b16 a[214:215], v25 offset:2048
v_mfma_f32_16x16x32_bf16 v[232:235], a[200:203], a[92:95], v[232:235]
buffer_load_dwordx4 v32, s[20:23], s65 offen offset:0 lds
v_mfma_f32_16x16x32_bf16 v[236:239], a[204:207], a[92:95], v[236:239]
ds_read_b64_tr_b16 a[216:217], v22 offset:4096
v_mfma_f32_16x16x32_bf16 v[228:231], a[204:207], a[88:91], v[228:231]
buffer_store_dwordx4 v[240:243], v38, s[24:27], s5 offen offset:0 sc1
v_mfma_f32_16x16x32_bf16 v[220:223], a[204:207], a[84:87], v[220:223]
ds_read_b64_tr_b16 a[218:219], v22 offset:6144
v_cvt_pk_bf16_f32 v244, v184, v185
v_mfma_f32_16x16x32_bf16 v[212:215], a[204:207], a[80:83], v[212:215]
v_cvt_pk_bf16_f32 v245, v186, v187
s_waitcnt lgkmcnt(2)
v_mfma_f32_16x16x32_bf16 v[208:211], a[208:211], a[96:99], v[208:211]
ds_read_b64_tr_b16 a[220:221], v25 offset:4096
v_cvt_pk_bf16_f32 v246, v188, v189
v_mfma_f32_16x16x32_bf16 v[216:219], a[208:211], a[100:103], v[216:219]
buffer_load_dwordx4 v33, s[20:23], s65 offen offset:1024 lds
v_mfma_f32_16x16x32_bf16 v[224:227], a[208:211], a[104:107], v[224:227]
ds_read_b64_tr_b16 a[222:223], v25 offset:6144
v_cvt_pk_bf16_f32 v247, v190, v191
v_mfma_f32_16x16x32_bf16 v[232:235], a[208:211], a[108:111], v[232:235]
buffer_store_dwordx4 v[244:247], v38, s[24:27], s5 offen offset:1024 sc1
v_mfma_f32_16x16x32_bf16 v[236:239], a[212:215], a[108:111], v[236:239]
ds_read_b64_tr_b16 a[224:225], v22 offset:8192
v_cvt_pk_bf16_f32 v248, v192, v193
v_mfma_f32_16x16x32_bf16 v[228:231], a[212:215], a[104:107], v[228:231]
v_cvt_pk_bf16_f32 v249, v194, v195
v_cvt_pk_bf16_f32 v250, v196, v197
v_mfma_f32_16x16x32_bf16 v[220:223], a[212:215], a[100:103], v[220:223]
ds_read_b64_tr_b16 a[226:227], v22 offset:10240
v_cvt_pk_bf16_f32 v251, v198, v199
v_mfma_f32_16x16x32_bf16 v[212:215], a[212:215], a[96:99], v[212:215]
v_mov_b32 v31, 2
s_waitcnt lgkmcnt(2)
v_mfma_f32_16x16x32_bf16 v[208:211], a[216:219], a[112:115], v[208:211]
ds_read_b64_tr_b16 a[228:229], v25 offset:8192
s_waitcnt vmcnt(12)
v_mfma_f32_16x16x32_bf16 v[216:219], a[216:219], a[116:119], v[216:219]
buffer_load_dwordx4 v34, s[20:23], s65 offen offset:2048 lds
s_cmp_eq_u32 s58, 0
s_cbranch_scc1 L_rel1
buffer_store_dword v31, v39, s[24:27], s37 offen
L_relb1:
v_mfma_f32_16x16x32_bf16 v[224:227], a[216:219], a[120:123], v[224:227]
ds_read_b64_tr_b16 a[230:231], v25 offset:10240
v_mfma_f32_16x16x32_bf16 v[232:235], a[216:219], a[124:127], v[232:235]
buffer_store_dwordx4 v[248:251], v38, s[24:27], s5 offen offset:2048 sc1
v_mfma_f32_16x16x32_bf16 v[236:239], a[220:223], a[124:127], v[236:239]
ds_read_b64_tr_b16 a[232:233], v22 offset:12288
v_cvt_pk_bf16_f32 v252, v200, v201
v_mfma_f32_16x16x32_bf16 v[228:231], a[220:223], a[120:123], v[228:231]
buffer_load_dwordx4 v35, s[20:23], s65 offen offset:3072 lds
v_mfma_f32_16x16x32_bf16 v[220:223], a[220:223], a[116:119], v[220:223]
ds_read_b64_tr_b16 a[234:235], v22 offset:14336
v_cvt_pk_bf16_f32 v253, v202, v203
v_mfma_f32_16x16x32_bf16 v[212:215], a[220:223], a[112:115], v[212:215]
v_cvt_pk_bf16_f32 v254, v204, v205
s_waitcnt lgkmcnt(2)
v_mfma_f32_16x16x32_bf16 v[208:211], a[224:227], a[128:131], v[208:211]
ds_read_b64_tr_b16 a[236:237], v25 offset:12288
v_cvt_pk_bf16_f32 v255, v206, v207
v_mfma_f32_16x16x32_bf16 v[216:219], a[224:227], a[132:135], v[216:219]
buffer_store_dwordx4 v[252:255], v38, s[24:27], s5 offen offset:3072 sc1
v_mfma_f32_16x16x32_bf16 v[224:227], a[224:227], a[136:139], v[224:227]
ds_read_b64_tr_b16 a[238:239], v25 offset:14336
s_add_u32 m0, s64, 77824
v_mfma_f32_16x16x32_bf16 v[232:235], a[224:227], a[140:143], v[232:235]
v_mfma_f32_16x16x32_bf16 v[236:239], a[228:231], a[140:143], v[236:239]
ds_read_b64_tr_b16 a[240:241], v22 offset:16384
s_waitcnt vmcnt(10)
v_mfma_f32_16x16x32_bf16 v[228:231], a[228:231], a[136:139], v[228:231]
s_add_u32 s65, s65, 36864
v_cmp_le_u32 vcc, 1, v29
v_mfma_f32_16x16x32_bf16 v[220:223], a[228:231], a[132:135], v[220:223]
ds_read_b64_tr_b16 a[242:243], v22 offset:18432
v_mfma_f32_16x16x32_bf16 v[212:215], a[228:231], a[128:131], v[212:215]
s_cbranch_vccz L_slowP3
L_backP3:
s_waitcnt lgkmcnt(2)
v_mfma_f32_16x16x32_bf16 v[208:211], a[232:235], a[144:147], v[208:211]
ds_read_b64_tr_b16 a[244:245], v25 offset:16384
s_add_u32 s69, s6, s59
v_mfma_f32_16x16x32_bf16 v[216:219], a[232:235], a[148:151], v[216:219]
buffer_load_dwordx4 v32, s[20:23], s65 offen offset:0 lds
v_mfma_f32_16x16x32_bf16 v[224:227], a[232:235], a[152:155], v[224:227]
ds_read_b64_tr_b16 a[246:247], v25 offset:18432
v_mfma_f32_16x16x32_bf16 v[232:235], a[232:235], a[156:159], v[232:235]
buffer_load_dwordx4 v[64:67], v38, s[24:27], s69 offen offset:0 sc1
v_mfma_f32_16x16x32_bf16 v[236:239], a[236:239], a[156:159], v[236:239]
ds_read_b64_tr_b16 a[248:249], v22 offset:20480
v_mfma_f32_16x16x32_bf16 v[228:231], a[236:239], a[152:155], v[228:231]
buffer_load_dwordx4 v[68:71], v38, s[24:27], s69 offen offset:1024 sc1
v_mfma_f32_16x16x32_bf16 v[220:223], a[236:239], a[148:151], v[220:223]
ds_read_b64_tr_b16 a[250:251], v22 offset:22528
v_mfma_f32_16x16x32_bf16 v[212:215], a[236:239], a[144:147], v[212:215]
buffer_load_dwordx4 v[72:75], v38, s[24:27], s69 offen offset:2048 sc1
s_waitcnt lgkmcnt(2)
v_mfma_f32_16x16x32_bf16 v[208:211], a[240:243], a[160:163], v[208:211]
ds_read_b64_tr_b16 a[252:253], v25 offset:20480
v_mfma_f32_16x16x32_bf16 v[216:219], a[240:243], a[164:167], v[216:219]
buffer_load_dwordx4 v33, s[20:23], s65 offen offset:1024 lds
v_mfma_f32_16x16x32_bf16 v[224:227], a[240:243], a[168:171], v[224:227]
ds_read_b64_tr_b16 a[254:255], v25 offset:22528
v_mfma_f32_16x16x32_bf16 v[232:235], a[240:243], a[172:175], v[232:235]
buffer_load_dwordx4 v[76:79], v38, s[24:27], s69 offen offset:3072 sc1
v_mfma_f32_16x16x32_bf16 v[236:239], a[244:247], a[172:175], v[236:239]
s_waitcnt vmcnt(24)
s_barrier
v_mfma_f32_16x16x32_bf16 v[228:231], a[244:247], a[168:171], v[228:231]
ds_read_b64_tr_b16 a[192:193], v22 offset:24576
s_add_u32 m0, s64, 98304
v_mfma_f32_16x16x32_bf16 v[220:223], a[244:247], a[164:167], v[220:223]
ds_read_b64_tr_b16 a[194:195], v22 offset:26624
v_mfma_f32_16x16x32_bf16 v[212:215], a[244:247], a[160:163], v[212:215]
s_add_u32 s65, s45, s1
s_waitcnt lgkmcnt(2)
v_mfma_f32_16x16x32_bf16 v[208:211], a[248:251], a[176:179], v[208:211]
ds_read_b64_tr_b16 a[196:197], v25 offset:24576
v_mfma_f32_16x16x32_bf16 v[216:219], a[248:251], a[180:183], v[216:219]
buffer_load_dword v29, v43, s[24:27], 0 offen sc1
v_mfma_f32_16x16x32_bf16 v[224:227], a[248:251], a[184:187], v[224:227]
ds_read_b64_tr_b16 a[198:199], v25 offset:26624
v_mfma_f32_16x16x32_bf16 v[232:235], a[248:251], a[188:191], v[232:235]
buffer_load_dwordx4 v32, s[20:23], s65 offen offset:0 lds
v_mfma_f32_16x16x32_bf16 v[236:239], a[252:255], a[188:191], v[236:239]
ds_read_b64_tr_b16 a[200:201], v22 offset:28672
v_mfma_f32_16x16x32_bf16 v[228:231], a[252:255], a[184:187], v[228:231]
v_mfma_f32_16x16x32_bf16 v[220:223], a[252:255], a[180:183], v[220:223]
ds_read_b64_tr_b16 a[202:203], v22 offset:30720
v_mfma_f32_16x16x32_bf16 v[212:215], a[252:255], a[176:179], v[212:215]
s_waitcnt lgkmcnt(2)
v_mfma_f32_16x16x32_bf16 v[112:115], a[192:195], a[0:3], 0
ds_read_b64_tr_b16 a[204:205], v25 offset:28672
v_mfma_f32_16x16x32_bf16 v[120:123], a[192:195], a[4:7], 0
buffer_load_dwordx4 v33, s[20:23], s65 offen offset:1024 lds
v_mfma_f32_16x16x32_bf16 v[128:131], a[192:195], a[8:11], 0
ds_read_b64_tr_b16 a[206:207], v25 offset:30720
v_mfma_f32_16x16x32_bf16 v[136:139], a[192:195], a[12:15], 0
v_mfma_f32_16x16x32_bf16 v[140:143], a[196:199], a[12:15], 0
ds_read_b64_tr_b16 a[208:209], v22 offset:32768
v_mfma_f32_16x16x32_bf16 v[132:135], a[196:199], a[8:11], 0
v_mfma_f32_16x16x32_bf16 v[124:127], a[196:199], a[4:7], 0
ds_read_b64_tr_b16 a[210:211], v22 offset:34816
v_mfma_f32_16x16x32_bf16 v[116:119], a[196:199], a[0:3], 0
s_waitcnt lgkmcnt(2)
v_mfma_f32_16x16x32_bf16 v[112:115], a[200:203], a[16:19], v[112:115]
ds_read_b64_tr_b16 a[212:213], v25 offset:32768
v_mfma_f32_16x16x32_bf16 v[120:123], a[200:203], a[20:23], v[120:123]
buffer_load_dwordx4 v34, s[20:23], s65 offen offset:2048 lds
v_mfma_f32_16x16x32_bf16 v[128:131], a[200:203], a[24:27], v[128:131]
ds_read_b64_tr_b16 a[214:215], v25 offset:34816
v_mfma_f32_16x16x32_bf16 v[136:139], a[200:203], a[28:31], v[136:139]
v_mfma_f32_16x16x32_bf16 v[140:143], a[204:207], a[28:31], v[140:143]
ds_read_b64_tr_b16 a[216:217], v22 offset:36864
v_mfma_f32_16x16x32_bf16 v[132:135], a[204:207], a[24:27], v[132:135]
buffer_load_dwordx4 v35, s[20:23], s65 offen offset:3072 lds
v_mfma_f32_16x16x32_bf16 v[124:127], a[204:207], a[20:23], v[124:127]
ds_read_b64_tr_b16 a[218:219], v22 offset:38912
v_mfma_f32_16x16x32_bf16 v[116:119], a[204:207], a[16:19], v[116:119]
s_waitcnt lgkmcnt(2)
v_mfma_f32_16x16x32_bf16 v[112:115], a[208:211], a[32:35], v[112:115]
ds_read_b64_tr_b16 a[220:221], v25 offset:36864
v_mfma_f32_16x16x32_bf16 v[120:123], a[208:211], a[36:39], v[120:123]
v_mfma_f32_16x16x32_bf16 v[128:131], a[208:211], a[40:43], v[128:131]
ds_read_b64_tr_b16 a[222:223], v25 offset:38912
s_add_u32 m0, s64, 102400
v_mfma_f32_16x16x32_bf16 v[136:139], a[208:211], a[44:47], v[136:139]
v_mfma_f32_16x16x32_bf16 v[140:143], a[212:215], a[44:47], v[140:143]
ds_read_b64_tr_b16 a[224:225], v22 offset:40960
v_mfma_f32_16x16x32_bf16 v[132:135], a[212:215], a[40:43], v[132:135]
s_add_u32 s65, s65, 36864
v_mfma_f32_16x16x32_bf16 v[124:127], a[212:215], a[36:39], v[124:127]
ds_read_b64_tr_b16 a[226:227], v22 offset:43008
v_mfma_f32_16x16x32_bf16 v[116:119], a[212:215], a[32:35], v[116:119]
s_waitcnt lgkmcnt(2)
v_mfma_f32_16x16x32_bf16 v[112:115], a[216:219], a[48:51], v[112:115]
ds_read_b64_tr_b16 a[228:229], v25 offset:40960
v_mfma_f32_16x16x32_bf16 v[120:123], a[216:219], a[52:55], v[120:123]
buffer_load_dwordx4 v32, s[20:23], s65 offen offset:0 lds
v_mfma_f32_16x16x32_bf16 v[128:131], a[216:219], a[56:59], v[128:131]
ds_read_b64_tr_b16 a[230:231], v25 offset:43008
v_mfma_f32_16x16x32_bf16 v[136:139], a[216:219], a[60:63], v[136:139]
v_mfma_f32_16x16x32_bf16 v[140:143], a[220:223], a[60:63], v[140:143]
ds_read_b64_tr_b16 a[232:233], v22 offset:45056
s_waitcnt vmcnt(5)
v_mfma_f32_16x16x32_bf16 v[132:135], a[220:223], a[56:59], v[132:135]
v_cmp_le_u32 vcc, 2, v29
v_mfma_f32_16x16x32_bf16 v[124:127], a[220:223], a[52:55], v[124:127]
ds_read_b64_tr_b16 a[234:235], v22 offset:47104
v_mfma_f32_16x16x32_bf16 v[116:119], a[220:223], a[48:51], v[116:119]
s_cbranch_vccz L_slowP4
L_backP4:
s_waitcnt lgkmcnt(2)
v_mfma_f32_16x16x32_bf16 v[112:115], a[224:227], a[64:67], v[112:115]
ds_read_b64_tr_b16 a[236:237], v25 offset:45056
s_add_u32 s69, s7, s59
v_mfma_f32_16x16x32_bf16 v[120:123], a[224:227], a[68:71], v[120:123]
buffer_load_dwordx4 v33, s[20:23], s65 offen offset:1024 lds
v_mfma_f32_16x16x32_bf16 v[128:131], a[224:227], a[72:75], v[128:131]
ds_read_b64_tr_b16 a[238:239], v25 offset:47104
v_mfma_f32_16x16x32_bf16 v[136:139], a[224:227], a[76:79], v[136:139]
buffer_load_dwordx4 v[48:51], v38, s[24:27], s69 offen offset:0 sc1
v_mfma_f32_16x16x32_bf16 v[140:143], a[228:231], a[76:79], v[140:143]
s_waitcnt vmcnt(23)
s_barrier
v_mfma_f32_16x16x32_bf16 v[132:135], a[228:231], a[72:75], v[132:135]
ds_read_b64_tr_b16 a[240:241], v23 offset:0
s_add_u32 m0, s64, 0
v_mfma_f32_16x16x32_bf16 v[124:127], a[228:231], a[68:71], v[124:127]
ds_read_b64_tr_b16 a[242:243], v23 offset:2048
v_mov_b32_e64 v31, 3
v_mfma_f32_16x16x32_bf16 v[116:119], a[228:231], a[64:67], v[116:119]
s_waitcnt lgkmcnt(2)
s_waitcnt vmcnt(8)
v_mfma_f32_16x16x32_bf16 v[208:211], v[18:21], v[64:67], v[208:211]
s_add_u32 s65, s46, s0
s_waitcnt vmcnt(14)
v_mfma_f32_16x16x32_bf16 v[216:219], v[18:21], v[68:71], v[216:219]
s_cmp_eq_u32 s58, 0
s_cbranch_scc1 L_rel2
buffer_store_dword v31, v39, s[24:27], s37 offen
L_relb2:
v_mfma_f32_16x16x32_bf16 v[224:227], v[18:21], v[72:75], v[224:227]
buffer_load_dwordx4 v[52:55], v38, s[24:27], s69 offen offset:1024 sc1
v_mfma_f32_16x16x32_bf16 v[232:235], v[18:21], v[76:79], v[232:235]
buffer_load_dwordx4 v32, s[20:23], s65 offen offset:0 lds
v_mfma_f32_16x16x32_bf16 v[212:215], v[16:19], v[64:67], v[212:215]
buffer_load_dwordx4 v[56:59], v38, s[24:27], s69 offen offset:2048 sc1
v_mfma_f32_16x16x32_bf16 v[220:223], v[16:19], v[68:71], v[220:223]
buffer_load_dwordx4 v[60:63], v38, s[24:27], s69 offen offset:3072 sc1
v_mfma_f32_16x16x32_bf16 v[228:231], v[16:19], v[72:75], v[228:231]
v_mfma_f32_16x16x32_bf16 v[236:239], v[16:19], v[76:79], v[236:239]
v_mfma_f32_16x16x32_bf16 v[112:115], a[232:235], a[80:83], v[112:115]
ds_read_b64_tr_b16 a[244:245], v26 offset:0
v_mfma_f32_16x16x32_bf16 v[120:123], a[232:235], a[84:87], v[120:123]
v_mfma_f32_16x16x32_bf16 v[128:131], a[232:235], a[88:91], v[128:131]
ds_read_b64_tr_b16 a[246:247], v26 offset:2048
v_mfma_f32_16x16x32_bf16 v[136:139], a[232:235], a[92:95], v[136:139]
buffer_load_dwordx4 v33, s[20:23], s65 offen offset:1024 lds
v_mfma_f32_16x16x32_bf16 v[140:143], a[236:239], a[92:95], v[140:143]
ds_read_b64_tr_b16 a[248:249], v23 offset:4096
v_cvt_pk_bf16_f32 v240, v208, v209
v_mfma_f32_16x16x32_bf16 v[132:135], a[236:239], a[88:91], v[132:135]
v_cvt_pk_bf16_f32 v241, v210, v211
v_cvt_pk_bf16_f32 v242, v212, v213
v_mfma_f32_16x16x32_bf16 v[124:127], a[236:239], a[84:87], v[124:127]
ds_read_b64_tr_b16 a[250:251], v23 offset:6144
v_cvt_pk_bf16_f32 v243, v214, v215
v_mfma_f32_16x16x32_bf16 v[116:119], a[236:239], a[80:83], v[116:119]
s_waitcnt lgkmcnt(2)
v_mfma_f32_16x16x32_bf16 v[112:115], a[240:243], a[96:99], v[112:115]
ds_read_b64_tr_b16 a[252:253], v26 offset:4096
v_mfma_f32_16x16x32_bf16 v[120:123], a[240:243], a[100:103], v[120:123]
buffer_load_dwordx4 v34, s[20:23], s65 offen offset:2048 lds
v_mfma_f32_16x16x32_bf16 v[128:131], a[240:243], a[104:107], v[128:131]
ds_read_b64_tr_b16 a[254:255], v26 offset:6144
v_mfma_f32_16x16x32_bf16 v[136:139], a[240:243], a[108:111], v[136:139]
buffer_store_dwordx4 v[240:243], v38, s[24:27], s6 offen offset:0
v_cvt_pk_bf16_f32 v244, v216, v217
v_mfma_f32_16x16x32_bf16 v[140:143], a[244:247], a[108:111], v[140:143]
ds_read_b64_tr_b16 a[192:193], v23 offset:8192
v_cvt_pk_bf16_f32 v245, v218, v219
v_mfma_f32_16x16x32_bf16 v[132:135], a[244:247], a[104:107], v[132:135]
v_cvt_pk_bf16_f32 v246, v220, v221
v_cvt_pk_bf16_f32 v247, v222, v223
v_mfma_f32_16x16x32_bf16 v[124:127], a[244:247], a[100:103], v[124:127]
ds_read_b64_tr_b16 a[194:195], v23 offset:10240
v_mfma_f32_16x16x32_bf16 v[116:119], a[244:247], a[96:99], v[116:119]
s_waitcnt lgkmcnt(2)
v_mfma_f32_16x16x32_bf16 v[112:115], a[248:251], a[112:115], v[112:115]
ds_read_b64_tr_b16 a[196:197], v26 offset:8192
v_mfma_f32_16x16x32_bf16 v[120:123], a[248:251], a[116:119], v[120:123]
buffer_load_dwordx4 v35, s[20:23], s65 offen offset:3072 lds
v_mfma_f32_16x16x32_bf16 v[128:131], a[248:251], a[120:123], v[128:131]
ds_read_b64_tr_b16 a[198:199], v26 offset:10240
buffer_store_dwordx4 v[244:247], v38, s[24:27], s6 offen offset:1024
v_mfma_f32_16x16x32_bf16 v[136:139], a[248:251], a[124:127], v[136:139]
v_cvt_pk_bf16_f32 v248, v224, v225
v_cvt_pk_bf16_f32 v249, v226, v227
v_mfma_f32_16x16x32_bf16 v[140:143], a[252:255], a[124:127], v[140:143]
ds_read_b64_tr_b16 a[200:201], v23 offset:12288
v_cvt_pk_bf16_f32 v250, v228, v229
v_mfma_f32_16x16x32_bf16 v[132:135], a[252:255], a[120:123], v[132:135]
v_cvt_pk_bf16_f32 v251, v230, v231
v_mfma_f32_16x16x32_bf16 v[124:127], a[252:255], a[116:119], v[124:127]
ds_read_b64_tr_b16 a[202:203], v23 offset:14336
v_mfma_f32_16x16x32_bf16 v[116:119], a[252:255], a[112:115], v[116:119]
s_add_u32 m0, s64, 4096
s_waitcnt lgkmcnt(2)
v_mfma_f32_16x16x32_bf16 v[112:115], a[192:195], a[128:131], v[112:115]
ds_read_b64_tr_b16 a[204:205], v26 offset:12288
v_mfma_f32_16x16x32_bf16 v[120:123], a[192:195], a[132:135], v[120:123]
buffer_store_dwordx4 v[248:251], v38, s[24:27], s6 offen offset:2048
v_mfma_f32_16x16x32_bf16 v[128:131], a[192:195], a[136:139], v[128:131]
ds_read_b64_tr_b16 a[206:207], v26 offset:14336
s_add_u32 s65, s65, 36864
v_cvt_pk_bf16_f32 v252, v232, v233
v_mfma_f32_16x16x32_bf16 v[136:139], a[192:195], a[140:143], v[136:139]
v_cvt_pk_bf16_f32 v253, v234, v235
v_cvt_pk_bf16_f32 v254, v236, v237
v_mfma_f32_16x16x32_bf16 v[140:143], a[196:199], a[140:143], v[140:143]
ds_read_b64_tr_b16 a[208:209], v23 offset:16384
v_cvt_pk_bf16_f32 v255, v238, v239
v_mfma_f32_16x16x32_bf16 v[132:135], a[196:199], a[136:139], v[132:135]
buffer_store_dwordx4 v[252:255], v38, s[24:27], s6 offen offset:3072
v_mfma_f32_16x16x32_bf16 v[124:127], a[196:199], a[132:135], v[124:127]
ds_read_b64_tr_b16 a[210:211], v23 offset:18432
v_mfma_f32_16x16x32_bf16 v[116:119], a[196:199], a[128:131], v[116:119]
s_waitcnt lgkmcnt(2)
v_mfma_f32_16x16x32_bf16 v[112:115], a[200:203], a[144:147], v[112:115]
ds_read_b64_tr_b16 a[212:213], v26 offset:16384
v_mfma_f32_16x16x32_bf16 v[120:123], a[200:203], a[148:151], v[120:123]
buffer_load_dwordx4 v32, s[20:23], s65 offen offset:0 lds
v_mfma_f32_16x16x32_bf16 v[128:131], a[200:203], a[152:155], v[128:131]
ds_read_b64_tr_b16 a[214:215], v26 offset:18432
v_mfma_f32_16x16x32_bf16 v[136:139], a[200:203], a[156:159], v[136:139]
v_mfma_f32_16x16x32_bf16 v[140:143], a[204:207], a[156:159], v[140:143]
ds_read_b64_tr_b16 a[216:217], v23 offset:20480
v_mfma_f32_16x16x32_bf16 v[132:135], a[204:207], a[152:155], v[132:135]
buffer_load_dwordx4 v33, s[20:23], s65 offen offset:1024 lds
v_mfma_f32_16x16x32_bf16 v[124:127], a[204:207], a[148:151], v[124:127]
ds_read_b64_tr_b16 a[218:219], v23 offset:22528
v_mfma_f32_16x16x32_bf16 v[116:119], a[204:207], a[144:147], v[116:119]
s_waitcnt lgkmcnt(2)
v_mfma_f32_16x16x32_bf16 v[112:115], a[208:211], a[160:163], v[112:115]
ds_read_b64_tr_b16 a[220:221], v26 offset:20480
v_mfma_f32_16x16x32_bf16 v[120:123], a[208:211], a[164:167], v[120:123]
v_mfma_f32_16x16x32_bf16 v[128:131], a[208:211], a[168:171], v[128:131]
ds_read_b64_tr_b16 a[222:223], v26 offset:22528
v_mfma_f32_16x16x32_bf16 v[136:139], a[208:211], a[172:175], v[136:139]
v_mfma_f32_16x16x32_bf16 v[140:143], a[212:215], a[172:175], v[140:143]
s_waitcnt vmcnt(23)
s_barrier
v_mfma_f32_16x16x32_bf16 v[132:135], a[212:215], a[168:171], v[132:135]
ds_read_b64_tr_b16 a[224:225], v23 offset:24576
s_add_u32 m0, s64, 24576
v_mfma_f32_16x16x32_bf16 v[124:127], a[212:215], a[164:167], v[124:127]
ds_read_b64_tr_b16 a[226:227], v23 offset:26624
v_mfma_f32_16x16x32_bf16 v[116:119], a[212:215], a[160:163], v[116:119]
s_waitcnt lgkmcnt(2)
v_mfma_f32_16x16x32_bf16 v[112:115], a[216:219], a[176:179], v[112:115]
ds_read_b64_tr_b16 a[228:229], v26 offset:24576
s_add_u32 s65, s46, s1
v_mfma_f32_16x16x32_bf16 v[120:123], a[216:219], a[180:183], v[120:123]
buffer_load_dword v29, v43, s[24:27], 0 offen sc1
v_mfma_f32_16x16x32_bf16 v[128:131], a[216:219], a[184:187], v[128:131]
ds_read_b64_tr_b16 a[230:231], v26 offset:26624
v_mfma_f32_16x16x32_bf16 v[136:139], a[216:219], a[188:191], v[136:139]
buffer_load_dwordx4 v32, s[20:23], s65 offen offset:0 lds
v_mfma_f32_16x16x32_bf16 v[140:143], a[220:223], a[188:191], v[140:143]
ds_read_b64_tr_b16 a[232:233], v23 offset:28672
v_mfma_f32_16x16x32_bf16 v[132:135], a[220:223], a[184:187], v[132:135]
v_mfma_f32_16x16x32_bf16 v[124:127], a[220:223], a[180:183], v[124:127]
ds_read_b64_tr_b16 a[234:235], v23 offset:30720
v_mfma_f32_16x16x32_bf16 v[116:119], a[220:223], a[176:179], v[116:119]
s_waitcnt lgkmcnt(2)
s_waitcnt vmcnt(11)
v_mfma_f32_16x16x32_bf16 v[112:115], v[18:21], v[48:51], v[112:115]
v_mfma_f32_16x16x32_bf16 v[120:123], v[18:21], v[52:55], v[120:123]
v_mfma_f32_16x16x32_bf16 v[128:131], v[18:21], v[56:59], v[128:131]
buffer_load_dwordx4 v33, s[20:23], s65 offen offset:1024 lds
v_mfma_f32_16x16x32_bf16 v[136:139], v[18:21], v[60:63], v[136:139]
v_mfma_f32_16x16x32_bf16 v[116:119], v[16:19], v[48:51], v[116:119]
v_mfma_f32_16x16x32_bf16 v[124:127], v[16:19], v[52:55], v[124:127]
v_mfma_f32_16x16x32_bf16 v[132:135], v[16:19], v[56:59], v[132:135]
v_mfma_f32_16x16x32_bf16 v[140:143], v[16:19], v[60:63], v[140:143]
v_mfma_f32_16x16x32_bf16 v[144:147], a[224:227], a[0:3], 0
ds_read_b64_tr_b16 a[236:237], v26 offset:28672
v_mfma_f32_16x16x32_bf16 v[152:155], a[224:227], a[4:7], 0
buffer_load_dwordx4 v34, s[20:23], s65 offen offset:2048 lds
v_mfma_f32_16x16x32_bf16 v[160:163], a[224:227], a[8:11], 0
ds_read_b64_tr_b16 a[238:239], v26 offset:30720
v_mov_b32 v31, 4
v_mfma_f32_16x16x32_bf16 v[168:171], a[224:227], a[12:15], 0
s_waitcnt vmcnt(6)
v_mfma_f32_16x16x32_bf16 v[172:175], a[228:231], a[12:15], 0
ds_read_b64_tr_b16 a[240:241], v23 offset:32768
v_cvt_pk_bf16_f32 v240, v112, v113
s_cmp_eq_u32 s58, 0
s_cbranch_scc1 L_rel3
buffer_store_dword v31, v39, s[24:27], s37 offen
L_relb3:
v_mfma_f32_16x16x32_bf16 v[164:167], a[228:231], a[8:11], 0
v_cvt_pk_bf16_f32 v241, v114, v115
v_cvt_pk_bf16_f32 v242, v116, v117
v_mfma_f32_16x16x32_bf16 v[156:159], a[228:231], a[4:7], 0
ds_read_b64_tr_b16 a[242:243], v23 offset:34816
v_cvt_pk_bf16_f32 v243, v118, v119
v_mfma_f32_16x16x32_bf16 v[148:151], a[228:231], a[0:3], 0
s_waitcnt lgkmcnt(2)
v_mfma_f32_16x16x32_bf16 v[144:147], a[232:235], a[16:19], v[144:147]
ds_read_b64_tr_b16 a[244:245], v26 offset:32768
v_mfma_f32_16x16x32_bf16 v[152:155], a[232:235], a[20:23], v[152:155]
buffer_load_dwordx4 v35, s[20:23], s65 offen offset:3072 lds
v_mfma_f32_16x16x32_bf16 v[160:163], a[232:235], a[24:27], v[160:163]
ds_read_b64_tr_b16 a[246:247], v26 offset:34816
v_mfma_f32_16x16x32_bf16 v[168:171], a[232:235], a[28:31], v[168:171]
buffer_store_dwordx4 v[240:243], v38, s[24:27], s7 offen offset:0
v_mfma_f32_16x16x32_bf16 v[172:175], a[236:239], a[28:31], v[172:175]
ds_read_b64_tr_b16 a[248:249], v23 offset:36864
v_cvt_pk_bf16_f32 v244, v120, v121
v_mfma_f32_16x16x32_bf16 v[164:167], a[236:239], a[24:27], v[164:167]
v_cvt_pk_bf16_f32 v245, v122, v123
v_cvt_pk_bf16_f32 v246, v124, v125
v_mfma_f32_16x16x32_bf16 v[156:159], a[236:239], a[20:23], v[156:159]
ds_read_b64_tr_b16 a[250:251], v23 offset:38912
v_cvt_pk_bf16_f32 v247, v126, v127
v_mfma_f32_16x16x32_bf16 v[148:151], a[236:239], a[16:19], v[148:151]
s_add_u32 m0, s64, 28672
s_waitcnt lgkmcnt(2)
v_mfma_f32_16x16x32_bf16 v[144:147], a[240:243], a[32:35], v[144:147]
ds_read_b64_tr_b16 a[252:253], v26 offset:36864
v_mfma_f32_16x16x32_bf16 v[152:155], a[240:243], a[36:39], v[152:155]
buffer_store_dwordx4 v[244:247], v38, s[24:27], s7 offen offset:1024
v_mfma_f32_16x16x32_bf16 v[160:163], a[240:243], a[40:43], v[160:163]
ds_read_b64_tr_b16 a[254:255], v26 offset:38912
s_add_u32 s65, s65, 36864
v_mfma_f32_16x16x32_bf16 v[168:171], a[240:243], a[44:47], v[168:171]
v_cvt_pk_bf16_f32 v248, v128, v129
v_cvt_pk_bf16_f32 v249, v130, v131
v_mfma_f32_16x16x32_bf16 v[172:175], a[244:247], a[44:47], v[172:175]
ds_read_b64_tr_b16 a[192:193], v23 offset:40960
v_cvt_pk_bf16_f32 v250, v132, v133
v_mfma_f32_16x16x32_bf16 v[164:167], a[244:247], a[40:43], v[164:167]
v_cvt_pk_bf16_f32 v251, v134, v135
v_mfma_f32_16x16x32_bf16 v[156:159], a[244:247], a[36:39], v[156:159]
ds_read_b64_tr_b16 a[194:195], v23 offset:43008
v_mfma_f32_16x16x32_bf16 v[148:151], a[244:247], a[32:35], v[148:151]
s_waitcnt lgkmcnt(2)
v_mfma_f32_16x16x32_bf16 v[144:147], a[248:251], a[48:51], v[144:147]
ds_read_b64_tr_b16 a[196:197], v26 offset:40960
v_mfma_f32_16x16x32_bf16 v[152:155], a[248:251], a[52:55], v[152:155]
buffer_load_dwordx4 v32, s[20:23], s65 offen offset:0 lds
v_mfma_f32_16x16x32_bf16 v[160:163], a[248:251], a[56:59], v[160:163]
ds_read_b64_tr_b16 a[198:199], v26 offset:43008
v_mfma_f32_16x16x32_bf16 v[168:171], a[248:251], a[60:63], v[168:171]
buffer_store_dwordx4 v[248:251], v38, s[24:27], s7 offen offset:2048
v_mfma_f32_16x16x32_bf16 v[172:175], a[252:255], a[60:63], v[172:175]
ds_read_b64_tr_b16 a[200:201], v23 offset:45056
v_cvt_pk_bf16_f32 v252, v136, v137
v_mfma_f32_16x16x32_bf16 v[164:167], a[252:255], a[56:59], v[164:167]
buffer_load_dwordx4 v33, s[20:23], s65 offen offset:1024 lds
s_waitcnt vmcnt(10)
v_mfma_f32_16x16x32_bf16 v[156:159], a[252:255], a[52:55], v[156:159]
ds_read_b64_tr_b16 a[202:203], v23 offset:47104
v_cvt_pk_bf16_f32 v253, v138, v139
v_mfma_f32_16x16x32_bf16 v[148:151], a[252:255], a[48:51], v[148:151]
v_cvt_pk_bf16_f32 v254, v140, v141
v_cmp_le_u32_e64 vcc, 3, v29
s_waitcnt lgkmcnt(2)
v_mfma_f32_16x16x32_bf16 v[144:147], a[192:195], a[64:67], v[144:147]
ds_read_b64_tr_b16 a[204:205], v26 offset:45056
v_cvt_pk_bf16_f32 v255, v142, v143
v_mfma_f32_16x16x32_bf16 v[152:155], a[192:195], a[68:71], v[152:155]
buffer_store_dwordx4 v[252:255], v38, s[24:27], s7 offen offset:3072
s_cbranch_vccz L_slowP5
L_backP5:
v_mfma_f32_16x16x32_bf16 v[160:163], a[192:195], a[72:75], v[160:163]
ds_read_b64_tr_b16 a[206:207], v26 offset:47104
s_add_u32 s69, s8, s59
v_mfma_f32_16x16x32_bf16 v[168:171], a[192:195], a[76:79], v[168:171]
buffer_load_dwordx4 v[64:67], v38, s[24:27], s69 offen offset:0 sc1
v_mfma_f32_16x16x32_bf16 v[172:175], a[196:199], a[76:79], v[172:175]
s_waitcnt vmcnt(28)
s_barrier
v_mfma_f32_16x16x32_bf16 v[164:167], a[196:199], a[72:75], v[164:167]
ds_read_b64_tr_b16 a[208:209], v24 offset:0
s_add_u32 m0, s64, 49152
v_mfma_f32_16x16x32_bf16 v[156:159], a[196:199], a[68:71], v[156:159]
ds_read_b64_tr_b16 a[210:211], v24 offset:2048
v_mfma_f32_16x16x32_bf16 v[148:151], a[196:199], a[64:67], v[148:151]
s_add_u32 s65, s47, s0
s_waitcnt lgkmcnt(2)
v_mfma_f32_16x16x32_bf16 v[144:147], a[200:203], a[80:83], v[144:147]
ds_read_b64_tr_b16 a[212:213], v27 offset:0
v_mfma_f32_16x16x32_bf16 v[152:155], a[200:203], a[84:87], v[152:155]
buffer_load_dwordx4 v[68:71], v38, s[24:27], s69 offen offset:1024 sc1
v_mfma_f32_16x16x32_bf16 v[160:163], a[200:203], a[88:91], v[160:163]
ds_read_b64_tr_b16 a[214:215], v27 offset:2048
v_mfma_f32_16x16x32_bf16 v[168:171], a[200:203], a[92:95], v[168:171]
buffer_load_dwordx4 v32, s[20:23], s65 offen offset:0 lds
v_mfma_f32_16x16x32_bf16 v[172:175], a[204:207], a[92:95], v[172:175]
ds_read_b64_tr_b16 a[216:217], v24 offset:4096
v_mfma_f32_16x16x32_bf16 v[164:167], a[204:207], a[88:91], v[164:167]
buffer_load_dwordx4 v[72:75], v38, s[24:27], s69 offen offset:2048 sc1
v_mfma_f32_16x16x32_bf16 v[156:159], a[204:207], a[84:87], v[156:159]
ds_read_b64_tr_b16 a[218:219], v24 offset:6144
v_mfma_f32_16x16x32_bf16 v[148:151], a[204:207], a[80:83], v[148:151]
buffer_load_dwordx4 v[76:79], v38, s[24:27], s69 offen offset:3072 sc1
s_waitcnt lgkmcnt(2)
v_mfma_f32_16x16x32_bf16 v[144:147], a[208:211], a[96:99], v[144:147]
ds_read_b64_tr_b16 a[220:221], v27 offset:4096
v_mfma_f32_16x16x32_bf16 v[152:155], a[208:211], a[100:103], v[152:155]
buffer_load_dwordx4 v33, s[20:23], s65 offen offset:1024 lds
v_mfma_f32_16x16x32_bf16 v[160:163], a[208:211], a[104:107], v[160:163]
ds_read_b64_tr_b16 a[222:223], v27 offset:6144
v_mfma_f32_16x16x32_bf16 v[168:171], a[208:211], a[108:111], v[168:171]
v_mfma_f32_16x16x32_bf16 v[172:175], a[212:215], a[108:111], v[172:175]
ds_read_b64_tr_b16 a[224:225], v24 offset:8192
v_mfma_f32_16x16x32_bf16 v[164:167], a[212:215], a[104:107], v[164:167]
v_mfma_f32_16x16x32_bf16 v[156:159], a[212:215], a[100:103], v[156:159]
ds_read_b64_tr_b16 a[226:227], v24 offset:10240
v_mfma_f32_16x16x32_bf16 v[148:151], a[212:215], a[96:99], v[148:151]
s_waitcnt lgkmcnt(2)
v_mfma_f32_16x16x32_bf16 v[144:147], a[216:219], a[112:115], v[144:147]
ds_read_b64_tr_b16 a[228:229], v27 offset:8192
v_mfma_f32_16x16x32_bf16 v[152:155], a[216:219], a[116:119], v[152:155]
buffer_load_dwordx4 v34, s[20:23], s65 offen offset:2048 lds
v_mfma_f32_16x16x32_bf16 v[160:163], a[216:219], a[120:123], v[160:163]
ds_read_b64_tr_b16 a[230:231], v27 offset:10240
v_mfma_f32_16x16x32_bf16 v[168:171], a[216:219], a[124:127], v[168:171]
v_mfma_f32_16x16x32_bf16 v[172:175], a[220:223], a[124:127], v[172:175]
ds_read_b64_tr_b16 a[232:233], v24 offset:12288
v_mfma_f32_16x16x32_bf16 v[164:167], a[220:223], a[120:123], v[164:167]
buffer_load_dwordx4 v35, s[20:23], s65 offen offset:3072 lds
v_mfma_f32_16x16x32_bf16 v[156:159], a[220:223], a[116:119], v[156:159]
ds_read_b64_tr_b16 a[234:235], v24 offset:14336
v_mfma_f32_16x16x32_bf16 v[148:151], a[220:223], a[112:115], v[148:151]
s_waitcnt lgkmcnt(2)
v_mfma_f32_16x16x32_bf16 v[144:147], a[224:227], a[128:131], v[144:147]
ds_read_b64_tr_b16 a[236:237], v27 offset:12288
v_mfma_f32_16x16x32_bf16 v[152:155], a[224:227], a[132:135], v[152:155]
v_mfma_f32_16x16x32_bf16 v[160:163], a[224:227], a[136:139], v[160:163]
ds_read_b64_tr_b16 a[238:239], v27 offset:14336
s_add_u32 m0, s64, 53248
v_mfma_f32_16x16x32_bf16 v[168:171], a[224:227], a[140:143], v[168:171]
v_mfma_f32_16x16x32_bf16 v[172:175], a[228:231], a[140:143], v[172:175]
ds_read_b64_tr_b16 a[240:241], v24 offset:16384
v_mfma_f32_16x16x32_bf16 v[164:167], a[228:231], a[136:139], v[164:167]
s_add_u32 s65, s65, 36864
v_mov_b32 v31, 5
v_mfma_f32_16x16x32_bf16 v[156:159], a[228:231], a[132:135], v[156:159]
ds_read_b64_tr_b16 a[242:243], v24 offset:18432
s_waitcnt vmcnt(8)
v_mfma_f32_16x16x32_bf16 v[148:151], a[228:231], a[128:131], v[148:151]
s_cmp_eq_u32 s58, 0
s_cbranch_scc1 L_rel4
buffer_store_dword v31, v39, s[24:27], s37 offen
L_relb4:
s_waitcnt lgkmcnt(2)
v_mfma_f32_16x16x32_bf16 v[144:147], a[232:235], a[144:147], v[144:147]
ds_read_b64_tr_b16 a[244:245], v27 offset:16384
v_mfma_f32_16x16x32_bf16 v[152:155], a[232:235], a[148:151], v[152:155]
buffer_load_dwordx4 v32, s[20:23], s65 offen offset:0 lds
v_mfma_f32_16x16x32_bf16 v[160:163], a[232:235], a[152:155], v[160:163]
ds_read_b64_tr_b16 a[246:247], v27 offset:18432
v_mfma_f32_16x16x32_bf16 v[168:171], a[232:235], a[156:159], v[168:171]
v_mfma_f32_16x16x32_bf16 v[172:175], a[236:239], a[156:159], v[172:175]
ds_read_b64_tr_b16 a[248:249], v24 offset:20480
v_mfma_f32_16x16x32_bf16 v[164:167], a[236:239], a[152:155], v[164:167]
v_mfma_f32_16x16x32_bf16 v[156:159], a[236:239], a[148:151], v[156:159]
ds_read_b64_tr_b16 a[250:251], v24 offset:22528
v_mfma_f32_16x16x32_bf16 v[148:151], a[236:239], a[144:147], v[148:151]
s_waitcnt lgkmcnt(2)
v_mfma_f32_16x16x32_bf16 v[144:147], a[240:243], a[160:163], v[144:147]
ds_read_b64_tr_b16 a[252:253], v27 offset:20480
v_mfma_f32_16x16x32_bf16 v[152:155], a[240:243], a[164:167], v[152:155]
buffer_load_dwordx4 v33, s[20:23], s65 offen offset:1024 lds
v_mfma_f32_16x16x32_bf16 v[160:163], a[240:243], a[168:171], v[160:163]
ds_read_b64_tr_b16 a[254:255], v27 offset:22528
v_mfma_f32_16x16x32_bf16 v[168:171], a[240:243], a[172:175], v[168:171]
v_mfma_f32_16x16x32_bf16 v[172:175], a[244:247], a[172:175], v[172:175]
s_waitcnt vmcnt(23)
s_barrier
v_mfma_f32_16x16x32_bf16 v[164:167], a[244:247], a[168:171], v[164:167]
ds_read_b64_tr_b16 a[192:193], v22 offset:0
s_add_u32 m0, s64, 73728
v_mfma_f32_16x16x32_bf16 v[156:159], a[244:247], a[164:167], v[156:159]
ds_read_b64_tr_b16 a[194:195], v22 offset:2048
v_mfma_f32_16x16x32_bf16 v[148:151], a[244:247], a[160:163], v[148:151]
s_waitcnt lgkmcnt(2)
v_mfma_f32_16x16x32_bf16 v[144:147], a[248:251], a[176:179], v[144:147]
ds_read_b64_tr_b16 a[196:197], v25 offset:0
s_add_u32 s65, s47, s1
v_mfma_f32_16x16x32_bf16 v[152:155], a[248:251], a[180:183], v[152:155]
v_mfma_f32_16x16x32_bf16 v[160:163], a[248:251], a[184:187], v[160:163]
ds_read_b64_tr_b16 a[198:199], v25 offset:2048
v_mfma_f32_16x16x32_bf16 v[168:171], a[248:251], a[188:191], v[168:171]
buffer_load_dwordx4 v32, s[20:23], s65 offen offset:0 lds
v_mfma_f32_16x16x32_bf16 v[172:175], a[252:255], a[188:191], v[172:175]
ds_read_b64_tr_b16 a[200:201], v22 offset:4096
v_mfma_f32_16x16x32_bf16 v[164:167], a[252:255], a[184:187], v[164:167]
v_mfma_f32_16x16x32_bf16 v[156:159], a[252:255], a[180:183], v[156:159]
ds_read_b64_tr_b16 a[202:203], v22 offset:6144
v_mfma_f32_16x16x32_bf16 v[148:151], a[252:255], a[176:179], v[148:151]
s_waitcnt lgkmcnt(2)
s_waitcnt vmcnt(7)
v_mfma_f32_16x16x32_bf16 v[144:147], v[18:21], v[64:67], v[144:147]
v_mfma_f32_16x16x32_bf16 v[152:155], v[18:21], v[68:71], v[152:155]
v_mfma_f32_16x16x32_bf16 v[160:163], v[18:21], v[72:75], v[160:163]
buffer_load_dwordx4 v33, s[20:23], s65 offen offset:1024 lds
v_mfma_f32_16x16x32_bf16 v[168:171], v[18:21], v[76:79], v[168:171]
v_mfma_f32_16x16x32_bf16 v[148:151], v[16:19], v[64:67], v[148:151]
v_mfma_f32_16x16x32_bf16 v[156:159], v[16:19], v[68:71], v[156:159]
v_mfma_f32_16x16x32_bf16 v[164:167], v[16:19], v[72:75], v[164:167]
v_mfma_f32_16x16x32_bf16 v[172:175], v[16:19], v[76:79], v[172:175]
v_mfma_f32_16x16x32_bf16 v[176:179], a[192:195], a[0:3], 0
ds_read_b64_tr_b16 a[204:205], v25 offset:4096
v_mfma_f32_16x16x32_bf16 v[184:187], a[192:195], a[4:7], 0
buffer_load_dwordx4 v34, s[20:23], s65 offen offset:2048 lds
v_mfma_f32_16x16x32_bf16 v[192:195], a[192:195], a[8:11], 0
ds_read_b64_tr_b16 a[206:207], v25 offset:6144
v_mfma_f32_16x16x32_bf16 v[200:203], a[192:195], a[12:15], 0
v_mfma_f32_16x16x32_bf16 v[204:207], a[196:199], a[12:15], 0
ds_read_b64_tr_b16 a[208:209], v22 offset:8192
v_cvt_pk_bf16_f32 v240, v144, v145
v_mfma_f32_16x16x32_bf16 v[196:199], a[196:199], a[8:11], 0
v_cvt_pk_bf16_f32 v241, v146, v147
v_cvt_pk_bf16_f32 v242, v148, v149
v_mfma_f32_16x16x32_bf16 v[188:191], a[196:199], a[4:7], 0
ds_read_b64_tr_b16 a[210:211], v22 offset:10240
v_cvt_pk_bf16_f32 v243, v150, v151
v_mfma_f32_16x16x32_bf16 v[180:183], a[196:199], a[0:3], 0
buffer_load_dword v29, v43, s[24:27], 0 offen sc1
s_waitcnt lgkmcnt(2)
v_mfma_f32_16x16x32_bf16 v[176:179], a[200:203], a[16:19], v[176:179]
ds_read_b64_tr_b16 a[212:213], v25 offset:8192
v_mfma_f32_16x16x32_bf16 v[184:187], a[200:203], a[20:23], v[184:187]
buffer_load_dwordx4 v35, s[20:23], s65 offen offset:3072 lds
v_mfma_f32_16x16x32_bf16 v[192:195], a[200:203], a[24:27], v[192:195]
ds_read_b64_tr_b16 a[214:215], v25 offset:10240
v_mfma_f32_16x16x32_bf16 v[200:203], a[200:203], a[28:31], v[200:203]
buffer_store_dwordx4 v[240:243], v38, s[24:27], s8 offen offset:0
v_mfma_f32_16x16x32_bf16 v[204:207], a[204:207], a[28:31], v[204:207]
ds_read_b64_tr_b16 a[216:217], v22 offset:12288
v_cvt_pk_bf16_f32 v244, v152, v153
v_mfma_f32_16x16x32_bf16 v[196:199], a[204:207], a[24:27], v[196:199]
v_cvt_pk_bf16_f32 v245, v154, v155
v_cvt_pk_bf16_f32 v246, v156, v157
v_mfma_f32_16x16x32_bf16 v[188:191], a[204:207], a[20:23], v[188:191]
ds_read_b64_tr_b16 a[218:219], v22 offset:14336
v_cvt_pk_bf16_f32 v247, v158, v159
v_mfma_f32_16x16x32_bf16 v[180:183], a[204:207], a[16:19], v[180:183]
s_add_u32 m0, s64, 77824
s_waitcnt lgkmcnt(2)
v_mfma_f32_16x16x32_bf16 v[176:179], a[208:211], a[32:35], v[176:179]
ds_read_b64_tr_b16 a[220:221], v25 offset:12288
v_mfma_f32_16x16x32_bf16 v[184:187], a[208:211], a[36:39], v[184:187]
buffer_store_dwordx4 v[244:247], v38, s[24:27], s8 offen offset:1024
v_mfma_f32_16x16x32_bf16 v[192:195], a[208:211], a[40:43], v[192:195]
ds_read_b64_tr_b16 a[222:223], v25 offset:14336
s_add_u32 s65, s65, 36864
v_mfma_f32_16x16x32_bf16 v[200:203], a[208:211], a[44:47], v[200:203]
v_cvt_pk_bf16_f32 v248, v160, v161
v_cvt_pk_bf16_f32 v249, v162, v163
v_mfma_f32_16x16x32_bf16 v[204:207], a[212:215], a[44:47], v[204:207]
ds_read_b64_tr_b16 a[224:225], v22 offset:16384
v_cvt_pk_bf16_f32 v250, v164, v165
v_mfma_f32_16x16x32_bf16 v[196:199], a[212:215], a[40:43], v[196:199]
v_cvt_pk_bf16_f32 v251, v166, v167
v_mfma_f32_16x16x32_bf16 v[188:191], a[212:215], a[36:39], v[188:191]
ds_read_b64_tr_b16 a[226:227], v22 offset:18432
v_mfma_f32_16x16x32_bf16 v[180:183], a[212:215], a[32:35], v[180:183]
s_waitcnt lgkmcnt(2)
v_mfma_f32_16x16x32_bf16 v[176:179], a[216:219], a[48:51], v[176:179]
ds_read_b64_tr_b16 a[228:229], v25 offset:16384
v_mfma_f32_16x16x32_bf16 v[184:187], a[216:219], a[52:55], v[184:187]
buffer_load_dwordx4 v32, s[20:23], s65 offen offset:0 lds
v_mfma_f32_16x16x32_bf16 v[192:195], a[216:219], a[56:59], v[192:195]
ds_read_b64_tr_b16 a[230:231], v25 offset:18432
v_mfma_f32_16x16x32_bf16 v[200:203], a[216:219], a[60:63], v[200:203]
buffer_store_dwordx4 v[248:251], v38, s[24:27], s8 offen offset:2048
v_mfma_f32_16x16x32_bf16 v[204:207], a[220:223], a[60:63], v[204:207]
ds_read_b64_tr_b16 a[232:233], v22 offset:20480
v_cvt_pk_bf16_f32 v252, v168, v169
v_mfma_f32_16x16x32_bf16 v[196:199], a[220:223], a[56:59], v[196:199]
buffer_load_dwordx4 v33, s[20:23], s65 offen offset:1024 lds
v_mfma_f32_16x16x32_bf16 v[188:191], a[220:223], a[52:55], v[188:191]
ds_read_b64_tr_b16 a[234:235], v22 offset:22528
v_cvt_pk_bf16_f32 v253, v170, v171
v_mfma_f32_16x16x32_bf16 v[180:183], a[220:223], a[48:51], v[180:183]
v_cvt_pk_bf16_f32 v254, v172, v173
s_waitcnt lgkmcnt(2)
v_mfma_f32_16x16x32_bf16 v[176:179], a[224:227], a[64:67], v[176:179]
ds_read_b64_tr_b16 a[236:237], v25 offset:20480
v_cvt_pk_bf16_f32 v255, v174, v175
v_mfma_f32_16x16x32_bf16 v[184:187], a[224:227], a[68:71], v[184:187]
buffer_store_dwordx4 v[252:255], v38, s[24:27], s8 offen offset:3072
v_mfma_f32_16x16x32_bf16 v[192:195], a[224:227], a[72:75], v[192:195]
ds_read_b64_tr_b16 a[238:239], v25 offset:22528
v_mfma_f32_16x16x32_bf16 v[200:203], a[224:227], a[76:79], v[200:203]
v_mfma_f32_16x16x32_bf16 v[204:207], a[228:231], a[76:79], v[204:207]
s_waitcnt vmcnt(23)
s_barrier
v_mfma_f32_16x16x32_bf16 v[196:199], a[228:231], a[72:75], v[196:199]
ds_read_b64_tr_b16 a[240:241], v22 offset:24576
s_add_u32 m0, s64, 98304
v_mfma_f32_16x16x32_bf16 v[188:191], a[228:231], a[68:71], v[188:191]
ds_read_b64_tr_b16 a[242:243], v22 offset:26624
v_mfma_f32_16x16x32_bf16 v[180:183], a[228:231], a[64:67], v[180:183]
s_add_u32 s65, s48, s0
s_waitcnt lgkmcnt(2)
v_mfma_f32_16x16x32_bf16 v[176:179], a[232:235], a[80:83], v[176:179]
ds_read_b64_tr_b16 a[244:245], v25 offset:24576
v_mfma_f32_16x16x32_bf16 v[184:187], a[232:235], a[84:87], v[184:187]
v_mfma_f32_16x16x32_bf16 v[192:195], a[232:235], a[88:91], v[192:195]
ds_read_b64_tr_b16 a[246:247], v25 offset:26624
v_mfma_f32_16x16x32_bf16 v[200:203], a[232:235], a[92:95], v[200:203]
buffer_load_dwordx4 v32, s[20:23], s65 offen offset:0 lds
v_mfma_f32_16x16x32_bf16 v[204:207], a[236:239], a[92:95], v[204:207]
ds_read_b64_tr_b16 a[248:249], v22 offset:28672
s_waitcnt vmcnt(8)
v_mfma_f32_16x16x32_bf16 v[196:199], a[236:239], a[88:91], v[196:199]
v_cmp_le_u32_e64 vcc, 4, v29
v_mfma_f32_16x16x32_bf16 v[188:191], a[236:239], a[84:87], v[188:191]
ds_read_b64_tr_b16 a[250:251], v22 offset:30720
v_mfma_f32_16x16x32_bf16 v[180:183], a[236:239], a[80:83], v[180:183]
s_cbranch_vccz L_slowP6
L_backP6:
s_waitcnt lgkmcnt(2)
v_mfma_f32_16x16x32_bf16 v[176:179], a[240:243], a[96:99], v[176:179]
ds_read_b64_tr_b16 a[252:253], v25 offset:28672
s_add_u32 s69, s9, s100
v_mfma_f32_16x16x32_bf16 v[184:187], a[240:243], a[100:103], v[184:187]
buffer_load_dwordx4 v33, s[20:23], s65 offen offset:1024 lds
v_mfma_f32_16x16x32_bf16 v[192:195], a[240:243], a[104:107], v[192:195]
ds_read_b64_tr_b16 a[254:255], v25 offset:30720
v_mfma_f32_16x16x32_bf16 v[200:203], a[240:243], a[108:111], v[200:203]
buffer_load_dwordx4 v[48:51], v38, s[24:27], s69 offen offset:0 sc1
v_mfma_f32_16x16x32_bf16 v[204:207], a[244:247], a[108:111], v[204:207]
ds_read_b64_tr_b16 a[192:193], v22 offset:32768
v_mfma_f32_16x16x32_bf16 v[196:199], a[244:247], a[104:107], v[196:199]
buffer_load_dwordx4 v[52:55], v38, s[24:27], s69 offen offset:1024 sc1
v_mfma_f32_16x16x32_bf16 v[188:191], a[244:247], a[100:103], v[188:191]
ds_read_b64_tr_b16 a[194:195], v22 offset:34816
v_mfma_f32_16x16x32_bf16 v[180:183], a[244:247], a[96:99], v[180:183]
s_waitcnt lgkmcnt(2)
v_mfma_f32_16x16x32_bf16 v[176:179], a[248:251], a[112:115], v[176:179]
ds_read_b64_tr_b16 a[196:197], v25 offset:32768
v_mfma_f32_16x16x32_bf16 v[184:187], a[248:251], a[116:119], v[184:187]
buffer_load_dwordx4 v34, s[20:23], s65 offen offset:2048 lds
v_mfma_f32_16x16x32_bf16 v[192:195], a[248:251], a[120:123], v[192:195]
ds_read_b64_tr_b16 a[198:199], v25 offset:34816
v_mfma_f32_16x16x32_bf16 v[200:203], a[248:251], a[124:127], v[200:203]
buffer_load_dwordx4 v[56:59], v38, s[24:27], s69 offen offset:2048 sc1
v_mfma_f32_16x16x32_bf16 v[204:207], a[252:255], a[124:127], v[204:207]
ds_read_b64_tr_b16 a[200:201], v22 offset:36864
v_mfma_f32_16x16x32_bf16 v[196:199], a[252:255], a[120:123], v[196:199]
buffer_load_dwordx4 v35, s[20:23], s65 offen offset:3072 lds
v_mfma_f32_16x16x32_bf16 v[188:191], a[252:255], a[116:119], v[188:191]
ds_read_b64_tr_b16 a[202:203], v22 offset:38912
v_mfma_f32_16x16x32_bf16 v[180:183], a[252:255], a[112:115], v[180:183]
buffer_load_dwordx4 v[60:63], v38, s[24:27], s69 offen offset:3072 sc1
s_waitcnt lgkmcnt(2)
v_mfma_f32_16x16x32_bf16 v[176:179], a[192:195], a[128:131], v[176:179]
ds_read_b64_tr_b16 a[204:205], v25 offset:36864
v_mfma_f32_16x16x32_bf16 v[184:187], a[192:195], a[132:135], v[184:187]
v_mfma_f32_16x16x32_bf16 v[192:195], a[192:195], a[136:139], v[192:195]
ds_read_b64_tr_b16 a[206:207], v25 offset:38912
s_add_u32 m0, s64, 102400
v_mfma_f32_16x16x32_bf16 v[200:203], a[192:195], a[140:143], v[200:203]
v_mfma_f32_16x16x32_bf16 v[204:207], a[196:199], a[140:143], v[204:207]
ds_read_b64_tr_b16 a[208:209], v22 offset:40960
v_mfma_f32_16x16x32_bf16 v[196:199], a[196:199], a[136:139], v[196:199]
s_add_u32 s65, s65, 36864
v_mov_b32 v31, 6
v_mfma_f32_16x16x32_bf16 v[188:191], a[196:199], a[132:135], v[188:191]
ds_read_b64_tr_b16 a[210:211], v22 offset:43008
s_waitcnt vmcnt(8)
v_mfma_f32_16x16x32_bf16 v[180:183], a[196:199], a[128:131], v[180:183]
s_cmp_eq_u32 s58, 0
s_cbranch_scc1 L_rel5
buffer_store_dword v31, v39, s[24:27], s37 offen
L_relb5:
s_waitcnt lgkmcnt(2)
v_mfma_f32_16x16x32_bf16 v[176:179], a[200:203], a[144:147], v[176:179]
ds_read_b64_tr_b16 a[212:213], v25 offset:40960
v_mfma_f32_16x16x32_bf16 v[184:187], a[200:203], a[148:151], v[184:187]
buffer_load_dwordx4 v32, s[20:23], s65 offen offset:0 lds
v_mfma_f32_16x16x32_bf16 v[192:195], a[200:203], a[152:155], v[192:195]
ds_read_b64_tr_b16 a[214:215], v25 offset:43008
v_mfma_f32_16x16x32_bf16 v[200:203], a[200:203], a[156:159], v[200:203]
v_mfma_f32_16x16x32_bf16 v[204:207], a[204:207], a[156:159], v[204:207]
ds_read_b64_tr_b16 a[216:217], v22 offset:45056
v_mfma_f32_16x16x32_bf16 v[196:199], a[204:207], a[152:155], v[196:199]
v_mfma_f32_16x16x32_bf16 v[188:191], a[204:207], a[148:151], v[188:191]
ds_read_b64_tr_b16 a[218:219], v22 offset:47104
v_mfma_f32_16x16x32_bf16 v[180:183], a[204:207], a[144:147], v[180:183]
s_waitcnt lgkmcnt(2)
v_mfma_f32_16x16x32_bf16 v[176:179], a[208:211], a[160:163], v[176:179]
ds_read_b64_tr_b16 a[220:221], v25 offset:45056
v_mfma_f32_16x16x32_bf16 v[184:187], a[208:211], a[164:167], v[184:187]
buffer_load_dwordx4 v33, s[20:23], s65 offen offset:1024 lds
v_mfma_f32_16x16x32_bf16 v[192:195], a[208:211], a[168:171], v[192:195]
ds_read_b64_tr_b16 a[222:223], v25 offset:47104
v_mfma_f32_16x16x32_bf16 v[200:203], a[208:211], a[172:175], v[200:203]
v_mfma_f32_16x16x32_bf16 v[204:207], a[212:215], a[172:175], v[204:207]
s_waitcnt vmcnt(22)
s_barrier
v_mfma_f32_16x16x32_bf16 v[196:199], a[212:215], a[168:171], v[196:199]
ds_read_b64_tr_b16 a[224:225], v23 offset:0
s_add_u32 m0, s64, 0
v_mfma_f32_16x16x32_bf16 v[188:191], a[212:215], a[164:167], v[188:191]
ds_read_b64_tr_b16 a[226:227], v23 offset:2048
v_mfma_f32_16x16x32_bf16 v[180:183], a[212:215], a[160:163], v[180:183]
s_waitcnt lgkmcnt(2)
v_mfma_f32_16x16x32_bf16 v[176:179], a[216:219], a[176:179], v[176:179]
ds_read_b64_tr_b16 a[228:229], v26 offset:0
s_add_u32 s65, s48, s1
v_mfma_f32_16x16x32_bf16 v[184:187], a[216:219], a[180:183], v[184:187]
v_mfma_f32_16x16x32_bf16 v[192:195], a[216:219], a[184:187], v[192:195]
ds_read_b64_tr_b16 a[230:231], v26 offset:2048
v_mfma_f32_16x16x32_bf16 v[200:203], a[216:219], a[188:191], v[200:203]
buffer_load_dwordx4 v32, s[20:23], s65 offen offset:0 lds
v_mfma_f32_16x16x32_bf16 v[204:207], a[220:223], a[188:191], v[204:207]
ds_read_b64_tr_b16 a[232:233], v23 offset:4096
v_mfma_f32_16x16x32_bf16 v[196:199], a[220:223], a[184:187], v[196:199]
v_mfma_f32_16x16x32_bf16 v[188:191], a[220:223], a[180:183], v[188:191]
ds_read_b64_tr_b16 a[234:235], v23 offset:6144
v_mfma_f32_16x16x32_bf16 v[180:183], a[220:223], a[176:179], v[180:183]
s_waitcnt lgkmcnt(2)
s_waitcnt vmcnt(4)
v_mfma_f32_16x16x32_bf16 v[176:179], v[18:21], v[48:51], v[176:179]
v_mfma_f32_16x16x32_bf16 v[184:187], v[18:21], v[52:55], v[184:187]
v_mfma_f32_16x16x32_bf16 v[192:195], v[18:21], v[56:59], v[192:195]
buffer_load_dwordx4 v33, s[20:23], s65 offen offset:1024 lds
v_mfma_f32_16x16x32_bf16 v[200:203], v[18:21], v[60:63], v[200:203]
v_mfma_f32_16x16x32_bf16 v[180:183], v[16:19], v[48:51], v[180:183]
v_mfma_f32_16x16x32_bf16 v[188:191], v[16:19], v[52:55], v[188:191]
v_mfma_f32_16x16x32_bf16 v[196:199], v[16:19], v[56:59], v[196:199]
v_mfma_f32_16x16x32_bf16 v[204:207], v[16:19], v[60:63], v[204:207]
v_mfma_f32_16x16x32_bf16 v[208:211], a[224:227], a[0:3], 0
ds_read_b64_tr_b16 a[236:237], v26 offset:4096
v_mfma_f32_16x16x32_bf16 v[216:219], a[224:227], a[4:7], 0
buffer_load_dwordx4 v34, s[20:23], s65 offen offset:2048 lds
v_mfma_f32_16x16x32_bf16 v[224:227], a[224:227], a[8:11], 0
ds_read_b64_tr_b16 a[238:239], v26 offset:6144
v_mfma_f32_16x16x32_bf16 v[232:235], a[224:227], a[12:15], 0
v_mfma_f32_16x16x32_bf16 v[236:239], a[228:231], a[12:15], 0
ds_read_b64_tr_b16 a[240:241], v23 offset:8192
v_cvt_pk_bf16_f32 v244, v184, v185
v_mfma_f32_16x16x32_bf16 v[228:231], a[228:231], a[8:11], 0
v_cvt_pk_bf16_f32 v245, v186, v187
v_cvt_pk_bf16_f32 v246, v188, v189
v_mfma_f32_16x16x32_bf16 v[220:223], a[228:231], a[4:7], 0
ds_read_b64_tr_b16 a[242:243], v23 offset:10240
v_cvt_pk_bf16_f32 v247, v190, v191
v_mfma_f32_16x16x32_bf16 v[212:215], a[228:231], a[0:3], 0
buffer_load_dword v29, v43, s[24:27], 0 offen sc1
s_waitcnt lgkmcnt(2)
v_mfma_f32_16x16x32_bf16 v[208:211], a[232:235], a[16:19], v[208:211]
ds_read_b64_tr_b16 a[244:245], v26 offset:8192
v_mfma_f32_16x16x32_bf16 v[216:219], a[232:235], a[20:23], v[216:219]
buffer_load_dwordx4 v35, s[20:23], s65 offen offset:3072 lds
v_mfma_f32_16x16x32_bf16 v[224:227], a[232:235], a[24:27], v[224:227]
ds_read_b64_tr_b16 a[246:247], v26 offset:10240
v_mfma_f32_16x16x32_bf16 v[232:235], a[232:235], a[28:31], v[232:235]
buffer_store_dwordx4 v[244:247], v38, s[24:27], s9 offen offset:1024 sc1
v_mfma_f32_16x16x32_bf16 v[236:239], a[236:239], a[28:31], v[236:239]
ds_read_b64_tr_b16 a[248:249], v23 offset:12288
v_cvt_pk_bf16_f32 v248, v192, v193
v_mfma_f32_16x16x32_bf16 v[228:231], a[236:239], a[24:27], v[228:231]
v_cvt_pk_bf16_f32 v249, v194, v195
v_cvt_pk_bf16_f32 v250, v196, v197
v_mfma_f32_16x16x32_bf16 v[220:223], a[236:239], a[20:23], v[220:223]
ds_read_b64_tr_b16 a[250:251], v23 offset:14336
v_cvt_pk_bf16_f32 v251, v198, v199
v_mfma_f32_16x16x32_bf16 v[212:215], a[236:239], a[16:19], v[212:215]
s_add_u32 m0, s64, 4096
s_waitcnt lgkmcnt(2)
v_mfma_f32_16x16x32_bf16 v[208:211], a[240:243], a[32:35], v[208:211]
ds_read_b64_tr_b16 a[252:253], v26 offset:12288
v_mfma_f32_16x16x32_bf16 v[216:219], a[240:243], a[36:39], v[216:219]
buffer_store_dwordx4 v[248:251], v38, s[24:27], s9 offen offset:2048 sc1
v_mfma_f32_16x16x32_bf16 v[224:227], a[240:243], a[40:43], v[224:227]
ds_read_b64_tr_b16 a[254:255], v26 offset:14336
s_add_u32 s65, s65, 36864
v_mfma_f32_16x16x32_bf16 v[232:235], a[240:243], a[44:47], v[232:235]
v_cvt_pk_bf16_f32 v252, v200, v201
v_cvt_pk_bf16_f32 v253, v202, v203
v_mfma_f32_16x16x32_bf16 v[236:239], a[244:247], a[44:47], v[236:239]
ds_read_b64_tr_b16 a[192:193], v23 offset:16384
v_cvt_pk_bf16_f32 v254, v204, v205
v_mfma_f32_16x16x32_bf16 v[228:231], a[244:247], a[40:43], v[228:231]
v_cvt_pk_bf16_f32 v255, v206, v207
v_mfma_f32_16x16x32_bf16 v[220:223], a[244:247], a[36:39], v[220:223]
ds_read_b64_tr_b16 a[194:195], v23 offset:18432
v_mfma_f32_16x16x32_bf16 v[212:215], a[244:247], a[32:35], v[212:215]
s_waitcnt lgkmcnt(2)
v_mfma_f32_16x16x32_bf16 v[208:211], a[248:251], a[48:51], v[208:211]
ds_read_b64_tr_b16 a[196:197], v26 offset:16384
v_mfma_f32_16x16x32_bf16 v[216:219], a[248:251], a[52:55], v[216:219]
buffer_load_dwordx4 v32, s[20:23], s65 offen offset:0 lds
v_mfma_f32_16x16x32_bf16 v[224:227], a[248:251], a[56:59], v[224:227]
ds_read_b64_tr_b16 a[198:199], v26 offset:18432
v_mfma_f32_16x16x32_bf16 v[232:235], a[248:251], a[60:63], v[232:235]
buffer_store_dwordx4 v[252:255], v38, s[24:27], s9 offen offset:3072 sc1
v_mfma_f32_16x16x32_bf16 v[236:239], a[252:255], a[60:63], v[236:239]
ds_read_b64_tr_b16 a[200:201], v23 offset:20480
v_mfma_f32_16x16x32_bf16 v[228:231], a[252:255], a[56:59], v[228:231]
buffer_load_dwordx4 v33, s[20:23], s65 offen offset:1024 lds
v_mfma_f32_16x16x32_bf16 v[220:223], a[252:255], a[52:55], v[220:223]
ds_read_b64_tr_b16 a[202:203], v23 offset:22528
v_mfma_f32_16x16x32_bf16 v[212:215], a[252:255], a[48:51], v[212:215]
s_waitcnt lgkmcnt(2)
v_mfma_f32_16x16x32_bf16 v[208:211], a[192:195], a[64:67], v[208:211]
ds_read_b64_tr_b16 a[204:205], v26 offset:20480
v_mfma_f32_16x16x32_bf16 v[216:219], a[192:195], a[68:71], v[216:219]
v_mfma_f32_16x16x32_bf16 v[224:227], a[192:195], a[72:75], v[224:227]
ds_read_b64_tr_b16 a[206:207], v26 offset:22528
v_mfma_f32_16x16x32_bf16 v[232:235], a[192:195], a[76:79], v[232:235]
v_mfma_f32_16x16x32_bf16 v[236:239], a[196:199], a[76:79], v[236:239]
s_waitcnt vmcnt(22)
s_barrier
v_mfma_f32_16x16x32_bf16 v[228:231], a[196:199], a[72:75], v[228:231]
ds_read_b64_tr_b16 a[208:209], v23 offset:24576
v_mfma_f32_16x16x32_bf16 v[220:223], a[196:199], a[68:71], v[220:223]
ds_read_b64_tr_b16 a[210:211], v23 offset:26624
v_mfma_f32_16x16x32_bf16 v[212:215], a[196:199], a[64:67], v[212:215]
s_waitcnt lgkmcnt(2)
v_mfma_f32_16x16x32_bf16 v[208:211], a[200:203], a[80:83], v[208:211]
ds_read_b64_tr_b16 a[212:213], v26 offset:24576
v_mfma_f32_16x16x32_bf16 v[216:219], a[200:203], a[84:87], v[216:219]
v_mfma_f32_16x16x32_bf16 v[224:227], a[200:203], a[88:91], v[224:227]
ds_read_b64_tr_b16 a[214:215], v26 offset:26624
v_mfma_f32_16x16x32_bf16 v[232:235], a[200:203], a[92:95], v[232:235]
v_mfma_f32_16x16x32_bf16 v[236:239], a[204:207], a[92:95], v[236:239]
ds_read_b64_tr_b16 a[216:217], v23 offset:28672
s_waitcnt vmcnt(6)
v_mfma_f32_16x16x32_bf16 v[228:231], a[204:207], a[88:91], v[228:231]
v_cmp_le_u32_e64 vcc, 5, v29
v_mfma_f32_16x16x32_bf16 v[220:223], a[204:207], a[84:87], v[220:223]
ds_read_b64_tr_b16 a[218:219], v23 offset:30720
v_mfma_f32_16x16x32_bf16 v[212:215], a[204:207], a[80:83], v[212:215]
s_cbranch_vccz L_slowP7
L_backP7:
s_waitcnt lgkmcnt(2)
v_mfma_f32_16x16x32_bf16 v[208:211], a[208:211], a[96:99], v[208:211]
ds_read_b64_tr_b16 a[220:221], v26 offset:28672
s_add_u32 s69, s10, s100
v_mfma_f32_16x16x32_bf16 v[216:219], a[208:211], a[100:103], v[216:219]
buffer_load_dwordx4 v[64:67], v38, s[24:27], s69 offen offset:0 sc1
v_mfma_f32_16x16x32_bf16 v[224:227], a[208:211], a[104:107], v[224:227]
ds_read_b64_tr_b16 a[222:223], v26 offset:30720
v_mfma_f32_16x16x32_bf16 v[232:235], a[208:211], a[108:111], v[232:235]
buffer_load_dwordx4 v[68:71], v38, s[24:27], s69 offen offset:1024 sc1
v_mfma_f32_16x16x32_bf16 v[236:239], a[212:215], a[108:111], v[236:239]
ds_read_b64_tr_b16 a[224:225], v23 offset:32768
v_mfma_f32_16x16x32_bf16 v[228:231], a[212:215], a[104:107], v[228:231]
buffer_load_dwordx4 v[72:75], v38, s[24:27], s69 offen offset:2048 sc1
v_mfma_f32_16x16x32_bf16 v[220:223], a[212:215], a[100:103], v[220:223]
ds_read_b64_tr_b16 a[226:227], v23 offset:34816
v_mfma_f32_16x16x32_bf16 v[212:215], a[212:215], a[96:99], v[212:215]
s_waitcnt lgkmcnt(2)
v_mfma_f32_16x16x32_bf16 v[208:211], a[216:219], a[112:115], v[208:211]
ds_read_b64_tr_b16 a[228:229], v26 offset:32768
v_mfma_f32_16x16x32_bf16 v[216:219], a[216:219], a[116:119], v[216:219]
buffer_load_dwordx4 v[76:79], v38, s[24:27], s69 offen offset:3072 sc1
v_mfma_f32_16x16x32_bf16 v[224:227], a[216:219], a[120:123], v[224:227]
ds_read_b64_tr_b16 a[230:231], v26 offset:34816
s_add_u32 m0, s36, 0
v_mfma_f32_16x16x32_bf16 v[232:235], a[216:219], a[124:127], v[232:235]
buffer_load_dwordx4 v30, s[12:15], s60 offen lds
v_mfma_f32_16x16x32_bf16 v[236:239], a[220:223], a[124:127], v[236:239]
ds_read_b64_tr_b16 a[232:233], v23 offset:36864
s_add_u32 m0, s36, 1024
v_mfma_f32_16x16x32_bf16 v[228:231], a[220:223], a[120:123], v[228:231]
buffer_load_dwordx4 v30, s[12:15], s61 offen lds
v_mfma_f32_16x16x32_bf16 v[220:223], a[220:223], a[116:119], v[220:223]
ds_read_b64_tr_b16 a[234:235], v23 offset:38912
s_add_u32 m0, s36, 2048
v_mfma_f32_16x16x32_bf16 v[212:215], a[220:223], a[112:115], v[212:215]
s_waitcnt lgkmcnt(2)
v_mfma_f32_16x16x32_bf16 v[208:211], a[224:227], a[128:131], v[208:211]
ds_read_b64_tr_b16 a[236:237], v26 offset:36864
v_mfma_f32_16x16x32_bf16 v[216:219], a[224:227], a[132:135], v[216:219]
buffer_load_dwordx4 v30, s[12:15], s62 offen lds
v_mfma_f32_16x16x32_bf16 v[224:227], a[224:227], a[136:139], v[224:227]
ds_read_b64_tr_b16 a[238:239], v26 offset:38912
v_mfma_f32_16x16x32_bf16 v[232:235], a[224:227], a[140:143], v[232:235]
buffer_load_dword v42, v28, s[24:27], 0 offen sc1
v_mfma_f32_16x16x32_bf16 v[236:239], a[228:231], a[140:143], v[236:239]
ds_read_b64_tr_b16 a[240:241], v23 offset:40960
v_mfma_f32_16x16x32_bf16 v[228:231], a[228:231], a[136:139], v[228:231]
v_mfma_f32_16x16x32_bf16 v[220:223], a[228:231], a[132:135], v[220:223]
ds_read_b64_tr_b16 a[242:243], v23 offset:43008
v_mfma_f32_16x16x32_bf16 v[212:215], a[228:231], a[128:131], v[212:215]
s_waitcnt lgkmcnt(2)
v_mfma_f32_16x16x32_bf16 v[208:211], a[232:235], a[144:147], v[208:211]
ds_read_b64_tr_b16 a[244:245], v26 offset:40960
v_mfma_f32_16x16x32_bf16 v[216:219], a[232:235], a[148:151], v[216:219]
v_mfma_f32_16x16x32_bf16 v[224:227], a[232:235], a[152:155], v[224:227]
ds_read_b64_tr_b16 a[246:247], v26 offset:43008
v_mfma_f32_16x16x32_bf16 v[232:235], a[232:235], a[156:159], v[232:235]
v_mfma_f32_16x16x32_bf16 v[236:239], a[236:239], a[156:159], v[236:239]
ds_read_b64_tr_b16 a[248:249], v23 offset:45056
v_mfma_f32_16x16x32_bf16 v[228:231], a[236:239], a[152:155], v[228:231]
v_mfma_f32_16x16x32_bf16 v[220:223], a[236:239], a[148:151], v[220:223]
ds_read_b64_tr_b16 a[250:251], v23 offset:47104
v_mfma_f32_16x16x32_bf16 v[212:215], a[236:239], a[144:147], v[212:215]
s_waitcnt lgkmcnt(2)
v_mfma_f32_16x16x32_bf16 v[208:211], a[240:243], a[160:163], v[208:211]
ds_read_b64_tr_b16 a[252:253], v26 offset:45056
v_mfma_f32_16x16x32_bf16 v[216:219], a[240:243], a[164:167], v[216:219]
v_mfma_f32_16x16x32_bf16 v[224:227], a[240:243], a[168:171], v[224:227]
ds_read_b64_tr_b16 a[254:255], v26 offset:47104
v_mfma_f32_16x16x32_bf16 v[232:235], a[240:243], a[172:175], v[232:235]
v_mfma_f32_16x16x32_bf16 v[236:239], a[244:247], a[172:175], v[236:239]
s_waitcnt vmcnt(18)
s_barrier
v_mfma_f32_16x16x32_bf16 v[228:231], a[244:247], a[168:171], v[228:231]
ds_read_b64_tr_b16 a[192:193], v24 offset:0
v_mfma_f32_16x16x32_bf16 v[220:223], a[244:247], a[164:167], v[220:223]
ds_read_b64_tr_b16 a[194:195], v24 offset:2048
v_mfma_f32_16x16x32_bf16 v[212:215], a[244:247], a[160:163], v[212:215]
s_waitcnt lgkmcnt(2)
v_mfma_f32_16x16x32_bf16 v[208:211], a[248:251], a[176:179], v[208:211]
ds_read_b64_tr_b16 a[196:197], v27 offset:0
v_mfma_f32_16x16x32_bf16 v[216:219], a[248:251], a[180:183], v[216:219]
v_mfma_f32_16x16x32_bf16 v[224:227], a[248:251], a[184:187], v[224:227]
ds_read_b64_tr_b16 a[198:199], v27 offset:2048
v_mfma_f32_16x16x32_bf16 v[232:235], a[248:251], a[188:191], v[232:235]
v_mfma_f32_16x16x32_bf16 v[236:239], a[252:255], a[188:191], v[236:239]
ds_read_b64_tr_b16 a[200:201], v24 offset:4096
v_mfma_f32_16x16x32_bf16 v[228:231], a[252:255], a[184:187], v[228:231]
v_mfma_f32_16x16x32_bf16 v[220:223], a[252:255], a[180:183], v[220:223]
ds_read_b64_tr_b16 a[202:203], v24 offset:6144
v_mfma_f32_16x16x32_bf16 v[212:215], a[252:255], a[176:179], v[212:215]
s_waitcnt lgkmcnt(2)
s_waitcnt vmcnt(4)
v_mfma_f32_16x16x32_bf16 v[208:211], v[18:21], v[64:67], v[208:211]
v_mfma_f32_16x16x32_bf16 v[216:219], v[18:21], v[68:71], v[216:219]
v_mfma_f32_16x16x32_bf16 v[224:227], v[18:21], v[72:75], v[224:227]
v_mfma_f32_16x16x32_bf16 v[232:235], v[18:21], v[76:79], v[232:235]
v_mfma_f32_16x16x32_bf16 v[212:215], v[16:19], v[64:67], v[212:215]
v_mfma_f32_16x16x32_bf16 v[220:223], v[16:19], v[68:71], v[220:223]
v_mfma_f32_16x16x32_bf16 v[228:231], v[16:19], v[72:75], v[228:231]
v_mfma_f32_16x16x32_bf16 v[236:239], v[16:19], v[76:79], v[236:239]
v_mfma_f32_16x16x32_bf16 v[112:115], a[192:195], a[0:3], 0
ds_read_b64_tr_b16 a[204:205], v27 offset:4096
v_mfma_f32_16x16x32_bf16 v[120:123], a[192:195], a[4:7], 0
v_mfma_f32_16x16x32_bf16 v[128:131], a[192:195], a[8:11], 0
ds_read_b64_tr_b16 a[206:207], v27 offset:6144
v_mfma_f32_16x16x32_bf16 v[136:139], a[192:195], a[12:15], 0
v_mfma_f32_16x16x32_bf16 v[140:143], a[196:199], a[12:15], 0
ds_read_b64_tr_b16 a[208:209], v24 offset:8192
v_cvt_pk_bf16_f32 v244, v216, v217
v_mfma_f32_16x16x32_bf16 v[132:135], a[196:199], a[8:11], 0
v_cvt_pk_bf16_f32 v245, v218, v219
v_cvt_pk_bf16_f32 v246, v220, v221
v_mfma_f32_16x16x32_bf16 v[124:127], a[196:199], a[4:7], 0
ds_read_b64_tr_b16 a[210:211], v24 offset:10240
v_cvt_pk_bf16_f32 v247, v222, v223
v_mfma_f32_16x16x32_bf16 v[116:119], a[196:199], a[0:3], 0
buffer_load_dword v29, v43, s[24:27], 0 offen sc1
s_waitcnt lgkmcnt(2)
v_mfma_f32_16x16x32_bf16 v[112:115], a[200:203], a[16:19], v[112:115]
ds_read_b64_tr_b16 a[212:213], v27 offset:8192
v_mfma_f32_16x16x32_bf16 v[120:123], a[200:203], a[20:23], v[120:123]
buffer_store_dwordx4 v[244:247], v38, s[24:27], s10 offen offset:1024 sc1
v_mfma_f32_16x16x32_bf16 v[128:131], a[200:203], a[24:27], v[128:131]
ds_read_b64_tr_b16 a[214:215], v27 offset:10240
v_cvt_pk_bf16_f32 v248, v224, v225
v_mfma_f32_16x16x32_bf16 v[136:139], a[200:203], a[28:31], v[136:139]
v_cvt_pk_bf16_f32 v249, v226, v227
v_cvt_pk_bf16_f32 v250, v228, v229
v_mfma_f32_16x16x32_bf16 v[140:143], a[204:207], a[28:31], v[140:143]
ds_read_b64_tr_b16 a[216:217], v24 offset:12288
v_cvt_pk_bf16_f32 v251, v230, v231
v_mfma_f32_16x16x32_bf16 v[132:135], a[204:207], a[24:27], v[132:135]
buffer_store_dwordx4 v[248:251], v38, s[24:27], s10 offen offset:2048 sc1
v_mfma_f32_16x16x32_bf16 v[124:127], a[204:207], a[20:23], v[124:127]
ds_read_b64_tr_b16 a[218:219], v24 offset:14336
v_cvt_pk_bf16_f32 v252, v232, v233
v_mfma_f32_16x16x32_bf16 v[116:119], a[204:207], a[16:19], v[116:119]
v_cvt_pk_bf16_f32 v253, v234, v235
s_waitcnt lgkmcnt(2)
v_mfma_f32_16x16x32_bf16 v[112:115], a[208:211], a[32:35], v[112:115]
ds_read_b64_tr_b16 a[220:221], v27 offset:12288
v_cvt_pk_bf16_f32 v254, v236, v237
v_mfma_f32_16x16x32_bf16 v[120:123], a[208:211], a[36:39], v[120:123]
v_cvt_pk_bf16_f32 v255, v238, v239
v_mfma_f32_16x16x32_bf16 v[128:131], a[208:211], a[40:43], v[128:131]
ds_read_b64_tr_b16 a[222:223], v27 offset:14336
v_mfma_f32_16x16x32_bf16 v[136:139], a[208:211], a[44:47], v[136:139]
buffer_store_dwordx4 v[252:255], v38, s[24:27], s10 offen offset:3072 sc1
v_mfma_f32_16x16x32_bf16 v[140:143], a[212:215], a[44:47], v[140:143]
ds_read_b64_tr_b16 a[224:225], v24 offset:16384
v_mfma_f32_16x16x32_bf16 v[132:135], a[212:215], a[40:43], v[132:135]
v_mfma_f32_16x16x32_bf16 v[124:127], a[212:215], a[36:39], v[124:127]
ds_read_b64_tr_b16 a[226:227], v24 offset:18432
v_mfma_f32_16x16x32_bf16 v[116:119], a[212:215], a[32:35], v[116:119]
s_waitcnt lgkmcnt(2)
v_mfma_f32_16x16x32_bf16 v[112:115], a[216:219], a[48:51], v[112:115]
ds_read_b64_tr_b16 a[228:229], v27 offset:16384
v_mfma_f32_16x16x32_bf16 v[120:123], a[216:219], a[52:55], v[120:123]
v_mfma_f32_16x16x32_bf16 v[128:131], a[216:219], a[56:59], v[128:131]
ds_read_b64_tr_b16 a[230:231], v27 offset:18432
v_mfma_f32_16x16x32_bf16 v[136:139], a[216:219], a[60:63], v[136:139]
v_mfma_f32_16x16x32_bf16 v[140:143], a[220:223], a[60:63], v[140:143]
ds_read_b64_tr_b16 a[232:233], v24 offset:20480
v_mfma_f32_16x16x32_bf16 v[132:135], a[220:223], a[56:59], v[132:135]
v_mfma_f32_16x16x32_bf16 v[124:127], a[220:223], a[52:55], v[124:127]
ds_read_b64_tr_b16 a[234:235], v24 offset:22528
v_mfma_f32_16x16x32_bf16 v[116:119], a[220:223], a[48:51], v[116:119]
s_waitcnt lgkmcnt(2)
v_mfma_f32_16x16x32_bf16 v[112:115], a[224:227], a[64:67], v[112:115]
ds_read_b64_tr_b16 a[236:237], v27 offset:20480
v_mfma_f32_16x16x32_bf16 v[120:123], a[224:227], a[68:71], v[120:123]
v_mfma_f32_16x16x32_bf16 v[128:131], a[224:227], a[72:75], v[128:131]
ds_read_b64_tr_b16 a[238:239], v27 offset:22528
v_mfma_f32_16x16x32_bf16 v[136:139], a[224:227], a[76:79], v[136:139]
v_mfma_f32_16x16x32_bf16 v[140:143], a[228:231], a[76:79], v[140:143]
s_waitcnt vmcnt(12)
s_barrier
v_mfma_f32_16x16x32_bf16 v[132:135], a[228:231], a[72:75], v[132:135]
ds_read_b64_tr_b16 a[240:241], v22 offset:0
v_mfma_f32_16x16x32_bf16 v[124:127], a[228:231], a[68:71], v[124:127]
ds_read_b64_tr_b16 a[242:243], v22 offset:2048
v_mfma_f32_16x16x32_bf16 v[116:119], a[228:231], a[64:67], v[116:119]
s_waitcnt lgkmcnt(2)
v_mfma_f32_16x16x32_bf16 v[112:115], a[232:235], a[80:83], v[112:115]
ds_read_b64_tr_b16 a[244:245], v25 offset:0
v_mfma_f32_16x16x32_bf16 v[120:123], a[232:235], a[84:87], v[120:123]
v_mfma_f32_16x16x32_bf16 v[128:131], a[232:235], a[88:91], v[128:131]
ds_read_b64_tr_b16 a[246:247], v25 offset:2048
v_mfma_f32_16x16x32_bf16 v[136:139], a[232:235], a[92:95], v[136:139]
v_mfma_f32_16x16x32_bf16 v[140:143], a[236:239], a[92:95], v[140:143]
ds_read_b64_tr_b16 a[248:249], v22 offset:4096
s_waitcnt vmcnt(3)
v_mfma_f32_16x16x32_bf16 v[132:135], a[236:239], a[88:91], v[132:135]
v_cmp_le_u32 vcc, 6, v29
v_mfma_f32_16x16x32_bf16 v[124:127], a[236:239], a[84:87], v[124:127]
ds_read_b64_tr_b16 a[250:251], v22 offset:6144
v_mfma_f32_16x16x32_bf16 v[116:119], a[236:239], a[80:83], v[116:119]
s_cbranch_vccz L_slowP8
L_backP8:
s_waitcnt lgkmcnt(2)
v_mfma_f32_16x16x32_bf16 v[112:115], a[240:243], a[96:99], v[112:115]
ds_read_b64_tr_b16 a[252:253], v25 offset:4096
s_add_u32 s69, s11, s100
v_mfma_f32_16x16x32_bf16 v[120:123], a[240:243], a[100:103], v[120:123]
buffer_load_dwordx4 v[48:51], v38, s[24:27], s69 offen offset:0 sc1
v_mfma_f32_16x16x32_bf16 v[128:131], a[240:243], a[104:107], v[128:131]
ds_read_b64_tr_b16 a[254:255], v25 offset:6144
v_mfma_f32_16x16x32_bf16 v[136:139], a[240:243], a[108:111], v[136:139]
buffer_load_dwordx4 v[52:55], v38, s[24:27], s69 offen offset:1024 sc1
v_mfma_f32_16x16x32_bf16 v[140:143], a[244:247], a[108:111], v[140:143]
ds_read_b64_tr_b16 a[192:193], v22 offset:8192
s_waitcnt vmcnt(6)
v_mfma_f32_16x16x32_bf16 v[132:135], a[244:247], a[104:107], v[132:135]
buffer_load_dwordx4 v[56:59], v38, s[24:27], s69 offen offset:2048 sc1
v_mfma_f32_16x16x32_bf16 v[124:127], a[244:247], a[100:103], v[124:127]
ds_read_b64_tr_b16 a[194:195], v22 offset:10240
v_cmp_le_u32 s[70:71], 9, v42
v_mfma_f32_16x16x32_bf16 v[116:119], a[244:247], a[96:99], v[116:119]
s_and_b32 s66, s70, s52
s_cmp_eq_u32 s66, s52
s_cselect_b32 s18, 100663296, 0
s_cselect_b32 s54, 1, 0
s_waitcnt lgkmcnt(2)
v_mfma_f32_16x16x32_bf16 v[112:115], a[248:251], a[112:115], v[112:115]
ds_read_b64_tr_b16 a[196:197], v25 offset:8192
ds_read_b64 v[92:93], v1 offset:0
v_mfma_f32_16x16x32_bf16 v[120:123], a[248:251], a[116:119], v[120:123]
buffer_load_dwordx4 v[60:63], v38, s[24:27], s69 offen offset:3072 sc1
v_mfma_f32_16x16x32_bf16 v[128:131], a[248:251], a[120:123], v[128:131]
ds_read_b64_tr_b16 a[198:199], v25 offset:10240
ds_read_b64 v[94:95], v1 offset:32
v_mfma_f32_16x16x32_bf16 v[136:139], a[248:251], a[124:127], v[136:139]
ds_read_b64 v[96:97], v1 offset:1024
ds_read_b64 v[98:99], v1 offset:1056
v_mfma_f32_16x16x32_bf16 v[140:143], a[252:255], a[124:127], v[140:143]
ds_read_b64_tr_b16 a[200:201], v22 offset:12288
ds_read_b64 v[100:101], v1 offset:2048
v_mfma_f32_16x16x32_bf16 v[132:135], a[252:255], a[120:123], v[132:135]
ds_read_b64 v[102:103], v1 offset:2080
s_lshl_b32 s69, s60, 4
v_mfma_f32_16x16x32_bf16 v[124:127], a[252:255], a[116:119], v[124:127]
ds_read_b64_tr_b16 a[202:203], v22 offset:14336
s_add_u32 s69, s69, s50
v_mfma_f32_16x16x32_bf16 v[116:119], a[252:255], a[112:115], v[116:119]
s_waitcnt lgkmcnt(7)
v_mfma_f32_16x16x32_bf16 v[112:115], a[192:195], a[128:131], v[112:115]
ds_read_b64_tr_b16 a[204:205], v25 offset:12288
v_mfma_f32_16x16x32_bf16 v[120:123], a[192:195], a[132:135], v[120:123]
buffer_load_dwordx2 v[80:81], v41, s[16:19], s69 offen offset:0 sc1
v_mfma_f32_16x16x32_bf16 v[128:131], a[192:195], a[136:139], v[128:131]
ds_read_b64_tr_b16 a[206:207], v25 offset:14336
v_mfma_f32_16x16x32_bf16 v[136:139], a[192:195], a[140:143], v[136:139]
buffer_load_dwordx2 v[82:83], v41, s[16:19], s69 offen offset:512 sc1
v_mfma_f32_16x16x32_bf16 v[140:143], a[196:199], a[140:143], v[140:143]
ds_read_b64_tr_b16 a[208:209], v22 offset:16384
s_lshl_b32 s69, s61, 4
v_mfma_f32_16x16x32_bf16 v[132:135], a[196:199], a[136:139], v[132:135]
s_add_u32 s69, s69, s50
v_mfma_f32_16x16x32_bf16 v[124:127], a[196:199], a[132:135], v[124:127]
ds_read_b64_tr_b16 a[210:211], v22 offset:18432
v_mfma_f32_16x16x32_bf16 v[116:119], a[196:199], a[128:131], v[116:119]
s_waitcnt lgkmcnt(2)
v_mfma_f32_16x16x32_bf16 v[112:115], a[200:203], a[144:147], v[112:115]
ds_read_b64_tr_b16 a[212:213], v25 offset:16384
v_mfma_f32_16x16x32_bf16 v[120:123], a[200:203], a[148:151], v[120:123]
buffer_load_dwordx2 v[84:85], v41, s[16:19], s69 offen offset:0 sc1
v_mfma_f32_16x16x32_bf16 v[128:131], a[200:203], a[152:155], v[128:131]
ds_read_b64_tr_b16 a[214:215], v25 offset:18432
v_mfma_f32_16x16x32_bf16 v[136:139], a[200:203], a[156:159], v[136:139]
buffer_load_dwordx2 v[86:87], v41, s[16:19], s69 offen offset:512 sc1
v_mfma_f32_16x16x32_bf16 v[140:143], a[204:207], a[156:159], v[140:143]
ds_read_b64_tr_b16 a[216:217], v22 offset:20480
s_lshl_b32 s69, s62, 4
v_mfma_f32_16x16x32_bf16 v[132:135], a[204:207], a[152:155], v[132:135]
s_add_u32 s69, s69, s50
v_mfma_f32_16x16x32_bf16 v[124:127], a[204:207], a[148:151], v[124:127]
ds_read_b64_tr_b16 a[218:219], v22 offset:22528
v_mfma_f32_16x16x32_bf16 v[116:119], a[204:207], a[144:147], v[116:119]
s_waitcnt lgkmcnt(2)
v_mfma_f32_16x16x32_bf16 v[112:115], a[208:211], a[160:163], v[112:115]
ds_read_b64_tr_b16 a[220:221], v25 offset:20480
v_mfma_f32_16x16x32_bf16 v[120:123], a[208:211], a[164:167], v[120:123]
buffer_load_dwordx2 v[88:89], v41, s[16:19], s69 offen offset:0 sc1
v_mfma_f32_16x16x32_bf16 v[128:131], a[208:211], a[168:171], v[128:131]
ds_read_b64_tr_b16 a[222:223], v25 offset:22528
v_mfma_f32_16x16x32_bf16 v[136:139], a[208:211], a[172:175], v[136:139]
buffer_load_dwordx2 v[90:91], v41, s[16:19], s69 offen offset:512 sc1
v_mfma_f32_16x16x32_bf16 v[140:143], a[212:215], a[172:175], v[140:143]
buffer_load_dword v29, v28, s[24:27], 0 offen sc1
v_mfma_f32_16x16x32_bf16 v[132:135], a[212:215], a[168:171], v[132:135]
v_mov_b32_e64 v31, 8
s_waitcnt vmcnt(11)
v_mfma_f32_16x16x32_bf16 v[124:127], a[212:215], a[164:167], v[124:127]
buffer_store_dword v31, v39, s[24:27], 0 offen sc1
v_mfma_f32_16x16x32_bf16 v[116:119], a[212:215], a[160:163], v[116:119]
s_waitcnt lgkmcnt(0)
v_mfma_f32_16x16x32_bf16 v[112:115], a[216:219], a[176:179], v[112:115]
v_mfma_f32_16x16x32_bf16 v[120:123], a[216:219], a[180:183], v[120:123]
v_mfma_f32_16x16x32_bf16 v[128:131], a[216:219], a[184:187], v[128:131]
v_mfma_f32_16x16x32_bf16 v[136:139], a[216:219], a[188:191], v[136:139]
v_mfma_f32_16x16x32_bf16 v[140:143], a[220:223], a[188:191], v[140:143]
v_mfma_f32_16x16x32_bf16 v[132:135], a[220:223], a[184:187], v[132:135]
v_mfma_f32_16x16x32_bf16 v[124:127], a[220:223], a[180:183], v[124:127]
v_mfma_f32_16x16x32_bf16 v[116:119], a[220:223], a[176:179], v[116:119]
s_waitcnt vmcnt(8)
v_mfma_f32_16x16x32_bf16 v[112:115], v[18:21], v[48:51], v[112:115]
v_mfma_f32_16x16x32_bf16 v[120:123], v[18:21], v[52:55], v[120:123]
v_mfma_f32_16x16x32_bf16 v[128:131], v[18:21], v[56:59], v[128:131]
v_mfma_f32_16x16x32_bf16 v[136:139], v[18:21], v[60:63], v[136:139]
v_mfma_f32_16x16x32_bf16 v[116:119], v[16:19], v[48:51], v[116:119]
v_mfma_f32_16x16x32_bf16 v[124:127], v[16:19], v[52:55], v[124:127]
v_mfma_f32_16x16x32_bf16 v[132:135], v[16:19], v[56:59], v[132:135]
v_mfma_f32_16x16x32_bf16 v[140:143], v[16:19], v[60:63], v[140:143]
s_nop 1
v_cvt_pk_bf16_f32 v244, v120, v121
v_cvt_pk_bf16_f32 v245, v122, v123
s_nop 1
v_cvt_pk_bf16_f32 v246, v124, v125
v_cvt_pk_bf16_f32 v247, v126, v127
buffer_store_dwordx4 v[244:247], v38, s[24:27], s11 offen offset:1024 sc1
v_cvt_pk_bf16_f32 v248, v128, v129
v_cvt_pk_bf16_f32 v249, v130, v131
v_cvt_pk_bf16_f32 v250, v132, v133
v_cvt_pk_bf16_f32 v251, v134, v135
buffer_store_dwordx4 v[248:251], v38, s[24:27], s11 offen offset:2048 sc1
v_cvt_pk_bf16_f32 v252, v136, v137
v_cvt_pk_bf16_f32 v253, v138, v139
v_cvt_pk_bf16_f32 v254, v140, v141
v_cvt_pk_bf16_f32 v255, v142, v143
buffer_store_dwordx4 v[252:255], v38, s[24:27], s11 offen offset:3072 sc1
s_waitcnt vmcnt(4)
v_cmp_le_u32 vcc, 8, v29
s_and_b32 s66, vcc_lo, s53
s_cmp_eq_u32 s66, s53
s_cselect_b32 s18, 100663296, 0
s_cselect_b32 s55, 1, 0
s_add_u32 s67, s9, s49
s_add_u32 s69, s67, s97
buffer_load_dwordx4 a[0:3], v38, s[16:19], s69 offen sc1
s_add_u32 s69, s67, s98
buffer_load_dwordx4 a[4:7], v38, s[16:19], s69 offen sc1
s_add_u32 s69, s67, s99
buffer_load_dwordx4 a[8:11], v38, s[16:19], s69 offen sc1
s_add_u32 s67, s10, s49
s_add_u32 s69, s67, s97
buffer_load_dwordx4 a[12:15], v38, s[16:19], s69 offen sc1
s_add_u32 s69, s67, s98
buffer_load_dwordx4 a[16:19], v38, s[16:19], s69 offen sc1
s_add_u32 s69, s67, s99
buffer_load_dwordx4 a[20:23], v38, s[16:19], s69 offen sc1
v_cmp_le_u32 vcc, 9, v29
s_and_b32 s66, vcc_lo, s53
s_cmp_eq_u32 s66, s53
s_cselect_b32 s18, 100663296, 0
s_cselect_b32 s56, 1, 0
s_add_u32 s67, s11, s49
s_add_u32 s69, s67, s97
buffer_load_dwordx4 a[24:27], v38, s[16:19], s69 offen sc1
s_add_u32 s69, s67, s98
buffer_load_dwordx4 a[28:31], v38, s[16:19], s69 offen sc1
s_add_u32 s69, s67, s99
buffer_load_dwordx4 a[32:35], v38, s[16:19], s69 offen sc1
v_mov_b32 v31, 9
s_mov_b32 s71, 0x3fb8aa3b
v_lshlrev_b32 v144, 16, v92
v_and_b32 v145, s57, v92
v_lshlrev_b32 v146, 16, v93
v_and_b32 v147, s57, v93
v_lshlrev_b32 v148, 16, v94
v_and_b32 v149, s57, v94
v_lshlrev_b32 v150, 16, v95
v_and_b32 v151, s57, v95
v_lshlrev_b32 v152, 16, v96
v_and_b32 v153, s57, v96
v_lshlrev_b32 v154, 16, v97
v_and_b32 v155, s57, v97
v_lshlrev_b32 v156, 16, v98
v_and_b32 v157, s57, v98
v_lshlrev_b32 v158, 16, v99
v_and_b32 v159, s57, v99
v_lshlrev_b32 v160, 16, v100
v_and_b32 v161, s57, v100
v_lshlrev_b32 v162, 16, v101
v_and_b32 v163, s57, v101
v_lshlrev_b32 v164, 16, v102
v_and_b32 v165, s57, v102
v_lshlrev_b32 v166, 16, v103
v_and_b32_e64 v167, s57, v103
s_waitcnt vmcnt(9)
buffer_store_dword v31, v39, s[24:27], 0 offen sc1
s_cmp_eq_u32 s54, 1
s_cbranch_scc1 L_chk8
v_cmp_le_u32_e64 vcc, 9, v29
s_and_b32 s66, vcc_lo, s52
s_cmp_eq_u32 s66, s52
s_cbranch_scc0 L_chk8
s_mov_b32 s54, 1
s_lshl_b32 s69, s60, 4
s_add_u32 s69, s69, s50
buffer_load_dwordx2 v[80:81], v41, s[24:27], s69 offen offset:0 sc1
buffer_load_dwordx2 v[82:83], v41, s[24:27], s69 offen offset:512 sc1
s_lshl_b32 s69, s61, 4
s_add_u32 s69, s69, s50
buffer_load_dwordx2 v[84:85], v41, s[24:27], s69 offen offset:0 sc1
buffer_load_dwordx2 v[86:87], v41, s[24:27], s69 offen offset:512 sc1
s_lshl_b32 s69, s62, 4
s_add_u32 s69, s69, s50
buffer_load_dwordx2 v[88:89], v41, s[24:27], s69 offen offset:0 sc1
buffer_load_dwordx2 v[90:91], v41, s[24:27], s69 offen offset:512 sc1
L_chk8:
s_cmp_eq_u32 s55, 1
s_cbranch_scc1 L_have8
s_mov_b32 s68, 0
L_spin8:
buffer_load_dword v29, v28, s[24:27], 0 offen sc1
s_waitcnt vmcnt(0)
v_cmp_le_u32 vcc, 8, v29
s_and_b32 s66, vcc_lo, s53
s_cmp_eq_u32 s66, s53
s_cbranch_scc1 L_done8
s_sleep 4
s_add_u32 s68, s68, 1
s_cmp_lt_u32 s68, 0x80000
s_cbranch_scc1 L_spin8
L_done8:
s_add_u32 s67, s9, s49
s_add_u32 s69, s67, s97
buffer_load_dwordx4 a[0:3], v38, s[24:27], s69 offen sc1
s_add_u32 s69, s67, s98
buffer_load_dwordx4 a[4:7], v38, s[24:27], s69 offen sc1
s_add_u32 s69, s67, s99
buffer_load_dwordx4 a[8:11], v38, s[24:27], s69 offen sc1
s_add_u32 s67, s10, s49
s_add_u32 s69, s67, s97
buffer_load_dwordx4 a[12:15], v38, s[24:27], s69 offen sc1
s_add_u32 s69, s67, s98
buffer_load_dwordx4 a[16:19], v38, s[24:27], s69 offen sc1
s_add_u32 s69, s67, s99
buffer_load_dwordx4 a[20:23], v38, s[24:27], s69 offen sc1
v_cmp_le_u32 vcc, 9, v29
s_and_b32 s66, vcc_lo, s53
s_cmp_eq_u32 s66, s53
s_cselect_b32 s18, 100663296, 0
s_cselect_b32 s56, 1, 0
s_add_u32 s67, s11, s49
s_add_u32 s69, s67, s97
buffer_load_dwordx4 a[24:27], v38, s[16:19], s69 offen sc1
s_add_u32 s69, s67, s98
buffer_load_dwordx4 a[28:31], v38, s[16:19], s69 offen sc1
s_add_u32 s69, s67, s99
buffer_load_dwordx4 a[32:35], v38, s[16:19], s69 offen sc1
s_waitcnt vmcnt(3)
L_have8:
buffer_load_dword v29, v28, s[24:27], 0 offen sc1
s_waitcnt vmcnt(5)
v_mfma_f32_16x16x32_bf16 v[176:179], v[18:21], a[0:3], v[176:179]
v_mfma_f32_16x16x32_bf16 v[180:183], v[16:19], a[0:3], v[180:183]
v_mfma_f32_16x16x32_bf16 v[176:179], v[18:21], a[4:7], v[176:179]
v_mfma_f32_16x16x32_bf16 v[180:183], v[16:19], a[4:7], v[180:183]
v_mfma_f32_16x16x32_bf16 v[176:179], v[18:21], a[8:11], v[176:179]
v_mfma_f32_16x16x32_bf16 v[180:183], v[16:19], a[8:11], v[180:183]
v_mfma_f32_16x16x32_bf16 v[208:211], v[18:21], a[12:15], v[208:211]
v_mfma_f32_16x16x32_bf16 v[212:215], v[16:19], a[12:15], v[212:215]
v_mfma_f32_16x16x32_bf16 v[208:211], v[18:21], a[16:19], v[208:211]
v_mfma_f32_16x16x32_bf16 v[212:215], v[16:19], a[16:19], v[212:215]
v_mfma_f32_16x16x32_bf16 v[208:211], v[18:21], a[20:23], v[208:211]
v_mfma_f32_16x16x32_bf16 v[212:215], v[16:19], a[20:23], v[212:215]
s_nop 0
v_exp_f32_e64 v192, -v176
v_exp_f32_e64 v193, -v177
v_exp_f32_e64 v194, -v178
v_exp_f32_e64 v195, -v179
v_exp_f32_e64 v196, -v180
v_exp_f32_e64 v197, -v181
v_exp_f32_e64 v198, -v182
v_exp_f32_e64 v199, -v183
v_fma_f32 v192, v192, s71, s71
v_fma_f32 v193, v193, s71, s71
v_fma_f32 v194, v194, s71, s71
v_fma_f32 v195, v195, s71, s71
v_fma_f32 v196, v196, s71, s71
v_fma_f32 v197, v197, s71, s71
v_fma_f32 v198, v198, s71, s71
v_fma_f32 v199, v199, s71, s71
v_rcp_f32 v192, v192
v_rcp_f32 v193, v193
v_rcp_f32 v194, v194
v_rcp_f32 v195, v195
v_rcp_f32 v196, v196
v_rcp_f32 v197, v197
v_rcp_f32 v198, v198
v_rcp_f32 v199, v199
v_mul_f32 v176, v176, v192
v_mul_f32 v177, v177, v193
v_mul_f32 v178, v178, v194
v_mul_f32 v179, v179, v195
v_mul_f32 v180, v180, v196
v_mul_f32 v181, v181, v197
v_mul_f32 v182, v182, v198
v_mul_f32 v183, v183, v199
v_exp_f32_e64 v224, -v208
v_exp_f32_e64 v225, -v209
v_exp_f32_e64 v226, -v210
v_exp_f32_e64 v227, -v211
v_exp_f32_e64 v228, -v212
v_exp_f32_e64 v229, -v213
v_exp_f32_e64 v230, -v214
v_exp_f32_e64 v231, -v215
v_fma_f32 v224, v224, s71, s71
v_fma_f32 v225, v225, s71, s71
v_fma_f32 v226, v226, s71, s71
v_fma_f32 v227, v227, s71, s71
v_fma_f32 v228, v228, s71, s71
v_fma_f32 v229, v229, s71, s71
v_fma_f32 v230, v230, s71, s71
v_fma_f32 v231, v231, s71, s71
v_rcp_f32 v224, v224
v_rcp_f32 v225, v225
v_rcp_f32 v226, v226
v_rcp_f32 v227, v227
v_rcp_f32 v228, v228
v_rcp_f32 v229, v229
v_rcp_f32 v230, v230
v_rcp_f32 v231, v231
v_mul_f32 v208, v208, v224
v_mul_f32 v209, v209, v225
v_mul_f32 v210, v210, v226
v_mul_f32 v211, v211, v227
v_mul_f32 v212, v212, v228
v_mul_f32 v213, v213, v229
v_mul_f32 v214, v214, v230
v_mul_f32 v215, v215, v231
s_waitcnt vmcnt(0)
s_cmp_eq_u32 s54, 1
s_cbranch_scc1 L_chk9
v_cmp_le_u32 vcc, 9, v29
s_and_b32 s66, vcc_lo, s52
s_cmp_eq_u32 s66, s52
s_cbranch_scc0 L_chk9
s_mov_b32 s54, 1
s_lshl_b32 s69, s60, 4
s_add_u32 s69, s69, s50
buffer_load_dwordx2 v[80:81], v41, s[24:27], s69 offen offset:0 sc1
buffer_load_dwordx2 v[82:83], v41, s[24:27], s69 offen offset:512 sc1
s_lshl_b32 s69, s61, 4
s_add_u32 s69, s69, s50
buffer_load_dwordx2 v[84:85], v41, s[24:27], s69 offen offset:0 sc1
buffer_load_dwordx2 v[86:87], v41, s[24:27], s69 offen offset:512 sc1
s_lshl_b32 s69, s62, 4
s_add_u32 s69, s69, s50
buffer_load_dwordx2 v[88:89], v41, s[24:27], s69 offen offset:0 sc1
buffer_load_dwordx2 v[90:91], v41, s[24:27], s69 offen offset:512 sc1
L_chk9:
s_cmp_eq_u32 s56, 1
s_cbranch_scc0 L_no9
s_waitcnt vmcnt(0)
s_branch L_have9
L_no9:
v_cmp_le_u32_e64 vcc, 9, v29
s_and_b32 s66, vcc_lo, s53
s_cmp_eq_u32 s66, s53
s_cbranch_scc1 L_done9
s_mov_b32 s68, 0
L_spin9:
buffer_load_dword v29, v28, s[24:27], 0 offen sc1
s_waitcnt vmcnt(0)
v_cmp_le_u32_e64 vcc, 9, v29
s_and_b32 s66, vcc_lo, s53
s_cmp_eq_u32 s66, s53
s_cbranch_scc1 L_done9
s_sleep 4
s_add_u32 s68, s68, 1
s_cmp_lt_u32 s68, 0x80000
s_cbranch_scc1 L_spin9
L_done9:
s_add_u32 s67, s11, s49
s_add_u32 s69, s67, s97
buffer_load_dwordx4 a[24:27], v38, s[24:27], s69 offen sc1
s_add_u32 s69, s67, s98
buffer_load_dwordx4 a[28:31], v38, s[24:27], s69 offen sc1
s_add_u32 s69, s67, s99
buffer_load_dwordx4 a[32:35], v38, s[24:27], s69 offen sc1
s_waitcnt vmcnt(3)
L_have9:
s_cmp_eq_u32 s54, 1
s_cbranch_scc1 L_haveS
s_mov_b32 s68, 0
L_spinS:
buffer_load_dword v29, v28, s[24:27], 0 offen sc1
s_waitcnt vmcnt(0)
v_cmp_le_u32 vcc, 9, v29
s_and_b32 s66, vcc_lo, s52
s_cmp_eq_u32 s66, s52
s_cbranch_scc1 L_doneS
s_sleep 4
s_add_u32 s68, s68, 1
s_cmp_lt_u32 s68, 0x80000
s_cbranch_scc1 L_spinS
L_doneS:
s_lshl_b32 s69, s60, 4
s_add_u32 s69, s69, s50
buffer_load_dwordx2 v[80:81], v41, s[24:27], s69 offen offset:0 sc1
buffer_load_dwordx2 v[82:83], v41, s[24:27], s69 offen offset:512 sc1
s_lshl_b32 s69, s61, 4
s_add_u32 s69, s69, s50
buffer_load_dwordx2 v[84:85], v41, s[24:27], s69 offen offset:0 sc1
buffer_load_dwordx2 v[86:87], v41, s[24:27], s69 offen offset:512 sc1
s_lshl_b32 s69, s62, 4
s_add_u32 s69, s69, s50
buffer_load_dwordx2 v[88:89], v41, s[24:27], s69 offen offset:0 sc1
buffer_load_dwordx2 v[90:91], v41, s[24:27], s69 offen offset:512 sc1
s_waitcnt vmcnt(0)
L_haveS:
v_lshlrev_b32 v184, 16, v80
v_and_b32 v185, s57, v80
v_lshlrev_b32 v186, 16, v81
v_and_b32 v187, s57, v81
v_lshlrev_b32 v188, 16, v82
v_and_b32 v189, s57, v82
v_lshlrev_b32 v190, 16, v83
v_and_b32 v191, s57, v83
v_lshlrev_b32 v216, 16, v84
v_and_b32 v217, s57, v84
v_lshlrev_b32 v218, 16, v85
v_and_b32 v219, s57, v85
v_lshlrev_b32 v220, 16, v86
v_and_b32 v221, s57, v86
v_lshlrev_b32 v222, 16, v87
v_and_b32 v223, s57, v87
v_lshlrev_b32 v120, 16, v88
v_and_b32 v121, s57, v88
v_lshlrev_b32 v122, 16, v89
v_and_b32 v123, s57, v89
v_lshlrev_b32 v124, 16, v90
v_and_b32 v125, s57, v90
v_lshlrev_b32 v126, 16, v91
v_and_b32 v127, s57, v91
v_fma_f32 v176, v176, v184, v144
v_fma_f32 v177, v177, v185, v145
v_fma_f32 v178, v178, v186, v146
v_fma_f32 v179, v179, v187, v147
v_fma_f32 v180, v180, v188, v148
v_fma_f32 v181, v181, v189, v149
v_fma_f32 v182, v182, v190, v150
v_fma_f32 v183, v183, v191, v151
v_cvt_pk_bf16_f32 v200, v176, v177
v_cvt_pk_bf16_f32 v201, v178, v179
v_cvt_pk_bf16_f32 v202, v180, v181
v_cvt_pk_bf16_f32 v203, v182, v183
ds_write_b64 v2, v[200:201] offset:4096
ds_write_b64 v2, v[202:203] offset:4128
ds_read_b128 v[204:207], v3 offset:4096
v_fma_f32 v208, v208, v216, v152
v_fma_f32 v209, v209, v217, v153
v_fma_f32 v210, v210, v218, v154
v_fma_f32 v211, v211, v219, v155
v_fma_f32 v212, v212, v220, v156
v_fma_f32 v213, v213, v221, v157
v_fma_f32 v214, v214, v222, v158
v_fma_f32 v215, v215, v223, v159
v_cvt_pk_bf16_f32 v232, v208, v209
v_cvt_pk_bf16_f32 v233, v210, v211
v_cvt_pk_bf16_f32 v234, v212, v213
v_cvt_pk_bf16_f32 v235, v214, v215
ds_write_b64 v2, v[232:233] offset:5376
ds_write_b64 v2, v[234:235] offset:5408
ds_read_b128 v[236:239], v3 offset:5376
s_waitcnt vmcnt(0)
v_mfma_f32_16x16x32_bf16 v[112:115], v[18:21], a[24:27], v[112:115]
v_mfma_f32_16x16x32_bf16 v[116:119], v[16:19], a[24:27], v[116:119]
v_mfma_f32_16x16x32_bf16 v[112:115], v[18:21], a[28:31], v[112:115]
v_mfma_f32_16x16x32_bf16 v[116:119], v[16:19], a[28:31], v[116:119]
v_mfma_f32_16x16x32_bf16 v[112:115], v[18:21], a[32:35], v[112:115]
v_mfma_f32_16x16x32_bf16 v[116:119], v[16:19], a[32:35], v[116:119]
s_waitcnt lgkmcnt(3)
buffer_store_dwordx4 v[204:207], v30, s[72:75], s60 offen
s_waitcnt lgkmcnt(0)
buffer_store_dwordx4 v[236:239], v30, s[72:75], s61 offen
s_nop 2
v_exp_f32_e64 v128, -v112
v_exp_f32_e64 v129, -v113
v_exp_f32_e64 v130, -v114
v_exp_f32_e64 v131, -v115
v_exp_f32_e64 v132, -v116
v_exp_f32_e64 v133, -v117
v_exp_f32_e64 v134, -v118
v_exp_f32_e64 v135, -v119
v_fma_f32 v128, v128, s71, s71
v_fma_f32 v129, v129, s71, s71
v_fma_f32 v130, v130, s71, s71
v_fma_f32 v131, v131, s71, s71
v_fma_f32 v132, v132, s71, s71
v_fma_f32 v133, v133, s71, s71
v_fma_f32 v134, v134, s71, s71
v_fma_f32 v135, v135, s71, s71
v_rcp_f32 v128, v128
v_rcp_f32 v129, v129
v_rcp_f32 v130, v130
v_rcp_f32 v131, v131
v_rcp_f32 v132, v132
v_rcp_f32 v133, v133
v_rcp_f32 v134, v134
v_rcp_f32 v135, v135
v_mul_f32 v112, v112, v128
v_mul_f32 v113, v113, v129
v_mul_f32 v114, v114, v130
v_mul_f32 v115, v115, v131
v_mul_f32 v116, v116, v132
v_mul_f32 v117, v117, v133
v_mul_f32 v118, v118, v134
v_mul_f32 v119, v119, v135
v_fma_f32 v112, v112, v120, v160
v_fma_f32 v113, v113, v121, v161
v_fma_f32 v114, v114, v122, v162
v_fma_f32 v115, v115, v123, v163
v_fma_f32 v116, v116, v124, v164
v_fma_f32 v117, v117, v125, v165
v_fma_f32 v118, v118, v126, v166
v_fma_f32 v119, v119, v127, v167
v_cvt_pk_bf16_f32 v136, v112, v113
v_cvt_pk_bf16_f32 v137, v114, v115
v_cvt_pk_bf16_f32 v138, v116, v117
v_cvt_pk_bf16_f32 v139, v118, v119
ds_write_b64 v2, v[136:137] offset:6656
ds_write_b64 v2, v[138:139] offset:6688
ds_read_b128 v[140:143], v3 offset:6656
s_waitcnt lgkmcnt(0)
buffer_store_dwordx4 v[140:143], v30, s[72:75], s62 offen
s_endpgm
L_slowH:
s_mov_b32 s68, 0
L_spinH:
buffer_load_dword v41, v40, s[28:31], 0 offen sc1
s_waitcnt vmcnt(0)
v_and_b32 v42, 0xff, v41
v_cmp_le_u32 vcc, 4, v42
s_and_b32 s66, vcc_lo, 15
s_cmp_eq_u32 s66, 15
s_cbranch_scc1 L_backH
s_sleep 1
s_add_u32 s68, s68, 1
s_cmp_lt_u32 s68, 0x80000
s_cbranch_scc1 L_spinH
s_branch L_backH
L_rel0:
buffer_wbl2 sc1
s_waitcnt vmcnt(0)
buffer_store_dword v31, v39, s[24:27], s37 offen sc1
s_branch L_relb0
L_rel1:
buffer_wbl2 sc1
s_waitcnt vmcnt(0)
buffer_store_dword v31, v39, s[24:27], s37 offen sc1
s_branch L_relb1
L_rel2:
buffer_wbl2 sc1
s_waitcnt vmcnt(0)
buffer_store_dword v31, v39, s[24:27], s37 offen sc1
s_branch L_relb2
L_rel3:
buffer_wbl2 sc1
s_waitcnt vmcnt(0)
buffer_store_dword v31, v39, s[24:27], s37 offen sc1
s_branch L_relb3
L_rel4:
buffer_wbl2 sc1
s_waitcnt vmcnt(0)
buffer_store_dword v31, v39, s[24:27], s37 offen sc1
s_branch L_relb4
L_rel5:
buffer_wbl2 sc1
s_waitcnt vmcnt(0)
buffer_store_dword v31, v39, s[24:27], s37 offen sc1
s_branch L_relb5
L_slowP3:
s_mov_b32 s68, 0
L_spinP3:
buffer_load_dword v29, v43, s[24:27], 0 offen sc1
s_waitcnt vmcnt(0)
v_cmp_le_u32 vcc, 1, v29
s_add_u32 s68, s68, 1
s_nop 4
s_cbranch_vccnz L_backP3
s_cmp_lt_u32 s68, 0x80000
s_cbranch_scc1 L_spinP3
s_branch L_backP3
L_slowP4:
s_mov_b32 s68, 0
L_spinP4:
buffer_load_dword v29, v43, s[24:27], 0 offen sc1
s_waitcnt vmcnt(0)
v_cmp_le_u32 vcc, 2, v29
s_add_u32 s68, s68, 1
s_nop 4
s_cbranch_vccnz L_backP4
s_cmp_lt_u32 s68, 0x80000
s_cbranch_scc1 L_spinP4
s_branch L_backP4
L_slowP5:
s_mov_b32 s68, 0
L_spinP5:
buffer_load_dword v29, v43, s[24:27], 0 offen sc1
s_waitcnt vmcnt(0)
v_cmp_le_u32 vcc, 3, v29
s_add_u32 s68, s68, 1
s_nop 4
s_cbranch_vccnz L_backP5
s_cmp_lt_u32 s68, 0x80000
s_cbranch_scc1 L_spinP5
s_branch L_backP5
L_slowP6:
s_mov_b32 s68, 0
L_spinP6:
buffer_load_dword v29, v43, s[24:27], 0 offen sc1
s_waitcnt vmcnt(0)
v_cmp_le_u32 vcc, 4, v29
s_add_u32 s68, s68, 1
s_nop 4
s_cbranch_vccnz L_backP6
s_cmp_lt_u32 s68, 0x80000
s_cbranch_scc1 L_spinP6
s_branch L_backP6
L_slowP7:
s_mov_b32 s68, 0
L_spinP7:
buffer_load_dword v29, v43, s[24:27], 0 offen sc1
s_waitcnt vmcnt(0)
v_cmp_le_u32 vcc, 5, v29
s_add_u32 s68, s68, 1
s_nop 4
s_cbranch_vccnz L_backP7
s_cmp_lt_u32 s68, 0x80000
s_cbranch_scc1 L_spinP7
s_branch L_backP7
L_slowP8:
s_mov_b32 s68, 0
L_spinP8:
buffer_load_dword v29, v43, s[24:27], 0 offen sc1
s_waitcnt vmcnt(0)
v_cmp_le_u32 vcc, 6, v29
s_add_u32 s68, s68, 1
s_nop 4
s_cbranch_vccnz L_backP8
s_cmp_lt_u32 s68, 0x80000
s_cbranch_scc1 L_spinP8
s_branch L_backP8
.p2align 6
L_attn:
s_and_b32 s33, s39, 3
s_mov_b32 s16, s6
s_mov_b32 s17, s7
s_mov_b32 s18, 1990656
s_mov_b32 s19, 0x20000
s_mov_b32 s20, s8
s_mov_b32 s21, s9
s_mov_b32 s22, 663552
s_mov_b32 s23, 0x20000
s_add_u32 s96, s33, 12
s_lshl_b32 s66, s34, 11
s_lshl_b32 s67, s96, 7
s_add_u32 s66, s66, s67
s_add_u32 s66, s66, 3687424
v_lshrrev_b32 v21, 5, v0
v_lshlrev_b32_e64 v21, 30, v21
v_lshl_add_u32 v21, v0, 2, v21
v_add_u32 v39, s66, v21
v_mov_b32 v21, 0
s_mov_b32 s37, 8192
s_lshl_b32 s66, s32, 2
s_and_b32 s67, s96, 3
s_add_u32 s66, s66, s67
s_lshl_b32 s66, s66, 2
s_lshl_b32 s67, s34, 8
s_add_u32 s66, s66, s67
v_lshlrev_b32 v1, 8, v0
v_add_u32 v1, s66, v1
s_getreg_b32 s66, hwreg(HW_REG_XCC_ID)
s_and_b32 s66, s66, 15
s_and_b32 s67, s96, 12
s_add_u32 s67, s67, 12
s_lshl_b32 s66, s66, s67
s_add_u32 s66, s66, 1
v_mov_b32 v38, s66
s_mul_i32 s49, s34, 9
s_lshr_b32 s49, s49, 1
s_lshl_b32 s3, s49, 10
s_mul_i32 s51, s33, 288
s_mul_i32 s58, s50, 221184
s_add_u32 s58, s58, s51
s_add_u32 s50, s50, 1
s_cmp_eq_u32 s50, 9
s_cselect_b32 s50, 0, s50
s_mul_i32 s59, s50, 221184
s_add_u32 s59, s59, s51
s_add_u32 s50, s50, 1
s_cmp_eq_u32 s50, 9
s_cselect_b32 s50, 0, s50
s_mul_i32 s60, s50, 221184
s_add_u32 s60, s60, s51
s_add_u32 s50, s50, 1
s_cmp_eq_u32 s50, 9
s_cselect_b32 s50, 0, s50
s_mul_i32 s61, s50, 221184
s_add_u32 s61, s61, s51
s_add_u32 s50, s50, 1
s_cmp_eq_u32 s50, 9
s_cselect_b32 s50, 0, s50
s_mul_i32 s62, s50, 221184
s_add_u32 s62, s62, s51
s_add_u32 s50, s50, 1
s_cmp_eq_u32 s50, 9
s_cselect_b32 s50, 0, s50
s_mul_i32 s63, s50, 221184
s_add_u32 s63, s63, s51
s_add_u32 s50, s50, 1
s_cmp_eq_u32 s50, 9
s_cselect_b32 s50, 0, s50
s_mul_i32 s64, s50, 221184
s_add_u32 s64, s64, s51
s_add_u32 s50, s50, 1
s_cmp_eq_u32 s50, 9
s_cselect_b32 s50, 0, s50
s_mul_i32 s65, s50, 221184
s_add_u32 s65, s65, s51
s_add_u32 s50, s50, 1
s_cmp_eq_u32 s50, 9
s_cselect_b32 s50, 0, s50
s_mul_i32 s66, s50, 221184
s_add_u32 s66, s66, s51
s_mov_b32 s96, 238609295
s_lshl_b32 s97, s49, 6
s_mov_b32 s98, 3456
v_add_u32 v2, s97, v0
s_add_u32 s97, s97, 64
v_mul_hi_u32 v3, v2, s96
v_mul_u32_u24 v4, 18, v3
v_sub_u32 v2, v2, v4
v_lshlrev_b32 v2, 4, v2
v_and_b32 v4, 35, v3
v_bfe_u32 v5, v3, 2, 2
v_lshl_add_u32 v4, v5, 3, v4
v_bfe_u32 v5, v3, 4, 1
v_lshl_add_u32 v4, v5, 2, v4
v_mad_u32_u24 v16, v4, s98, v2
v_add_u32 v2, s97, v0
s_add_u32 s97, s97, 64
v_mul_hi_u32 v3, v2, s96
v_mul_u32_u24 v4, 18, v3
v_sub_u32 v2, v2, v4
v_lshlrev_b32 v2, 4, v2
v_and_b32 v4, 35, v3
v_bfe_u32 v5, v3, 2, 2
v_lshl_add_u32 v4, v5, 3, v4
v_bfe_u32 v5, v3, 4, 1
v_lshl_add_u32 v4, v5, 2, v4
v_mad_u32_u24 v17, v4, s98, v2
v_subrev_u32 v17, 1024, v17
v_add_u32 v2, s97, v0
s_add_u32 s97, s97, 64
v_mul_hi_u32 v3, v2, s96
v_mul_u32_u24 v4, 18, v3
v_sub_u32 v2, v2, v4
v_lshlrev_b32 v2, 4, v2
v_and_b32 v4, 35, v3
v_bfe_u32 v5, v3, 2, 2
v_lshl_add_u32 v4, v5, 3, v4
v_bfe_u32 v5, v3, 4, 1
v_lshl_add_u32 v4, v5, 2, v4
v_mad_u32_u24 v18, v4, s98, v2
v_subrev_u32 v18, 2048, v18
v_add_u32 v2, s97, v0
s_add_u32 s97, s97, 64
v_mul_hi_u32 v3, v2, s96
v_mul_u32_u24 v4, 18, v3
v_sub_u32 v2, v2, v4
v_lshlrev_b32 v2, 4, v2
v_and_b32 v4, 35, v3
v_bfe_u32 v5, v3, 2, 2
v_lshl_add_u32 v4, v5, 3, v4
v_bfe_u32 v5, v3, 4, 1
v_lshl_add_u32 v4, v5, 2, v4
v_mad_u32_u24 v19, v4, s98, v2
v_subrev_u32 v19, 3072, v19
v_add_u32_e64 v2, s97, v0
v_mul_hi_u32 v3, v2, s96
v_mul_u32_u24 v4, 18, v3
v_sub_u32 v2, v2, v4
v_lshlrev_b32 v2, 4, v2
v_and_b32 v4, 35, v3
v_bfe_u32 v5, v3, 2, 2
v_lshl_add_u32 v4, v5, 3, v4
v_bfe_u32 v5, v3, 4, 1
v_lshl_add_u32 v4, v5, 2, v4
v_mad_u32_u24 v20, v4, s98, v2
v_lshrrev_b32_e64 v2, 2, v0
v_mul_u32_u24 v2, 288, v2
v_and_b32_e64 v3, 3, v0
v_lshl_add_u32 v26, v3, 3, v2
v_mul_u32_u24 v4, 72, v3
v_add3_u32 v29, v2, v4, 32
v_add_u32 v27, 55296, v26
v_add_u32 v30, 55296, v29
v_add_u32 v28, 110592, v26
v_add_u32 v31, 110592, v29
v_and_b32 v2, 15, v0
v_lshlrev_b32 v2, 7, v2
v_add_u32_e64 v2, s54, v2
v_bfe_u32 v3, v0, 1, 3
v_lshrrev_b32 v4, 4, v0
v_xor_b32 v3, v3, v4
v_lshl_add_u32 v34, v3, 4, v2
v_xor_b32_e64 v35, 64, v34
v_add_u32 v36, 98304, v34
v_add_u32 v37, 98304, v35
v_mov_b32 v48, 0
v_mov_b32 v49, 0
v_mov_b32 v52, 0
v_mov_b32 v53, 0
v_and_b32 v2, 1, v0
v_lshlrev_b32 v2, 4, v2
v_mov_b32 v3, 0x3f80
v_lshlrev_b32_e64 v2, v2, v3
v_bfe_u32 v3, v0, 2, 2
v_lshrrev_b32 v4, 4, v0
v_cmp_eq_u32 vcc, v3, v4
s_nop 1
v_cndmask_b32 v2, 0, v2, vcc
v_and_b32 v3, 2, v0
v_cmp_eq_u32 vcc, 0, v3
s_nop 1
v_cndmask_b32 v50, 0, v2, vcc
v_cndmask_b32_e64 v51, v2, v48, vcc
v_accvgpr_write_b32 a144, v48
v_accvgpr_write_b32 a145, v49
v_accvgpr_write_b32 a146, v50
v_accvgpr_write_b32 a147, v51
v_accvgpr_write_b32 a148, v52
v_accvgpr_write_b32 a149, v53
v_mov_b32 v8, 0
v_mov_b32 v9, 0
v_mov_b32 v10, 0
v_mov_b32 v11, 0
v_mov_b32 v12, 0
v_mov_b32 v13, 0
v_mov_b32 v14, 0
v_mov_b32 v15, 0
s_mov_b32 s57, 0x3f803f80
s_add_u32 m0, s54, 49152
s_add_u32 s56, s55, 1152
buffer_load_dwordx4 v44, s[12:15], s55 offen lds
buffer_load_dwordx4 v45, s[12:15], s55 offen offset:1024 lds
s_add_u32 m0, m0, 2048
s_add_u32 s55, s55, 128
buffer_load_dwordx4 v44, s[12:15], s56 offen lds
buffer_load_dwordx4 v45, s[12:15], s56 offen offset:1024 lds
s_cmp_eq_u32 s55, 1152
s_cselect_b32 s55, 0, s55
s_waitcnt vmcnt(12)
ds_read_b128 v[112:115], v34 offset:0
ds_read_b128 v[116:119], v34 offset:2048
ds_read_b128 v[120:123], v35 offset:0
ds_read_b128 v[124:127], v35 offset:2048
s_add_u32 m0, s54, 53248
s_add_u32 s56, s55, 1152
buffer_load_dwordx4 v44, s[12:15], s55 offen lds
buffer_load_dwordx4 v45, s[12:15], s55 offen offset:1024 lds
s_add_u32 m0, m0, 2048
s_add_u32 s55, s55, 128
buffer_load_dwordx4 v44, s[12:15], s56 offen lds
buffer_load_dwordx4 v45, s[12:15], s56 offen offset:1024 lds
s_cmp_eq_u32 s55, 1152
s_cselect_b32 s55, 0, s55
s_waitcnt vmcnt(12)
ds_read_b128 v[128:131], v34 offset:4096
ds_read_b128 v[132:135], v34 offset:6144
ds_read_b128 v[136:139], v35 offset:4096
ds_read_b128 v[140:143], v35 offset:6144
s_waitcnt lgkmcnt(4)
v_dot2c_f32_bf16 v8, s57, v112
v_dot2c_f32_bf16 v12, v112, v112
v_dot2c_f32_bf16 v9, s57, v113
v_dot2c_f32_bf16 v13, v113, v113
v_dot2c_f32_bf16 v8, s57, v114
v_dot2c_f32_bf16 v12, v114, v114
s_add_u32 m0, s54, 57344
s_add_u32 s56, s55, 1152
buffer_load_dwordx4 v44, s[12:15], s55 offen lds
v_dot2c_f32_bf16 v9, s57, v115
v_dot2c_f32_bf16 v13, v115, v115
v_dot2c_f32_bf16 v10, s57, v116
v_dot2c_f32_bf16 v14, v116, v116
v_dot2c_f32_bf16 v11, s57, v117
v_dot2c_f32_bf16 v15, v117, v117
buffer_load_dwordx4 v45, s[12:15], s55 offen offset:1024 lds
v_dot2c_f32_bf16 v10, s57, v118
v_dot2c_f32_bf16 v14, v118, v118
v_dot2c_f32_bf16 v11, s57, v119
v_dot2c_f32_bf16 v15, v119, v119
v_dot2c_f32_bf16 v8, s57, v120
v_dot2c_f32_bf16 v12, v120, v120
s_add_u32 m0, m0, 2048
s_add_u32 s55, s55, 128
buffer_load_dwordx4 v44, s[12:15], s56 offen lds
v_dot2c_f32_bf16 v9, s57, v121
v_dot2c_f32_bf16 v13, v121, v121
v_dot2c_f32_bf16 v8, s57, v122
v_dot2c_f32_bf16 v12, v122, v122
v_dot2c_f32_bf16 v9, s57, v123
v_dot2c_f32_bf16 v13, v123, v123
buffer_load_dwordx4 v45, s[12:15], s56 offen offset:1024 lds
s_cmp_eq_u32 s55, 1152
s_cselect_b32 s55, 0, s55
v_dot2c_f32_bf16 v10, s57, v124
v_dot2c_f32_bf16 v14, v124, v124
v_dot2c_f32_bf16 v11, s57, v125
v_dot2c_f32_bf16 v15, v125, v125
v_dot2c_f32_bf16 v10, s57, v126
v_dot2c_f32_bf16 v14, v126, v126
v_dot2c_f32_bf16 v11, s57, v127
v_dot2c_f32_bf16 v15, v127, v127
s_waitcnt vmcnt(12)
ds_read_b128 v[144:147], v34 offset:8192
ds_read_b128 v[148:151], v34 offset:10240
ds_read_b128 v[152:155], v35 offset:8192
ds_read_b128 v[156:159], v35 offset:10240
s_waitcnt lgkmcnt(4)
v_dot2c_f32_bf16 v8, s57, v128
v_dot2c_f32_bf16 v12, v128, v128
v_dot2c_f32_bf16 v9, s57, v129
v_dot2c_f32_bf16 v13, v129, v129
v_dot2c_f32_bf16 v8, s57, v130
v_dot2c_f32_bf16 v12, v130, v130
s_add_u32 m0, s54, 98304
s_add_u32 s56, s55, 1152
buffer_load_dwordx4 v44, s[12:15], s55 offen lds
v_dot2c_f32_bf16 v9, s57, v131
v_dot2c_f32_bf16 v13, v131, v131
v_dot2c_f32_bf16 v10, s57, v132
v_dot2c_f32_bf16 v14, v132, v132
v_dot2c_f32_bf16 v11, s57, v133
v_dot2c_f32_bf16 v15, v133, v133
buffer_load_dwordx4 v45, s[12:15], s55 offen offset:1024 lds
v_dot2c_f32_bf16 v10, s57, v134
v_dot2c_f32_bf16 v14, v134, v134
v_dot2c_f32_bf16 v11, s57, v135
v_dot2c_f32_bf16 v15, v135, v135
v_dot2c_f32_bf16 v8, s57, v136
v_dot2c_f32_bf16 v12, v136, v136
s_add_u32 m0, m0, 2048
s_add_u32 s55, s55, 128
buffer_load_dwordx4 v44, s[12:15], s56 offen lds
v_dot2c_f32_bf16 v9, s57, v137
v_dot2c_f32_bf16 v13, v137, v137
v_dot2c_f32_bf16 v8, s57, v138
v_dot2c_f32_bf16 v12, v138, v138
v_dot2c_f32_bf16 v9, s57, v139
v_dot2c_f32_bf16 v13, v139, v139
buffer_load_dwordx4 v45, s[12:15], s56 offen offset:1024 lds
s_cmp_eq_u32 s55, 1152
s_cselect_b32 s55, 0, s55
v_dot2c_f32_bf16 v10, s57, v140
v_dot2c_f32_bf16 v14, v140, v140
v_dot2c_f32_bf16 v11, s57, v141
v_dot2c_f32_bf16 v15, v141, v141
v_dot2c_f32_bf16 v10, s57, v142
v_dot2c_f32_bf16 v14, v142, v142
v_dot2c_f32_bf16 v11, s57, v143
v_dot2c_f32_bf16 v15, v143, v143
s_waitcnt vmcnt(12)
ds_read_b128 v[160:163], v34 offset:49152
ds_read_b128 v[164:167], v34 offset:51200
ds_read_b128 v[168:171], v35 offset:49152
ds_read_b128 v[172:175], v35 offset:51200
s_waitcnt lgkmcnt(4)
s_barrier
v_dot2c_f32_bf16 v8, s57, v144
v_dot2c_f32_bf16 v12, v144, v144
v_dot2c_f32_bf16 v9, s57, v145
v_dot2c_f32_bf16 v13, v145, v145
v_dot2c_f32_bf16 v8, s57, v146
v_dot2c_f32_bf16 v12, v146, v146
s_add_u32 m0, s54, 102400
s_add_u32 s56, s55, 1152
buffer_load_dwordx4 v44, s[12:15], s55 offen lds
v_dot2c_f32_bf16 v9, s57, v147
v_dot2c_f32_bf16 v13, v147, v147
v_dot2c_f32_bf16 v10, s57, v148
v_dot2c_f32_bf16 v14, v148, v148
v_dot2c_f32_bf16 v11, s57, v149
v_dot2c_f32_bf16 v15, v149, v149
buffer_load_dwordx4 v45, s[12:15], s55 offen offset:1024 lds
v_dot2c_f32_bf16 v10, s57, v150
v_dot2c_f32_bf16 v14, v150, v150
v_dot2c_f32_bf16 v11, s57, v151
v_dot2c_f32_bf16 v15, v151, v151
v_dot2c_f32_bf16 v8, s57, v152
v_dot2c_f32_bf16 v12, v152, v152
s_add_u32 m0, m0, 2048
s_add_u32 s55, s55, 128
buffer_load_dwordx4 v44, s[12:15], s56 offen lds
v_dot2c_f32_bf16 v9, s57, v153
v_dot2c_f32_bf16 v13, v153, v153
v_dot2c_f32_bf16 v8, s57, v154
v_dot2c_f32_bf16 v12, v154, v154
v_dot2c_f32_bf16 v9, s57, v155
v_dot2c_f32_bf16 v13, v155, v155
buffer_load_dwordx4 v45, s[12:15], s56 offen offset:1024 lds
s_cmp_eq_u32 s55, 1152
s_cselect_b32 s55, 0, s55
v_dot2c_f32_bf16 v10, s57, v156
v_dot2c_f32_bf16 v14, v156, v156
v_dot2c_f32_bf16 v11, s57, v157
v_dot2c_f32_bf16 v15, v157, v157
v_dot2c_f32_bf16 v10, s57, v158
v_dot2c_f32_bf16 v14, v158, v158
v_dot2c_f32_bf16 v11, s57, v159
v_dot2c_f32_bf16 v15, v159, v159
s_waitcnt vmcnt(12)
ds_read_b128 v[176:179], v34 offset:53248
ds_read_b128 v[180:183], v34 offset:55296
ds_read_b128 v[184:187], v35 offset:53248
ds_read_b128 v[188:191], v35 offset:55296
s_waitcnt lgkmcnt(4)
v_dot2c_f32_bf16 v8, s57, v160
v_dot2c_f32_bf16 v12, v160, v160
v_dot2c_f32_bf16 v9, s57, v161
v_dot2c_f32_bf16 v13, v161, v161
v_dot2c_f32_bf16 v8, s57, v162
v_dot2c_f32_bf16 v12, v162, v162
s_add_u32 m0, s54, 106496
s_add_u32 s56, s55, 1152
buffer_load_dwordx4 v44, s[12:15], s55 offen lds
v_dot2c_f32_bf16 v9, s57, v163
v_dot2c_f32_bf16 v13, v163, v163
v_dot2c_f32_bf16 v10, s57, v164
v_dot2c_f32_bf16 v14, v164, v164
v_dot2c_f32_bf16 v11, s57, v165
v_dot2c_f32_bf16 v15, v165, v165
buffer_load_dwordx4 v45, s[12:15], s55 offen offset:1024 lds
v_dot2c_f32_bf16 v10, s57, v166
v_dot2c_f32_bf16 v14, v166, v166
v_dot2c_f32_bf16 v11, s57, v167
v_dot2c_f32_bf16 v15, v167, v167
v_dot2c_f32_bf16 v8, s57, v168
v_dot2c_f32_bf16 v12, v168, v168
s_add_u32 m0, m0, 2048
s_add_u32 s55, s55, 128
buffer_load_dwordx4 v44, s[12:15], s56 offen lds
v_dot2c_f32_bf16 v9, s57, v169
v_dot2c_f32_bf16 v13, v169, v169
v_dot2c_f32_bf16 v8, s57, v170
v_dot2c_f32_bf16 v12, v170, v170
v_dot2c_f32_bf16 v9, s57, v171
v_dot2c_f32_bf16 v13, v171, v171
buffer_load_dwordx4 v45, s[12:15], s56 offen offset:1024 lds
s_cmp_eq_u32 s55, 1152
s_cselect_b32 s55, 0, s55
v_dot2c_f32_bf16 v10, s57, v172
v_dot2c_f32_bf16 v14, v172, v172
v_dot2c_f32_bf16 v11, s57, v173
v_dot2c_f32_bf16 v15, v173, v173
v_dot2c_f32_bf16 v10, s57, v174
v_dot2c_f32_bf16 v14, v174, v174
v_dot2c_f32_bf16 v11, s57, v175
v_dot2c_f32_bf16 v15, v175, v175
s_waitcnt vmcnt(12)
ds_read_b128 v[192:195], v34 offset:57344
ds_read_b128 v[196:199], v34 offset:59392
ds_read_b128 v[200:203], v35 offset:57344
ds_read_b128 v[204:207], v35 offset:59392
s_waitcnt lgkmcnt(4)
v_dot2c_f32_bf16 v8, s57, v176
v_dot2c_f32_bf16 v12, v176, v176
v_dot2c_f32_bf16 v9, s57, v177
v_dot2c_f32_bf16 v13, v177, v177
v_dot2c_f32_bf16 v8, s57, v178
s_add_u32 m0, s3, 0
s_add_u32 s99, s58, 1152
buffer_load_dwordx4 v16, s[16:19], s99 offen offset:0 lds
v_dot2c_f32_bf16 v12, v178, v178
v_dot2c_f32_bf16 v9, s57, v179
v_dot2c_f32_bf16 v13, v179, v179
v_dot2c_f32_bf16 v10, s57, v180
v_dot2c_f32_bf16 v14, v180, v180
buffer_load_dwordx4 v17, s[16:19], s99 offen offset:1024 lds
v_dot2c_f32_bf16 v11, s57, v181
v_dot2c_f32_bf16 v15, v181, v181
v_dot2c_f32_bf16 v10, s57, v182
v_dot2c_f32_bf16 v14, v182, v182
v_dot2c_f32_bf16 v11, s57, v183
buffer_load_dwordx4 v18, s[16:19], s99 offen offset:2048 lds
v_dot2c_f32_bf16 v15, v183, v183
v_dot2c_f32_bf16 v8, s57, v184
v_dot2c_f32_bf16 v12, v184, v184
v_dot2c_f32_bf16 v9, s57, v185
v_dot2c_f32_bf16 v13, v185, v185
buffer_load_dwordx4 v19, s[16:19], s99 offen offset:3072 lds
v_dot2c_f32_bf16 v8, s57, v186
v_dot2c_f32_bf16 v12, v186, v186
v_dot2c_f32_bf16 v9, s57, v187
v_dot2c_f32_bf16 v13, v187, v187
v_dot2c_f32_bf16 v10, s57, v188
s_add_u32 m0, s3, 4096
s_nop 0
buffer_load_dwordx4 v20, s[16:19], s99 offen lds
v_dot2c_f32_bf16 v14, v188, v188
v_dot2c_f32_bf16 v11, s57, v189
v_dot2c_f32_bf16 v15, v189, v189
v_dot2c_f32_bf16 v10, s57, v190
v_dot2c_f32_bf16 v14, v190, v190
v_dot2c_f32_bf16 v11, s57, v191
v_dot2c_f32_bf16 v15, v191, v191
s_waitcnt vmcnt(13)
ds_read_b128 v[208:211], v36 offset:0
ds_read_b128 v[212:215], v36 offset:2048
ds_read_b128 v[216:219], v37 offset:0
ds_read_b128 v[220:223], v37 offset:2048
s_waitcnt lgkmcnt(4)
s_barrier
v_dot2c_f32_bf16 v8, s57, v192
v_dot2c_f32_bf16 v12, v192, v192
v_dot2c_f32_bf16 v9, s57, v193
v_dot2c_f32_bf16 v13, v193, v193
v_dot2c_f32_bf16 v8, s57, v194
v_dot2c_f32_bf16 v12, v194, v194
v_dot2c_f32_bf16 v9, s57, v195
v_dot2c_f32_bf16 v13, v195, v195
v_dot2c_f32_bf16 v10, s57, v196
v_dot2c_f32_bf16 v14, v196, v196
v_dot2c_f32_bf16 v11, s57, v197
v_dot2c_f32_bf16 v15, v197, v197
v_dot2c_f32_bf16 v10, s57, v198
v_dot2c_f32_bf16 v14, v198, v198
v_dot2c_f32_bf16 v11, s57, v199
v_dot2c_f32_bf16 v15, v199, v199
v_dot2c_f32_bf16 v8, s57, v200
v_dot2c_f32_bf16 v12, v200, v200
v_dot2c_f32_bf16 v9, s57, v201
v_dot2c_f32_bf16 v13, v201, v201
v_dot2c_f32_bf16 v8, s57, v202
v_dot2c_f32_bf16 v12, v202, v202
v_dot2c_f32_bf16 v9, s57, v203
v_dot2c_f32_bf16 v13, v203, v203
v_dot2c_f32_bf16 v10, s57, v204
v_dot2c_f32_bf16 v14, v204, v204
v_dot2c_f32_bf16 v11, s57, v205
v_dot2c_f32_bf16 v15, v205, v205
v_dot2c_f32_bf16 v10, s57, v206
v_dot2c_f32_bf16 v14, v206, v206
v_dot2c_f32_bf16 v11, s57, v207
v_dot2c_f32_bf16 v15, v207, v207
s_waitcnt vmcnt(9)
ds_read_b128 v[224:227], v36 offset:4096
ds_read_b128 v[228:231], v36 offset:6144
ds_read_b128 v[232:235], v37 offset:4096
ds_read_b128 v[236:239], v37 offset:6144
s_waitcnt lgkmcnt(4)
v_dot2c_f32_bf16 v8, s57, v208
v_dot2c_f32_bf16 v12, v208, v208
v_dot2c_f32_bf16 v9, s57, v209
v_dot2c_f32_bf16 v13, v209, v209
v_dot2c_f32_bf16 v8, s57, v210
s_add_u32 m0, s3, 18432
s_add_u32 s99, s59, 1152
buffer_load_dwordx4 v16, s[16:19], s99 offen offset:0 lds
v_dot2c_f32_bf16 v12, v210, v210
v_dot2c_f32_bf16 v9, s57, v211
v_dot2c_f32_bf16 v13, v211, v211
v_dot2c_f32_bf16 v10, s57, v212
v_dot2c_f32_bf16 v14, v212, v212
buffer_load_dwordx4 v17, s[16:19], s99 offen offset:1024 lds
v_dot2c_f32_bf16 v11, s57, v213
v_dot2c_f32_bf16 v15, v213, v213
v_dot2c_f32_bf16 v10, s57, v214
v_dot2c_f32_bf16 v14, v214, v214
v_dot2c_f32_bf16 v11, s57, v215
buffer_load_dwordx4 v18, s[16:19], s99 offen offset:2048 lds
v_dot2c_f32_bf16 v15, v215, v215
v_dot2c_f32_bf16 v8, s57, v216
v_dot2c_f32_bf16 v12, v216, v216
v_dot2c_f32_bf16 v9, s57, v217
v_dot2c_f32_bf16 v13, v217, v217
buffer_load_dwordx4 v19, s[16:19], s99 offen offset:3072 lds
v_dot2c_f32_bf16 v8, s57, v218
v_dot2c_f32_bf16 v12, v218, v218
v_dot2c_f32_bf16 v9, s57, v219
v_dot2c_f32_bf16 v13, v219, v219
v_dot2c_f32_bf16 v10, s57, v220
s_add_u32 m0, s3, 22528
s_nop 0
buffer_load_dwordx4 v20, s[16:19], s99 offen lds
v_dot2c_f32_bf16 v14, v220, v220
v_dot2c_f32_bf16 v11, s57, v221
v_dot2c_f32_bf16 v15, v221, v221
v_dot2c_f32_bf16 v10, s57, v222
v_dot2c_f32_bf16 v14, v222, v222
v_dot2c_f32_bf16 v11, s57, v223
v_dot2c_f32_bf16 v15, v223, v223
s_waitcnt vmcnt(10)
ds_read_b128 v[240:243], v36 offset:8192
ds_read_b128 v[244:247], v36 offset:10240
ds_read_b128 v[248:251], v37 offset:8192
ds_read_b128 v[252:255], v37 offset:10240
s_waitcnt lgkmcnt(4)
v_dot2c_f32_bf16 v8, s57, v224
v_dot2c_f32_bf16 v12, v224, v224
v_dot2c_f32_bf16 v9, s57, v225
v_dot2c_f32_bf16 v13, v225, v225
v_dot2c_f32_bf16 v8, s57, v226
v_dot2c_f32_bf16 v12, v226, v226
v_dot2c_f32_bf16 v9, s57, v227
v_dot2c_f32_bf16 v13, v227, v227
v_dot2c_f32_bf16 v10, s57, v228
v_dot2c_f32_bf16 v14, v228, v228
v_dot2c_f32_bf16 v11, s57, v229
v_dot2c_f32_bf16 v15, v229, v229
v_dot2c_f32_bf16 v10, s57, v230
v_dot2c_f32_bf16 v14, v230, v230
v_dot2c_f32_bf16 v11, s57, v231
v_dot2c_f32_bf16 v15, v231, v231
v_dot2c_f32_bf16 v8, s57, v232
v_dot2c_f32_bf16 v12, v232, v232
v_dot2c_f32_bf16 v9, s57, v233
v_dot2c_f32_bf16 v13, v233, v233
v_dot2c_f32_bf16 v8, s57, v234
v_dot2c_f32_bf16 v12, v234, v234
v_dot2c_f32_bf16 v9, s57, v235
v_dot2c_f32_bf16 v13, v235, v235
v_dot2c_f32_bf16 v10, s57, v236
v_dot2c_f32_bf16 v14, v236, v236
v_dot2c_f32_bf16 v11, s57, v237
v_dot2c_f32_bf16 v15, v237, v237
v_dot2c_f32_bf16 v10, s57, v238
v_dot2c_f32_bf16 v14, v238, v238
v_dot2c_f32_bf16 v11, s57, v239
v_dot2c_f32_bf16 v15, v239, v239
s_waitcnt lgkmcnt(0)
v_dot2c_f32_bf16 v8, s57, v240
v_dot2c_f32_bf16 v12, v240, v240
v_dot2c_f32_bf16 v9, s57, v241
v_dot2c_f32_bf16 v13, v241, v241
s_add_u32 m0, s3, 36864
s_add_u32 s99, s60, 1152
buffer_load_dwordx4 v16, s[16:19], s99 offen offset:0 lds
v_dot2c_f32_bf16 v8, s57, v242
v_dot2c_f32_bf16 v12, v242, v242
v_dot2c_f32_bf16 v9, s57, v243
v_dot2c_f32_bf16 v13, v243, v243
buffer_load_dwordx4 v17, s[16:19], s99 offen offset:1024 lds
v_dot2c_f32_bf16 v10, s57, v244
v_dot2c_f32_bf16 v14, v244, v244
v_dot2c_f32_bf16 v11, s57, v245
v_dot2c_f32_bf16 v15, v245, v245
buffer_load_dwordx4 v18, s[16:19], s99 offen offset:2048 lds
v_dot2c_f32_bf16 v10, s57, v246
v_dot2c_f32_bf16 v14, v246, v246
v_dot2c_f32_bf16 v11, s57, v247
v_dot2c_f32_bf16 v15, v247, v247
buffer_load_dwordx4 v19, s[16:19], s99 offen offset:3072 lds
v_dot2c_f32_bf16 v8, s57, v248
v_dot2c_f32_bf16 v12, v248, v248
v_dot2c_f32_bf16 v9, s57, v249
v_dot2c_f32_bf16 v13, v249, v249
s_add_u32 m0, s3, 40960
s_nop 0
buffer_load_dwordx4 v20, s[16:19], s99 offen lds
v_dot2c_f32_bf16 v8, s57, v250
v_dot2c_f32_bf16 v12, v250, v250
v_dot2c_f32_bf16 v9, s57, v251
v_dot2c_f32_bf16 v13, v251, v251
buffer_store_dword v21, v39, s[24:27], 0 offen sc1
v_dot2c_f32_bf16 v10, s57, v252
v_dot2c_f32_bf16 v14, v252, v252
v_dot2c_f32_bf16 v11, s57, v253
v_dot2c_f32_bf16 v15, v253, v253
buffer_store_dword v21, v39, s[24:27], s37 offen sc1
v_dot2c_f32_bf16 v10, s57, v254
v_dot2c_f32_bf16 v14, v254, v254
v_dot2c_f32_bf16 v11, s57, v255
v_dot2c_f32_bf16 v15, v255, v255
v_add_f32 v8, v8, v9
s_nop 0
v_add_f32 v10, v10, v11
v_add_f32 v12, v12, v13
v_add_f32_e64 v14, v14, v15
v_mfma_f32_16x16x32_bf16 v[48:51], a[146:149], v[112:115], 0
v_mfma_f32_16x16x32_bf16 v[52:55], a[144:147], v[112:115], 0
v_mfma_f32_16x16x32_bf16 v[56:59], a[146:149], v[116:119], 0
v_mfma_f32_16x16x32_bf16 v[60:63], a[144:147], v[116:119], 0
v_mfma_f32_16x16x32_bf16 v[64:67], a[146:149], v[120:123], 0
v_mfma_f32_16x16x32_bf16 v[68:71], a[144:147], v[120:123], 0
v_mov_b32 v9, v8
v_mov_b32 v11, v10
v_mov_b32 v13, v12
v_mov_b32 v15, v14
v_permlane32_swap_b32 v8, v9
v_permlane32_swap_b32 v10, v11
v_permlane32_swap_b32 v12, v13
v_permlane32_swap_b32 v14, v15
v_add_f32 v8, v8, v9
v_add_f32 v10, v10, v11
v_add_f32 v12, v12, v13
v_add_f32 v14, v14, v15
v_mov_b32 v9, v8
v_mov_b32 v11, v10
v_mov_b32 v13, v12
v_mov_b32 v15, v14
v_permlane16_swap_b32 v8, v9
v_permlane16_swap_b32 v10, v11
v_permlane16_swap_b32 v12, v13
v_permlane16_swap_b32 v14, v15
v_add_f32 v8, v8, v9
v_add_f32 v10, v10, v11
v_add_f32 v12, v12, v13
v_add_f32 v14, v14, v15
v_mul_f32 v8, 0x3ae38e39, v8
v_mul_f32 v10, 0x3ae38e39, v10
v_mul_f32 v12, 0x3ae38e39, v12
v_mul_f32 v14, 0x3ae38e39, v14
v_fma_f32 v12, -v8, v8, v12
v_fma_f32 v14, -v10, v10, v14
v_max_f32 v12, 0, v12
v_max_f32 v14, 0, v14
v_cvt_pk_bf16_f32 v4, v8, v8
v_cvt_pk_bf16_f32 v5, v10, v10
v_and_b32 v4, 0xffff0000, v4
v_and_b32 v5, 0xffff0000, v5
v_xor_b32 v4, 0x80000000, v4
v_xor_b32 v5, 0x80000000, v5
v_cvt_pk_bf16_f32 v12, v12, v12
v_cvt_pk_bf16_f32 v14, v14, v14
v_and_b32 v12, 0xffff0000, v12
v_and_b32 v14, 0xffff0000, v14
v_add_f32 v12, 0x3727c5ac, v12
v_add_f32 v14, 0x3727c5ac, v14
v_cvt_pk_bf16_f32 v12, v12, v12
v_cvt_pk_bf16_f32 v14, v14, v14
v_and_b32 v12, 0xffff0000, v12
v_and_b32 v14, 0xffff0000, v14
v_sqrt_f32 v12, v12
v_sqrt_f32 v14, v14
v_cvt_pk_bf16_f32 v12, v12, v12
v_cvt_pk_bf16_f32 v14, v14, v14
v_and_b32 v12, 0xffff0000, v12
v_and_b32 v14, 0xffff0000, v14
v_rcp_f32 v2, v12
v_rcp_f32 v3, v14
v_mul_f32 v4, v4, v2
v_mul_f32 v5, v5, v3
s_waitcnt vmcnt(12)
s_barrier
ds_read_b64_tr_b16 a[192:193], v26 offset:0
ds_read_b64_tr_b16 a[194:195], v26 offset:4608
ds_read_b64_tr_b16 a[196:197], v26 offset:40
ds_read_b64_tr_b16 a[198:199], v26 offset:4648
ds_read_b64_tr_b16 a[200:201], v26 offset:72
ds_read_b64_tr_b16 a[202:203], v26 offset:4680
ds_read_b64_tr_b16 a[204:205], v26 offset:112
ds_read_b64_tr_b16 a[206:207], v26 offset:4720
ds_read_b64_tr_b16 a[208:209], v26 offset:144
ds_read_b64_tr_b16 a[210:211], v26 offset:4752
v_fma_f32 v48, v48, v2, v4
v_fma_f32 v49, v49, v2, v4
v_fma_f32 v50, v50, v2, v4
v_fma_f32 v51, v51, v2, v4
v_fma_f32 v52, v52, v2, v4
v_fma_f32 v53, v53, v2, v4
v_fma_f32 v54, v54, v2, v4
v_fma_f32 v55, v55, v2, v4
v_cvt_pk_bf16_f32 v112, v48, v49
v_cvt_pk_bf16_f32 v113, v50, v51
v_cvt_pk_bf16_f32 v114, v52, v53
v_cvt_pk_bf16_f32 v115, v54, v55
v_fma_f32 v56, v56, v3, v5
v_fma_f32 v57, v57, v3, v5
v_fma_f32 v58, v58, v3, v5
v_fma_f32 v59, v59, v3, v5
v_fma_f32 v60, v60, v3, v5
v_fma_f32 v61, v61, v3, v5
v_fma_f32 v62, v62, v3, v5
v_fma_f32 v63, v63, v3, v5
v_cvt_pk_bf16_f32 v116, v56, v57
v_cvt_pk_bf16_f32 v117, v58, v59
v_cvt_pk_bf16_f32 v118, v60, v61
v_cvt_pk_bf16_f32 v119, v62, v63
v_fma_f32 v64, v64, v2, v4
v_fma_f32 v65, v65, v2, v4
v_fma_f32 v66, v66, v2, v4
v_fma_f32 v67, v67, v2, v4
v_fma_f32 v68, v68, v2, v4
v_fma_f32 v69, v69, v2, v4
v_fma_f32 v70, v70, v2, v4
v_fma_f32 v71, v71, v2, v4
v_cvt_pk_bf16_f32 v120, v64, v65
v_cvt_pk_bf16_f32 v121, v66, v67
v_cvt_pk_bf16_f32 v122, v68, v69
v_cvt_pk_bf16_f32 v123, v70, v71
s_waitcnt lgkmcnt(4)
v_mfma_f32_16x16x32_bf16 v[22:25], a[146:149], v[124:127], 0
s_add_u32 m0, s3, 55296
v_mfma_f32_16x16x32_bf16 v[32:35], a[144:147], v[124:127], 0
s_add_u32 s99, s61, 1152
v_mfma_f32_16x16x32_bf16 v[40:43], a[192:195], v[112:115], 0
ds_read_b64_tr_b16 a[212:213], v26 offset:184
ds_read_b64_tr_b16 a[214:215], v26 offset:4792
v_mfma_f32_16x16x32_bf16 v[44:47], a[192:195], v[116:119], 0
buffer_load_dwordx4 v16, s[16:19], s99 offen offset:0 lds
v_mfma_f32_16x16x32_bf16 v[48:51], a[196:199], v[112:115], 0
ds_read_b64_tr_b16 a[216:217], v26 offset:216
ds_read_b64_tr_b16 a[218:219], v26 offset:4824
v_mfma_f32_16x16x32_bf16 v[52:55], a[196:199], v[116:119], 0
buffer_load_dwordx4 v17, s[16:19], s99 offen offset:1024 lds
v_fma_f32 v22, v22, v3, v5
v_mfma_f32_16x16x32_bf16 v[56:59], a[200:203], v[112:115], 0
ds_read_b64_tr_b16 a[220:221], v26 offset:256
ds_read_b64_tr_b16 a[222:223], v26 offset:4864
v_fma_f32 v23, v23, v3, v5
v_mfma_f32_16x16x32_bf16 v[60:63], a[200:203], v[116:119], 0
v_fma_f32 v24, v24, v3, v5
v_fma_f32 v25, v25, v3, v5
s_waitcnt lgkmcnt(4)
v_mfma_f32_16x16x32_bf16 v[64:67], a[204:207], v[112:115], 0
ds_read_b64_tr_b16 a[224:225], v29 offset:0
ds_read_b64_tr_b16 a[226:227], v29 offset:4608
v_mfma_f32_16x16x32_bf16 v[68:71], a[204:207], v[116:119], 0
buffer_load_dwordx4 v18, s[16:19], s99 offen offset:2048 lds
v_fma_f32 v32, v32, v3, v5
v_mfma_f32_16x16x32_bf16 v[72:75], a[208:211], v[112:115], 0
ds_read_b64_tr_b16 a[228:229], v26 offset:9216
ds_read_b64_tr_b16 a[230:231], v26 offset:13824
v_fma_f32 v33, v33, v3, v5
v_mfma_f32_16x16x32_bf16 v[76:79], a[208:211], v[116:119], 0
buffer_load_dwordx4 v19, s[16:19], s99 offen offset:3072 lds
v_fma_f32 v34, v34, v3, v5
v_mfma_f32_16x16x32_bf16 v[8:11], a[146:149], v[128:131], 0
s_add_u32 m0, s3, 59392
v_fma_f32 v35, v35, v3, v5
v_mfma_f32_16x16x32_bf16 v[12:15], a[144:147], v[128:131], 0
buffer_load_dwordx4 v20, s[16:19], s99 offen lds
v_cvt_pk_bf16_f32 v124, v22, v23
v_mfma_f32_16x16x32_bf16 v[80:83], a[212:215], v[112:115], 0
ds_read_b64_tr_b16 a[232:233], v26 offset:9256
ds_read_b64_tr_b16 a[234:235], v26 offset:13864
v_cvt_pk_bf16_f32 v125, v24, v25
v_mfma_f32_16x16x32_bf16 v[84:87], a[212:215], v[116:119], 0
v_cvt_pk_bf16_f32 v126, v32, v33
v_cvt_pk_bf16_f32 v127, v34, v35
s_waitcnt lgkmcnt(4)
v_mfma_f32_16x16x32_bf16 v[88:91], a[216:219], v[112:115], 0
ds_read_b64_tr_b16 a[236:237], v26 offset:9288
ds_read_b64_tr_b16 a[238:239], v26 offset:13896
v_fma_f32 v8, v8, v2, v4
v_mfma_f32_16x16x32_bf16 v[92:95], a[216:219], v[116:119], 0
s_add_u32 m0, s3, 73728
s_add_u32 s99, s62, 1152
v_fma_f32 v9, v9, v2, v4
v_mfma_f32_16x16x32_bf16 v[96:99], a[220:223], v[112:115], 0
ds_read_b64_tr_b16 a[240:241], v26 offset:9328
ds_read_b64_tr_b16 a[242:243], v26 offset:13936
v_fma_f32 v10, v10, v2, v4
v_mfma_f32_16x16x32_bf16 v[100:103], a[220:223], v[116:119], 0
buffer_load_dwordx4 v16, s[16:19], s99 offen offset:0 lds
v_fma_f32 v11, v11, v2, v4
v_mfma_f32_16x16x32_bf16 v[104:107], a[224:227], v[112:115], 0
ds_read_b64_tr_b16 a[244:245], v26 offset:9360
ds_read_b64_tr_b16 a[246:247], v26 offset:13968
v_fma_f32 v12, v12, v2, v4
v_mfma_f32_16x16x32_bf16 v[108:111], a[224:227], v[116:119], 0
v_fma_f32 v13, v13, v2, v4
v_fma_f32 v14, v14, v2, v4
s_waitcnt lgkmcnt(4)
v_mfma_f32_16x16x32_bf16 v[22:25], a[146:149], v[132:135], 0
buffer_load_dwordx4 v17, s[16:19], s99 offen offset:1024 lds
v_fma_f32 v15, v15, v2, v4
v_mfma_f32_16x16x32_bf16 v[32:35], a[144:147], v[132:135], 0
buffer_load_dwordx4 v18, s[16:19], s99 offen offset:2048 lds
v_cvt_pk_bf16_f32 v128, v8, v9
v_mfma_f32_16x16x32_bf16 v[40:43], a[228:231], v[120:123], v[40:43]
ds_read_b64_tr_b16 a[248:249], v26 offset:9400
ds_read_b64_tr_b16 a[250:251], v26 offset:14008
v_cvt_pk_bf16_f32 v129, v10, v11
v_mfma_f32_16x16x32_bf16 v[44:47], a[228:231], v[124:127], v[44:47]
buffer_load_dwordx4 v19, s[16:19], s99 offen offset:3072 lds
v_cvt_pk_bf16_f32 v130, v12, v13
v_cvt_pk_bf16_f32 v131, v14, v15
v_mfma_f32_16x16x32_bf16 v[48:51], a[232:235], v[120:123], v[48:51]
ds_read_b64_tr_b16 a[252:253], v26 offset:9432
ds_read_b64_tr_b16 a[254:255], v26 offset:14040
v_mfma_f32_16x16x32_bf16 v[52:55], a[232:235], v[124:127], v[52:55]
v_fma_f32 v22, v22, v3, v5
v_fma_f32 v23, v23, v3, v5
v_fma_f32 v24, v24, v3, v5
v_mfma_f32_16x16x32_bf16 v[56:59], a[236:239], v[120:123], v[56:59]
ds_read_b64_tr_b16 a[192:193], v26 offset:9472
ds_read_b64_tr_b16 a[194:195], v26 offset:14080
v_mfma_f32_16x16x32_bf16 v[60:63], a[236:239], v[124:127], v[60:63]
s_add_u32 m0, s3, 77824
v_fma_f32 v25, v25, v3, v5
s_waitcnt lgkmcnt(4)
v_mfma_f32_16x16x32_bf16 v[64:67], a[240:243], v[120:123], v[64:67]
ds_read_b64_tr_b16 a[196:197], v29 offset:9216
ds_read_b64_tr_b16 a[198:199], v29 offset:13824
v_mfma_f32_16x16x32_bf16 v[68:71], a[240:243], v[124:127], v[68:71]
buffer_load_dwordx4 v20, s[16:19], s99 offen lds
v_fma_f32 v32, v32, v3, v5
v_mfma_f32_16x16x32_bf16 v[72:75], a[244:247], v[120:123], v[72:75]
s_waitcnt vmcnt(17)
s_barrier
v_fma_f32 v33, v33, v3, v5
v_mfma_f32_16x16x32_bf16 v[76:79], a[244:247], v[124:127], v[76:79]
ds_read_b64_tr_b16 a[200:201], v26 offset:18432
ds_read_b64_tr_b16 a[202:203], v26 offset:23040
v_mfma_f32_16x16x32_bf16 v[8:11], a[146:149], v[136:139], 0
s_add_u32 m0, s3, 92160
s_add_u32 s99, s63, 1152
v_fma_f32 v34, v34, v3, v5
v_mfma_f32_16x16x32_bf16 v[12:15], a[144:147], v[136:139], 0
v_fma_f32 v35, v35, v3, v5
v_cvt_pk_bf16_f32 v132, v22, v23
v_mfma_f32_16x16x32_bf16 v[80:83], a[248:251], v[120:123], v[80:83]
ds_read_b64_tr_b16 a[204:205], v26 offset:18472
ds_read_b64_tr_b16 a[206:207], v26 offset:23080
v_cvt_pk_bf16_f32 v133, v24, v25
v_mfma_f32_16x16x32_bf16 v[84:87], a[248:251], v[124:127], v[84:87]
v_cvt_pk_bf16_f32 v134, v32, v33
v_cvt_pk_bf16_f32 v135, v34, v35
s_waitcnt lgkmcnt(4)
v_mfma_f32_16x16x32_bf16 v[88:91], a[252:255], v[120:123], v[88:91]
ds_read_b64_tr_b16 a[208:209], v26 offset:18504
ds_read_b64_tr_b16 a[210:211], v26 offset:23112
v_mfma_f32_16x16x32_bf16 v[92:95], a[252:255], v[124:127], v[92:95]
buffer_load_dwordx4 v16, s[16:19], s99 offen offset:0 lds
v_fma_f32 v8, v8, v2, v4
v_mfma_f32_16x16x32_bf16 v[96:99], a[192:195], v[120:123], v[96:99]
ds_read_b64_tr_b16 a[212:213], v26 offset:18544
ds_read_b64_tr_b16 a[214:215], v26 offset:23152
v_fma_f32 v9, v9, v2, v4
v_mfma_f32_16x16x32_bf16 v[100:103], a[192:195], v[124:127], v[100:103]
buffer_load_dwordx4 v17, s[16:19], s99 offen offset:1024 lds
v_fma_f32 v10, v10, v2, v4
v_mfma_f32_16x16x32_bf16 v[104:107], a[196:199], v[120:123], v[104:107]
ds_read_b64_tr_b16 a[216:217], v26 offset:18576
ds_read_b64_tr_b16 a[218:219], v26 offset:23184
v_fma_f32 v11, v11, v2, v4
v_mfma_f32_16x16x32_bf16 v[108:111], a[196:199], v[124:127], v[108:111]
v_fma_f32 v12, v12, v2, v4
v_fma_f32 v13, v13, v2, v4
s_waitcnt lgkmcnt(4)
v_mfma_f32_16x16x32_bf16 v[22:25], a[146:149], v[140:143], 0
buffer_load_dwordx4 v18, s[16:19], s99 offen offset:2048 lds
v_fma_f32 v14, v14, v2, v4
v_mfma_f32_16x16x32_bf16 v[32:35], a[144:147], v[140:143], 0
v_fma_f32 v15, v15, v2, v4
v_cvt_pk_bf16_f32 v136, v8, v9
v_cvt_pk_bf16_f32 v137, v10, v11
v_mfma_f32_16x16x32_bf16 v[40:43], a[200:203], v[128:131], v[40:43]
ds_read_b64_tr_b16 a[220:221], v26 offset:18616
ds_read_b64_tr_b16 a[222:223], v26 offset:23224
v_cvt_pk_bf16_f32 v138, v12, v13
v_mfma_f32_16x16x32_bf16 v[44:47], a[200:203], v[132:135], v[44:47]
buffer_load_dwordx4 v19, s[16:19], s99 offen offset:3072 lds
v_cvt_pk_bf16_f32 v139, v14, v15
v_mfma_f32_16x16x32_bf16 v[48:51], a[204:207], v[128:131], v[48:51]
ds_read_b64_tr_b16 a[224:225], v26 offset:18648
ds_read_b64_tr_b16 a[226:227], v26 offset:23256
v_mfma_f32_16x16x32_bf16 v[52:55], a[204:207], v[132:135], v[52:55]
s_add_u32 m0, s3, 96256
v_fma_f32 v22, v22, v3, v5
v_fma_f32 v23, v23, v3, v5
v_mfma_f32_16x16x32_bf16 v[56:59], a[208:211], v[128:131], v[56:59]
ds_read_b64_tr_b16 a[228:229], v26 offset:18688
ds_read_b64_tr_b16 a[230:231], v26 offset:23296
v_mfma_f32_16x16x32_bf16 v[60:63], a[208:211], v[132:135], v[60:63]
v_fma_f32 v24, v24, v3, v5
v_fma_f32 v25, v25, v3, v5
s_waitcnt lgkmcnt(4)
v_mfma_f32_16x16x32_bf16 v[64:67], a[212:215], v[128:131], v[64:67]
ds_read_b64_tr_b16 a[232:233], v29 offset:18432
ds_read_b64_tr_b16 a[234:235], v29 offset:23040
v_mfma_f32_16x16x32_bf16 v[68:71], a[212:215], v[132:135], v[68:71]
buffer_load_dwordx4 v20, s[16:19], s99 offen lds
v_fma_f32 v32, v32, v3, v5
v_mfma_f32_16x16x32_bf16 v[72:75], a[216:219], v[128:131], v[72:75]
ds_read_b64_tr_b16 a[236:237], v26 offset:27648
ds_read_b64_tr_b16 a[238:239], v26 offset:32256
v_fma_f32 v33, v33, v3, v5
v_mfma_f32_16x16x32_bf16 v[76:79], a[216:219], v[132:135], v[76:79]
s_add_u32 m0, s3, 110592
v_fma_f32 v34, v34, v3, v5
v_mfma_f32_16x16x32_bf16 v[8:11], a[146:149], v[144:147], 0
s_add_u32 s99, s64, 1152
v_fma_f32 v35, v35, v3, v5
v_cvt_pk_bf16_f32 v140, v22, v23
v_mfma_f32_16x16x32_bf16 v[12:15], a[144:147], v[144:147], 0
buffer_load_dwordx4 v16, s[16:19], s99 offen offset:0 lds
v_mfma_f32_16x16x32_bf16 v[80:83], a[220:223], v[128:131], v[80:83]
ds_read_b64_tr_b16 a[240:241], v26 offset:27688
ds_read_b64_tr_b16 a[242:243], v26 offset:32296
v_cvt_pk_bf16_f32 v141, v24, v25
v_mfma_f32_16x16x32_bf16 v[84:87], a[220:223], v[132:135], v[84:87]
v_cvt_pk_bf16_f32 v142, v32, v33
v_cvt_pk_bf16_f32 v143, v34, v35
s_waitcnt lgkmcnt(4)
v_mfma_f32_16x16x32_bf16 v[88:91], a[224:227], v[128:131], v[88:91]
ds_read_b64_tr_b16 a[244:245], v26 offset:27720
ds_read_b64_tr_b16 a[246:247], v26 offset:32328
v_mfma_f32_16x16x32_bf16 v[92:95], a[224:227], v[132:135], v[92:95]
buffer_load_dwordx4 v17, s[16:19], s99 offen offset:1024 lds
v_fma_f32 v8, v8, v2, v4
v_mfma_f32_16x16x32_bf16 v[96:99], a[228:231], v[128:131], v[96:99]
ds_read_b64_tr_b16 a[248:249], v26 offset:27760
ds_read_b64_tr_b16 a[250:251], v26 offset:32368
v_fma_f32 v9, v9, v2, v4
v_mfma_f32_16x16x32_bf16 v[100:103], a[228:231], v[132:135], v[100:103]
v_fma_f32 v10, v10, v2, v4
v_fma_f32 v11, v11, v2, v4
v_mfma_f32_16x16x32_bf16 v[104:107], a[232:235], v[128:131], v[104:107]
ds_read_b64_tr_b16 a[252:253], v26 offset:27792
ds_read_b64_tr_b16 a[254:255], v26 offset:32400
v_fma_f32 v12, v12, v2, v4
v_mfma_f32_16x16x32_bf16 v[108:111], a[232:235], v[132:135], v[108:111]
v_fma_f32 v13, v13, v2, v4
v_fma_f32 v14, v14, v2, v4
s_waitcnt lgkmcnt(4)
v_mfma_f32_16x16x32_bf16 v[22:25], a[146:149], v[148:151], 0
buffer_load_dwordx4 v18, s[16:19], s99 offen offset:2048 lds
v_mfma_f32_16x16x32_bf16 v[32:35], a[144:147], v[148:151], 0
buffer_load_dwordx4 v19, s[16:19], s99 offen offset:3072 lds
v_fma_f32 v15, v15, v2, v4
v_mfma_f32_16x16x32_bf16 v[40:43], a[236:239], v[136:139], v[40:43]
ds_read_b64_tr_b16 a[192:193], v26 offset:27832
ds_read_b64_tr_b16 a[194:195], v26 offset:32440
v_cvt_pk_bf16_f32 v144, v8, v9
v_mfma_f32_16x16x32_bf16 v[44:47], a[236:239], v[140:143], v[44:47]
v_cvt_pk_bf16_f32 v145, v10, v11
v_cvt_pk_bf16_f32 v146, v12, v13
v_cvt_pk_bf16_f32 v147, v14, v15
v_mfma_f32_16x16x32_bf16 v[48:51], a[240:243], v[136:139], v[48:51]
ds_read_b64_tr_b16 a[196:197], v26 offset:27864
ds_read_b64_tr_b16 a[198:199], v26 offset:32472
v_mfma_f32_16x16x32_bf16 v[52:55], a[240:243], v[140:143], v[52:55]
s_add_u32 m0, s3, 114688
v_fma_f32 v22, v22, v3, v5
v_fma_f32 v23, v23, v3, v5
v_mfma_f32_16x16x32_bf16 v[56:59], a[244:247], v[136:139], v[56:59]
ds_read_b64_tr_b16 a[200:201], v26 offset:27904
ds_read_b64_tr_b16 a[202:203], v26 offset:32512
v_fma_f32 v24, v24, v3, v5
v_mfma_f32_16x16x32_bf16 v[60:63], a[244:247], v[140:143], v[60:63]
v_fma_f32 v25, v25, v3, v5
s_waitcnt lgkmcnt(4)
v_mfma_f32_16x16x32_bf16 v[64:67], a[248:251], v[136:139], v[64:67]
ds_read_b64_tr_b16 a[204:205], v29 offset:27648
ds_read_b64_tr_b16 a[206:207], v29 offset:32256
v_fma_f32 v32, v32, v3, v5
v_mfma_f32_16x16x32_bf16 v[68:71], a[248:251], v[140:143], v[68:71]
buffer_load_dwordx4 v20, s[16:19], s99 offen lds
v_fma_f32 v33, v33, v3, v5
v_mfma_f32_16x16x32_bf16 v[72:75], a[252:255], v[136:139], v[72:75]
s_waitcnt vmcnt(15)
s_waitcnt vmcnt(20)
s_barrier
v_mfma_f32_16x16x32_bf16 v[76:79], a[252:255], v[140:143], v[76:79]
ds_read_b64_tr_b16 a[208:209], v26 offset:36864
ds_read_b64_tr_b16 a[210:211], v26 offset:41472
v_fma_f32 v34, v34, v3, v5
v_mfma_f32_16x16x32_bf16 v[8:11], a[146:149], v[152:155], 0
s_add_u32 m0, s3, 129024
v_fma_f32 v35, v35, v3, v5
v_cvt_pk_bf16_f32 v148, v22, v23
v_mfma_f32_16x16x32_bf16 v[12:15], a[144:147], v[152:155], 0
v_cvt_pk_bf16_f32 v149, v24, v25
v_cvt_pk_bf16_f32 v150, v32, v33
v_mfma_f32_16x16x32_bf16 v[80:83], a[192:195], v[136:139], v[80:83]
ds_read_b64_tr_b16 a[212:213], v26 offset:36904
ds_read_b64_tr_b16 a[214:215], v26 offset:41512
v_cvt_pk_bf16_f32 v151, v34, v35
v_mfma_f32_16x16x32_bf16 v[84:87], a[192:195], v[140:143], v[84:87]
s_add_u32 s99, s65, 1152
s_waitcnt lgkmcnt(4)
v_mfma_f32_16x16x32_bf16 v[88:91], a[196:199], v[136:139], v[88:91]
ds_read_b64_tr_b16 a[216:217], v26 offset:36936
ds_read_b64_tr_b16 a[218:219], v26 offset:41544
buffer_atomic_add v38, v1, s[28:31], 0 offen sc1
v_mfma_f32_16x16x32_bf16 v[92:95], a[196:199], v[140:143], v[92:95]
buffer_load_dwordx4 v16, s[16:19], s99 offen offset:0 lds
v_fma_f32 v8, v8, v2, v4
v_mfma_f32_16x16x32_bf16 v[96:99], a[200:203], v[136:139], v[96:99]
ds_read_b64_tr_b16 a[220:221], v26 offset:36976
ds_read_b64_tr_b16 a[222:223], v26 offset:41584
v_mfma_f32_16x16x32_bf16 v[100:103], a[200:203], v[140:143], v[100:103]
v_fma_f32 v9, v9, v2, v4
v_fma_f32 v10, v10, v2, v4
v_fma_f32 v11, v11, v2, v4
v_mfma_f32_16x16x32_bf16 v[104:107], a[204:207], v[136:139], v[104:107]
ds_read_b64_tr_b16 a[224:225], v26 offset:37008
ds_read_b64_tr_b16 a[226:227], v26 offset:41616
v_mfma_f32_16x16x32_bf16 v[108:111], a[204:207], v[140:143], v[108:111]
v_fma_f32 v12, v12, v2, v4
v_fma_f32 v13, v13, v2, v4
s_waitcnt lgkmcnt(4)
v_mfma_f32_16x16x32_bf16 v[22:25], a[146:149], v[156:159], 0
v_fma_f32 v14, v14, v2, v4
v_fma_f32 v15, v15, v2, v4
v_mfma_f32_16x16x32_bf16 v[32:35], a[144:147], v[156:159], 0
v_cvt_pk_bf16_f32 v152, v8, v9
v_cvt_pk_bf16_f32 v153, v10, v11
v_cvt_pk_bf16_f32 v154, v12, v13
v_mfma_f32_16x16x32_bf16 v[40:43], a[208:211], v[144:147], v[40:43]
ds_read_b64_tr_b16 a[228:229], v26 offset:37048
ds_read_b64_tr_b16 a[230:231], v26 offset:41656
v_mfma_f32_16x16x32_bf16 v[44:47], a[208:211], v[148:151], v[44:47]
buffer_load_dwordx4 v17, s[16:19], s99 offen offset:1024 lds
v_cvt_pk_bf16_f32 v155, v14, v15
v_mfma_f32_16x16x32_bf16 v[48:51], a[212:215], v[144:147], v[48:51]
ds_read_b64_tr_b16 a[232:233], v26 offset:37080
ds_read_b64_tr_b16 a[234:235], v26 offset:41688
v_mfma_f32_16x16x32_bf16 v[52:55], a[212:215], v[148:151], v[52:55]
v_fma_f32 v22, v22, v3, v5
v_fma_f32 v23, v23, v3, v5
v_mfma_f32_16x16x32_bf16 v[56:59], a[216:219], v[144:147], v[56:59]
ds_read_b64_tr_b16 a[236:237], v26 offset:37120
ds_read_b64_tr_b16 a[238:239], v26 offset:41728
v_mfma_f32_16x16x32_bf16 v[60:63], a[216:219], v[148:151], v[60:63]
v_fma_f32 v24, v24, v3, v5
s_waitcnt lgkmcnt(4)
v_mfma_f32_16x16x32_bf16 v[64:67], a[220:223], v[144:147], v[64:67]
ds_read_b64_tr_b16 a[240:241], v29 offset:36864
ds_read_b64_tr_b16 a[242:243], v29 offset:41472
v_mfma_f32_16x16x32_bf16 v[68:71], a[220:223], v[148:151], v[68:71]
buffer_load_dwordx4 v18, s[16:19], s99 offen offset:2048 lds
v_fma_f32 v25, v25, v3, v5
v_mfma_f32_16x16x32_bf16 v[72:75], a[224:227], v[144:147], v[72:75]
ds_read_b64_tr_b16 a[244:245], v26 offset:46080
ds_read_b64_tr_b16 a[246:247], v26 offset:50688
v_mfma_f32_16x16x32_bf16 v[76:79], a[224:227], v[148:151], v[76:79]
v_fma_f32 v32, v32, v3, v5
v_fma_f32 v33, v33, v3, v5
v_mfma_f32_16x16x32_bf16 v[8:11], a[146:149], v[160:163], 0
v_fma_f32 v34, v34, v3, v5
v_fma_f32 v35, v35, v3, v5
v_mfma_f32_16x16x32_bf16 v[12:15], a[144:147], v[160:163], 0
v_cvt_pk_bf16_f32 v156, v22, v23
v_cvt_pk_bf16_f32 v157, v24, v25
v_mfma_f32_16x16x32_bf16 v[80:83], a[228:231], v[144:147], v[80:83]
ds_read_b64_tr_b16 a[248:249], v26 offset:46120
ds_read_b64_tr_b16 a[250:251], v26 offset:50728
v_mfma_f32_16x16x32_bf16 v[84:87], a[228:231], v[148:151], v[84:87]
v_cvt_pk_bf16_f32 v158, v32, v33
v_cvt_pk_bf16_f32 v159, v34, v35
s_waitcnt lgkmcnt(4)
v_mfma_f32_16x16x32_bf16 v[88:91], a[232:235], v[144:147], v[88:91]
ds_read_b64_tr_b16 a[252:253], v26 offset:46152
ds_read_b64_tr_b16 a[254:255], v26 offset:50760
v_mfma_f32_16x16x32_bf16 v[92:95], a[232:235], v[148:151], v[92:95]
buffer_load_dwordx4 v19, s[16:19], s99 offen offset:3072 lds
v_fma_f32 v8, v8, v2, v4
v_mfma_f32_16x16x32_bf16 v[96:99], a[236:239], v[144:147], v[96:99]
ds_read_b64_tr_b16 a[192:193], v26 offset:46192
ds_read_b64_tr_b16 a[194:195], v26 offset:50800
v_mfma_f32_16x16x32_bf16 v[100:103], a[236:239], v[148:151], v[100:103]
v_fma_f32 v9, v9, v2, v4
v_fma_f32 v10, v10, v2, v4
v_fma_f32 v11, v11, v2, v4
v_mfma_f32_16x16x32_bf16 v[104:107], a[240:243], v[144:147], v[104:107]
ds_read_b64_tr_b16 a[196:197], v26 offset:46224
ds_read_b64_tr_b16 a[198:199], v26 offset:50832
v_fma_f32 v12, v12, v2, v4
v_mfma_f32_16x16x32_bf16 v[108:111], a[240:243], v[148:151], v[108:111]
v_fma_f32 v13, v13, v2, v4
s_waitcnt lgkmcnt(4)
v_mfma_f32_16x16x32_bf16 v[22:25], a[146:149], v[164:167], 0
s_add_u32 m0, s3, 133120
v_fma_f32 v14, v14, v2, v4
v_fma_f32 v15, v15, v2, v4
v_mfma_f32_16x16x32_bf16 v[32:35], a[144:147], v[164:167], 0
v_cvt_pk_bf16_f32 v160, v8, v9
v_cvt_pk_bf16_f32 v161, v10, v11
v_mfma_f32_16x16x32_bf16 v[40:43], a[244:247], v[152:155], v[40:43]
ds_read_b64_tr_b16 a[200:201], v26 offset:46264
ds_read_b64_tr_b16 a[202:203], v26 offset:50872
v_cvt_pk_bf16_f32 v162, v12, v13
v_mfma_f32_16x16x32_bf16 v[44:47], a[244:247], v[156:159], v[44:47]
buffer_load_dwordx4 v20, s[16:19], s99 offen lds
v_cvt_pk_bf16_f32 v163, v14, v15
v_mfma_f32_16x16x32_bf16 v[48:51], a[248:251], v[152:155], v[48:51]
ds_read_b64_tr_b16 a[204:205], v26 offset:46296
ds_read_b64_tr_b16 a[206:207], v26 offset:50904
v_mfma_f32_16x16x32_bf16 v[52:55], a[248:251], v[156:159], v[52:55]
v_fma_f32 v22, v22, v3, v5
v_fma_f32 v23, v23, v3, v5
v_mfma_f32_16x16x32_bf16 v[56:59], a[252:255], v[152:155], v[56:59]
ds_read_b64_tr_b16 a[208:209], v26 offset:46336
ds_read_b64_tr_b16 a[210:211], v26 offset:50944
v_mfma_f32_16x16x32_bf16 v[60:63], a[252:255], v[156:159], v[60:63]
v_fma_f32 v24, v24, v3, v5
s_waitcnt lgkmcnt(4)
v_mfma_f32_16x16x32_bf16 v[64:67], a[192:195], v[152:155], v[64:67]
ds_read_b64_tr_b16 a[212:213], v29 offset:46080
ds_read_b64_tr_b16 a[214:215], v29 offset:50688
v_mfma_f32_16x16x32_bf16 v[68:71], a[192:195], v[156:159], v[68:71]
v_fma_f32 v25, v25, v3, v5
v_fma_f32 v32, v32, v3, v5
v_fma_f32 v33, v33, v3, v5
v_mfma_f32_16x16x32_bf16 v[72:75], a[196:199], v[152:155], v[72:75]
ds_read_b64_tr_b16 a[216:217], v27 offset:0
ds_read_b64_tr_b16 a[218:219], v27 offset:4608
v_mfma_f32_16x16x32_bf16 v[76:79], a[196:199], v[156:159], v[76:79]
s_add_u32 m0, s3, 0
v_fma_f32 v34, v34, v3, v5
v_mfma_f32_16x16x32_bf16 v[8:11], a[146:149], v[168:171], 0
v_fma_f32 v35, v35, v3, v5
v_cvt_pk_bf16_f32 v164, v22, v23
v_mfma_f32_16x16x32_bf16 v[12:15], a[144:147], v[168:171], 0
s_add_u32 s99, s66, 1152
v_cvt_pk_bf16_f32 v165, v24, v25
v_mfma_f32_16x16x32_bf16 v[80:83], a[200:203], v[152:155], v[80:83]
ds_read_b64_tr_b16 a[220:221], v27 offset:40
ds_read_b64_tr_b16 a[222:223], v27 offset:4648
v_mfma_f32_16x16x32_bf16 v[84:87], a[200:203], v[156:159], v[84:87]
v_cvt_pk_bf16_f32 v166, v32, v33
v_cvt_pk_bf16_f32 v167, v34, v35
s_waitcnt lgkmcnt(4)
v_mfma_f32_16x16x32_bf16 v[88:91], a[204:207], v[152:155], v[88:91]
ds_read_b64_tr_b16 a[224:225], v27 offset:72
ds_read_b64_tr_b16 a[226:227], v27 offset:4680
v_mfma_f32_16x16x32_bf16 v[92:95], a[204:207], v[156:159], v[92:95]
buffer_load_dwordx4 v16, s[16:19], s99 offen offset:0 lds
v_fma_f32 v8, v8, v2, v4
v_mfma_f32_16x16x32_bf16 v[96:99], a[208:211], v[152:155], v[96:99]
ds_read_b64_tr_b16 a[228:229], v27 offset:112
ds_read_b64_tr_b16 a[230:231], v27 offset:4720
v_mfma_f32_16x16x32_bf16 v[100:103], a[208:211], v[156:159], v[100:103]
v_fma_f32 v9, v9, v2, v4
v_fma_f32 v10, v10, v2, v4
v_fma_f32 v11, v11, v2, v4
v_mfma_f32_16x16x32_bf16 v[104:107], a[212:215], v[152:155], v[104:107]
ds_read_b64_tr_b16 a[232:233], v27 offset:144
ds_read_b64_tr_b16 a[234:235], v27 offset:4752
v_mfma_f32_16x16x32_bf16 v[108:111], a[212:215], v[156:159], v[108:111]
v_fma_f32 v12, v12, v2, v4
v_fma_f32 v13, v13, v2, v4
s_waitcnt lgkmcnt(4)
v_mfma_f32_16x16x32_bf16 v[22:25], a[146:149], v[172:175], 0
v_fma_f32 v14, v14, v2, v4
v_fma_f32 v15, v15, v2, v4
v_mfma_f32_16x16x32_bf16 v[32:35], a[144:147], v[172:175], 0
buffer_load_dwordx4 v17, s[16:19], s99 offen offset:1024 lds
v_cvt_pk_bf16_f32 v168, v8, v9
v_mfma_f32_16x16x32_bf16 v[40:43], a[216:219], v[160:163], v[40:43]
ds_read_b64_tr_b16 a[236:237], v27 offset:184
ds_read_b64_tr_b16 a[238:239], v27 offset:4792
v_mfma_f32_16x16x32_bf16 v[44:47], a[216:219], v[164:167], v[44:47]
v_cvt_pk_bf16_f32 v169, v10, v11
v_cvt_pk_bf16_f32 v170, v12, v13
v_cvt_pk_bf16_f32 v171, v14, v15
v_mfma_f32_16x16x32_bf16 v[48:51], a[220:223], v[160:163], v[48:51]
ds_read_b64_tr_b16 a[240:241], v27 offset:216
ds_read_b64_tr_b16 a[242:243], v27 offset:4824
v_mfma_f32_16x16x32_bf16 v[52:55], a[220:223], v[164:167], v[52:55]
v_fma_f32 v22, v22, v3, v5
v_fma_f32 v23, v23, v3, v5
v_mfma_f32_16x16x32_bf16 v[56:59], a[224:227], v[160:163], v[56:59]
ds_read_b64_tr_b16 a[244:245], v27 offset:256
ds_read_b64_tr_b16 a[246:247], v27 offset:4864
v_mfma_f32_16x16x32_bf16 v[60:63], a[224:227], v[164:167], v[60:63]
v_fma_f32 v24, v24, v3, v5
s_waitcnt lgkmcnt(4)
v_mfma_f32_16x16x32_bf16 v[64:67], a[228:231], v[160:163], v[64:67]
ds_read_b64_tr_b16 a[248:249], v30 offset:0
ds_read_b64_tr_b16 a[250:251], v30 offset:4608
v_mfma_f32_16x16x32_bf16 v[68:71], a[228:231], v[164:167], v[68:71]
buffer_load_dwordx4 v18, s[16:19], s99 offen offset:2048 lds
v_fma_f32 v25, v25, v3, v5
v_mfma_f32_16x16x32_bf16 v[72:75], a[232:235], v[160:163], v[72:75]
ds_read_b64_tr_b16 a[252:253], v27 offset:9216
ds_read_b64_tr_b16 a[254:255], v27 offset:13824
v_mfma_f32_16x16x32_bf16 v[76:79], a[232:235], v[164:167], v[76:79]
v_fma_f32 v32, v32, v3, v5
v_fma_f32 v33, v33, v3, v5
v_mfma_f32_16x16x32_bf16 v[8:11], a[146:149], v[176:179], 0
v_fma_f32 v34, v34, v3, v5
v_fma_f32 v35, v35, v3, v5
v_mfma_f32_16x16x32_bf16 v[12:15], a[144:147], v[176:179], 0
v_cvt_pk_bf16_f32 v172, v22, v23
v_cvt_pk_bf16_f32 v173, v24, v25
v_mfma_f32_16x16x32_bf16 v[80:83], a[236:239], v[160:163], v[80:83]
ds_read_b64_tr_b16 a[192:193], v27 offset:9256
ds_read_b64_tr_b16 a[194:195], v27 offset:13864
v_mfma_f32_16x16x32_bf16 v[84:87], a[236:239], v[164:167], v[84:87]
v_cvt_pk_bf16_f32 v174, v32, v33
v_cvt_pk_bf16_f32 v175, v34, v35
s_waitcnt lgkmcnt(4)
v_mfma_f32_16x16x32_bf16 v[88:91], a[240:243], v[160:163], v[88:91]
ds_read_b64_tr_b16 a[196:197], v27 offset:9288
ds_read_b64_tr_b16 a[198:199], v27 offset:13896
v_mfma_f32_16x16x32_bf16 v[92:95], a[240:243], v[164:167], v[92:95]
buffer_load_dwordx4 v19, s[16:19], s99 offen offset:3072 lds
v_fma_f32 v8, v8, v2, v4
v_mfma_f32_16x16x32_bf16 v[96:99], a[244:247], v[160:163], v[96:99]
ds_read_b64_tr_b16 a[200:201], v27 offset:9328
ds_read_b64_tr_b16 a[202:203], v27 offset:13936
v_mfma_f32_16x16x32_bf16 v[100:103], a[244:247], v[164:167], v[100:103]
v_fma_f32 v9, v9, v2, v4
v_fma_f32 v10, v10, v2, v4
v_fma_f32 v11, v11, v2, v4
v_mfma_f32_16x16x32_bf16 v[104:107], a[248:251], v[160:163], v[104:107]
ds_read_b64_tr_b16 a[204:205], v27 offset:9360
ds_read_b64_tr_b16 a[206:207], v27 offset:13968
v_fma_f32 v12, v12, v2, v4
v_mfma_f32_16x16x32_bf16 v[108:111], a[248:251], v[164:167], v[108:111]
s_add_u32 m0, s3, 4096
s_waitcnt lgkmcnt(4)
v_mfma_f32_16x16x32_bf16 v[22:25], a[146:149], v[180:183], 0
v_fma_f32 v13, v13, v2, v4
v_fma_f32 v14, v14, v2, v4
v_fma_f32 v15, v15, v2, v4
v_mfma_f32_16x16x32_bf16 v[32:35], a[144:147], v[180:183], 0
v_cvt_pk_bf16_f32 v176, v8, v9
v_cvt_pk_bf16_f32 v177, v10, v11
v_mfma_f32_16x16x32_bf16 v[40:43], a[252:255], v[168:171], v[40:43]
ds_read_b64_tr_b16 a[208:209], v27 offset:9400
ds_read_b64_tr_b16 a[210:211], v27 offset:14008
v_cvt_pk_bf16_f32 v178, v12, v13
v_mfma_f32_16x16x32_bf16 v[44:47], a[252:255], v[172:175], v[44:47]
buffer_load_dwordx4 v20, s[16:19], s99 offen lds
v_cvt_pk_bf16_f32 v179, v14, v15
v_mfma_f32_16x16x32_bf16 v[48:51], a[192:195], v[168:171], v[48:51]
ds_read_b64_tr_b16 a[212:213], v27 offset:9432
ds_read_b64_tr_b16 a[214:215], v27 offset:14040
v_mfma_f32_16x16x32_bf16 v[52:55], a[192:195], v[172:175], v[52:55]
v_fma_f32 v22, v22, v3, v5
v_fma_f32 v23, v23, v3, v5
v_mfma_f32_16x16x32_bf16 v[56:59], a[196:199], v[168:171], v[56:59]
ds_read_b64_tr_b16 a[216:217], v27 offset:9472
ds_read_b64_tr_b16 a[218:219], v27 offset:14080
v_fma_f32 v24, v24, v3, v5
v_mfma_f32_16x16x32_bf16 v[60:63], a[196:199], v[172:175], v[60:63]
v_fma_f32 v25, v25, v3, v5
s_waitcnt lgkmcnt(4)
v_mfma_f32_16x16x32_bf16 v[64:67], a[200:203], v[168:171], v[64:67]
ds_read_b64_tr_b16 a[220:221], v30 offset:9216
ds_read_b64_tr_b16 a[222:223], v30 offset:13824
v_mfma_f32_16x16x32_bf16 v[68:71], a[200:203], v[172:175], v[68:71]
v_fma_f32 v32, v32, v3, v5
v_fma_f32 v33, v33, v3, v5
v_fma_f32 v34, v34, v3, v5
v_mfma_f32_16x16x32_bf16 v[72:75], a[204:207], v[168:171], v[72:75]
s_waitcnt vmcnt(16)
s_barrier
v_mfma_f32_16x16x32_bf16 v[76:79], a[204:207], v[172:175], v[76:79]
ds_read_b64_tr_b16 a[224:225], v27 offset:18432
ds_read_b64_tr_b16 a[226:227], v27 offset:23040
v_mfma_f32_16x16x32_bf16 v[8:11], a[146:149], v[184:187], 0
s_add_u32 m0, s3, 18432
v_fma_f32 v35, v35, v3, v5
v_cvt_pk_bf16_f32 v180, v22, v23
v_mfma_f32_16x16x32_bf16 v[12:15], a[144:147], v[184:187], 0
v_cvt_pk_bf16_f32 v181, v24, v25
v_cvt_pk_bf16_f32 v182, v32, v33
v_mfma_f32_16x16x32_bf16 v[80:83], a[208:211], v[168:171], v[80:83]
ds_read_b64_tr_b16 a[228:229], v27 offset:18472
ds_read_b64_tr_b16 a[230:231], v27 offset:23080
v_mfma_f32_16x16x32_bf16 v[84:87], a[208:211], v[172:175], v[84:87]
s_add_u32 s99, s58, 2304
v_cvt_pk_bf16_f32 v183, v34, v35
s_waitcnt lgkmcnt(4)
v_mfma_f32_16x16x32_bf16 v[88:91], a[212:215], v[168:171], v[88:91]
ds_read_b64_tr_b16 a[232:233], v27 offset:18504
ds_read_b64_tr_b16 a[234:235], v27 offset:23112
v_mfma_f32_16x16x32_bf16 v[92:95], a[212:215], v[172:175], v[92:95]
buffer_load_dwordx4 v16, s[16:19], s99 offen offset:0 lds
v_fma_f32 v8, v8, v2, v4
v_mfma_f32_16x16x32_bf16 v[96:99], a[216:219], v[168:171], v[96:99]
ds_read_b64_tr_b16 a[236:237], v27 offset:18544
ds_read_b64_tr_b16 a[238:239], v27 offset:23152
v_mfma_f32_16x16x32_bf16 v[100:103], a[216:219], v[172:175], v[100:103]
v_fma_f32 v9, v9, v2, v4
v_fma_f32 v10, v10, v2, v4
v_fma_f32 v11, v11, v2, v4
v_mfma_f32_16x16x32_bf16 v[104:107], a[220:223], v[168:171], v[104:107]
ds_read_b64_tr_b16 a[240:241], v27 offset:18576
ds_read_b64_tr_b16 a[242:243], v27 offset:23184
v_mfma_f32_16x16x32_bf16 v[108:111], a[220:223], v[172:175], v[108:111]
v_fma_f32 v12, v12, v2, v4
v_fma_f32 v13, v13, v2, v4
s_waitcnt lgkmcnt(4)
v_mfma_f32_16x16x32_bf16 v[22:25], a[146:149], v[188:191], 0
v_fma_f32 v14, v14, v2, v4
v_fma_f32 v15, v15, v2, v4
v_mfma_f32_16x16x32_bf16 v[32:35], a[144:147], v[188:191], 0
v_cvt_pk_bf16_f32 v184, v8, v9
v_cvt_pk_bf16_f32 v185, v10, v11
v_cvt_pk_bf16_f32 v186, v12, v13
v_mfma_f32_16x16x32_bf16 v[40:43], a[224:227], v[176:179], v[40:43]
ds_read_b64_tr_b16 a[244:245], v27 offset:18616
ds_read_b64_tr_b16 a[246:247], v27 offset:23224
v_mfma_f32_16x16x32_bf16 v[44:47], a[224:227], v[180:183], v[44:47]
buffer_load_dwordx4 v17, s[16:19], s99 offen offset:1024 lds
v_cvt_pk_bf16_f32 v187, v14, v15
v_mfma_f32_16x16x32_bf16 v[48:51], a[228:231], v[176:179], v[48:51]
ds_read_b64_tr_b16 a[248:249], v27 offset:18648
ds_read_b64_tr_b16 a[250:251], v27 offset:23256
v_mfma_f32_16x16x32_bf16 v[52:55], a[228:231], v[180:183], v[52:55]
v_fma_f32 v22, v22, v3, v5
v_fma_f32 v23, v23, v3, v5
v_mfma_f32_16x16x32_bf16 v[56:59], a[232:235], v[176:179], v[56:59]
ds_read_b64_tr_b16 a[252:253], v27 offset:18688
ds_read_b64_tr_b16 a[254:255], v27 offset:23296
v_mfma_f32_16x16x32_bf16 v[60:63], a[232:235], v[180:183], v[60:63]
v_fma_f32 v24, v24, v3, v5
s_waitcnt lgkmcnt(4)
v_mfma_f32_16x16x32_bf16 v[64:67], a[236:239], v[176:179], v[64:67]
ds_read_b64_tr_b16 a[192:193], v30 offset:18432
ds_read_b64_tr_b16 a[194:195], v30 offset:23040
v_mfma_f32_16x16x32_bf16 v[68:71], a[236:239], v[180:183], v[68:71]
buffer_load_dwordx4 v18, s[16:19], s99 offen offset:2048 lds
v_fma_f32 v25, v25, v3, v5
v_mfma_f32_16x16x32_bf16 v[72:75], a[240:243], v[176:179], v[72:75]
ds_read_b64_tr_b16 a[196:197], v27 offset:27648
ds_read_b64_tr_b16 a[198:199], v27 offset:32256
v_mfma_f32_16x16x32_bf16 v[76:79], a[240:243], v[180:183], v[76:79]
v_fma_f32 v32, v32, v3, v5
v_fma_f32 v33, v33, v3, v5
v_mfma_f32_16x16x32_bf16 v[8:11], a[146:149], v[192:195], 0
v_fma_f32 v34, v34, v3, v5
v_fma_f32 v35, v35, v3, v5
v_mfma_f32_16x16x32_bf16 v[12:15], a[144:147], v[192:195], 0
v_cvt_pk_bf16_f32 v188, v22, v23
v_cvt_pk_bf16_f32 v189, v24, v25
v_mfma_f32_16x16x32_bf16 v[80:83], a[244:247], v[176:179], v[80:83]
ds_read_b64_tr_b16 a[200:201], v27 offset:27688
ds_read_b64_tr_b16 a[202:203], v27 offset:32296
v_mfma_f32_16x16x32_bf16 v[84:87], a[244:247], v[180:183], v[84:87]
v_cvt_pk_bf16_f32 v190, v32, v33
v_cvt_pk_bf16_f32 v191, v34, v35
s_waitcnt lgkmcnt(4)
v_mfma_f32_16x16x32_bf16 v[88:91], a[248:251], v[176:179], v[88:91]
ds_read_b64_tr_b16 a[204:205], v27 offset:27720
ds_read_b64_tr_b16 a[206:207], v27 offset:32328
v_mfma_f32_16x16x32_bf16 v[92:95], a[248:251], v[180:183], v[92:95]
buffer_load_dwordx4 v19, s[16:19], s99 offen offset:3072 lds
v_fma_f32 v8, v8, v2, v4
v_mfma_f32_16x16x32_bf16 v[96:99], a[252:255], v[176:179], v[96:99]
ds_read_b64_tr_b16 a[208:209], v27 offset:27760
ds_read_b64_tr_b16 a[210:211], v27 offset:32368
v_mfma_f32_16x16x32_bf16 v[100:103], a[252:255], v[180:183], v[100:103]
v_fma_f32 v9, v9, v2, v4
v_fma_f32 v10, v10, v2, v4
v_fma_f32 v11, v11, v2, v4
v_mfma_f32_16x16x32_bf16 v[104:107], a[192:195], v[176:179], v[104:107]
ds_read_b64_tr_b16 a[212:213], v27 offset:27792
ds_read_b64_tr_b16 a[214:215], v27 offset:32400
v_fma_f32 v12, v12, v2, v4
v_mfma_f32_16x16x32_bf16 v[108:111], a[192:195], v[180:183], v[108:111]
v_fma_f32 v13, v13, v2, v4
s_waitcnt lgkmcnt(4)
v_mfma_f32_16x16x32_bf16 v[22:25], a[146:149], v[196:199], 0
s_add_u32 m0, s3, 22528
v_fma_f32 v14, v14, v2, v4
v_fma_f32 v15, v15, v2, v4
v_mfma_f32_16x16x32_bf16 v[32:35], a[144:147], v[196:199], 0
v_cvt_pk_bf16_f32 v192, v8, v9
v_cvt_pk_bf16_f32 v193, v10, v11
v_mfma_f32_16x16x32_bf16 v[40:43], a[196:199], v[184:187], v[40:43]
ds_read_b64_tr_b16 a[216:217], v27 offset:27832
ds_read_b64_tr_b16 a[218:219], v27 offset:32440
v_cvt_pk_bf16_f32 v194, v12, v13
v_mfma_f32_16x16x32_bf16 v[44:47], a[196:199], v[188:191], v[44:47]
buffer_load_dwordx4 v20, s[16:19], s99 offen lds
v_cvt_pk_bf16_f32 v195, v14, v15
v_mfma_f32_16x16x32_bf16 v[48:51], a[200:203], v[184:187], v[48:51]
ds_read_b64_tr_b16 a[220:221], v27 offset:27864
ds_read_b64_tr_b16 a[222:223], v27 offset:32472
v_mfma_f32_16x16x32_bf16 v[52:55], a[200:203], v[188:191], v[52:55]
v_fma_f32 v22, v22, v3, v5
v_fma_f32 v23, v23, v3, v5
v_mfma_f32_16x16x32_bf16 v[56:59], a[204:207], v[184:187], v[56:59]
ds_read_b64_tr_b16 a[224:225], v27 offset:27904
ds_read_b64_tr_b16 a[226:227], v27 offset:32512
v_mfma_f32_16x16x32_bf16 v[60:63], a[204:207], v[188:191], v[60:63]
v_fma_f32 v24, v24, v3, v5
s_waitcnt lgkmcnt(4)
v_mfma_f32_16x16x32_bf16 v[64:67], a[208:211], v[184:187], v[64:67]
ds_read_b64_tr_b16 a[228:229], v30 offset:27648
ds_read_b64_tr_b16 a[230:231], v30 offset:32256
v_mfma_f32_16x16x32_bf16 v[68:71], a[208:211], v[188:191], v[68:71]
v_fma_f32 v25, v25, v3, v5
v_fma_f32 v32, v32, v3, v5
v_fma_f32 v33, v33, v3, v5
v_mfma_f32_16x16x32_bf16 v[72:75], a[212:215], v[184:187], v[72:75]
ds_read_b64_tr_b16 a[232:233], v27 offset:36864
ds_read_b64_tr_b16 a[234:235], v27 offset:41472
v_mfma_f32_16x16x32_bf16 v[76:79], a[212:215], v[188:191], v[76:79]
s_add_u32 m0, s3, 36864
v_fma_f32 v34, v34, v3, v5
v_mfma_f32_16x16x32_bf16 v[8:11], a[146:149], v[200:203], 0
v_fma_f32 v35, v35, v3, v5
v_cvt_pk_bf16_f32 v196, v22, v23
v_mfma_f32_16x16x32_bf16 v[12:15], a[144:147], v[200:203], 0
s_add_u32 s99, s59, 2304
v_cvt_pk_bf16_f32 v197, v24, v25
v_mfma_f32_16x16x32_bf16 v[80:83], a[216:219], v[184:187], v[80:83]
ds_read_b64_tr_b16 a[236:237], v27 offset:36904
ds_read_b64_tr_b16 a[238:239], v27 offset:41512
v_mfma_f32_16x16x32_bf16 v[84:87], a[216:219], v[188:191], v[84:87]
v_cvt_pk_bf16_f32 v198, v32, v33
v_cvt_pk_bf16_f32 v199, v34, v35
s_waitcnt lgkmcnt(4)
v_mfma_f32_16x16x32_bf16 v[88:91], a[220:223], v[184:187], v[88:91]
ds_read_b64_tr_b16 a[240:241], v27 offset:36936
ds_read_b64_tr_b16 a[242:243], v27 offset:41544
v_mfma_f32_16x16x32_bf16 v[92:95], a[220:223], v[188:191], v[92:95]
buffer_load_dwordx4 v16, s[16:19], s99 offen offset:0 lds
v_fma_f32 v8, v8, v2, v4
v_mfma_f32_16x16x32_bf16 v[96:99], a[224:227], v[184:187], v[96:99]
ds_read_b64_tr_b16 a[244:245], v27 offset:36976
ds_read_b64_tr_b16 a[246:247], v27 offset:41584
v_mfma_f32_16x16x32_bf16 v[100:103], a[224:227], v[188:191], v[100:103]
v_fma_f32 v9, v9, v2, v4
v_fma_f32 v10, v10, v2, v4
v_fma_f32 v11, v11, v2, v4
v_mfma_f32_16x16x32_bf16 v[104:107], a[228:231], v[184:187], v[104:107]
ds_read_b64_tr_b16 a[248:249], v27 offset:37008
ds_read_b64_tr_b16 a[250:251], v27 offset:41616
v_mfma_f32_16x16x32_bf16 v[108:111], a[228:231], v[188:191], v[108:111]
v_fma_f32 v12, v12, v2, v4
v_fma_f32 v13, v13, v2, v4
s_waitcnt lgkmcnt(4)
v_mfma_f32_16x16x32_bf16 v[22:25], a[146:149], v[204:207], 0
v_fma_f32 v14, v14, v2, v4
v_fma_f32 v15, v15, v2, v4
v_mfma_f32_16x16x32_bf16 v[32:35], a[144:147], v[204:207], 0
buffer_load_dwordx4 v17, s[16:19], s99 offen offset:1024 lds
v_cvt_pk_bf16_f32 v200, v8, v9
v_mfma_f32_16x16x32_bf16 v[40:43], a[232:235], v[192:195], v[40:43]
ds_read_b64_tr_b16 a[252:253], v27 offset:37048
ds_read_b64_tr_b16 a[254:255], v27 offset:41656
v_mfma_f32_16x16x32_bf16 v[44:47], a[232:235], v[196:199], v[44:47]
v_cvt_pk_bf16_f32 v201, v10, v11
v_cvt_pk_bf16_f32 v202, v12, v13
v_cvt_pk_bf16_f32 v203, v14, v15
v_mfma_f32_16x16x32_bf16 v[48:51], a[236:239], v[192:195], v[48:51]
ds_read_b64_tr_b16 a[192:193], v27 offset:37080
ds_read_b64_tr_b16 a[194:195], v27 offset:41688
v_mfma_f32_16x16x32_bf16 v[52:55], a[236:239], v[196:199], v[52:55]
v_fma_f32 v22, v22, v3, v5
v_fma_f32 v23, v23, v3, v5
v_mfma_f32_16x16x32_bf16 v[56:59], a[240:243], v[192:195], v[56:59]
ds_read_b64_tr_b16 a[196:197], v27 offset:37120
ds_read_b64_tr_b16 a[198:199], v27 offset:41728
v_mfma_f32_16x16x32_bf16 v[60:63], a[240:243], v[196:199], v[60:63]
v_fma_f32 v24, v24, v3, v5
s_waitcnt lgkmcnt(4)
v_mfma_f32_16x16x32_bf16 v[64:67], a[244:247], v[192:195], v[64:67]
ds_read_b64_tr_b16 a[200:201], v30 offset:36864
ds_read_b64_tr_b16 a[202:203], v30 offset:41472
v_mfma_f32_16x16x32_bf16 v[68:71], a[244:247], v[196:199], v[68:71]
buffer_load_dwordx4 v18, s[16:19], s99 offen offset:2048 lds
v_fma_f32 v25, v25, v3, v5
v_mfma_f32_16x16x32_bf16 v[72:75], a[248:251], v[192:195], v[72:75]
ds_read_b64_tr_b16 a[204:205], v27 offset:46080
ds_read_b64_tr_b16 a[206:207], v27 offset:50688
v_mfma_f32_16x16x32_bf16 v[76:79], a[248:251], v[196:199], v[76:79]
v_fma_f32 v32, v32, v3, v5
v_fma_f32 v33, v33, v3, v5
v_mfma_f32_16x16x32_bf16 v[8:11], a[146:149], v[208:211], 0
v_fma_f32 v34, v34, v3, v5
v_fma_f32 v35, v35, v3, v5
v_mfma_f32_16x16x32_bf16 v[12:15], a[144:147], v[208:211], 0
v_cvt_pk_bf16_f32 v204, v22, v23
v_cvt_pk_bf16_f32 v205, v24, v25
v_mfma_f32_16x16x32_bf16 v[80:83], a[252:255], v[192:195], v[80:83]
ds_read_b64_tr_b16 a[208:209], v27 offset:46120
ds_read_b64_tr_b16 a[210:211], v27 offset:50728
v_mfma_f32_16x16x32_bf16 v[84:87], a[252:255], v[196:199], v[84:87]
v_cvt_pk_bf16_f32 v206, v32, v33
v_cvt_pk_bf16_f32 v207, v34, v35
s_waitcnt lgkmcnt(4)
v_mfma_f32_16x16x32_bf16 v[88:91], a[192:195], v[192:195], v[88:91]
ds_read_b64_tr_b16 a[212:213], v27 offset:46152
ds_read_b64_tr_b16 a[214:215], v27 offset:50760
v_mfma_f32_16x16x32_bf16 v[92:95], a[192:195], v[196:199], v[92:95]
buffer_load_dwordx4 v19, s[16:19], s99 offen offset:3072 lds
v_fma_f32 v8, v8, v2, v4
v_mfma_f32_16x16x32_bf16 v[96:99], a[196:199], v[192:195], v[96:99]
ds_read_b64_tr_b16 a[216:217], v27 offset:46192
ds_read_b64_tr_b16 a[218:219], v27 offset:50800
v_mfma_f32_16x16x32_bf16 v[100:103], a[196:199], v[196:199], v[100:103]
v_fma_f32 v9, v9, v2, v4
v_fma_f32 v10, v10, v2, v4
v_fma_f32 v11, v11, v2, v4
v_mfma_f32_16x16x32_bf16 v[104:107], a[200:203], v[192:195], v[104:107]
ds_read_b64_tr_b16 a[220:221], v27 offset:46224
ds_read_b64_tr_b16 a[222:223], v27 offset:50832
v_fma_f32 v12, v12, v2, v4
v_mfma_f32_16x16x32_bf16 v[108:111], a[200:203], v[196:199], v[108:111]
s_add_u32 m0, s3, 40960
s_waitcnt lgkmcnt(4)
v_mfma_f32_16x16x32_bf16 v[22:25], a[146:149], v[212:215], 0
v_fma_f32 v13, v13, v2, v4
v_fma_f32 v14, v14, v2, v4
v_fma_f32 v15, v15, v2, v4
v_mfma_f32_16x16x32_bf16 v[32:35], a[144:147], v[212:215], 0
v_cvt_pk_bf16_f32 v208, v8, v9
v_cvt_pk_bf16_f32 v209, v10, v11
v_mfma_f32_16x16x32_bf16 v[40:43], a[204:207], v[200:203], v[40:43]
ds_read_b64_tr_b16 a[224:225], v27 offset:46264
ds_read_b64_tr_b16 a[226:227], v27 offset:50872
v_cvt_pk_bf16_f32 v210, v12, v13
v_mfma_f32_16x16x32_bf16 v[44:47], a[204:207], v[204:207], v[44:47]
buffer_load_dwordx4 v20, s[16:19], s99 offen lds
v_cvt_pk_bf16_f32 v211, v14, v15
v_mfma_f32_16x16x32_bf16 v[48:51], a[208:211], v[200:203], v[48:51]
ds_read_b64_tr_b16 a[228:229], v27 offset:46296
ds_read_b64_tr_b16 a[230:231], v27 offset:50904
v_mfma_f32_16x16x32_bf16 v[52:55], a[208:211], v[204:207], v[52:55]
v_fma_f32 v22, v22, v3, v5
v_fma_f32 v23, v23, v3, v5
v_mfma_f32_16x16x32_bf16 v[56:59], a[212:215], v[200:203], v[56:59]
ds_read_b64_tr_b16 a[232:233], v27 offset:46336
ds_read_b64_tr_b16 a[234:235], v27 offset:50944
v_fma_f32 v24, v24, v3, v5
v_mfma_f32_16x16x32_bf16 v[60:63], a[212:215], v[204:207], v[60:63]
v_fma_f32 v25, v25, v3, v5
s_waitcnt lgkmcnt(4)
v_mfma_f32_16x16x32_bf16 v[64:67], a[216:219], v[200:203], v[64:67]
ds_read_b64_tr_b16 a[236:237], v30 offset:46080
ds_read_b64_tr_b16 a[238:239], v30 offset:50688
v_mfma_f32_16x16x32_bf16 v[68:71], a[216:219], v[204:207], v[68:71]
v_fma_f32 v32, v32, v3, v5
v_fma_f32 v33, v33, v3, v5
v_fma_f32 v34, v34, v3, v5
v_mfma_f32_16x16x32_bf16 v[72:75], a[220:223], v[200:203], v[72:75]
s_waitcnt vmcnt(15)
s_barrier
v_mfma_f32_16x16x32_bf16 v[76:79], a[220:223], v[204:207], v[76:79]
ds_read_b64_tr_b16 a[240:241], v28 offset:0
ds_read_b64_tr_b16 a[242:243], v28 offset:4608
v_mfma_f32_16x16x32_bf16 v[8:11], a[146:149], v[216:219], 0
s_add_u32 m0, s3, 55296
v_fma_f32 v35, v35, v3, v5
v_cvt_pk_bf16_f32 v212, v22, v23
v_mfma_f32_16x16x32_bf16 v[12:15], a[144:147], v[216:219], 0
v_cvt_pk_bf16_f32 v213, v24, v25
v_cvt_pk_bf16_f32 v214, v32, v33
v_mfma_f32_16x16x32_bf16 v[80:83], a[224:227], v[200:203], v[80:83]
ds_read_b64_tr_b16 a[244:245], v28 offset:40
ds_read_b64_tr_b16 a[246:247], v28 offset:4648
v_mfma_f32_16x16x32_bf16 v[84:87], a[224:227], v[204:207], v[84:87]
s_add_u32 s99, s60, 2304
v_cvt_pk_bf16_f32 v215, v34, v35
s_waitcnt lgkmcnt(4)
v_mfma_f32_16x16x32_bf16 v[88:91], a[228:231], v[200:203], v[88:91]
ds_read_b64_tr_b16 a[248:249], v28 offset:72
ds_read_b64_tr_b16 a[250:251], v28 offset:4680
v_mfma_f32_16x16x32_bf16 v[92:95], a[228:231], v[204:207], v[92:95]
buffer_load_dwordx4 v16, s[16:19], s99 offen offset:0 lds
v_fma_f32 v8, v8, v2, v4
v_mfma_f32_16x16x32_bf16 v[96:99], a[232:235], v[200:203], v[96:99]
ds_read_b64_tr_b16 a[252:253], v28 offset:112
ds_read_b64_tr_b16 a[254:255], v28 offset:4720
v_mfma_f32_16x16x32_bf16 v[100:103], a[232:235], v[204:207], v[100:103]
v_fma_f32 v9, v9, v2, v4
v_fma_f32 v10, v10, v2, v4
v_fma_f32 v11, v11, v2, v4
v_mfma_f32_16x16x32_bf16 v[104:107], a[236:239], v[200:203], v[104:107]
ds_read_b64_tr_b16 a[192:193], v28 offset:144
ds_read_b64_tr_b16 a[194:195], v28 offset:4752
v_mfma_f32_16x16x32_bf16 v[108:111], a[236:239], v[204:207], v[108:111]
v_fma_f32 v12, v12, v2, v4
v_fma_f32 v13, v13, v2, v4
s_waitcnt lgkmcnt(4)
v_mfma_f32_16x16x32_bf16 v[22:25], a[146:149], v[220:223], 0
v_fma_f32 v14, v14, v2, v4
v_fma_f32 v15, v15, v2, v4
v_mfma_f32_16x16x32_bf16 v[32:35], a[144:147], v[220:223], 0
v_cvt_pk_bf16_f32 v216, v8, v9
v_cvt_pk_bf16_f32 v217, v10, v11
v_cvt_pk_bf16_f32 v218, v12, v13
v_mfma_f32_16x16x32_bf16 v[40:43], a[240:243], v[208:211], v[40:43]
ds_read_b64_tr_b16 a[196:197], v28 offset:184
ds_read_b64_tr_b16 a[198:199], v28 offset:4792
v_mfma_f32_16x16x32_bf16 v[44:47], a[240:243], v[212:215], v[44:47]
buffer_load_dwordx4 v17, s[16:19], s99 offen offset:1024 lds
v_cvt_pk_bf16_f32 v219, v14, v15
v_mfma_f32_16x16x32_bf16 v[48:51], a[244:247], v[208:211], v[48:51]
ds_read_b64_tr_b16 a[200:201], v28 offset:216
ds_read_b64_tr_b16 a[202:203], v28 offset:4824
v_mfma_f32_16x16x32_bf16 v[52:55], a[244:247], v[212:215], v[52:55]
v_fma_f32 v22, v22, v3, v5
v_fma_f32 v23, v23, v3, v5
v_mfma_f32_16x16x32_bf16 v[56:59], a[248:251], v[208:211], v[56:59]
ds_read_b64_tr_b16 a[204:205], v28 offset:256
ds_read_b64_tr_b16 a[206:207], v28 offset:4864
v_mfma_f32_16x16x32_bf16 v[60:63], a[248:251], v[212:215], v[60:63]
v_fma_f32 v24, v24, v3, v5
s_waitcnt lgkmcnt(4)
v_mfma_f32_16x16x32_bf16 v[64:67], a[252:255], v[208:211], v[64:67]
ds_read_b64_tr_b16 a[208:209], v31 offset:0
ds_read_b64_tr_b16 a[210:211], v31 offset:4608
v_mfma_f32_16x16x32_bf16 v[68:71], a[252:255], v[212:215], v[68:71]
buffer_load_dwordx4 v18, s[16:19], s99 offen offset:2048 lds
v_fma_f32 v25, v25, v3, v5
v_mfma_f32_16x16x32_bf16 v[72:75], a[192:195], v[208:211], v[72:75]
ds_read_b64_tr_b16 a[212:213], v28 offset:9216
ds_read_b64_tr_b16 a[214:215], v28 offset:13824
v_mfma_f32_16x16x32_bf16 v[76:79], a[192:195], v[212:215], v[76:79]
v_fma_f32 v32, v32, v3, v5
v_fma_f32 v33, v33, v3, v5
v_mfma_f32_16x16x32_bf16 v[8:11], a[146:149], v[224:227], 0
v_fma_f32 v34, v34, v3, v5
v_fma_f32 v35, v35, v3, v5
v_mfma_f32_16x16x32_bf16 v[12:15], a[144:147], v[224:227], 0
v_cvt_pk_bf16_f32 v220, v22, v23
v_cvt_pk_bf16_f32 v221, v24, v25
v_mfma_f32_16x16x32_bf16 v[80:83], a[196:199], v[208:211], v[80:83]
ds_read_b64_tr_b16 a[216:217], v28 offset:9256
ds_read_b64_tr_b16 a[218:219], v28 offset:13864
v_mfma_f32_16x16x32_bf16 v[84:87], a[196:199], v[212:215], v[84:87]
v_cvt_pk_bf16_f32 v222, v32, v33
v_cvt_pk_bf16_f32 v223, v34, v35
s_waitcnt lgkmcnt(4)
v_mfma_f32_16x16x32_bf16 v[88:91], a[200:203], v[208:211], v[88:91]
ds_read_b64_tr_b16 a[220:221], v28 offset:9288
ds_read_b64_tr_b16 a[222:223], v28 offset:13896
v_mfma_f32_16x16x32_bf16 v[92:95], a[200:203], v[212:215], v[92:95]
buffer_load_dwordx4 v19, s[16:19], s99 offen offset:3072 lds
v_fma_f32 v8, v8, v2, v4
v_mfma_f32_16x16x32_bf16 v[96:99], a[204:207], v[208:211], v[96:99]
ds_read_b64_tr_b16 a[224:225], v28 offset:9328
ds_read_b64_tr_b16 a[226:227], v28 offset:13936
v_mfma_f32_16x16x32_bf16 v[100:103], a[204:207], v[212:215], v[100:103]
v_fma_f32 v9, v9, v2, v4
v_fma_f32 v10, v10, v2, v4
v_fma_f32 v11, v11, v2, v4
v_mfma_f32_16x16x32_bf16 v[104:107], a[208:211], v[208:211], v[104:107]
ds_read_b64_tr_b16 a[228:229], v28 offset:9360
ds_read_b64_tr_b16 a[230:231], v28 offset:13968
v_fma_f32 v12, v12, v2, v4
v_mfma_f32_16x16x32_bf16 v[108:111], a[208:211], v[212:215], v[108:111]
v_fma_f32 v13, v13, v2, v4
s_waitcnt lgkmcnt(4)
v_mfma_f32_16x16x32_bf16 v[22:25], a[146:149], v[228:231], 0
s_add_u32 m0, s3, 59392
v_fma_f32 v14, v14, v2, v4
v_fma_f32 v15, v15, v2, v4
v_mfma_f32_16x16x32_bf16 v[32:35], a[144:147], v[228:231], 0
v_cvt_pk_bf16_f32 v224, v8, v9
v_cvt_pk_bf16_f32 v225, v10, v11
v_mfma_f32_16x16x32_bf16 v[40:43], a[212:215], v[216:219], v[40:43]
ds_read_b64_tr_b16 a[232:233], v28 offset:9400
ds_read_b64_tr_b16 a[234:235], v28 offset:14008
v_cvt_pk_bf16_f32 v226, v12, v13
v_mfma_f32_16x16x32_bf16 v[44:47], a[212:215], v[220:223], v[44:47]
buffer_load_dwordx4 v20, s[16:19], s99 offen lds
v_cvt_pk_bf16_f32 v227, v14, v15
v_mfma_f32_16x16x32_bf16 v[48:51], a[216:219], v[216:219], v[48:51]
ds_read_b64_tr_b16 a[236:237], v28 offset:9432
ds_read_b64_tr_b16 a[238:239], v28 offset:14040
v_mfma_f32_16x16x32_bf16 v[52:55], a[216:219], v[220:223], v[52:55]
v_fma_f32 v22, v22, v3, v5
v_fma_f32 v23, v23, v3, v5
v_mfma_f32_16x16x32_bf16 v[56:59], a[220:223], v[216:219], v[56:59]
ds_read_b64_tr_b16 a[240:241], v28 offset:9472
ds_read_b64_tr_b16 a[242:243], v28 offset:14080
v_mfma_f32_16x16x32_bf16 v[60:63], a[220:223], v[220:223], v[60:63]
v_fma_f32 v24, v24, v3, v5
s_waitcnt lgkmcnt(4)
v_mfma_f32_16x16x32_bf16 v[64:67], a[224:227], v[216:219], v[64:67]
ds_read_b64_tr_b16 a[244:245], v31 offset:9216
ds_read_b64_tr_b16 a[246:247], v31 offset:13824
v_mfma_f32_16x16x32_bf16 v[68:71], a[224:227], v[220:223], v[68:71]
v_fma_f32 v25, v25, v3, v5
v_fma_f32 v32, v32, v3, v5
v_fma_f32 v33, v33, v3, v5
v_mfma_f32_16x16x32_bf16 v[72:75], a[228:231], v[216:219], v[72:75]
ds_read_b64_tr_b16 a[248:249], v28 offset:18432
ds_read_b64_tr_b16 a[250:251], v28 offset:23040
v_mfma_f32_16x16x32_bf16 v[76:79], a[228:231], v[220:223], v[76:79]
s_add_u32 m0, s3, 73728
v_fma_f32 v34, v34, v3, v5
v_mfma_f32_16x16x32_bf16 v[8:11], a[146:149], v[232:235], 0
v_fma_f32 v35, v35, v3, v5
v_cvt_pk_bf16_f32 v228, v22, v23
v_mfma_f32_16x16x32_bf16 v[12:15], a[144:147], v[232:235], 0
s_add_u32 s99, s61, 2304
v_cvt_pk_bf16_f32 v229, v24, v25
v_mfma_f32_16x16x32_bf16 v[80:83], a[232:235], v[216:219], v[80:83]
ds_read_b64_tr_b16 a[252:253], v28 offset:18472
ds_read_b64_tr_b16 a[254:255], v28 offset:23080
v_mfma_f32_16x16x32_bf16 v[84:87], a[232:235], v[220:223], v[84:87]
v_cvt_pk_bf16_f32 v230, v32, v33
v_cvt_pk_bf16_f32 v231, v34, v35
s_waitcnt lgkmcnt(4)
v_mfma_f32_16x16x32_bf16 v[88:91], a[236:239], v[216:219], v[88:91]
ds_read_b64_tr_b16 a[192:193], v28 offset:18504
ds_read_b64_tr_b16 a[194:195], v28 offset:23112
v_mfma_f32_16x16x32_bf16 v[92:95], a[236:239], v[220:223], v[92:95]
buffer_load_dwordx4 v16, s[16:19], s99 offen offset:0 lds
v_fma_f32 v8, v8, v2, v4
v_mfma_f32_16x16x32_bf16 v[96:99], a[240:243], v[216:219], v[96:99]
ds_read_b64_tr_b16 a[196:197], v28 offset:18544
ds_read_b64_tr_b16 a[198:199], v28 offset:23152
v_mfma_f32_16x16x32_bf16 v[100:103], a[240:243], v[220:223], v[100:103]
v_fma_f32 v9, v9, v2, v4
v_fma_f32 v10, v10, v2, v4
v_fma_f32 v11, v11, v2, v4
v_mfma_f32_16x16x32_bf16 v[104:107], a[244:247], v[216:219], v[104:107]
ds_read_b64_tr_b16 a[200:201], v28 offset:18576
ds_read_b64_tr_b16 a[202:203], v28 offset:23184
v_mfma_f32_16x16x32_bf16 v[108:111], a[244:247], v[220:223], v[108:111]
v_fma_f32 v12, v12, v2, v4
v_fma_f32 v13, v13, v2, v4
s_waitcnt lgkmcnt(4)
v_mfma_f32_16x16x32_bf16 v[22:25], a[146:149], v[236:239], 0
v_fma_f32 v14, v14, v2, v4
v_fma_f32 v15, v15, v2, v4
v_mfma_f32_16x16x32_bf16 v[32:35], a[144:147], v[236:239], 0
buffer_load_dwordx4 v17, s[16:19], s99 offen offset:1024 lds
v_cvt_pk_bf16_f32 v232, v8, v9
v_mfma_f32_16x16x32_bf16 v[40:43], a[248:251], v[224:227], v[40:43]
ds_read_b64_tr_b16 a[204:205], v28 offset:18616
ds_read_b64_tr_b16 a[206:207], v28 offset:23224
v_mfma_f32_16x16x32_bf16 v[44:47], a[248:251], v[228:231], v[44:47]
v_cvt_pk_bf16_f32 v233, v10, v11
v_cvt_pk_bf16_f32 v234, v12, v13
v_cvt_pk_bf16_f32 v235, v14, v15
v_mfma_f32_16x16x32_bf16 v[48:51], a[252:255], v[224:227], v[48:51]
ds_read_b64_tr_b16 a[208:209], v28 offset:18648
ds_read_b64_tr_b16 a[210:211], v28 offset:23256
v_mfma_f32_16x16x32_bf16 v[52:55], a[252:255], v[228:231], v[52:55]
v_fma_f32 v22, v22, v3, v5
v_fma_f32 v23, v23, v3, v5
v_mfma_f32_16x16x32_bf16 v[56:59], a[192:195], v[224:227], v[56:59]
ds_read_b64_tr_b16 a[212:213], v28 offset:18688
ds_read_b64_tr_b16 a[214:215], v28 offset:23296
v_mfma_f32_16x16x32_bf16 v[60:63], a[192:195], v[228:231], v[60:63]
v_fma_f32 v24, v24, v3, v5
s_waitcnt lgkmcnt(4)
v_mfma_f32_16x16x32_bf16 v[64:67], a[196:199], v[224:227], v[64:67]
ds_read_b64_tr_b16 a[216:217], v31 offset:18432
ds_read_b64_tr_b16 a[218:219], v31 offset:23040
v_mfma_f32_16x16x32_bf16 v[68:71], a[196:199], v[228:231], v[68:71]
buffer_load_dwordx4 v18, s[16:19], s99 offen offset:2048 lds
v_fma_f32 v25, v25, v3, v5
v_mfma_f32_16x16x32_bf16 v[72:75], a[200:203], v[224:227], v[72:75]
ds_read_b64_tr_b16 a[220:221], v28 offset:27648
ds_read_b64_tr_b16 a[222:223], v28 offset:32256
v_mfma_f32_16x16x32_bf16 v[76:79], a[200:203], v[228:231], v[76:79]
v_fma_f32 v32, v32, v3, v5
v_fma_f32 v33, v33, v3, v5
v_mfma_f32_16x16x32_bf16 v[8:11], a[146:149], v[240:243], 0
v_fma_f32 v34, v34, v3, v5
v_fma_f32 v35, v35, v3, v5
v_mfma_f32_16x16x32_bf16 v[12:15], a[144:147], v[240:243], 0
v_cvt_pk_bf16_f32 v236, v22, v23
v_cvt_pk_bf16_f32 v237, v24, v25
v_mfma_f32_16x16x32_bf16 v[80:83], a[204:207], v[224:227], v[80:83]
ds_read_b64_tr_b16 a[224:225], v28 offset:27688
ds_read_b64_tr_b16 a[226:227], v28 offset:32296
v_mfma_f32_16x16x32_bf16 v[84:87], a[204:207], v[228:231], v[84:87]
v_cvt_pk_bf16_f32 v238, v32, v33
v_cvt_pk_bf16_f32 v239, v34, v35
s_waitcnt lgkmcnt(4)
v_mfma_f32_16x16x32_bf16 v[88:91], a[208:211], v[224:227], v[88:91]
ds_read_b64_tr_b16 a[228:229], v28 offset:27720
ds_read_b64_tr_b16 a[230:231], v28 offset:32328
v_mfma_f32_16x16x32_bf16 v[92:95], a[208:211], v[228:231], v[92:95]
buffer_load_dwordx4 v19, s[16:19], s99 offen offset:3072 lds
v_fma_f32 v8, v8, v2, v4
v_mfma_f32_16x16x32_bf16 v[96:99], a[212:215], v[224:227], v[96:99]
ds_read_b64_tr_b16 a[232:233], v28 offset:27760
ds_read_b64_tr_b16 a[234:235], v28 offset:32368
v_mfma_f32_16x16x32_bf16 v[100:103], a[212:215], v[228:231], v[100:103]
v_fma_f32 v9, v9, v2, v4
v_fma_f32 v10, v10, v2, v4
v_fma_f32 v11, v11, v2, v4
v_mfma_f32_16x16x32_bf16 v[104:107], a[216:219], v[224:227], v[104:107]
ds_read_b64_tr_b16 a[236:237], v28 offset:27792
ds_read_b64_tr_b16 a[238:239], v28 offset:32400
v_fma_f32 v12, v12, v2, v4
v_mfma_f32_16x16x32_bf16 v[108:111], a[216:219], v[228:231], v[108:111]
s_add_u32 m0, s3, 77824
s_waitcnt lgkmcnt(4)
v_mfma_f32_16x16x32_bf16 v[22:25], a[146:149], v[244:247], 0
v_fma_f32 v13, v13, v2, v4
v_fma_f32 v14, v14, v2, v4
v_fma_f32 v15, v15, v2, v4
v_mfma_f32_16x16x32_bf16 v[32:35], a[144:147], v[244:247], 0
v_cvt_pk_bf16_f32 v240, v8, v9
v_cvt_pk_bf16_f32 v241, v10, v11
v_mfma_f32_16x16x32_bf16 v[40:43], a[220:223], v[232:235], v[40:43]
ds_read_b64_tr_b16 a[240:241], v28 offset:27832
ds_read_b64_tr_b16 a[242:243], v28 offset:32440
v_cvt_pk_bf16_f32 v242, v12, v13
v_mfma_f32_16x16x32_bf16 v[44:47], a[220:223], v[236:239], v[44:47]
buffer_load_dwordx4 v20, s[16:19], s99 offen lds
v_cvt_pk_bf16_f32 v243, v14, v15
v_mfma_f32_16x16x32_bf16 v[48:51], a[224:227], v[232:235], v[48:51]
ds_read_b64_tr_b16 a[244:245], v28 offset:27864
ds_read_b64_tr_b16 a[246:247], v28 offset:32472
v_mfma_f32_16x16x32_bf16 v[52:55], a[224:227], v[236:239], v[52:55]
v_fma_f32 v22, v22, v3, v5
v_fma_f32 v23, v23, v3, v5
v_mfma_f32_16x16x32_bf16 v[56:59], a[228:231], v[232:235], v[56:59]
ds_read_b64_tr_b16 a[248:249], v28 offset:27904
ds_read_b64_tr_b16 a[250:251], v28 offset:32512
v_fma_f32 v24, v24, v3, v5
v_mfma_f32_16x16x32_bf16 v[60:63], a[228:231], v[236:239], v[60:63]
v_fma_f32 v25, v25, v3, v5
s_waitcnt lgkmcnt(4)
v_mfma_f32_16x16x32_bf16 v[64:67], a[232:235], v[232:235], v[64:67]
ds_read_b64_tr_b16 a[252:253], v31 offset:27648
ds_read_b64_tr_b16 a[254:255], v31 offset:32256
v_mfma_f32_16x16x32_bf16 v[68:71], a[232:235], v[236:239], v[68:71]
v_fma_f32 v32, v32, v3, v5
v_fma_f32 v33, v33, v3, v5
v_fma_f32 v34, v34, v3, v5
v_mfma_f32_16x16x32_bf16 v[72:75], a[236:239], v[232:235], v[72:75]
s_waitcnt vmcnt(15)
s_barrier
v_mfma_f32_16x16x32_bf16 v[76:79], a[236:239], v[236:239], v[76:79]
ds_read_b64_tr_b16 a[192:193], v26 offset:0
ds_read_b64_tr_b16 a[194:195], v26 offset:4608
v_mfma_f32_16x16x32_bf16 v[8:11], a[146:149], v[248:251], 0
s_add_u32 m0, s3, 92160
v_fma_f32 v35, v35, v3, v5
v_cvt_pk_bf16_f32 v244, v22, v23
v_mfma_f32_16x16x32_bf16 v[12:15], a[144:147], v[248:251], 0
s_add_u32 s99, s62, 2304
v_cvt_pk_bf16_f32 v245, v24, v25
v_mfma_f32_16x16x32_bf16 v[80:83], a[240:243], v[232:235], v[80:83]
ds_read_b64_tr_b16 a[196:197], v26 offset:40
ds_read_b64_tr_b16 a[198:199], v26 offset:4648
v_mfma_f32_16x16x32_bf16 v[84:87], a[240:243], v[236:239], v[84:87]
v_cvt_pk_bf16_f32 v246, v32, v33
v_cvt_pk_bf16_f32 v247, v34, v35
s_waitcnt lgkmcnt(4)
v_mfma_f32_16x16x32_bf16 v[88:91], a[244:247], v[232:235], v[88:91]
ds_read_b64_tr_b16 a[200:201], v26 offset:72
ds_read_b64_tr_b16 a[202:203], v26 offset:4680
v_mfma_f32_16x16x32_bf16 v[92:95], a[244:247], v[236:239], v[92:95]
buffer_load_dwordx4 v16, s[16:19], s99 offen offset:0 lds
v_fma_f32 v8, v8, v2, v4
v_mfma_f32_16x16x32_bf16 v[96:99], a[248:251], v[232:235], v[96:99]
ds_read_b64_tr_b16 a[204:205], v26 offset:112
ds_read_b64_tr_b16 a[206:207], v26 offset:4720
v_mfma_f32_16x16x32_bf16 v[100:103], a[248:251], v[236:239], v[100:103]
v_fma_f32 v9, v9, v2, v4
v_fma_f32 v10, v10, v2, v4
v_fma_f32 v11, v11, v2, v4
v_mfma_f32_16x16x32_bf16 v[104:107], a[252:255], v[232:235], v[104:107]
ds_read_b64_tr_b16 a[208:209], v26 offset:144
ds_read_b64_tr_b16 a[210:211], v26 offset:4752
v_mfma_f32_16x16x32_bf16 v[108:111], a[252:255], v[236:239], v[108:111]
v_fma_f32 v12, v12, v2, v4
v_fma_f32 v13, v13, v2, v4
s_waitcnt lgkmcnt(4)
v_mfma_f32_16x16x32_bf16 v[22:25], a[146:149], v[252:255], 0
buffer_load_dwordx4 v17, s[16:19], s99 offen offset:1024 lds
v_mfma_f32_16x16x32_bf16 v[32:35], a[144:147], v[252:255], 0
v_fma_f32 v14, v14, v2, v4
v_fma_f32 v15, v15, v2, v4
v_cvt_pk_bf16_f32 v248, v8, v9
v_mfma_f32_16x16x32_bf16 v[40:43], a[192:195], v[240:243], v[40:43]
ds_read_b64_tr_b16 a[212:213], v26 offset:184
ds_read_b64_tr_b16 a[214:215], v26 offset:4792
v_mfma_f32_16x16x32_bf16 v[44:47], a[192:195], v[244:247], v[44:47]
v_cvt_pk_bf16_f32 v249, v10, v11
v_cvt_pk_bf16_f32 v250, v12, v13
v_cvt_pk_bf16_f32 v251, v14, v15
v_mfma_f32_16x16x32_bf16 v[48:51], a[196:199], v[240:243], v[48:51]
ds_read_b64_tr_b16 a[216:217], v26 offset:216
ds_read_b64_tr_b16 a[218:219], v26 offset:4824
v_mfma_f32_16x16x32_bf16 v[52:55], a[196:199], v[244:247], v[52:55]
v_fma_f32 v22, v22, v3, v5
v_fma_f32 v23, v23, v3, v5
v_fma_f32 v24, v24, v3, v5
v_mfma_f32_16x16x32_bf16 v[56:59], a[200:203], v[240:243], v[56:59]
ds_read_b64_tr_b16 a[220:221], v26 offset:256
ds_read_b64_tr_b16 a[222:223], v26 offset:4864
v_mfma_f32_16x16x32_bf16 v[60:63], a[200:203], v[244:247], v[60:63]
v_fma_f32 v25, v25, v3, v5
v_fma_f32 v32, v32, v3, v5
s_waitcnt lgkmcnt(4)
v_mfma_f32_16x16x32_bf16 v[64:67], a[204:207], v[240:243], v[64:67]
ds_read_b64_tr_b16 a[224:225], v29 offset:0
ds_read_b64_tr_b16 a[226:227], v29 offset:4608
v_mfma_f32_16x16x32_bf16 v[68:71], a[204:207], v[244:247], v[68:71]
buffer_load_dwordx4 v18, s[16:19], s99 offen offset:2048 lds
v_fma_f32 v33, v33, v3, v5
v_mfma_f32_16x16x32_bf16 v[72:75], a[208:211], v[240:243], v[72:75]
ds_read_b64_tr_b16 a[228:229], v26 offset:9216
ds_read_b64_tr_b16 a[230:231], v26 offset:13824
v_mfma_f32_16x16x32_bf16 v[76:79], a[208:211], v[244:247], v[76:79]
v_fma_f32 v34, v34, v3, v5
v_fma_f32 v35, v35, v3, v5
v_cvt_pk_bf16_f32 v252, v22, v23
v_mfma_f32_16x16x32_bf16 v[80:83], a[212:215], v[240:243], v[80:83]
ds_read_b64_tr_b16 a[232:233], v26 offset:9256
ds_read_b64_tr_b16 a[234:235], v26 offset:13864
v_mfma_f32_16x16x32_bf16 v[84:87], a[212:215], v[244:247], v[84:87]
v_cvt_pk_bf16_f32 v253, v24, v25
v_cvt_pk_bf16_f32 v254, v32, v33
s_waitcnt lgkmcnt(4)
v_mfma_f32_16x16x32_bf16 v[88:91], a[216:219], v[240:243], v[88:91]
ds_read_b64_tr_b16 a[236:237], v26 offset:9288
ds_read_b64_tr_b16 a[238:239], v26 offset:13896
v_mfma_f32_16x16x32_bf16 v[92:95], a[216:219], v[244:247], v[92:95]
buffer_load_dwordx4 v19, s[16:19], s99 offen offset:3072 lds
v_cvt_pk_bf16_f32 v255, v34, v35
v_mfma_f32_16x16x32_bf16 v[96:99], a[220:223], v[240:243], v[96:99]
ds_read_b64_tr_b16 a[240:241], v26 offset:9328
ds_read_b64_tr_b16 a[242:243], v26 offset:13936
v_mfma_f32_16x16x32_bf16 v[100:103], a[220:223], v[244:247], v[100:103]
s_add_u32 m0, s3, 96256
v_mfma_f32_16x16x32_bf16 v[104:107], a[224:227], v[240:243], v[104:107]
ds_read_b64_tr_b16 a[244:245], v26 offset:9360
ds_read_b64_tr_b16 a[246:247], v26 offset:13968
v_mfma_f32_16x16x32_bf16 v[108:111], a[224:227], v[244:247], v[108:111]
s_waitcnt lgkmcnt(4)
v_mfma_f32_16x16x32_bf16 v[40:43], a[228:231], v[248:251], v[40:43]
ds_read_b64_tr_b16 a[248:249], v26 offset:9400
ds_read_b64_tr_b16 a[250:251], v26 offset:14008
v_mfma_f32_16x16x32_bf16 v[44:47], a[228:231], v[252:255], v[44:47]
buffer_load_dwordx4 v20, s[16:19], s99 offen lds
v_mfma_f32_16x16x32_bf16 v[48:51], a[232:235], v[248:251], v[48:51]
ds_read_b64_tr_b16 a[252:253], v26 offset:9432
ds_read_b64_tr_b16 a[254:255], v26 offset:14040
v_mfma_f32_16x16x32_bf16 v[52:55], a[232:235], v[252:255], v[52:55]
v_mfma_f32_16x16x32_bf16 v[56:59], a[236:239], v[248:251], v[56:59]
ds_read_b64_tr_b16 a[192:193], v26 offset:9472
ds_read_b64_tr_b16 a[194:195], v26 offset:14080
v_mfma_f32_16x16x32_bf16 v[60:63], a[236:239], v[252:255], v[60:63]
s_waitcnt lgkmcnt(4)
v_mfma_f32_16x16x32_bf16 v[64:67], a[240:243], v[248:251], v[64:67]
ds_read_b64_tr_b16 a[196:197], v29 offset:9216
ds_read_b64_tr_b16 a[198:199], v29 offset:13824
v_mfma_f32_16x16x32_bf16 v[68:71], a[240:243], v[252:255], v[68:71]
s_add_u32 m0, s3, 110592
v_mfma_f32_16x16x32_bf16 v[72:75], a[244:247], v[248:251], v[72:75]
ds_read_b64_tr_b16 a[200:201], v26 offset:18432
ds_read_b64_tr_b16 a[202:203], v26 offset:23040
v_mfma_f32_16x16x32_bf16 v[76:79], a[244:247], v[252:255], v[76:79]
s_add_u32 s99, s63, 2304
v_mfma_f32_16x16x32_bf16 v[80:83], a[248:251], v[248:251], v[80:83]
ds_read_b64_tr_b16 a[204:205], v26 offset:18472
ds_read_b64_tr_b16 a[206:207], v26 offset:23080
v_cvt_pk_bf16_f32 v8, v40, v41
v_mfma_f32_16x16x32_bf16 v[84:87], a[248:251], v[252:255], v[84:87]
v_cvt_pk_bf16_f32 v9, v42, v43
v_cvt_pk_bf16_f32 v10, v44, v45
v_cvt_pk_bf16_f32 v11, v46, v47
s_waitcnt lgkmcnt(4)
v_mfma_f32_16x16x32_bf16 v[88:91], a[252:255], v[248:251], v[88:91]
ds_read_b64_tr_b16 a[208:209], v26 offset:18504
ds_read_b64_tr_b16 a[210:211], v26 offset:23112
v_accvgpr_write_b32 a0, v8
v_accvgpr_write_b32 a1, v9
v_cvt_pk_bf16_f32 v12, v48, v49
v_mfma_f32_16x16x32_bf16 v[92:95], a[252:255], v[252:255], v[92:95]
v_accvgpr_write_b32 a2, v10
v_accvgpr_write_b32 a3, v11
v_cvt_pk_bf16_f32 v13, v50, v51
v_cvt_pk_bf16_f32 v14, v52, v53
v_cvt_pk_bf16_f32 v15, v54, v55
v_mfma_f32_16x16x32_bf16 v[96:99], a[192:195], v[248:251], v[96:99]
ds_read_b64_tr_b16 a[212:213], v26 offset:18544
ds_read_b64_tr_b16 a[214:215], v26 offset:23152
v_accvgpr_write_b32 a4, v12
v_accvgpr_write_b32 a5, v13
v_cvt_pk_bf16_f32 v8, v56, v57
v_mfma_f32_16x16x32_bf16 v[100:103], a[192:195], v[252:255], v[100:103]
v_accvgpr_write_b32 a6, v14
v_accvgpr_write_b32 a7, v15
v_cvt_pk_bf16_f32 v9, v58, v59
v_cvt_pk_bf16_f32 v10, v60, v61
v_cvt_pk_bf16_f32 v11, v62, v63
v_mfma_f32_16x16x32_bf16 v[104:107], a[196:199], v[248:251], v[104:107]
ds_read_b64_tr_b16 a[216:217], v26 offset:18576
ds_read_b64_tr_b16 a[218:219], v26 offset:23184
v_accvgpr_write_b32 a8, v8
v_accvgpr_write_b32 a9, v9
v_cvt_pk_bf16_f32 v12, v64, v65
v_mfma_f32_16x16x32_bf16 v[108:111], a[196:199], v[252:255], v[108:111]
v_accvgpr_write_b32 a10, v10
v_accvgpr_write_b32 a11, v11
v_cvt_pk_bf16_f32 v13, v66, v67
v_cvt_pk_bf16_f32 v14, v68, v69
v_cvt_pk_bf16_f32 v15, v70, v71
s_waitcnt lgkmcnt(4)
v_mfma_f32_16x16x32_bf16 v[40:43], v[112:115], a[200:203], 0
ds_read_b64_tr_b16 a[220:221], v26 offset:18616
ds_read_b64_tr_b16 a[222:223], v26 offset:23224
v_accvgpr_write_b32 a12, v12
v_accvgpr_write_b32 a13, v13
v_cvt_pk_bf16_f32 v8, v72, v73
v_mfma_f32_16x16x32_bf16 v[44:47], v[116:119], a[200:203], 0
v_accvgpr_write_b32 a14, v14
v_accvgpr_write_b32 a15, v15
v_cvt_pk_bf16_f32 v9, v74, v75
v_cvt_pk_bf16_f32 v10, v76, v77
v_cvt_pk_bf16_f32 v11, v78, v79
v_mfma_f32_16x16x32_bf16 v[48:51], v[112:115], a[204:207], 0
ds_read_b64_tr_b16 a[224:225], v26 offset:18648
ds_read_b64_tr_b16 a[226:227], v26 offset:23256
v_accvgpr_write_b32 a16, v8
v_accvgpr_write_b32 a17, v9
v_cvt_pk_bf16_f32 v12, v80, v81
v_mfma_f32_16x16x32_bf16 v[52:55], v[116:119], a[204:207], 0
v_accvgpr_write_b32 a18, v10
v_accvgpr_write_b32 a19, v11
v_cvt_pk_bf16_f32 v13, v82, v83
v_cvt_pk_bf16_f32 v14, v84, v85
v_cvt_pk_bf16_f32 v15, v86, v87
v_mfma_f32_16x16x32_bf16 v[56:59], v[112:115], a[208:211], 0
ds_read_b64_tr_b16 a[228:229], v26 offset:18688
ds_read_b64_tr_b16 a[230:231], v26 offset:23296
v_accvgpr_write_b32 a20, v12
v_accvgpr_write_b32 a21, v13
v_cvt_pk_bf16_f32 v8, v88, v89
v_mfma_f32_16x16x32_bf16 v[60:63], v[116:119], a[208:211], 0
v_accvgpr_write_b32 a22, v14
v_accvgpr_write_b32 a23, v15
v_cvt_pk_bf16_f32 v9, v90, v91
v_cvt_pk_bf16_f32 v10, v92, v93
v_cvt_pk_bf16_f32 v11, v94, v95
s_waitcnt lgkmcnt(4)
v_mfma_f32_16x16x32_bf16 v[64:67], v[112:115], a[212:215], 0
ds_read_b64_tr_b16 a[232:233], v29 offset:18432
ds_read_b64_tr_b16 a[234:235], v29 offset:23040
v_accvgpr_write_b32 a24, v8
v_accvgpr_write_b32 a25, v9
v_cvt_pk_bf16_f32 v12, v96, v97
v_mfma_f32_16x16x32_bf16 v[68:71], v[116:119], a[212:215], 0
v_accvgpr_write_b32 a26, v10
v_accvgpr_write_b32 a27, v11
v_cvt_pk_bf16_f32 v13, v98, v99
v_cvt_pk_bf16_f32 v14, v100, v101
v_cvt_pk_bf16_f32 v15, v102, v103
v_mfma_f32_16x16x32_bf16 v[72:75], v[112:115], a[216:219], 0
ds_read_b64_tr_b16 a[236:237], v26 offset:27648
ds_read_b64_tr_b16 a[238:239], v26 offset:32256
v_accvgpr_write_b32 a28, v12
v_accvgpr_write_b32 a29, v13
v_cvt_pk_bf16_f32 v8, v104, v105
v_mfma_f32_16x16x32_bf16 v[76:79], v[116:119], a[216:219], 0
v_accvgpr_write_b32 a30, v14
v_accvgpr_write_b32 a31, v15
v_cvt_pk_bf16_f32 v9, v106, v107
v_cvt_pk_bf16_f32 v10, v108, v109
v_cvt_pk_bf16_f32 v11, v110, v111
v_mfma_f32_16x16x32_bf16 v[80:83], v[112:115], a[220:223], 0
ds_read_b64_tr_b16 a[240:241], v26 offset:27688
ds_read_b64_tr_b16 a[242:243], v26 offset:32296
v_accvgpr_write_b32 a32, v8
v_accvgpr_write_b32 a33, v9
v_mfma_f32_16x16x32_bf16 v[84:87], v[116:119], a[220:223], 0
v_accvgpr_write_b32 a34, v10
v_accvgpr_write_b32 a35, v11
s_waitcnt lgkmcnt(4)
v_mfma_f32_16x16x32_bf16 v[88:91], v[112:115], a[224:227], 0
ds_read_b64_tr_b16 a[244:245], v26 offset:27720
ds_read_b64_tr_b16 a[246:247], v26 offset:32328
v_mfma_f32_16x16x32_bf16 v[92:95], v[116:119], a[224:227], 0
buffer_load_dwordx4 v16, s[16:19], s99 offen offset:0 lds
v_mfma_f32_16x16x32_bf16 v[96:99], v[112:115], a[228:231], 0
ds_read_b64_tr_b16 a[248:249], v26 offset:27760
ds_read_b64_tr_b16 a[250:251], v26 offset:32368
v_mfma_f32_16x16x32_bf16 v[100:103], v[116:119], a[228:231], 0
buffer_load_dwordx4 v17, s[16:19], s99 offen offset:1024 lds
v_mfma_f32_16x16x32_bf16 v[104:107], v[112:115], a[232:235], 0
ds_read_b64_tr_b16 a[252:253], v26 offset:27792
ds_read_b64_tr_b16 a[254:255], v26 offset:32400
v_mfma_f32_16x16x32_bf16 v[108:111], v[116:119], a[232:235], 0
s_waitcnt lgkmcnt(4)
v_mfma_f32_16x16x32_bf16 v[40:43], v[120:123], a[236:239], v[40:43]
ds_read_b64_tr_b16 a[192:193], v26 offset:27832
ds_read_b64_tr_b16 a[194:195], v26 offset:32440
v_mfma_f32_16x16x32_bf16 v[44:47], v[124:127], a[236:239], v[44:47]
buffer_load_dwordx4 v18, s[16:19], s99 offen offset:2048 lds
v_mfma_f32_16x16x32_bf16 v[48:51], v[120:123], a[240:243], v[48:51]
ds_read_b64_tr_b16 a[196:197], v26 offset:27864
ds_read_b64_tr_b16 a[198:199], v26 offset:32472
v_mfma_f32_16x16x32_bf16 v[52:55], v[124:127], a[240:243], v[52:55]
buffer_load_dwordx4 v19, s[16:19], s99 offen offset:3072 lds
v_mfma_f32_16x16x32_bf16 v[56:59], v[120:123], a[244:247], v[56:59]
ds_read_b64_tr_b16 a[200:201], v26 offset:27904
ds_read_b64_tr_b16 a[202:203], v26 offset:32512
v_mfma_f32_16x16x32_bf16 v[60:63], v[124:127], a[244:247], v[60:63]
s_add_u32 m0, s3, 114688
s_waitcnt lgkmcnt(4)
v_mfma_f32_16x16x32_bf16 v[64:67], v[120:123], a[248:251], v[64:67]
ds_read_b64_tr_b16 a[204:205], v29 offset:27648
ds_read_b64_tr_b16 a[206:207], v29 offset:32256
v_mfma_f32_16x16x32_bf16 v[68:71], v[124:127], a[248:251], v[68:71]
buffer_load_dwordx4 v20, s[16:19], s99 offen lds
v_mfma_f32_16x16x32_bf16 v[72:75], v[120:123], a[252:255], v[72:75]
s_waitcnt vmcnt(15)
s_barrier
v_mfma_f32_16x16x32_bf16 v[76:79], v[124:127], a[252:255], v[76:79]
ds_read_b64_tr_b16 a[208:209], v26 offset:36864
ds_read_b64_tr_b16 a[210:211], v26 offset:41472
v_mfma_f32_16x16x32_bf16 v[80:83], v[120:123], a[192:195], v[80:83]
ds_read_b64_tr_b16 a[212:213], v26 offset:36904
ds_read_b64_tr_b16 a[214:215], v26 offset:41512
v_mfma_f32_16x16x32_bf16 v[84:87], v[124:127], a[192:195], v[84:87]
s_add_u32 m0, s3, 129024
s_waitcnt lgkmcnt(4)
v_mfma_f32_16x16x32_bf16 v[88:91], v[120:123], a[196:199], v[88:91]
ds_read_b64_tr_b16 a[216:217], v26 offset:36936
ds_read_b64_tr_b16 a[218:219], v26 offset:41544
v_mfma_f32_16x16x32_bf16 v[92:95], v[124:127], a[196:199], v[92:95]
s_add_u32 s99, s64, 2304
v_lshlrev_b32_e64 v32, 4, v0
v_mfma_f32_16x16x32_bf16 v[96:99], v[120:123], a[200:203], v[96:99]
ds_read_b64_tr_b16 a[220:221], v26 offset:36976
ds_read_b64_tr_b16 a[222:223], v26 offset:41584
v_mfma_f32_16x16x32_bf16 v[100:103], v[124:127], a[200:203], v[100:103]
buffer_load_dwordx4 v16, s[16:19], s99 offen offset:0 lds
v_mfma_f32_16x16x32_bf16 v[104:107], v[120:123], a[204:207], v[104:107]
ds_read_b64_tr_b16 a[224:225], v26 offset:37008
ds_read_b64_tr_b16 a[226:227], v26 offset:41616
v_mfma_f32_16x16x32_bf16 v[108:111], v[124:127], a[204:207], v[108:111]
s_lshl_b32 s96, s33, 2
s_waitcnt lgkmcnt(4)
v_mfma_f32_16x16x32_bf16 v[40:43], v[128:131], a[208:211], v[40:43]
ds_read_b64_tr_b16 a[228:229], v26 offset:37048
ds_read_b64_tr_b16 a[230:231], v26 offset:41656
v_mfma_f32_16x16x32_bf16 v[44:47], v[132:135], a[208:211], v[44:47]
buffer_load_dwordx4 v17, s[16:19], s99 offen offset:1024 lds
v_mfma_f32_16x16x32_bf16 v[48:51], v[128:131], a[212:215], v[48:51]
ds_read_b64_tr_b16 a[232:233], v26 offset:37080
ds_read_b64_tr_b16 a[234:235], v26 offset:41688
v_mfma_f32_16x16x32_bf16 v[52:55], v[132:135], a[212:215], v[52:55]
s_add_u32 s96, s96, s34
s_mul_i32 s100, s96, 18432
v_mfma_f32_16x16x32_bf16 v[56:59], v[128:131], a[216:219], v[56:59]
ds_read_b64_tr_b16 a[236:237], v26 offset:37120
ds_read_b64_tr_b16 a[238:239], v26 offset:41728
v_mfma_f32_16x16x32_bf16 v[60:63], v[132:135], a[216:219], v[60:63]
s_add_u32 s100, s100, 3392512
s_waitcnt lgkmcnt(4)
v_mfma_f32_16x16x32_bf16 v[64:67], v[128:131], a[220:223], v[64:67]
ds_read_b64_tr_b16 a[240:241], v29 offset:36864
ds_read_b64_tr_b16 a[242:243], v29 offset:41472
v_mfma_f32_16x16x32_bf16 v[68:71], v[132:135], a[220:223], v[68:71]
buffer_load_dwordx4 v18, s[16:19], s99 offen offset:2048 lds
v_mfma_f32_16x16x32_bf16 v[72:75], v[128:131], a[224:227], v[72:75]
ds_read_b64_tr_b16 a[244:245], v26 offset:46080
ds_read_b64_tr_b16 a[246:247], v26 offset:50688
v_mfma_f32_16x16x32_bf16 v[76:79], v[132:135], a[224:227], v[76:79]
s_min_u32 s97, s34, 1
s_min_u32 s96, s32, 1
v_mfma_f32_16x16x32_bf16 v[80:83], v[128:131], a[228:231], v[80:83]
ds_read_b64_tr_b16 a[248:249], v26 offset:46120
ds_read_b64_tr_b16 a[250:251], v26 offset:50728
v_mfma_f32_16x16x32_bf16 v[84:87], v[132:135], a[228:231], v[84:87]
s_andn2_b32 s96, s96, s97
s_waitcnt lgkmcnt(4)
v_mfma_f32_16x16x32_bf16 v[88:91], v[128:131], a[232:235], v[88:91]
ds_read_b64_tr_b16 a[252:253], v26 offset:46152
ds_read_b64_tr_b16 a[254:255], v26 offset:50760
v_mfma_f32_16x16x32_bf16 v[92:95], v[132:135], a[232:235], v[92:95]
buffer_load_dwordx4 v19, s[16:19], s99 offen offset:3072 lds
v_mfma_f32_16x16x32_bf16 v[96:99], v[128:131], a[236:239], v[96:99]
ds_read_b64_tr_b16 a[192:193], v26 offset:46192
ds_read_b64_tr_b16 a[194:195], v26 offset:50800
v_mfma_f32_16x16x32_bf16 v[100:103], v[132:135], a[236:239], v[100:103]
s_mul_i32 s97, s97, 18432
s_sub_u32 s8, s100, s97
v_mfma_f32_16x16x32_bf16 v[104:107], v[128:131], a[240:243], v[104:107]
ds_read_b64_tr_b16 a[196:197], v26 offset:46224
ds_read_b64_tr_b16 a[198:199], v26 offset:50832
v_mfma_f32_16x16x32_bf16 v[108:111], v[132:135], a[240:243], v[108:111]
s_mul_i32 s97, s96, 1862656
s_waitcnt lgkmcnt(4)
v_mfma_f32_16x16x32_bf16 v[40:43], v[136:139], a[244:247], v[40:43]
ds_read_b64_tr_b16 a[200:201], v26 offset:46264
ds_read_b64_tr_b16 a[202:203], v26 offset:50872
v_mfma_f32_16x16x32_bf16 v[44:47], v[140:143], a[244:247], v[44:47]
s_add_u32 m0, s3, 133120
s_sub_u32 s8, s8, s97
v_mfma_f32_16x16x32_bf16 v[48:51], v[136:139], a[248:251], v[48:51]
ds_read_b64_tr_b16 a[204:205], v26 offset:46296
ds_read_b64_tr_b16 a[206:207], v26 offset:50904
v_mfma_f32_16x16x32_bf16 v[52:55], v[140:143], a[248:251], v[52:55]
buffer_load_dwordx4 v20, s[16:19], s99 offen lds
v_mfma_f32_16x16x32_bf16 v[56:59], v[136:139], a[252:255], v[56:59]
ds_read_b64_tr_b16 a[208:209], v26 offset:46336
ds_read_b64_tr_b16 a[210:211], v26 offset:50944
v_mfma_f32_16x16x32_bf16 v[60:63], v[140:143], a[252:255], v[60:63]
s_xor_b32 s96, s96, 1
s_waitcnt lgkmcnt(4)
v_mfma_f32_16x16x32_bf16 v[64:67], v[136:139], a[192:195], v[64:67]
ds_read_b64_tr_b16 a[212:213], v29 offset:46080
ds_read_b64_tr_b16 a[214:215], v29 offset:50688
v_mfma_f32_16x16x32_bf16 v[68:71], v[140:143], a[192:195], v[68:71]
s_lshl_b32 s9, s96, 30
s_lshl_b32 s96, s33, 7
v_mfma_f32_16x16x32_bf16 v[72:75], v[136:139], a[196:199], v[72:75]
ds_read_b64_tr_b16 a[216:217], v27 offset:0
ds_read_b64_tr_b16 a[218:219], v27 offset:4608
v_mfma_f32_16x16x32_bf16 v[76:79], v[140:143], a[196:199], v[76:79]
s_add_u32 m0, s3, 0
s_add_u32 s96, s96, 1777152
v_mfma_f32_16x16x32_bf16 v[80:83], v[136:139], a[200:203], v[80:83]
ds_read_b64_tr_b16 a[220:221], v27 offset:40
ds_read_b64_tr_b16 a[222:223], v27 offset:4648
v_mfma_f32_16x16x32_bf16 v[84:87], v[140:143], a[200:203], v[84:87]
s_add_u32 s99, s65, 2304
s_waitcnt lgkmcnt(4)
v_mfma_f32_16x16x32_bf16 v[88:91], v[136:139], a[204:207], v[88:91]
ds_read_b64_tr_b16 a[224:225], v27 offset:72
ds_read_b64_tr_b16 a[226:227], v27 offset:4680
v_mfma_f32_16x16x32_bf16 v[92:95], v[140:143], a[204:207], v[92:95]
buffer_load_dwordx4 v16, s[16:19], s99 offen offset:0 lds
v_mfma_f32_16x16x32_bf16 v[96:99], v[136:139], a[208:211], v[96:99]
ds_read_b64_tr_b16 a[228:229], v27 offset:112
ds_read_b64_tr_b16 a[230:231], v27 offset:4720
v_mfma_f32_16x16x32_bf16 v[100:103], v[140:143], a[208:211], v[100:103]
s_add_u32 s96, s96, s9
v_mov_b32_e64 v1, s96
v_mfma_f32_16x16x32_bf16 v[104:107], v[136:139], a[212:215], v[104:107]
ds_read_b64_tr_b16 a[232:233], v27 offset:144
ds_read_b64_tr_b16 a[234:235], v27 offset:4752
v_mfma_f32_16x16x32_bf16 v[108:111], v[140:143], a[212:215], v[108:111]
v_mov_b32 v38, 1
s_waitcnt lgkmcnt(4)
v_mfma_f32_16x16x32_bf16 v[40:43], v[144:147], a[216:219], v[40:43]
ds_read_b64_tr_b16 a[236:237], v27 offset:184
ds_read_b64_tr_b16 a[238:239], v27 offset:4792
v_mfma_f32_16x16x32_bf16 v[44:47], v[148:151], a[216:219], v[44:47]
buffer_load_dwordx4 v17, s[16:19], s99 offen offset:1024 lds
v_mfma_f32_16x16x32_bf16 v[48:51], v[144:147], a[220:223], v[48:51]
ds_read_b64_tr_b16 a[240:241], v27 offset:216
ds_read_b64_tr_b16 a[242:243], v27 offset:4824
v_mfma_f32_16x16x32_bf16 v[52:55], v[148:151], a[220:223], v[52:55]
s_add_u32 s101, s100, 0
s_lshl_b32 s53, s32, 2
v_mfma_f32_16x16x32_bf16 v[56:59], v[144:147], a[224:227], v[56:59]
ds_read_b64_tr_b16 a[244:245], v27 offset:256
ds_read_b64_tr_b16 a[246:247], v27 offset:4864
s_xor_b32 s52, s33, 0
v_mfma_f32_16x16x32_bf16 v[60:63], v[148:151], a[224:227], v[60:63]
s_mul_i32 s67, s52, 165888
s_waitcnt lgkmcnt(4)
v_mfma_f32_16x16x32_bf16 v[64:67], v[144:147], a[228:231], v[64:67]
ds_read_b64_tr_b16 a[248:249], v30 offset:0
ds_read_b64_tr_b16 a[250:251], v30 offset:4608
v_mfma_f32_16x16x32_bf16 v[68:71], v[148:151], a[228:231], v[68:71]
buffer_load_dwordx4 v18, s[16:19], s99 offen offset:2048 lds
v_mfma_f32_16x16x32_bf16 v[72:75], v[144:147], a[232:235], v[72:75]
ds_read_b64_tr_b16 a[252:253], v27 offset:9216
ds_read_b64_tr_b16 a[254:255], v27 offset:13824
s_add_u32 s67, s67, s51
v_mfma_f32_16x16x32_bf16 v[76:79], v[148:151], a[232:235], v[76:79]
buffer_store_dwordx4 a[0:3], v32, s[24:27], s101 offen offset:0 sc1
v_mfma_f32_16x16x32_bf16 v[80:83], v[144:147], a[236:239], v[80:83]
ds_read_b64_tr_b16 a[192:193], v27 offset:9256
ds_read_b64_tr_b16 a[194:195], v27 offset:13864
v_mfma_f32_16x16x32_bf16 v[84:87], v[148:151], a[236:239], v[84:87]
s_lshl_b32 s52, s52, 2
s_waitcnt lgkmcnt(4)
v_mfma_f32_16x16x32_bf16 v[88:91], v[144:147], a[240:243], v[88:91]
ds_read_b64_tr_b16 a[196:197], v27 offset:9288
ds_read_b64_tr_b16 a[198:199], v27 offset:13896
s_add_u32 s52, s52, s34
v_mfma_f32_16x16x32_bf16 v[92:95], v[148:151], a[240:243], v[92:95]
buffer_load_dwordx4 v19, s[16:19], s99 offen offset:3072 lds
v_mfma_f32_16x16x32_bf16 v[96:99], v[144:147], a[244:247], v[96:99]
ds_read_b64_tr_b16 a[200:201], v27 offset:9328
ds_read_b64_tr_b16 a[202:203], v27 offset:13936
v_mfma_f32_16x16x32_bf16 v[100:103], v[148:151], a[244:247], v[100:103]
buffer_store_dwordx4 a[4:7], v32, s[24:27], s101 offen offset:1024 sc1
v_mfma_f32_16x16x32_bf16 v[104:107], v[144:147], a[248:251], v[104:107]
ds_read_b64_tr_b16 a[204:205], v27 offset:9360
ds_read_b64_tr_b16 a[206:207], v27 offset:13968
s_mul_i32 s71, s52, 9216
v_mfma_f32_16x16x32_bf16 v[108:111], v[148:151], a[248:251], v[108:111]
s_add_u32 m0, s3, 4096
s_waitcnt lgkmcnt(4)
v_mfma_f32_16x16x32_bf16 v[40:43], v[152:155], a[252:255], v[40:43]
ds_read_b64_tr_b16 a[208:209], v27 offset:9400
ds_read_b64_tr_b16 a[210:211], v27 offset:14008
v_mfma_f32_16x16x32_bf16 v[44:47], v[156:159], a[252:255], v[44:47]
buffer_store_dwordx4 a[8:11], v32, s[24:27], s101 offen offset:2048 sc1
v_mfma_f32_16x16x32_bf16 v[48:51], v[152:155], a[192:195], v[48:51]
ds_read_b64_tr_b16 a[212:213], v27 offset:9432
ds_read_b64_tr_b16 a[214:215], v27 offset:14040
s_add_u32 s71, s71, 3245056
v_mfma_f32_16x16x32_bf16 v[52:55], v[156:159], a[192:195], v[52:55]
buffer_load_dwordx4 v20, s[16:19], s99 offen lds
v_mfma_f32_16x16x32_bf16 v[56:59], v[152:155], a[196:199], v[56:59]
ds_read_b64_tr_b16 a[216:217], v27 offset:9472
ds_read_b64_tr_b16 a[218:219], v27 offset:14080
v_mfma_f32_16x16x32_bf16 v[60:63], v[156:159], a[196:199], v[60:63]
s_xor_b32 s52, s33, 1
s_waitcnt lgkmcnt(4)
v_mfma_f32_16x16x32_bf16 v[64:67], v[152:155], a[200:203], v[64:67]
ds_read_b64_tr_b16 a[220:221], v30 offset:9216
ds_read_b64_tr_b16 a[222:223], v30 offset:13824
s_mul_i32 s68, s52, 165888
v_mfma_f32_16x16x32_bf16 v[68:71], v[156:159], a[200:203], v[68:71]
buffer_store_dwordx4 a[12:15], v32, s[24:27], s101 offen offset:3072 sc1
v_mfma_f32_16x16x32_bf16 v[72:75], v[152:155], a[204:207], v[72:75]
s_waitcnt vmcnt(19)
s_barrier
v_mfma_f32_16x16x32_bf16 v[76:79], v[156:159], a[204:207], v[76:79]
ds_read_b64_tr_b16 a[224:225], v27 offset:18432
ds_read_b64_tr_b16 a[226:227], v27 offset:23040
v_mfma_f32_16x16x32_bf16 v[80:83], v[152:155], a[208:211], v[80:83]
ds_read_b64_tr_b16 a[228:229], v27 offset:18472
ds_read_b64_tr_b16 a[230:231], v27 offset:23080
s_add_u32 s68, s68, s51
v_mfma_f32_16x16x32_bf16 v[84:87], v[156:159], a[208:211], v[84:87]
s_add_u32 m0, s3, 18432
s_waitcnt lgkmcnt(4)
v_mfma_f32_16x16x32_bf16 v[88:91], v[152:155], a[212:215], v[88:91]
ds_read_b64_tr_b16 a[232:233], v27 offset:18504
ds_read_b64_tr_b16 a[234:235], v27 offset:23112
v_mfma_f32_16x16x32_bf16 v[92:95], v[156:159], a[212:215], v[92:95]
s_add_u32 s99, s66, 2304
s_add_u32 s101, s100, 4096
v_mfma_f32_16x16x32_bf16 v[96:99], v[152:155], a[216:219], v[96:99]
ds_read_b64_tr_b16 a[236:237], v27 offset:18544
ds_read_b64_tr_b16 a[238:239], v27 offset:23152
s_lshl_b32 s52, s52, 2
v_mfma_f32_16x16x32_bf16 v[100:103], v[156:159], a[216:219], v[100:103]
buffer_load_dwordx4 v16, s[16:19], s99 offen offset:0 lds
v_mfma_f32_16x16x32_bf16 v[104:107], v[152:155], a[220:223], v[104:107]
ds_read_b64_tr_b16 a[240:241], v27 offset:18576
ds_read_b64_tr_b16 a[242:243], v27 offset:23184
v_mfma_f32_16x16x32_bf16 v[108:111], v[156:159], a[220:223], v[108:111]
s_add_u32 s52, s52, s34
s_waitcnt lgkmcnt(4)
v_mfma_f32_16x16x32_bf16 v[40:43], v[160:163], a[224:227], v[40:43]
ds_read_b64_tr_b16 a[244:245], v27 offset:18616
ds_read_b64_tr_b16 a[246:247], v27 offset:23224
s_mul_i32 s72, s52, 9216
v_mfma_f32_16x16x32_bf16 v[44:47], v[164:167], a[224:227], v[44:47]
buffer_store_dwordx4 a[16:19], v32, s[24:27], s101 offen offset:0 sc1
v_mfma_f32_16x16x32_bf16 v[48:51], v[160:163], a[228:231], v[48:51]
ds_read_b64_tr_b16 a[248:249], v27 offset:18648
ds_read_b64_tr_b16 a[250:251], v27 offset:23256
v_mfma_f32_16x16x32_bf16 v[52:55], v[164:167], a[228:231], v[52:55]
buffer_load_dwordx4 v17, s[16:19], s99 offen offset:1024 lds
v_mfma_f32_16x16x32_bf16 v[56:59], v[160:163], a[232:235], v[56:59]
ds_read_b64_tr_b16 a[252:253], v27 offset:18688
ds_read_b64_tr_b16 a[254:255], v27 offset:23296
s_add_u32 s72, s72, 3245056
v_mfma_f32_16x16x32_bf16 v[60:63], v[164:167], a[232:235], v[60:63]
buffer_store_dwordx4 a[20:23], v32, s[24:27], s101 offen offset:1024 sc1
s_waitcnt lgkmcnt(4)
v_mfma_f32_16x16x32_bf16 v[64:67], v[160:163], a[236:239], v[64:67]
ds_read_b64_tr_b16 a[192:193], v30 offset:18432
ds_read_b64_tr_b16 a[194:195], v30 offset:23040
v_mfma_f32_16x16x32_bf16 v[68:71], v[164:167], a[236:239], v[68:71]
buffer_store_dwordx4 a[24:27], v32, s[24:27], s101 offen offset:2048 sc1
v_mfma_f32_16x16x32_bf16 v[72:75], v[160:163], a[240:243], v[72:75]
ds_read_b64_tr_b16 a[196:197], v27 offset:27648
ds_read_b64_tr_b16 a[198:199], v27 offset:32256
s_xor_b32 s52, s33, 2
v_mfma_f32_16x16x32_bf16 v[76:79], v[164:167], a[240:243], v[76:79]
buffer_load_dwordx4 v18, s[16:19], s99 offen offset:2048 lds
v_mfma_f32_16x16x32_bf16 v[80:83], v[160:163], a[244:247], v[80:83]
ds_read_b64_tr_b16 a[200:201], v27 offset:27688
ds_read_b64_tr_b16 a[202:203], v27 offset:32296
v_mfma_f32_16x16x32_bf16 v[84:87], v[164:167], a[244:247], v[84:87]
s_mul_i32 s69, s52, 165888
s_waitcnt lgkmcnt(4)
v_mfma_f32_16x16x32_bf16 v[88:91], v[160:163], a[248:251], v[88:91]
ds_read_b64_tr_b16 a[204:205], v27 offset:27720
ds_read_b64_tr_b16 a[206:207], v27 offset:32328
s_add_u32 s69, s69, s51
v_mfma_f32_16x16x32_bf16 v[92:95], v[164:167], a[248:251], v[92:95]
buffer_load_dwordx4 v19, s[16:19], s99 offen offset:3072 lds
v_mfma_f32_16x16x32_bf16 v[96:99], v[160:163], a[252:255], v[96:99]
ds_read_b64_tr_b16 a[208:209], v27 offset:27760
ds_read_b64_tr_b16 a[210:211], v27 offset:32368
v_mfma_f32_16x16x32_bf16 v[100:103], v[164:167], a[252:255], v[100:103]
buffer_store_dwordx4 a[28:31], v32, s[24:27], s101 offen offset:3072 sc1
v_mfma_f32_16x16x32_bf16 v[104:107], v[160:163], a[192:195], v[104:107]
ds_read_b64_tr_b16 a[212:213], v27 offset:27792
ds_read_b64_tr_b16 a[214:215], v27 offset:32400
s_lshl_b32 s52, s52, 2
v_mfma_f32_16x16x32_bf16 v[108:111], v[164:167], a[192:195], v[108:111]
s_add_u32 s101, s100, 8192
s_waitcnt lgkmcnt(4)
v_mfma_f32_16x16x32_bf16 v[40:43], v[168:171], a[196:199], v[40:43]
ds_read_b64_tr_b16 a[216:217], v27 offset:27832
ds_read_b64_tr_b16 a[218:219], v27 offset:32440
v_mfma_f32_16x16x32_bf16 v[44:47], v[172:175], a[196:199], v[44:47]
s_add_u32 m0, s3, 22528
s_add_u32 s52, s52, s34
v_mfma_f32_16x16x32_bf16 v[48:51], v[168:171], a[200:203], v[48:51]
ds_read_b64_tr_b16 a[220:221], v27 offset:27864
ds_read_b64_tr_b16 a[222:223], v27 offset:32472
s_mul_i32 s73, s52, 9216
v_mfma_f32_16x16x32_bf16 v[52:55], v[172:175], a[200:203], v[52:55]
buffer_store_dwordx4 a[32:35], v32, s[24:27], s101 offen offset:0 sc1
v_mfma_f32_16x16x32_bf16 v[56:59], v[168:171], a[204:207], v[56:59]
ds_read_b64_tr_b16 a[224:225], v27 offset:27904
ds_read_b64_tr_b16 a[226:227], v27 offset:32512
v_mfma_f32_16x16x32_bf16 v[60:63], v[172:175], a[204:207], v[60:63]
s_add_u32 s73, s73, 3245056
s_waitcnt lgkmcnt(4)
v_mfma_f32_16x16x32_bf16 v[64:67], v[168:171], a[208:211], v[64:67]
ds_read_b64_tr_b16 a[228:229], v30 offset:27648
ds_read_b64_tr_b16 a[230:231], v30 offset:32256
s_xor_b32 s52, s33, 3
v_mfma_f32_16x16x32_bf16 v[68:71], v[172:175], a[208:211], v[68:71]
buffer_load_dwordx4 v20, s[16:19], s99 offen lds
v_mfma_f32_16x16x32_bf16 v[72:75], v[168:171], a[212:215], v[72:75]
ds_read_b64_tr_b16 a[232:233], v27 offset:36864
ds_read_b64_tr_b16 a[234:235], v27 offset:41472
v_mfma_f32_16x16x32_bf16 v[76:79], v[172:175], a[212:215], v[76:79]
s_add_u32 m0, s3, 36864
s_mul_i32 s70, s52, 165888
v_mfma_f32_16x16x32_bf16 v[80:83], v[168:171], a[216:219], v[80:83]
ds_read_b64_tr_b16 a[236:237], v27 offset:36904
ds_read_b64_tr_b16 a[238:239], v27 offset:41512
s_add_u32 s70, s70, s51
v_mfma_f32_16x16x32_bf16 v[84:87], v[172:175], a[216:219], v[84:87]
s_lshl_b32 s52, s52, 2
s_waitcnt lgkmcnt(4)
v_mfma_f32_16x16x32_bf16 v[88:91], v[168:171], a[220:223], v[88:91]
ds_read_b64_tr_b16 a[240:241], v27 offset:36936
ds_read_b64_tr_b16 a[242:243], v27 offset:41544
v_mfma_f32_16x16x32_bf16 v[92:95], v[172:175], a[220:223], v[92:95]
buffer_load_dwordx4 v16, s[16:19], s58 offen offset:0 lds
v_mfma_f32_16x16x32_bf16 v[96:99], v[168:171], a[224:227], v[96:99]
ds_read_b64_tr_b16 a[244:245], v27 offset:36976
ds_read_b64_tr_b16 a[246:247], v27 offset:41584
s_add_u32 s52, s52, s34
v_mfma_f32_16x16x32_bf16 v[100:103], v[172:175], a[224:227], v[100:103]
s_mul_i32 s74, s52, 9216
s_add_u32 s74, s74, 3245056
v_mfma_f32_16x16x32_bf16 v[104:107], v[168:171], a[228:231], v[104:107]
ds_read_b64_tr_b16 a[248:249], v27 offset:37008
ds_read_b64_tr_b16 a[250:251], v27 offset:41616
v_mfma_f32_16x16x32_bf16 v[108:111], v[172:175], a[228:231], v[108:111]
s_mul_i32 s40, s34, 72
s_waitcnt lgkmcnt(4)
v_mfma_f32_16x16x32_bf16 v[40:43], v[176:179], a[232:235], v[40:43]
ds_read_b64_tr_b16 a[252:253], v27 offset:37048
ds_read_b64_tr_b16 a[254:255], v27 offset:41656
s_mul_i32 s52, s33, 9
v_mfma_f32_16x16x32_bf16 v[44:47], v[180:183], a[232:235], v[44:47]
buffer_load_dwordx4 v17, s[16:19], s58 offen offset:1024 lds
v_mfma_f32_16x16x32_bf16 v[48:51], v[176:179], a[236:239], v[48:51]
ds_read_b64_tr_b16 a[192:193], v27 offset:37080
ds_read_b64_tr_b16 a[194:195], v27 offset:41688
v_mfma_f32_16x16x32_bf16 v[52:55], v[180:183], a[236:239], v[52:55]
s_add_u32 s40, s40, s52
s_lshl_b32 s40, s40, 9
v_mfma_f32_16x16x32_bf16 v[56:59], v[176:179], a[240:243], v[56:59]
ds_read_b64_tr_b16 a[196:197], v27 offset:37120
ds_read_b64_tr_b16 a[198:199], v27 offset:41728
s_add_u32 s40, s40, 3097600
v_mfma_f32_16x16x32_bf16 v[60:63], v[180:183], a[240:243], v[60:63]
s_mov_b32 s96, 238609295
s_waitcnt lgkmcnt(4)
v_mfma_f32_16x16x32_bf16 v[64:67], v[176:179], a[244:247], v[64:67]
ds_read_b64_tr_b16 a[200:201], v30 offset:36864
ds_read_b64_tr_b16 a[202:203], v30 offset:41472
v_mfma_f32_16x16x32_bf16 v[68:71], v[180:183], a[244:247], v[68:71]
buffer_load_dwordx4 v18, s[16:19], s58 offen offset:2048 lds
v_mfma_f32_16x16x32_bf16 v[72:75], v[176:179], a[248:251], v[72:75]
ds_read_b64_tr_b16 a[204:205], v27 offset:46080
ds_read_b64_tr_b16 a[206:207], v27 offset:50688
s_lshl_b32 s97, s49, 6
v_mfma_f32_16x16x32_bf16 v[76:79], v[180:183], a[248:251], v[76:79]
s_mov_b32 s98, 1152
v_add_u32 v34, s97, v0
v_mfma_f32_16x16x32_bf16 v[80:83], v[176:179], a[252:255], v[80:83]
ds_read_b64_tr_b16 a[208:209], v27 offset:46120
ds_read_b64_tr_b16 a[210:211], v27 offset:50728
v_mfma_f32_16x16x32_bf16 v[84:87], v[180:183], a[252:255], v[84:87]
s_add_u32 s97, s97, 64
s_waitcnt lgkmcnt(4)
v_mfma_f32_16x16x32_bf16 v[88:91], v[176:179], a[192:195], v[88:91]
ds_read_b64_tr_b16 a[212:213], v27 offset:46152
ds_read_b64_tr_b16 a[214:215], v27 offset:50760
v_mul_hi_u32 v35, v34, s96
v_mfma_f32_16x16x32_bf16 v[92:95], v[180:183], a[192:195], v[92:95]
buffer_load_dwordx4 v19, s[16:19], s58 offen offset:3072 lds
v_mfma_f32_16x16x32_bf16 v[96:99], v[176:179], a[196:199], v[96:99]
ds_read_b64_tr_b16 a[216:217], v27 offset:46192
ds_read_b64_tr_b16 a[218:219], v27 offset:50800
v_mfma_f32_16x16x32_bf16 v[100:103], v[180:183], a[196:199], v[100:103]
v_mul_u32_u24 v36, 18, v35
v_sub_u32 v34, v34, v36
v_mfma_f32_16x16x32_bf16 v[104:107], v[176:179], a[200:203], v[104:107]
ds_read_b64_tr_b16 a[220:221], v27 offset:46224
ds_read_b64_tr_b16 a[222:223], v27 offset:50832
v_lshlrev_b32_e64 v34, 4, v34
v_mfma_f32_16x16x32_bf16 v[108:111], v[180:183], a[200:203], v[108:111]
s_add_u32 m0, s3, 40960
s_waitcnt lgkmcnt(4)
v_mfma_f32_16x16x32_bf16 v[40:43], v[184:187], a[204:207], v[40:43]
ds_read_b64_tr_b16 a[224:225], v27 offset:46264
ds_read_b64_tr_b16 a[226:227], v27 offset:50872
v_mfma_f32_16x16x32_bf16 v[44:47], v[188:191], a[204:207], v[44:47]
v_lshrrev_b32 v36, 4, v35
v_add_u32_e64 v36, 1, v36
v_mfma_f32_16x16x32_bf16 v[48:51], v[184:187], a[208:211], v[48:51]
ds_read_b64_tr_b16 a[228:229], v27 offset:46296
ds_read_b64_tr_b16 a[230:231], v27 offset:50904
v_and_b32_e64 v36, 6, v36
v_mfma_f32_16x16x32_bf16 v[52:55], v[188:191], a[208:211], v[52:55]
buffer_load_dwordx4 v20, s[16:19], s58 offen lds
v_mfma_f32_16x16x32_bf16 v[56:59], v[184:187], a[212:215], v[56:59]
ds_read_b64_tr_b16 a[232:233], v27 offset:46336
ds_read_b64_tr_b16 a[234:235], v27 offset:50944
v_mfma_f32_16x16x32_bf16 v[60:63], v[188:191], a[212:215], v[60:63]
v_lshl_add_u32 v35, v36, 1, v35
s_waitcnt lgkmcnt(4)
v_mfma_f32_16x16x32_bf16 v[64:67], v[184:187], a[216:219], v[64:67]
ds_read_b64_tr_b16 a[236:237], v30 offset:46080
ds_read_b64_tr_b16 a[238:239], v30 offset:50688
v_mad_u32_u24 v21, v35, s98, v34
v_mfma_f32_16x16x32_bf16 v[68:71], v[188:191], a[216:219], v[68:71]
v_add_u32_e64 v34, s97, v0
s_add_u32 s97, s97, 64
v_mfma_f32_16x16x32_bf16 v[72:75], v[184:187], a[220:223], v[72:75]
s_waitcnt vmcnt(24)
s_barrier
v_mfma_f32_16x16x32_bf16 v[76:79], v[188:191], a[220:223], v[76:79]
ds_read_b64_tr_b16 a[240:241], v28 offset:0
ds_read_b64_tr_b16 a[242:243], v28 offset:4608
v_mfma_f32_16x16x32_bf16 v[80:83], v[184:187], a[224:227], v[80:83]
ds_read_b64_tr_b16 a[244:245], v28 offset:40
ds_read_b64_tr_b16 a[246:247], v28 offset:4648
v_mul_hi_u32 v35, v34, s96
v_mfma_f32_16x16x32_bf16 v[84:87], v[188:191], a[224:227], v[84:87]
s_add_u32 m0, s3, 55296
s_waitcnt lgkmcnt(4)
v_mfma_f32_16x16x32_bf16 v[88:91], v[184:187], a[228:231], v[88:91]
ds_read_b64_tr_b16 a[248:249], v28 offset:72
ds_read_b64_tr_b16 a[250:251], v28 offset:4680
v_mfma_f32_16x16x32_bf16 v[92:95], v[188:191], a[228:231], v[92:95]
buffer_load_dwordx4 v16, s[16:19], s59 offen offset:0 lds
v_mfma_f32_16x16x32_bf16 v[96:99], v[184:187], a[232:235], v[96:99]
ds_read_b64_tr_b16 a[252:253], v28 offset:112
ds_read_b64_tr_b16 a[254:255], v28 offset:4720
v_mfma_f32_16x16x32_bf16 v[100:103], v[188:191], a[232:235], v[100:103]
s_mov_b32 s41, s51
s_max_u32 s42, s32, 1
s_lshl_b32 s42, s42, 4
v_mfma_f32_16x16x32_bf16 v[104:107], v[184:187], a[236:239], v[104:107]
ds_read_b64_tr_b16 a[192:193], v28 offset:144
ds_read_b64_tr_b16 a[194:195], v28 offset:4752
v_mfma_f32_16x16x32_bf16 v[108:111], v[188:191], a[236:239], v[108:111]
s_sub_u32 s42, s42, 16
s_waitcnt lgkmcnt(4)
v_mfma_f32_16x16x32_bf16 v[40:43], v[192:195], a[240:243], v[40:43]
ds_read_b64_tr_b16 a[196:197], v28 offset:184
ds_read_b64_tr_b16 a[198:199], v28 offset:4792
v_mfma_f32_16x16x32_bf16 v[44:47], v[196:199], a[240:243], v[44:47]
buffer_load_dwordx4 v17, s[16:19], s59 offen offset:1024 lds
v_mfma_f32_16x16x32_bf16 v[48:51], v[192:195], a[244:247], v[48:51]
ds_read_b64_tr_b16 a[200:201], v28 offset:216
ds_read_b64_tr_b16 a[202:203], v28 offset:4824
v_mfma_f32_16x16x32_bf16 v[52:55], v[196:199], a[244:247], v[52:55]
s_min_u32 s4, s32, 1
s_lshl_b32 s4, s4, 2
v_mfma_f32_16x16x32_bf16 v[56:59], v[192:195], a[248:251], v[56:59]
ds_read_b64_tr_b16 a[204:205], v28 offset:256
ds_read_b64_tr_b16 a[206:207], v28 offset:4864
v_mfma_f32_16x16x32_bf16 v[60:63], v[196:199], a[248:251], v[60:63]
s_or_b32 s4, s4, 3
v_xor_b32_e64 v6, 4, v0
s_waitcnt lgkmcnt(4)
v_mfma_f32_16x16x32_bf16 v[64:67], v[192:195], a[252:255], v[64:67]
ds_read_b64_tr_b16 a[208:209], v31 offset:0
ds_read_b64_tr_b16 a[210:211], v31 offset:4608
v_mfma_f32_16x16x32_bf16 v[68:71], v[196:199], a[252:255], v[68:71]
buffer_load_dwordx4 v18, s[16:19], s59 offen offset:2048 lds
v_mfma_f32_16x16x32_bf16 v[72:75], v[192:195], a[192:195], v[72:75]
ds_read_b64_tr_b16 a[212:213], v28 offset:9216
ds_read_b64_tr_b16 a[214:215], v28 offset:13824
v_mfma_f32_16x16x32_bf16 v[76:79], v[196:199], a[192:195], v[76:79]
v_and_b32 v6, s4, v6
v_lshlrev_b32 v6, 2, v6
v_add_u32_e64 v6, s42, v6
v_mfma_f32_16x16x32_bf16 v[80:83], v[192:195], a[196:199], v[80:83]
ds_read_b64_tr_b16 a[216:217], v28 offset:9256
ds_read_b64_tr_b16 a[218:219], v28 offset:13864
v_mfma_f32_16x16x32_bf16 v[84:87], v[196:199], a[196:199], v[84:87]
s_waitcnt lgkmcnt(4)
v_mfma_f32_16x16x32_bf16 v[88:91], v[192:195], a[200:203], v[88:91]
ds_read_b64_tr_b16 a[220:221], v28 offset:9288
ds_read_b64_tr_b16 a[222:223], v28 offset:13896
v_mfma_f32_16x16x32_bf16 v[92:95], v[196:199], a[200:203], v[92:95]
buffer_load_dwordx4 v19, s[16:19], s59 offen offset:3072 lds
v_mfma_f32_16x16x32_bf16 v[96:99], v[192:195], a[204:207], v[96:99]
ds_read_b64_tr_b16 a[224:225], v28 offset:9328
ds_read_b64_tr_b16 a[226:227], v28 offset:13936
v_mfma_f32_16x16x32_bf16 v[100:103], v[196:199], a[204:207], v[100:103]
buffer_load_dword v7, v6, s[28:31], 0 offen sc1
v_mfma_f32_16x16x32_bf16 v[104:107], v[192:195], a[208:211], v[104:107]
ds_read_b64_tr_b16 a[228:229], v28 offset:9360
ds_read_b64_tr_b16 a[230:231], v28 offset:13968
v_mfma_f32_16x16x32_bf16 v[108:111], v[196:199], a[208:211], v[108:111]
s_add_u32 m0, s3, 59392
v_mul_u32_u24_e64 v36, 18, v35
s_waitcnt lgkmcnt(4)
v_mfma_f32_16x16x32_bf16 v[40:43], v[200:203], a[212:215], v[40:43]
ds_read_b64_tr_b16 a[232:233], v28 offset:9400
ds_read_b64_tr_b16 a[234:235], v28 offset:14008
v_mfma_f32_16x16x32_bf16 v[44:47], v[204:207], a[212:215], v[44:47]
v_sub_u32 v34, v34, v36
v_lshlrev_b32 v34, 4, v34
v_mfma_f32_16x16x32_bf16 v[48:51], v[200:203], a[216:219], v[48:51]
ds_read_b64_tr_b16 a[236:237], v28 offset:9432
ds_read_b64_tr_b16 a[238:239], v28 offset:14040
v_mfma_f32_16x16x32_bf16 v[52:55], v[204:207], a[216:219], v[52:55]
buffer_load_dwordx4 v20, s[16:19], s59 offen lds
v_lshrrev_b32_e64 v36, 4, v35
v_mfma_f32_16x16x32_bf16 v[56:59], v[200:203], a[220:223], v[56:59]
ds_read_b64_tr_b16 a[240:241], v28 offset:9472
ds_read_b64_tr_b16 a[242:243], v28 offset:14080
v_mfma_f32_16x16x32_bf16 v[60:63], v[204:207], a[220:223], v[60:63]
v_add_u32 v36, 1, v36
s_waitcnt lgkmcnt(4)
v_mfma_f32_16x16x32_bf16 v[64:67], v[200:203], a[224:227], v[64:67]
ds_read_b64_tr_b16 a[244:245], v31 offset:9216
ds_read_b64_tr_b16 a[246:247], v31 offset:13824
v_mfma_f32_16x16x32_bf16 v[68:71], v[204:207], a[224:227], v[68:71]
v_and_b32_e64 v36, 6, v36
v_lshl_add_u32 v35, v36, 1, v35
v_mad_u32_u24 v22, v35, s98, v34
v_mfma_f32_16x16x32_bf16 v[72:75], v[200:203], a[228:231], v[72:75]
ds_read_b64_tr_b16 a[248:249], v28 offset:18432
ds_read_b64_tr_b16 a[250:251], v28 offset:23040
v_mfma_f32_16x16x32_bf16 v[76:79], v[204:207], a[228:231], v[76:79]
s_add_u32 m0, s3, 73728
v_subrev_u32 v22, 1024, v22
v_mfma_f32_16x16x32_bf16 v[80:83], v[200:203], a[232:235], v[80:83]
ds_read_b64_tr_b16 a[252:253], v28 offset:18472
ds_read_b64_tr_b16 a[254:255], v28 offset:23080
v_mfma_f32_16x16x32_bf16 v[84:87], v[204:207], a[232:235], v[84:87]
v_add_u32_e64 v34, s97, v0
s_add_u32 s97, s97, 64
s_waitcnt lgkmcnt(4)
v_mfma_f32_16x16x32_bf16 v[88:91], v[200:203], a[236:239], v[88:91]
ds_read_b64_tr_b16 a[192:193], v28 offset:18504
ds_read_b64_tr_b16 a[194:195], v28 offset:23112
v_mfma_f32_16x16x32_bf16 v[92:95], v[204:207], a[236:239], v[92:95]
buffer_load_dwordx4 v16, s[16:19], s60 offen offset:0 lds
v_mfma_f32_16x16x32_bf16 v[96:99], v[200:203], a[240:243], v[96:99]
ds_read_b64_tr_b16 a[196:197], v28 offset:18544
ds_read_b64_tr_b16 a[198:199], v28 offset:23152
v_mfma_f32_16x16x32_bf16 v[100:103], v[204:207], a[240:243], v[100:103]
v_mul_hi_u32 v35, v34, s96
v_mul_u32_u24 v36, 18, v35
v_sub_u32 v34, v34, v36
v_mfma_f32_16x16x32_bf16 v[104:107], v[200:203], a[244:247], v[104:107]
ds_read_b64_tr_b16 a[200:201], v28 offset:18576
ds_read_b64_tr_b16 a[202:203], v28 offset:23184
v_mfma_f32_16x16x32_bf16 v[108:111], v[204:207], a[244:247], v[108:111]
v_lshlrev_b32 v34, 4, v34
s_waitcnt lgkmcnt(4)
v_mfma_f32_16x16x32_bf16 v[40:43], v[208:211], a[248:251], v[40:43]
ds_read_b64_tr_b16 a[204:205], v28 offset:18616
ds_read_b64_tr_b16 a[206:207], v28 offset:23224
v_mfma_f32_16x16x32_bf16 v[44:47], v[212:215], a[248:251], v[44:47]
buffer_load_dwordx4 v17, s[16:19], s60 offen offset:1024 lds
v_lshrrev_b32_e64 v36, 4, v35
v_mfma_f32_16x16x32_bf16 v[48:51], v[208:211], a[252:255], v[48:51]
ds_read_b64_tr_b16 a[208:209], v28 offset:18648
ds_read_b64_tr_b16 a[210:211], v28 offset:23256
v_mfma_f32_16x16x32_bf16 v[52:55], v[212:215], a[252:255], v[52:55]
v_add_u32 v36, 1, v36
v_and_b32 v36, 6, v36
v_mfma_f32_16x16x32_bf16 v[56:59], v[208:211], a[192:195], v[56:59]
ds_read_b64_tr_b16 a[212:213], v28 offset:18688
ds_read_b64_tr_b16 a[214:215], v28 offset:23296
v_mfma_f32_16x16x32_bf16 v[60:63], v[212:215], a[192:195], v[60:63]
v_lshl_add_u32 v35, v36, 1, v35
v_mad_u32_u24 v23, v35, s98, v34
s_waitcnt lgkmcnt(4)
v_mfma_f32_16x16x32_bf16 v[64:67], v[208:211], a[196:199], v[64:67]
ds_read_b64_tr_b16 a[216:217], v31 offset:18432
ds_read_b64_tr_b16 a[218:219], v31 offset:23040
v_mfma_f32_16x16x32_bf16 v[68:71], v[212:215], a[196:199], v[68:71]
buffer_load_dwordx4 v18, s[16:19], s60 offen offset:2048 lds
v_mfma_f32_16x16x32_bf16 v[72:75], v[208:211], a[200:203], v[72:75]
ds_read_b64_tr_b16 a[220:221], v28 offset:27648
ds_read_b64_tr_b16 a[222:223], v28 offset:32256
v_mfma_f32_16x16x32_bf16 v[76:79], v[212:215], a[200:203], v[76:79]
v_subrev_u32 v23, 2048, v23
v_add_u32_e64 v34, s97, v0
s_add_u32 s97, s97, 64
v_mfma_f32_16x16x32_bf16 v[80:83], v[208:211], a[204:207], v[80:83]
ds_read_b64_tr_b16 a[224:225], v28 offset:27688
ds_read_b64_tr_b16 a[226:227], v28 offset:32296
v_mfma_f32_16x16x32_bf16 v[84:87], v[212:215], a[204:207], v[84:87]
v_mul_hi_u32 v35, v34, s96
s_waitcnt lgkmcnt(4)
v_mfma_f32_16x16x32_bf16 v[88:91], v[208:211], a[208:211], v[88:91]
ds_read_b64_tr_b16 a[228:229], v28 offset:27720
ds_read_b64_tr_b16 a[230:231], v28 offset:32328
v_mfma_f32_16x16x32_bf16 v[92:95], v[212:215], a[208:211], v[92:95]
buffer_load_dwordx4 v19, s[16:19], s60 offen offset:3072 lds
v_mul_u32_u24 v36, 18, v35
v_mfma_f32_16x16x32_bf16 v[96:99], v[208:211], a[212:215], v[96:99]
ds_read_b64_tr_b16 a[232:233], v28 offset:27760
ds_read_b64_tr_b16 a[234:235], v28 offset:32368
v_mfma_f32_16x16x32_bf16 v[100:103], v[212:215], a[212:215], v[100:103]
v_sub_u32 v34, v34, v36
v_lshlrev_b32 v34, 4, v34
v_mfma_f32_16x16x32_bf16 v[104:107], v[208:211], a[216:219], v[104:107]
ds_read_b64_tr_b16 a[236:237], v28 offset:27792
ds_read_b64_tr_b16 a[238:239], v28 offset:32400
v_mfma_f32_16x16x32_bf16 v[108:111], v[212:215], a[216:219], v[108:111]
s_add_u32 m0, s3, 77824
v_lshrrev_b32 v36, 4, v35
s_waitcnt lgkmcnt(4)
v_mfma_f32_16x16x32_bf16 v[40:43], v[216:219], a[220:223], v[40:43]
ds_read_b64_tr_b16 a[240:241], v28 offset:27832
ds_read_b64_tr_b16 a[242:243], v28 offset:32440
v_mfma_f32_16x16x32_bf16 v[44:47], v[220:223], a[220:223], v[44:47]
v_add_u32 v36, 1, v36
v_and_b32 v36, 6, v36
v_mfma_f32_16x16x32_bf16 v[48:51], v[216:219], a[224:227], v[48:51]
ds_read_b64_tr_b16 a[244:245], v28 offset:27864
ds_read_b64_tr_b16 a[246:247], v28 offset:32472
v_mfma_f32_16x16x32_bf16 v[52:55], v[220:223], a[224:227], v[52:55]
buffer_load_dwordx4 v20, s[16:19], s60 offen lds
v_lshl_add_u32 v35, v36, 1, v35
v_mfma_f32_16x16x32_bf16 v[56:59], v[216:219], a[228:231], v[56:59]
ds_read_b64_tr_b16 a[248:249], v28 offset:27904
ds_read_b64_tr_b16 a[250:251], v28 offset:32512
v_mfma_f32_16x16x32_bf16 v[60:63], v[220:223], a[228:231], v[60:63]
v_mad_u32_u24 v24, v35, s98, v34
s_waitcnt lgkmcnt(4)
v_mfma_f32_16x16x32_bf16 v[64:67], v[216:219], a[232:235], v[64:67]
ds_read_b64_tr_b16 a[252:253], v31 offset:27648
ds_read_b64_tr_b16 a[254:255], v31 offset:32256
v_mfma_f32_16x16x32_bf16 v[68:71], v[220:223], a[232:235], v[68:71]
v_subrev_u32 v24, 3072, v24
v_add_u32 v34, s97, v0
v_mul_hi_u32 v35, v34, s96
v_mfma_f32_16x16x32_bf16 v[72:75], v[216:219], a[236:239], v[72:75]
s_waitcnt vmcnt(16)
s_waitcnt vmcnt(17)
s_barrier
v_mfma_f32_16x16x32_bf16 v[76:79], v[220:223], a[236:239], v[76:79]
ds_read_b64_tr_b16 a[192:193], v26 offset:0
ds_read_b64_tr_b16 a[194:195], v26 offset:4608
v_mfma_f32_16x16x32_bf16 v[80:83], v[216:219], a[240:243], v[80:83]
ds_read_b64_tr_b16 a[196:197], v26 offset:40
ds_read_b64_tr_b16 a[198:199], v26 offset:4648
v_mfma_f32_16x16x32_bf16 v[84:87], v[220:223], a[240:243], v[84:87]
s_add_u32 m0, s3, 92160
v_mul_u32_u24_e64 v36, 18, v35
s_waitcnt lgkmcnt(4)
v_mfma_f32_16x16x32_bf16 v[88:91], v[216:219], a[244:247], v[88:91]
ds_read_b64_tr_b16 a[200:201], v26 offset:72
ds_read_b64_tr_b16 a[202:203], v26 offset:4680
v_mfma_f32_16x16x32_bf16 v[92:95], v[220:223], a[244:247], v[92:95]
buffer_load_dwordx4 v16, s[16:19], s61 offen offset:0 lds
v_mfma_f32_16x16x32_bf16 v[96:99], v[216:219], a[248:251], v[96:99]
ds_read_b64_tr_b16 a[204:205], v26 offset:112
ds_read_b64_tr_b16 a[206:207], v26 offset:4720
v_mfma_f32_16x16x32_bf16 v[100:103], v[220:223], a[248:251], v[100:103]
v_sub_u32 v34, v34, v36
v_lshlrev_b32 v34, 4, v34
v_lshrrev_b32_e64 v36, 4, v35
v_mfma_f32_16x16x32_bf16 v[104:107], v[216:219], a[252:255], v[104:107]
ds_read_b64_tr_b16 a[208:209], v26 offset:144
ds_read_b64_tr_b16 a[210:211], v26 offset:4752
v_mfma_f32_16x16x32_bf16 v[108:111], v[220:223], a[252:255], v[108:111]
v_add_u32 v36, 1, v36
s_waitcnt lgkmcnt(4)
v_mfma_f32_16x16x32_bf16 v[40:43], v[224:227], a[192:195], v[40:43]
ds_read_b64_tr_b16 a[212:213], v26 offset:184
ds_read_b64_tr_b16 a[214:215], v26 offset:4792
v_mfma_f32_16x16x32_bf16 v[44:47], v[228:231], a[192:195], v[44:47]
buffer_load_dwordx4 v17, s[16:19], s61 offen offset:1024 lds
v_and_b32_e64 v36, 6, v36
v_mfma_f32_16x16x32_bf16 v[48:51], v[224:227], a[196:199], v[48:51]
ds_read_b64_tr_b16 a[216:217], v26 offset:216
ds_read_b64_tr_b16 a[218:219], v26 offset:4824
v_mfma_f32_16x16x32_bf16 v[52:55], v[228:231], a[196:199], v[52:55]
v_lshl_add_u32 v35, v36, 1, v35
v_mad_u32_u24 v25, v35, s98, v34
v_mfma_f32_16x16x32_bf16 v[56:59], v[224:227], a[200:203], v[56:59]
ds_read_b64_tr_b16 a[220:221], v26 offset:256
ds_read_b64_tr_b16 a[222:223], v26 offset:4864
v_mfma_f32_16x16x32_bf16 v[60:63], v[228:231], a[200:203], v[60:63]
s_add_u32 s96, s53, s33
s_mul_i32 s96, s96, 81
s_waitcnt lgkmcnt(4)
v_mfma_f32_16x16x32_bf16 v[64:67], v[224:227], a[204:207], v[64:67]
ds_read_b64_tr_b16 a[224:225], v29 offset:0
ds_read_b64_tr_b16 a[226:227], v29 offset:4608
v_mfma_f32_16x16x32_bf16 v[68:71], v[228:231], a[204:207], v[68:71]
buffer_load_dwordx4 v18, s[16:19], s61 offen offset:2048 lds
v_mfma_f32_16x16x32_bf16 v[72:75], v[224:227], a[208:211], v[72:75]
ds_read_b64_tr_b16 a[228:229], v26 offset:9216
ds_read_b64_tr_b16 a[230:231], v26 offset:13824
v_mfma_f32_16x16x32_bf16 v[76:79], v[228:231], a[208:211], v[76:79]
s_mul_i32 s97, s34, 20
s_add_u32 s96, s96, s97
s_lshl_b32 s96, s96, 7
v_mfma_f32_16x16x32_bf16 v[80:83], v[224:227], a[212:215], v[80:83]
ds_read_b64_tr_b16 a[232:233], v26 offset:9256
ds_read_b64_tr_b16 a[234:235], v26 offset:13864
v_mfma_f32_16x16x32_bf16 v[84:87], v[228:231], a[212:215], v[84:87]
v_min_u32_e64 v34, 20, v0
s_waitcnt lgkmcnt(4)
v_mfma_f32_16x16x32_bf16 v[88:91], v[224:227], a[216:219], v[88:91]
ds_read_b64_tr_b16 a[236:237], v26 offset:9288
ds_read_b64_tr_b16 a[238:239], v26 offset:13896
v_mfma_f32_16x16x32_bf16 v[92:95], v[228:231], a[216:219], v[92:95]
buffer_load_dwordx4 v19, s[16:19], s61 offen offset:3072 lds
v_lshlrev_b32_e64 v34, 7, v34
v_mfma_f32_16x16x32_bf16 v[96:99], v[224:227], a[220:223], v[96:99]
ds_read_b64_tr_b16 a[240:241], v26 offset:9328
ds_read_b64_tr_b16 a[242:243], v26 offset:13936
v_mfma_f32_16x16x32_bf16 v[100:103], v[228:231], a[220:223], v[100:103]
buffer_load_dword a191, v34, s[20:23], s96 offen
v_mfma_f32_16x16x32_bf16 v[104:107], v[224:227], a[224:227], v[104:107]
ds_read_b64_tr_b16 a[244:245], v26 offset:9360
ds_read_b64_tr_b16 a[246:247], v26 offset:13968
v_mfma_f32_16x16x32_bf16 v[108:111], v[228:231], a[224:227], v[108:111]
s_add_u32 m0, s3, 96256
s_waitcnt lgkmcnt(4)
v_mfma_f32_16x16x32_bf16 v[40:43], v[232:235], a[228:231], v[40:43]
ds_read_b64_tr_b16 a[248:249], v26 offset:9400
ds_read_b64_tr_b16 a[250:251], v26 offset:14008
v_mfma_f32_16x16x32_bf16 v[44:47], v[236:239], a[228:231], v[44:47]
buffer_load_dword a191, v39, s[24:27], s37 offen sc1
v_mfma_f32_16x16x32_bf16 v[48:51], v[232:235], a[232:235], v[48:51]
ds_read_b64_tr_b16 a[252:253], v26 offset:9432
ds_read_b64_tr_b16 a[254:255], v26 offset:14040
v_mfma_f32_16x16x32_bf16 v[52:55], v[236:239], a[232:235], v[52:55]
buffer_load_dwordx4 v20, s[16:19], s61 offen lds
v_mfma_f32_16x16x32_bf16 v[56:59], v[232:235], a[236:239], v[56:59]
ds_read_b64_tr_b16 a[192:193], v26 offset:9472
ds_read_b64_tr_b16 a[194:195], v26 offset:14080
v_mfma_f32_16x16x32_bf16 v[60:63], v[236:239], a[236:239], v[60:63]
s_waitcnt lgkmcnt(4)
v_mfma_f32_16x16x32_bf16 v[64:67], v[232:235], a[240:243], v[64:67]
ds_read_b64_tr_b16 a[196:197], v29 offset:9216
ds_read_b64_tr_b16 a[198:199], v29 offset:13824
v_mfma_f32_16x16x32_bf16 v[68:71], v[236:239], a[240:243], v[68:71]
buffer_store_dword v38, v39, s[24:27], 0 offen sc1
v_mov_b32_e64 v38, 2
v_mfma_f32_16x16x32_bf16 v[72:75], v[232:235], a[244:247], v[72:75]
ds_read_b64_tr_b16 a[200:201], v26 offset:18432
ds_read_b64_tr_b16 a[202:203], v26 offset:23040
v_mfma_f32_16x16x32_bf16 v[76:79], v[236:239], a[244:247], v[76:79]
s_add_u32 m0, s3, 110592
v_mfma_f32_16x16x32_bf16 v[80:83], v[232:235], a[248:251], v[80:83]
ds_read_b64_tr_b16 a[204:205], v26 offset:18472
ds_read_b64_tr_b16 a[206:207], v26 offset:23080
v_mfma_f32_16x16x32_bf16 v[84:87], v[236:239], a[248:251], v[84:87]
s_waitcnt lgkmcnt(4)
v_mfma_f32_16x16x32_bf16 v[88:91], v[232:235], a[252:255], v[88:91]
ds_read_b64_tr_b16 a[208:209], v26 offset:18504
ds_read_b64_tr_b16 a[210:211], v26 offset:23112
v_mfma_f32_16x16x32_bf16 v[92:95], v[236:239], a[252:255], v[92:95]
buffer_load_dwordx4 v16, s[16:19], s62 offen offset:0 lds
v_mfma_f32_16x16x32_bf16 v[96:99], v[232:235], a[192:195], v[96:99]
ds_read_b64_tr_b16 a[212:213], v26 offset:18544
ds_read_b64_tr_b16 a[214:215], v26 offset:23152
v_mfma_f32_16x16x32_bf16 v[100:103], v[236:239], a[192:195], v[100:103]
v_mfma_f32_16x16x32_bf16 v[104:107], v[232:235], a[196:199], v[104:107]
ds_read_b64_tr_b16 a[216:217], v26 offset:18576
ds_read_b64_tr_b16 a[218:219], v26 offset:23184
v_mfma_f32_16x16x32_bf16 v[108:111], v[236:239], a[196:199], v[108:111]
s_waitcnt lgkmcnt(4)
v_mfma_f32_16x16x32_bf16 v[40:43], v[240:243], a[200:203], v[40:43]
ds_read_b64_tr_b16 a[220:221], v26 offset:18616
ds_read_b64_tr_b16 a[222:223], v26 offset:23224
v_mfma_f32_16x16x32_bf16 v[44:47], v[244:247], a[200:203], v[44:47]
buffer_load_dwordx4 v17, s[16:19], s62 offen offset:1024 lds
v_mfma_f32_16x16x32_bf16 v[48:51], v[240:243], a[204:207], v[48:51]
ds_read_b64_tr_b16 a[224:225], v26 offset:18648
ds_read_b64_tr_b16 a[226:227], v26 offset:23256
v_mfma_f32_16x16x32_bf16 v[52:55], v[244:247], a[204:207], v[52:55]
v_mfma_f32_16x16x32_bf16 v[56:59], v[240:243], a[208:211], v[56:59]
ds_read_b64_tr_b16 a[228:229], v26 offset:18688
ds_read_b64_tr_b16 a[230:231], v26 offset:23296
v_mfma_f32_16x16x32_bf16 v[60:63], v[244:247], a[208:211], v[60:63]
s_waitcnt lgkmcnt(4)
v_mfma_f32_16x16x32_bf16 v[64:67], v[240:243], a[212:215], v[64:67]
ds_read_b64_tr_b16 a[232:233], v29 offset:18432
ds_read_b64_tr_b16 a[234:235], v29 offset:23040
v_mfma_f32_16x16x32_bf16 v[68:71], v[244:247], a[212:215], v[68:71]
buffer_load_dwordx4 v18, s[16:19], s62 offen offset:2048 lds
v_mfma_f32_16x16x32_bf16 v[72:75], v[240:243], a[216:219], v[72:75]
ds_read_b64_tr_b16 a[236:237], v26 offset:27648
ds_read_b64_tr_b16 a[238:239], v26 offset:32256
v_mfma_f32_16x16x32_bf16 v[76:79], v[244:247], a[216:219], v[76:79]
v_mfma_f32_16x16x32_bf16 v[80:83], v[240:243], a[220:223], v[80:83]
ds_read_b64_tr_b16 a[240:241], v26 offset:27688
ds_read_b64_tr_b16 a[242:243], v26 offset:32296
v_mfma_f32_16x16x32_bf16 v[84:87], v[244:247], a[220:223], v[84:87]
s_waitcnt lgkmcnt(4)
v_mfma_f32_16x16x32_bf16 v[88:91], v[240:243], a[224:227], v[88:91]
ds_read_b64_tr_b16 a[244:245], v26 offset:27720
ds_read_b64_tr_b16 a[246:247], v26 offset:32328
v_mfma_f32_16x16x32_bf16 v[92:95], v[244:247], a[224:227], v[92:95]
buffer_load_dwordx4 v19, s[16:19], s62 offen offset:3072 lds
v_mfma_f32_16x16x32_bf16 v[96:99], v[240:243], a[228:231], v[96:99]
ds_read_b64_tr_b16 a[248:249], v26 offset:27760
ds_read_b64_tr_b16 a[250:251], v26 offset:32368
v_mfma_f32_16x16x32_bf16 v[100:103], v[244:247], a[228:231], v[100:103]
v_mfma_f32_16x16x32_bf16 v[104:107], v[240:243], a[232:235], v[104:107]
ds_read_b64_tr_b16 a[252:253], v26 offset:27792
ds_read_b64_tr_b16 a[254:255], v26 offset:32400
v_mfma_f32_16x16x32_bf16 v[108:111], v[244:247], a[232:235], v[108:111]
s_add_u32 m0, s3, 114688
s_waitcnt lgkmcnt(4)
v_mfma_f32_16x16x32_bf16 v[40:43], v[248:251], a[236:239], v[40:43]
ds_read_b64_tr_b16 a[192:193], v26 offset:27832
ds_read_b64_tr_b16 a[194:195], v26 offset:32440
v_mfma_f32_16x16x32_bf16 v[44:47], v[252:255], a[236:239], v[44:47]
v_mfma_f32_16x16x32_bf16 v[48:51], v[248:251], a[240:243], v[48:51]
ds_read_b64_tr_b16 a[196:197], v26 offset:27864
ds_read_b64_tr_b16 a[198:199], v26 offset:32472
v_mfma_f32_16x16x32_bf16 v[52:55], v[252:255], a[240:243], v[52:55]
buffer_load_dwordx4 v20, s[16:19], s62 offen lds
v_mfma_f32_16x16x32_bf16 v[56:59], v[248:251], a[244:247], v[56:59]
ds_read_b64_tr_b16 a[200:201], v26 offset:27904
ds_read_b64_tr_b16 a[202:203], v26 offset:32512
v_mfma_f32_16x16x32_bf16 v[60:63], v[252:255], a[244:247], v[60:63]
s_waitcnt lgkmcnt(4)
v_mfma_f32_16x16x32_bf16 v[64:67], v[248:251], a[248:251], v[64:67]
ds_read_b64_tr_b16 a[204:205], v29 offset:27648
ds_read_b64_tr_b16 a[206:207], v29 offset:32256
v_mfma_f32_16x16x32_bf16 v[68:71], v[252:255], a[248:251], v[68:71]
v_mfma_f32_16x16x32_bf16 v[72:75], v[248:251], a[252:255], v[72:75]
s_waitcnt vmcnt(18)
s_barrier
v_mfma_f32_16x16x32_bf16 v[76:79], v[252:255], a[252:255], v[76:79]
ds_read_b64_tr_b16 a[208:209], v26 offset:36864
ds_read_b64_tr_b16 a[210:211], v26 offset:41472
v_mfma_f32_16x16x32_bf16 v[80:83], v[248:251], a[192:195], v[80:83]
ds_read_b64_tr_b16 a[212:213], v26 offset:36904
ds_read_b64_tr_b16 a[214:215], v26 offset:41512
v_cvt_pk_bf16_f32 v8, v40, v41
v_mfma_f32_16x16x32_bf16 v[84:87], v[252:255], a[192:195], v[84:87]
v_cvt_pk_bf16_f32 v9, v42, v43
v_cvt_pk_bf16_f32 v10, v44, v45
v_cvt_pk_bf16_f32 v11, v46, v47
s_waitcnt lgkmcnt(4)
v_mfma_f32_16x16x32_bf16 v[88:91], v[248:251], a[196:199], v[88:91]
ds_read_b64_tr_b16 a[216:217], v26 offset:36936
ds_read_b64_tr_b16 a[218:219], v26 offset:41544
v_accvgpr_write_b32 a72, v8
v_accvgpr_write_b32 a73, v9
v_cvt_pk_bf16_f32 v12, v48, v49
v_mfma_f32_16x16x32_bf16 v[92:95], v[252:255], a[196:199], v[92:95]
v_accvgpr_write_b32 a78, v10
v_accvgpr_write_b32 a79, v11
s_add_u32 s101, s100, 9216
buffer_store_dwordx4 v[8:11], v32, s[24:27], s101 offen offset:0 sc1
v_cvt_pk_bf16_f32 v13, v50, v51
v_cvt_pk_bf16_f32 v14, v52, v53
v_cvt_pk_bf16_f32 v15, v54, v55
v_mfma_f32_16x16x32_bf16 v[96:99], v[248:251], a[200:203], v[96:99]
ds_read_b64_tr_b16 a[220:221], v26 offset:36976
ds_read_b64_tr_b16 a[222:223], v26 offset:41584
v_accvgpr_write_b32 a80, v12
v_accvgpr_write_b32 a81, v13
v_cvt_pk_bf16_f32 v8, v56, v57
v_mfma_f32_16x16x32_bf16 v[100:103], v[252:255], a[200:203], v[100:103]
v_accvgpr_write_b32 a86, v14
v_accvgpr_write_b32 a87, v15
buffer_store_dwordx4 v[12:15], v32, s[24:27], s101 offen offset:1024 sc1
v_cvt_pk_bf16_f32 v9, v58, v59
v_cvt_pk_bf16_f32 v10, v60, v61
v_cvt_pk_bf16_f32 v11, v62, v63
v_mfma_f32_16x16x32_bf16 v[104:107], v[248:251], a[204:207], v[104:107]
ds_read_b64_tr_b16 a[224:225], v26 offset:37008
ds_read_b64_tr_b16 a[226:227], v26 offset:41616
v_accvgpr_write_b32 a88, v8
v_accvgpr_write_b32 a89, v9
v_cvt_pk_bf16_f32 v12, v64, v65
v_mfma_f32_16x16x32_bf16 v[108:111], v[252:255], a[204:207], v[108:111]
v_accvgpr_write_b32 a94, v10
v_accvgpr_write_b32 a95, v11
buffer_store_dwordx4 v[8:11], v32, s[24:27], s101 offen offset:2048 sc1
v_cvt_pk_bf16_f32 v13, v66, v67
v_cvt_pk_bf16_f32 v14, v68, v69
v_cvt_pk_bf16_f32 v15, v70, v71
s_waitcnt lgkmcnt(4)
v_mfma_f32_16x16x32_bf16 v[40:43], a[208:211], v[112:115], 0
ds_read_b64_tr_b16 a[228:229], v26 offset:37048
ds_read_b64_tr_b16 a[230:231], v26 offset:41656
v_accvgpr_write_b32 a96, v12
v_accvgpr_write_b32 a97, v13
v_cvt_pk_bf16_f32 v8, v72, v73
v_mfma_f32_16x16x32_bf16 v[44:47], a[208:211], v[116:119], 0
v_accvgpr_write_b32 a102, v14
v_accvgpr_write_b32 a103, v15
buffer_store_dwordx4 v[12:15], v32, s[24:27], s101 offen offset:3072 sc1
v_cvt_pk_bf16_f32 v9, v74, v75
v_cvt_pk_bf16_f32 v10, v76, v77
v_cvt_pk_bf16_f32 v11, v78, v79
v_mfma_f32_16x16x32_bf16 v[48:51], a[212:215], v[112:115], 0
ds_read_b64_tr_b16 a[232:233], v26 offset:37080
ds_read_b64_tr_b16 a[234:235], v26 offset:41688
v_accvgpr_write_b32 a104, v8
v_accvgpr_write_b32 a105, v9
v_cvt_pk_bf16_f32 v12, v80, v81
v_mfma_f32_16x16x32_bf16 v[52:55], a[212:215], v[116:119], 0
v_accvgpr_write_b32 a110, v10
v_accvgpr_write_b32 a111, v11
s_add_u32 s101, s100, 13312
buffer_store_dwordx4 v[8:11], v32, s[24:27], s101 offen offset:0 sc1
v_cvt_pk_bf16_f32 v13, v82, v83
v_cvt_pk_bf16_f32 v14, v84, v85
v_cvt_pk_bf16_f32 v15, v86, v87
v_mfma_f32_16x16x32_bf16 v[56:59], a[216:219], v[112:115], 0
ds_read_b64_tr_b16 a[236:237], v26 offset:37120
ds_read_b64_tr_b16 a[238:239], v26 offset:41728
v_accvgpr_write_b32 a112, v12
v_accvgpr_write_b32 a113, v13
v_cvt_pk_bf16_f32 v8, v88, v89
v_mfma_f32_16x16x32_bf16 v[60:63], a[216:219], v[116:119], 0
v_accvgpr_write_b32 a118, v14
v_accvgpr_write_b32 a119, v15
buffer_store_dwordx4 v[12:15], v32, s[24:27], s101 offen offset:1024 sc1
v_cvt_pk_bf16_f32 v9, v90, v91
v_cvt_pk_bf16_f32 v10, v92, v93
v_cvt_pk_bf16_f32 v11, v94, v95
s_waitcnt lgkmcnt(4)
v_mfma_f32_16x16x32_bf16 v[64:67], a[220:223], v[112:115], 0
ds_read_b64_tr_b16 a[240:241], v29 offset:36864
ds_read_b64_tr_b16 a[242:243], v29 offset:41472
v_accvgpr_write_b32 a120, v8
v_accvgpr_write_b32 a121, v9
v_cvt_pk_bf16_f32 v12, v96, v97
v_mfma_f32_16x16x32_bf16 v[68:71], a[220:223], v[116:119], 0
v_accvgpr_write_b32 a126, v10
v_accvgpr_write_b32 a127, v11
buffer_store_dwordx4 v[8:11], v32, s[24:27], s101 offen offset:2048 sc1
v_cvt_pk_bf16_f32 v13, v98, v99
v_cvt_pk_bf16_f32 v14, v100, v101
v_cvt_pk_bf16_f32 v15, v102, v103
v_mfma_f32_16x16x32_bf16 v[72:75], a[224:227], v[112:115], 0
ds_read_b64_tr_b16 a[244:245], v26 offset:46080
ds_read_b64_tr_b16 a[246:247], v26 offset:50688
v_accvgpr_write_b32 a128, v12
v_accvgpr_write_b32 a129, v13
v_cvt_pk_bf16_f32 v8, v104, v105
v_mfma_f32_16x16x32_bf16 v[76:79], a[224:227], v[116:119], 0
v_accvgpr_write_b32 a134, v14
v_accvgpr_write_b32 a135, v15
buffer_store_dwordx4 v[12:15], v32, s[24:27], s101 offen offset:3072 sc1
v_cvt_pk_bf16_f32 v9, v106, v107
v_cvt_pk_bf16_f32 v10, v108, v109
v_cvt_pk_bf16_f32 v11, v110, v111
v_mfma_f32_16x16x32_bf16 v[80:83], a[228:231], v[112:115], 0
ds_read_b64_tr_b16 a[248:249], v26 offset:46120
ds_read_b64_tr_b16 a[250:251], v26 offset:50728
v_accvgpr_write_b32 a136, v8
v_accvgpr_write_b32 a137, v9
v_mfma_f32_16x16x32_bf16 v[84:87], a[228:231], v[116:119], 0
v_accvgpr_write_b32 a142, v10
v_accvgpr_write_b32 a143, v11
s_add_u32 s101, s100, 17408
buffer_store_dwordx4 v[8:11], v32, s[24:27], s101 offen offset:0 sc1
s_waitcnt lgkmcnt(4)
v_mfma_f32_16x16x32_bf16 v[88:91], a[232:235], v[112:115], 0
ds_read_b64_tr_b16 a[252:253], v26 offset:46152
ds_read_b64_tr_b16 a[254:255], v26 offset:50760
v_mfma_f32_16x16x32_bf16 v[92:95], a[232:235], v[116:119], 0
s_add_u32 m0, s3, 129024
v_mfma_f32_16x16x32_bf16 v[96:99], a[236:239], v[112:115], 0
ds_read_b64_tr_b16 a[192:193], v26 offset:46192
ds_read_b64_tr_b16 a[194:195], v26 offset:50800
v_mfma_f32_16x16x32_bf16 v[100:103], a[236:239], v[116:119], 0
buffer_load_dwordx4 v16, s[16:19], s63 offen offset:0 lds
v_mfma_f32_16x16x32_bf16 v[104:107], a[240:243], v[112:115], 0
ds_read_b64_tr_b16 a[196:197], v26 offset:46224
ds_read_b64_tr_b16 a[198:199], v26 offset:50832
v_mfma_f32_16x16x32_bf16 v[108:111], a[240:243], v[116:119], 0
s_waitcnt lgkmcnt(4)
v_mfma_f32_16x16x32_bf16 v[40:43], a[244:247], v[120:123], v[40:43]
ds_read_b64_tr_b16 a[200:201], v26 offset:46264
ds_read_b64_tr_b16 a[202:203], v26 offset:50872
v_mfma_f32_16x16x32_bf16 v[44:47], a[244:247], v[124:127], v[44:47]
buffer_load_dwordx4 v17, s[16:19], s63 offen offset:1024 lds
v_mfma_f32_16x16x32_bf16 v[48:51], a[248:251], v[120:123], v[48:51]
ds_read_b64_tr_b16 a[204:205], v26 offset:46296
ds_read_b64_tr_b16 a[206:207], v26 offset:50904
v_mfma_f32_16x16x32_bf16 v[52:55], a[248:251], v[124:127], v[52:55]
buffer_load_dwordx4 v18, s[16:19], s63 offen offset:2048 lds
v_mfma_f32_16x16x32_bf16 v[56:59], a[252:255], v[120:123], v[56:59]
ds_read_b64_tr_b16 a[208:209], v26 offset:46336
ds_read_b64_tr_b16 a[210:211], v26 offset:50944
v_mfma_f32_16x16x32_bf16 v[60:63], a[252:255], v[124:127], v[60:63]
s_waitcnt lgkmcnt(4)
v_mfma_f32_16x16x32_bf16 v[64:67], a[192:195], v[120:123], v[64:67]
ds_read_b64_tr_b16 a[212:213], v29 offset:46080
ds_read_b64_tr_b16 a[214:215], v29 offset:50688
v_mfma_f32_16x16x32_bf16 v[68:71], a[192:195], v[124:127], v[68:71]
buffer_load_dwordx4 v19, s[16:19], s63 offen offset:3072 lds
v_mfma_f32_16x16x32_bf16 v[72:75], a[196:199], v[120:123], v[72:75]
ds_read_b64_tr_b16 a[216:217], v27 offset:0
ds_read_b64_tr_b16 a[218:219], v27 offset:4608
v_mfma_f32_16x16x32_bf16 v[76:79], a[196:199], v[124:127], v[76:79]
s_add_u32 m0, s3, 133120
v_mfma_f32_16x16x32_bf16 v[80:83], a[200:203], v[120:123], v[80:83]
ds_read_b64_tr_b16 a[220:221], v27 offset:40
ds_read_b64_tr_b16 a[222:223], v27 offset:4648
v_mfma_f32_16x16x32_bf16 v[84:87], a[200:203], v[124:127], v[84:87]
s_waitcnt vmcnt(32)
s_waitcnt lgkmcnt(4)
v_mfma_f32_16x16x32_bf16 v[88:91], a[204:207], v[120:123], v[88:91]
ds_read_b64_tr_b16 a[224:225], v27 offset:72
ds_read_b64_tr_b16 a[226:227], v27 offset:4680
v_mfma_f32_16x16x32_bf16 v[92:95], a[204:207], v[124:127], v[92:95]
buffer_load_dwordx4 v20, s[16:19], s63 offen lds
v_mfma_f32_16x16x32_bf16 v[96:99], a[208:211], v[120:123], v[96:99]
ds_read_b64_tr_b16 a[228:229], v27 offset:112
ds_read_b64_tr_b16 a[230:231], v27 offset:4720
v_mfma_f32_16x16x32_bf16 v[100:103], a[208:211], v[124:127], v[100:103]
s_add_u32 m0, s3, 0
v_and_b32 v5, 0xff, v7
v_mfma_f32_16x16x32_bf16 v[104:107], a[212:215], v[120:123], v[104:107]
ds_read_b64_tr_b16 a[232:233], v27 offset:144
ds_read_b64_tr_b16 a[234:235], v27 offset:4752
v_mfma_f32_16x16x32_bf16 v[108:111], a[212:215], v[124:127], v[108:111]
v_cmp_le_u32_e64 vcc, 4, v5
s_waitcnt lgkmcnt(4)
v_mfma_f32_16x16x32_bf16 v[40:43], a[216:219], v[128:131], v[40:43]
ds_read_b64_tr_b16 a[236:237], v27 offset:184
ds_read_b64_tr_b16 a[238:239], v27 offset:4792
s_and_b32 s96, vcc_lo, 0xff
s_cmp_eq_u32 s96, 0xff
s_cbranch_scc0 L_aslowH
L_abackH:
v_mfma_f32_16x16x32_bf16 v[44:47], a[216:219], v[132:135], v[44:47]
buffer_load_dwordx4 v16, s[16:19], s64 offen offset:0 lds
v_mfma_f32_16x16x32_bf16 v[48:51], a[220:223], v[128:131], v[48:51]
ds_read_b64_tr_b16 a[240:241], v27 offset:216
ds_read_b64_tr_b16 a[242:243], v27 offset:4824
v_mfma_f32_16x16x32_bf16 v[52:55], a[220:223], v[132:135], v[52:55]
buffer_load_dwordx4 v17, s[16:19], s64 offen offset:1024 lds
v_mfma_f32_16x16x32_bf16 v[56:59], a[224:227], v[128:131], v[56:59]
ds_read_b64_tr_b16 a[244:245], v27 offset:256
ds_read_b64_tr_b16 a[246:247], v27 offset:4864
v_mfma_f32_16x16x32_bf16 v[60:63], a[224:227], v[132:135], v[60:63]
v_lshrrev_b32_e64 v7, 24, v7
s_waitcnt lgkmcnt(4)
v_mfma_f32_16x16x32_bf16 v[64:67], a[228:231], v[128:131], v[64:67]
ds_read_b64_tr_b16 a[248:249], v30 offset:0
ds_read_b64_tr_b16 a[250:251], v30 offset:4608
v_mfma_f32_16x16x32_bf16 v[68:71], a[228:231], v[132:135], v[68:71]
buffer_load_dwordx4 v18, s[16:19], s64 offen offset:2048 lds
v_mfma_f32_16x16x32_bf16 v[72:75], a[232:235], v[128:131], v[72:75]
ds_read_b64_tr_b16 a[252:253], v27 offset:9216
ds_read_b64_tr_b16 a[254:255], v27 offset:13824
v_mfma_f32_16x16x32_bf16 v[76:79], a[232:235], v[132:135], v[76:79]
v_readfirstlane_b32 s96, v7
v_mfma_f32_16x16x32_bf16 v[80:83], a[236:239], v[128:131], v[80:83]
ds_read_b64_tr_b16 a[192:193], v27 offset:9256
ds_read_b64_tr_b16 a[194:195], v27 offset:13864
v_mfma_f32_16x16x32_bf16 v[84:87], a[236:239], v[132:135], v[84:87]
s_waitcnt lgkmcnt(4)
v_mfma_f32_16x16x32_bf16 v[88:91], a[240:243], v[128:131], v[88:91]
ds_read_b64_tr_b16 a[196:197], v27 offset:9288
ds_read_b64_tr_b16 a[198:199], v27 offset:13896
v_mfma_f32_16x16x32_bf16 v[92:95], a[240:243], v[132:135], v[92:95]
buffer_load_dwordx4 v19, s[16:19], s64 offen offset:3072 lds
v_mfma_f32_16x16x32_bf16 v[96:99], a[244:247], v[128:131], v[96:99]
ds_read_b64_tr_b16 a[200:201], v27 offset:9328
ds_read_b64_tr_b16 a[202:203], v27 offset:13936
v_mfma_f32_16x16x32_bf16 v[100:103], a[244:247], v[132:135], v[100:103]
v_cmp_ne_u32_e64 vcc, s96, v7
v_mfma_f32_16x16x32_bf16 v[104:107], a[248:251], v[128:131], v[104:107]
ds_read_b64_tr_b16 a[204:205], v27 offset:9360
ds_read_b64_tr_b16 a[206:207], v27 offset:13968
v_mfma_f32_16x16x32_bf16 v[108:111], a[248:251], v[132:135], v[108:111]
s_add_u32 m0, s3, 4096
s_waitcnt lgkmcnt(4)
v_mfma_f32_16x16x32_bf16 v[40:43], a[252:255], v[136:139], v[40:43]
ds_read_b64_tr_b16 a[208:209], v27 offset:9400
ds_read_b64_tr_b16 a[210:211], v27 offset:14008
s_and_b32 s96, vcc_lo, 15
s_cselect_b32 s46, 0, 1
v_mfma_f32_16x16x32_bf16 v[44:47], a[252:255], v[140:143], v[44:47]
v_mfma_f32_16x16x32_bf16 v[48:51], a[192:195], v[136:139], v[48:51]
ds_read_b64_tr_b16 a[212:213], v27 offset:9432
ds_read_b64_tr_b16 a[214:215], v27 offset:14040
v_mfma_f32_16x16x32_bf16 v[52:55], a[192:195], v[140:143], v[52:55]
buffer_load_dwordx4 v20, s[16:19], s64 offen lds
v_mfma_f32_16x16x32_bf16 v[56:59], a[196:199], v[136:139], v[56:59]
ds_read_b64_tr_b16 a[216:217], v27 offset:9472
ds_read_b64_tr_b16 a[218:219], v27 offset:14080
v_mfma_f32_16x16x32_bf16 v[60:63], a[196:199], v[140:143], v[60:63]
s_waitcnt lgkmcnt(4)
v_mfma_f32_16x16x32_bf16 v[64:67], a[200:203], v[136:139], v[64:67]
ds_read_b64_tr_b16 a[220:221], v30 offset:9216
ds_read_b64_tr_b16 a[222:223], v30 offset:13824
v_mfma_f32_16x16x32_bf16 v[68:71], a[200:203], v[140:143], v[68:71]
v_mfma_f32_16x16x32_bf16 v[72:75], a[204:207], v[136:139], v[72:75]
s_waitcnt vmcnt(25)
s_barrier
v_mfma_f32_16x16x32_bf16 v[76:79], a[204:207], v[140:143], v[76:79]
ds_read_b64_tr_b16 a[224:225], v27 offset:18432
ds_read_b64_tr_b16 a[226:227], v27 offset:23040
v_mfma_f32_16x16x32_bf16 v[80:83], a[208:211], v[136:139], v[80:83]
ds_read_b64_tr_b16 a[228:229], v27 offset:18472
ds_read_b64_tr_b16 a[230:231], v27 offset:23080
v_mfma_f32_16x16x32_bf16 v[84:87], a[208:211], v[140:143], v[84:87]
s_add_u32 m0, s3, 18432
s_waitcnt lgkmcnt(4)
v_mfma_f32_16x16x32_bf16 v[88:91], a[212:215], v[136:139], v[88:91]
ds_read_b64_tr_b16 a[232:233], v27 offset:18504
ds_read_b64_tr_b16 a[234:235], v27 offset:23112
v_mfma_f32_16x16x32_bf16 v[92:95], a[212:215], v[140:143], v[92:95]
buffer_load_dwordx4 v16, s[16:19], s65 offen offset:0 lds
v_mfma_f32_16x16x32_bf16 v[96:99], a[216:219], v[136:139], v[96:99]
ds_read_b64_tr_b16 a[236:237], v27 offset:18544
ds_read_b64_tr_b16 a[238:239], v27 offset:23152
v_mfma_f32_16x16x32_bf16 v[100:103], a[216:219], v[140:143], v[100:103]
s_or_b32 s98, s32, s34
s_min_u32 s98, s98, 1
v_mfma_f32_16x16x32_bf16 v[104:107], a[220:223], v[136:139], v[104:107]
ds_read_b64_tr_b16 a[240:241], v27 offset:18576
ds_read_b64_tr_b16 a[242:243], v27 offset:23184
v_mfma_f32_16x16x32_bf16 v[108:111], a[220:223], v[140:143], v[108:111]
s_mul_i32 s98, s98, -90
s_waitcnt lgkmcnt(4)
v_mfma_f32_16x16x32_bf16 v[40:43], a[224:227], v[144:147], v[40:43]
ds_read_b64_tr_b16 a[244:245], v27 offset:18616
ds_read_b64_tr_b16 a[246:247], v27 offset:23224
v_mfma_f32_16x16x32_bf16 v[44:47], a[224:227], v[148:151], v[44:47]
buffer_load_dwordx4 v17, s[16:19], s65 offen offset:1024 lds
v_mfma_f32_16x16x32_bf16 v[48:51], a[228:231], v[144:147], v[48:51]
ds_read_b64_tr_b16 a[248:249], v27 offset:18648
ds_read_b64_tr_b16 a[250:251], v27 offset:23256
v_mfma_f32_16x16x32_bf16 v[52:55], a[228:231], v[148:151], v[52:55]
s_add_u32 s98, s98, 99
v_and_b32_e64 v34, 15, v0
buffer_load_dword v33, v1, s[24:27], 0 offen sc1
v_mfma_f32_16x16x32_bf16 v[56:59], a[232:235], v[144:147], v[56:59]
ds_read_b64_tr_b16 a[252:253], v27 offset:18688
ds_read_b64_tr_b16 a[254:255], v27 offset:23296
v_mfma_f32_16x16x32_bf16 v[60:63], a[232:235], v[148:151], v[60:63]
v_lshrrev_b32 v35, 4, v0
s_waitcnt lgkmcnt(4)
v_mfma_f32_16x16x32_bf16 v[64:67], a[236:239], v[144:147], v[64:67]
ds_read_b64_tr_b16 a[192:193], v30 offset:18432
ds_read_b64_tr_b16 a[194:195], v30 offset:23040
v_mfma_f32_16x16x32_bf16 v[68:71], a[236:239], v[148:151], v[68:71]
buffer_load_dwordx4 v18, s[16:19], s65 offen offset:2048 lds
v_mfma_f32_16x16x32_bf16 v[72:75], a[240:243], v[144:147], v[72:75]
ds_read_b64_tr_b16 a[196:197], v27 offset:27648
ds_read_b64_tr_b16 a[198:199], v27 offset:32256
v_mfma_f32_16x16x32_bf16 v[76:79], a[240:243], v[148:151], v[76:79]
v_cmp_eq_u32 s[50:51], 0, v35
v_cmp_eq_u32 s[52:53], 1, v35
v_mfma_f32_16x16x32_bf16 v[80:83], a[244:247], v[144:147], v[80:83]
ds_read_b64_tr_b16 a[200:201], v27 offset:27688
ds_read_b64_tr_b16 a[202:203], v27 offset:32296
v_mfma_f32_16x16x32_bf16 v[84:87], a[244:247], v[148:151], v[84:87]
v_cmp_eq_u32 s[54:55], 2, v35
s_waitcnt lgkmcnt(4)
v_mfma_f32_16x16x32_bf16 v[88:91], a[248:251], v[144:147], v[88:91]
ds_read_b64_tr_b16 a[204:205], v27 offset:27720
ds_read_b64_tr_b16 a[206:207], v27 offset:32328
v_mfma_f32_16x16x32_bf16 v[92:95], a[248:251], v[148:151], v[92:95]
buffer_load_dwordx4 v19, s[16:19], s65 offen offset:3072 lds
v_mfma_f32_16x16x32_bf16 v[96:99], a[252:255], v[144:147], v[96:99]
ds_read_b64_tr_b16 a[208:209], v27 offset:27760
ds_read_b64_tr_b16 a[210:211], v27 offset:32368
v_mfma_f32_16x16x32_bf16 v[100:103], a[252:255], v[148:151], v[100:103]
v_cmp_eq_u32 s[56:57], 3, v35
v_lshlrev_b32 v35, 2, v35
v_mfma_f32_16x16x32_bf16 v[104:107], a[192:195], v[144:147], v[104:107]
ds_read_b64_tr_b16 a[212:213], v27 offset:27792
ds_read_b64_tr_b16 a[214:215], v27 offset:32400
v_mfma_f32_16x16x32_bf16 v[108:111], a[192:195], v[148:151], v[108:111]
s_add_u32 m0, s3, 22528
s_waitcnt lgkmcnt(4)
v_mfma_f32_16x16x32_bf16 v[40:43], a[196:199], v[152:155], v[40:43]
ds_read_b64_tr_b16 a[216:217], v27 offset:27832
ds_read_b64_tr_b16 a[218:219], v27 offset:32440
v_mfma_f32_16x16x32_bf16 v[44:47], a[196:199], v[156:159], v[44:47]
v_sub_u32 v35, v35, v34
v_add_u32_e64 v35, 7, v35
v_mfma_f32_16x16x32_bf16 v[48:51], a[200:203], v[152:155], v[48:51]
ds_read_b64_tr_b16 a[220:221], v27 offset:27864
ds_read_b64_tr_b16 a[222:223], v27 offset:32472
v_mfma_f32_16x16x32_bf16 v[52:55], a[200:203], v[156:159], v[52:55]
buffer_load_dwordx4 v20, s[16:19], s65 offen lds
v_mfma_f32_16x16x32_bf16 v[56:59], a[204:207], v[152:155], v[56:59]
ds_read_b64_tr_b16 a[224:225], v27 offset:27904
ds_read_b64_tr_b16 a[226:227], v27 offset:32512
v_mfma_f32_16x16x32_bf16 v[60:63], a[204:207], v[156:159], v[60:63]
v_mov_b32 v36, 0xff7f0000
s_waitcnt lgkmcnt(4)
v_mfma_f32_16x16x32_bf16 v[64:67], a[208:211], v[152:155], v[64:67]
ds_read_b64_tr_b16 a[228:229], v30 offset:27648
ds_read_b64_tr_b16 a[230:231], v30 offset:32256
v_mfma_f32_16x16x32_bf16 v[68:71], a[208:211], v[156:159], v[68:71]
v_mov_b32 v2, 0xffff
v_mov_b32 v3, 0xffff0000
v_mfma_f32_16x16x32_bf16 v[72:75], a[212:215], v[152:155], v[72:75]
ds_read_b64_tr_b16 a[232:233], v27 offset:36864
ds_read_b64_tr_b16 a[234:235], v27 offset:41472
v_mfma_f32_16x16x32_bf16 v[76:79], a[212:215], v[156:159], v[76:79]
s_add_u32 m0, s3, 36864
s_add_u32 s98, s98, 7
v_mfma_f32_16x16x32_bf16 v[80:83], a[216:219], v[152:155], v[80:83]
ds_read_b64_tr_b16 a[236:237], v27 offset:36904
ds_read_b64_tr_b16 a[238:239], v27 offset:41512
v_mfma_f32_16x16x32_bf16 v[84:87], a[216:219], v[156:159], v[84:87]
v_add_u32 v34, 0, v35
s_waitcnt lgkmcnt(4)
v_mfma_f32_16x16x32_bf16 v[88:91], a[220:223], v[152:155], v[88:91]
ds_read_b64_tr_b16 a[240:241], v27 offset:36936
ds_read_b64_tr_b16 a[242:243], v27 offset:41544
v_mfma_f32_16x16x32_bf16 v[92:95], a[220:223], v[156:159], v[92:95]
buffer_load_dwordx4 v16, s[16:19], s66 offen offset:0 lds
v_mfma_f32_16x16x32_bf16 v[96:99], a[224:227], v[152:155], v[96:99]
ds_read_b64_tr_b16 a[244:245], v27 offset:36976
ds_read_b64_tr_b16 a[246:247], v27 offset:41584
v_mfma_f32_16x16x32_bf16 v[100:103], a[224:227], v[156:159], v[100:103]
v_cmp_gt_u32_e64 vcc, 8, v34
v_cmp_le_i32 s[96:97], s98, v34
v_mfma_f32_16x16x32_bf16 v[104:107], a[228:231], v[152:155], v[104:107]
ds_read_b64_tr_b16 a[248:249], v27 offset:37008
ds_read_b64_tr_b16 a[250:251], v27 offset:41616
v_mfma_f32_16x16x32_bf16 v[108:111], a[228:231], v[156:159], v[108:111]
v_cndmask_b32 v4, v36, 0, vcc
s_waitcnt lgkmcnt(4)
v_mfma_f32_16x16x32_bf16 v[40:43], a[232:235], v[160:163], v[40:43]
ds_read_b64_tr_b16 a[252:253], v27 offset:37048
ds_read_b64_tr_b16 a[254:255], v27 offset:41656
v_mfma_f32_16x16x32_bf16 v[44:47], a[232:235], v[164:167], v[44:47]
buffer_load_dwordx4 v17, s[16:19], s66 offen offset:1024 lds
v_mfma_f32_16x16x32_bf16 v[48:51], a[236:239], v[160:163], v[48:51]
ds_read_b64_tr_b16 a[192:193], v27 offset:37080
ds_read_b64_tr_b16 a[194:195], v27 offset:41688
v_mfma_f32_16x16x32_bf16 v[52:55], a[236:239], v[164:167], v[52:55]
v_cndmask_b32 v37, 0, v2, vcc
v_mov_b32_e64 v12, v37
v_mfma_f32_16x16x32_bf16 v[56:59], a[240:243], v[160:163], v[56:59]
ds_read_b64_tr_b16 a[196:197], v27 offset:37120
ds_read_b64_tr_b16 a[198:199], v27 offset:41728
v_mfma_f32_16x16x32_bf16 v[60:63], a[240:243], v[164:167], v[60:63]
v_cndmask_b32 v8, v36, 0, s[96:97]
s_waitcnt lgkmcnt(4)
v_mfma_f32_16x16x32_bf16 v[64:67], a[244:247], v[160:163], v[64:67]
ds_read_b64_tr_b16 a[200:201], v30 offset:36864
ds_read_b64_tr_b16 a[202:203], v30 offset:41472
v_mfma_f32_16x16x32_bf16 v[68:71], a[244:247], v[164:167], v[68:71]
buffer_load_dwordx4 v18, s[16:19], s66 offen offset:2048 lds
v_mfma_f32_16x16x32_bf16 v[72:75], a[248:251], v[160:163], v[72:75]
ds_read_b64_tr_b16 a[204:205], v27 offset:46080
ds_read_b64_tr_b16 a[206:207], v27 offset:50688
v_mfma_f32_16x16x32_bf16 v[76:79], a[248:251], v[164:167], v[76:79]
v_cndmask_b32 v37, 0, v2, s[96:97]
v_mov_b32 v14, v37
v_mfma_f32_16x16x32_bf16 v[80:83], a[252:255], v[160:163], v[80:83]
ds_read_b64_tr_b16 a[208:209], v27 offset:46120
ds_read_b64_tr_b16 a[210:211], v27 offset:50728
v_mfma_f32_16x16x32_bf16 v[84:87], a[252:255], v[164:167], v[84:87]
v_add_u32 v34, 1, v35
s_waitcnt lgkmcnt(4)
v_mfma_f32_16x16x32_bf16 v[88:91], a[192:195], v[160:163], v[88:91]
ds_read_b64_tr_b16 a[212:213], v27 offset:46152
ds_read_b64_tr_b16 a[214:215], v27 offset:50760
v_mfma_f32_16x16x32_bf16 v[92:95], a[192:195], v[164:167], v[92:95]
buffer_load_dwordx4 v19, s[16:19], s66 offen offset:3072 lds
v_mfma_f32_16x16x32_bf16 v[96:99], a[196:199], v[160:163], v[96:99]
ds_read_b64_tr_b16 a[216:217], v27 offset:46192
ds_read_b64_tr_b16 a[218:219], v27 offset:50800
v_mfma_f32_16x16x32_bf16 v[100:103], a[196:199], v[164:167], v[100:103]
v_cmp_gt_u32_e64 vcc, 8, v34
v_cmp_le_i32 s[96:97], s98, v34
v_mfma_f32_16x16x32_bf16 v[104:107], a[200:203], v[160:163], v[104:107]
ds_read_b64_tr_b16 a[220:221], v27 offset:46224
ds_read_b64_tr_b16 a[222:223], v27 offset:50832
v_mfma_f32_16x16x32_bf16 v[108:111], a[200:203], v[164:167], v[108:111]
s_add_u32 m0, s3, 40960
s_waitcnt lgkmcnt(4)
v_mfma_f32_16x16x32_bf16 v[40:43], a[204:207], v[168:171], v[40:43]
ds_read_b64_tr_b16 a[224:225], v27 offset:46264
ds_read_b64_tr_b16 a[226:227], v27 offset:50872
v_mfma_f32_16x16x32_bf16 v[44:47], a[204:207], v[172:175], v[44:47]
v_cndmask_b32 v5, v36, 0, vcc
v_cndmask_b32 v37, 0, v3, vcc
v_mfma_f32_16x16x32_bf16 v[48:51], a[208:211], v[168:171], v[48:51]
ds_read_b64_tr_b16 a[228:229], v27 offset:46296
ds_read_b64_tr_b16 a[230:231], v27 offset:50904
v_mfma_f32_16x16x32_bf16 v[52:55], a[208:211], v[172:175], v[52:55]
buffer_load_dwordx4 v20, s[16:19], s66 offen lds
v_mfma_f32_16x16x32_bf16 v[56:59], a[212:215], v[168:171], v[56:59]
ds_read_b64_tr_b16 a[232:233], v27 offset:46336
ds_read_b64_tr_b16 a[234:235], v27 offset:50944
v_mfma_f32_16x16x32_bf16 v[60:63], a[212:215], v[172:175], v[60:63]
v_or_b32 v12, v12, v37
s_waitcnt lgkmcnt(4)
v_mfma_f32_16x16x32_bf16 v[64:67], a[216:219], v[168:171], v[64:67]
ds_read_b64_tr_b16 a[236:237], v30 offset:46080
ds_read_b64_tr_b16 a[238:239], v30 offset:50688
v_mfma_f32_16x16x32_bf16 v[68:71], a[216:219], v[172:175], v[68:71]
v_cndmask_b32 v9, v36, 0, s[96:97]
v_cndmask_b32 v37, 0, v3, s[96:97]
v_mfma_f32_16x16x32_bf16 v[72:75], a[220:223], v[168:171], v[72:75]
s_waitcnt vmcnt(16)
s_waitcnt vmcnt(21)
s_barrier
v_mfma_f32_16x16x32_bf16 v[76:79], a[220:223], v[172:175], v[76:79]
ds_read_b64_tr_b16 a[240:241], v28 offset:0
ds_read_b64_tr_b16 a[242:243], v28 offset:4608
v_mfma_f32_16x16x32_bf16 v[80:83], a[224:227], v[168:171], v[80:83]
ds_read_b64_tr_b16 a[244:245], v28 offset:40
ds_read_b64_tr_b16 a[246:247], v28 offset:4648
v_mfma_f32_16x16x32_bf16 v[84:87], a[224:227], v[172:175], v[84:87]
s_add_u32 m0, s3, 55296
s_waitcnt lgkmcnt(4)
v_mfma_f32_16x16x32_bf16 v[88:91], a[228:231], v[168:171], v[88:91]
ds_read_b64_tr_b16 a[248:249], v28 offset:72
ds_read_b64_tr_b16 a[250:251], v28 offset:4680
v_mfma_f32_16x16x32_bf16 v[92:95], a[228:231], v[172:175], v[92:95]
buffer_load_dwordx4 v21, s[20:23], s67 offen offset:0 lds
v_mfma_f32_16x16x32_bf16 v[96:99], a[232:235], v[168:171], v[96:99]
ds_read_b64_tr_b16 a[252:253], v28 offset:112
ds_read_b64_tr_b16 a[254:255], v28 offset:4720
v_mfma_f32_16x16x32_bf16 v[100:103], a[232:235], v[172:175], v[100:103]
buffer_store_dword v38, v39, s[24:27], 0 offen sc1
v_mfma_f32_16x16x32_bf16 v[104:107], a[236:239], v[168:171], v[104:107]
ds_read_b64_tr_b16 a[192:193], v28 offset:144
ds_read_b64_tr_b16 a[194:195], v28 offset:4752
v_mfma_f32_16x16x32_bf16 v[108:111], a[236:239], v[172:175], v[108:111]
v_or_b32 v14, v14, v37
s_waitcnt lgkmcnt(4)
v_mfma_f32_16x16x32_bf16 v[40:43], a[240:243], v[176:179], v[40:43]
ds_read_b64_tr_b16 a[196:197], v28 offset:184
ds_read_b64_tr_b16 a[198:199], v28 offset:4792
v_mfma_f32_16x16x32_bf16 v[44:47], a[240:243], v[180:183], v[44:47]
buffer_load_dwordx4 v22, s[20:23], s67 offen offset:1024 lds
v_mfma_f32_16x16x32_bf16 v[48:51], a[244:247], v[176:179], v[48:51]
ds_read_b64_tr_b16 a[200:201], v28 offset:216
ds_read_b64_tr_b16 a[202:203], v28 offset:4824
v_mfma_f32_16x16x32_bf16 v[52:55], a[244:247], v[180:183], v[52:55]
v_add_u32 v34, 2, v35
v_cmp_gt_u32 vcc, 8, v34
v_mfma_f32_16x16x32_bf16 v[56:59], a[248:251], v[176:179], v[56:59]
ds_read_b64_tr_b16 a[204:205], v28 offset:256
ds_read_b64_tr_b16 a[206:207], v28 offset:4864
v_mfma_f32_16x16x32_bf16 v[60:63], a[248:251], v[180:183], v[60:63]
v_cmp_le_i32 s[96:97], s98, v34
s_waitcnt lgkmcnt(4)
v_mfma_f32_16x16x32_bf16 v[64:67], a[252:255], v[176:179], v[64:67]
ds_read_b64_tr_b16 a[208:209], v31 offset:0
ds_read_b64_tr_b16 a[210:211], v31 offset:4608
v_mfma_f32_16x16x32_bf16 v[68:71], a[252:255], v[180:183], v[68:71]
buffer_load_dwordx4 v23, s[20:23], s67 offen offset:2048 lds
v_mfma_f32_16x16x32_bf16 v[72:75], a[192:195], v[176:179], v[72:75]
ds_read_b64_tr_b16 a[212:213], v28 offset:9216
ds_read_b64_tr_b16 a[214:215], v28 offset:13824
v_mfma_f32_16x16x32_bf16 v[76:79], a[192:195], v[180:183], v[76:79]
v_cndmask_b32 v6, v36, 0, vcc
v_cndmask_b32 v37, 0, v2, vcc
v_mfma_f32_16x16x32_bf16 v[80:83], a[196:199], v[176:179], v[80:83]
ds_read_b64_tr_b16 a[216:217], v28 offset:9256
ds_read_b64_tr_b16 a[218:219], v28 offset:13864
v_mfma_f32_16x16x32_bf16 v[84:87], a[196:199], v[180:183], v[84:87]
v_mov_b32 v13, v37
s_waitcnt lgkmcnt(4)
v_mfma_f32_16x16x32_bf16 v[88:91], a[200:203], v[176:179], v[88:91]
ds_read_b64_tr_b16 a[220:221], v28 offset:9288
ds_read_b64_tr_b16 a[222:223], v28 offset:13896
v_mfma_f32_16x16x32_bf16 v[92:95], a[200:203], v[180:183], v[92:95]
buffer_load_dwordx4 v24, s[20:23], s67 offen offset:3072 lds
v_mfma_f32_16x16x32_bf16 v[96:99], a[204:207], v[176:179], v[96:99]
ds_read_b64_tr_b16 a[224:225], v28 offset:9328
ds_read_b64_tr_b16 a[226:227], v28 offset:13936
v_mfma_f32_16x16x32_bf16 v[100:103], a[204:207], v[180:183], v[100:103]
v_cndmask_b32 v10, v36, 0, s[96:97]
v_cndmask_b32 v37, 0, v2, s[96:97]
v_mfma_f32_16x16x32_bf16 v[104:107], a[208:211], v[176:179], v[104:107]
ds_read_b64_tr_b16 a[228:229], v28 offset:9360
ds_read_b64_tr_b16 a[230:231], v28 offset:13968
v_mfma_f32_16x16x32_bf16 v[108:111], a[208:211], v[180:183], v[108:111]
s_add_u32 m0, s3, 59392
s_waitcnt lgkmcnt(4)
v_mfma_f32_16x16x32_bf16 v[40:43], a[212:215], v[184:187], v[40:43]
ds_read_b64_tr_b16 a[232:233], v28 offset:9400
ds_read_b64_tr_b16 a[234:235], v28 offset:14008
v_mfma_f32_16x16x32_bf16 v[44:47], a[212:215], v[188:191], v[44:47]
buffer_load_dwordx4 v25, s[20:23], s67 offen lds
v_mfma_f32_16x16x32_bf16 v[48:51], a[216:219], v[184:187], v[48:51]
ds_read_b64_tr_b16 a[236:237], v28 offset:9432
ds_read_b64_tr_b16 a[238:239], v28 offset:14040
v_mfma_f32_16x16x32_bf16 v[52:55], a[216:219], v[188:191], v[52:55]
v_mov_b32 v15, v37
v_add_u32_e64 v34, 3, v35
v_mfma_f32_16x16x32_bf16 v[56:59], a[220:223], v[184:187], v[56:59]
ds_read_b64_tr_b16 a[240:241], v28 offset:9472
ds_read_b64_tr_b16 a[242:243], v28 offset:14080
v_mfma_f32_16x16x32_bf16 v[60:63], a[220:223], v[188:191], v[60:63]
v_cmp_gt_u32 vcc, 8, v34
s_waitcnt lgkmcnt(4)
v_mfma_f32_16x16x32_bf16 v[64:67], a[224:227], v[184:187], v[64:67]
ds_read_b64_tr_b16 a[244:245], v31 offset:9216
ds_read_b64_tr_b16 a[246:247], v31 offset:13824
v_mfma_f32_16x16x32_bf16 v[68:71], a[224:227], v[188:191], v[68:71]
s_add_u32 m0, s3, 73728
v_cmp_le_i32 s[96:97], s98, v34
v_mfma_f32_16x16x32_bf16 v[72:75], a[228:231], v[184:187], v[72:75]
ds_read_b64_tr_b16 a[248:249], v28 offset:18432
ds_read_b64_tr_b16 a[250:251], v28 offset:23040
v_mfma_f32_16x16x32_bf16 v[76:79], a[228:231], v[188:191], v[76:79]
s_add_u32 s10, s67, 82944
v_cndmask_b32 v7, v36, 0, vcc
v_mfma_f32_16x16x32_bf16 v[80:83], a[232:235], v[184:187], v[80:83]
ds_read_b64_tr_b16 a[252:253], v28 offset:18472
ds_read_b64_tr_b16 a[254:255], v28 offset:23080
v_mfma_f32_16x16x32_bf16 v[84:87], a[232:235], v[188:191], v[84:87]
v_cndmask_b32 v37, 0, v3, vcc
s_waitcnt lgkmcnt(4)
v_mfma_f32_16x16x32_bf16 v[88:91], a[236:239], v[184:187], v[88:91]
ds_read_b64_tr_b16 a[192:193], v28 offset:18504
ds_read_b64_tr_b16 a[194:195], v28 offset:23112
v_mfma_f32_16x16x32_bf16 v[92:95], a[236:239], v[188:191], v[92:95]
buffer_load_dwordx4 v21, s[20:23], s10 offen offset:0 lds
s_waitcnt vmcnt(15)
v_mfma_f32_16x16x32_bf16 v[96:99], a[240:243], v[184:187], v[96:99]
ds_read_b64_tr_b16 a[196:197], v28 offset:18544
ds_read_b64_tr_b16 a[198:199], v28 offset:23152
v_mfma_f32_16x16x32_bf16 v[100:103], a[240:243], v[188:191], v[100:103]
v_or_b32 v13, v13, v37
v_cndmask_b32 v11, v36, 0, s[96:97]
v_mfma_f32_16x16x32_bf16 v[104:107], a[244:247], v[184:187], v[104:107]
ds_read_b64_tr_b16 a[200:201], v28 offset:18576
ds_read_b64_tr_b16 a[202:203], v28 offset:23184
v_mfma_f32_16x16x32_bf16 v[108:111], a[244:247], v[188:191], v[108:111]
v_cndmask_b32 v37, 0, v3, s[96:97]
s_waitcnt lgkmcnt(4)
v_mfma_f32_16x16x32_bf16 v[40:43], a[248:251], v[192:195], v[40:43]
ds_read_b64_tr_b16 a[204:205], v28 offset:18616
ds_read_b64_tr_b16 a[206:207], v28 offset:23224
v_mfma_f32_16x16x32_bf16 v[44:47], a[248:251], v[196:199], v[44:47]
buffer_load_dwordx4 v22, s[20:23], s10 offen offset:1024 lds
v_readfirstlane_b32 s11, v33
v_mfma_f32_16x16x32_bf16 v[48:51], a[252:255], v[192:195], v[48:51]
ds_read_b64_tr_b16 a[208:209], v28 offset:18648
ds_read_b64_tr_b16 a[210:211], v28 offset:23256
s_or_b32 s11, s11, s9
s_cmp_lt_u32 s11, 1
s_cbranch_scc1 L_hslowK
L_hbackK:
v_mfma_f32_16x16x32_bf16 v[52:55], a[252:255], v[196:199], v[52:55]
v_or_b32 v15, v15, v37
s_mov_b32 s99, 0x3eae1a93
v_mfma_f32_16x16x32_bf16 v[56:59], a[192:195], v[192:195], v[56:59]
ds_read_b64_tr_b16 a[212:213], v28 offset:18688
ds_read_b64_tr_b16 a[214:215], v28 offset:23296
v_mfma_f32_16x16x32_bf16 v[60:63], a[192:195], v[196:199], v[60:63]
v_mov_b32 v2, 0x3f803f80
s_waitcnt lgkmcnt(4)
v_mfma_f32_16x16x32_bf16 v[64:67], a[196:199], v[192:195], v[64:67]
ds_read_b64_tr_b16 a[216:217], v31 offset:18432
ds_read_b64_tr_b16 a[218:219], v31 offset:23040
v_mfma_f32_16x16x32_bf16 v[68:71], a[196:199], v[196:199], v[68:71]
buffer_load_dwordx4 v23, s[20:23], s10 offen offset:2048 lds
v_mfma_f32_16x16x32_bf16 v[72:75], a[200:203], v[192:195], v[72:75]
ds_read_b64_tr_b16 a[220:221], v28 offset:27648
ds_read_b64_tr_b16 a[222:223], v28 offset:32256
v_mfma_f32_16x16x32_bf16 v[76:79], a[200:203], v[196:199], v[76:79]
v_mov_b32 v3, 0x3f803f80
s_add_u32 s101, s8, 0
v_mfma_f32_16x16x32_bf16 v[80:83], a[204:207], v[192:195], v[80:83]
ds_read_b64_tr_b16 a[224:225], v28 offset:27688
ds_read_b64_tr_b16 a[226:227], v28 offset:32296
v_mfma_f32_16x16x32_bf16 v[84:87], a[204:207], v[196:199], v[84:87]
s_waitcnt lgkmcnt(4)
v_mfma_f32_16x16x32_bf16 v[88:91], a[208:211], v[192:195], v[88:91]
ds_read_b64_tr_b16 a[228:229], v28 offset:27720
ds_read_b64_tr_b16 a[230:231], v28 offset:32328
v_mfma_f32_16x16x32_bf16 v[92:95], a[208:211], v[196:199], v[92:95]
buffer_load_dwordx4 v24, s[20:23], s10 offen offset:3072 lds
v_mfma_f32_16x16x32_bf16 v[96:99], a[212:215], v[192:195], v[96:99]
ds_read_b64_tr_b16 a[232:233], v28 offset:27760
ds_read_b64_tr_b16 a[234:235], v28 offset:32368
v_mfma_f32_16x16x32_bf16 v[100:103], a[212:215], v[196:199], v[100:103]
buffer_load_dwordx4 a[36:39], v32, s[24:27], s101 offen offset:0 sc1
v_mfma_f32_16x16x32_bf16 v[104:107], a[216:219], v[192:195], v[104:107]
ds_read_b64_tr_b16 a[236:237], v28 offset:27792
ds_read_b64_tr_b16 a[238:239], v28 offset:32400
v_mfma_f32_16x16x32_bf16 v[108:111], a[216:219], v[196:199], v[108:111]
s_add_u32 m0, s3, 77824
s_waitcnt lgkmcnt(4)
v_mfma_f32_16x16x32_bf16 v[40:43], a[220:223], v[200:203], v[40:43]
ds_read_b64_tr_b16 a[240:241], v28 offset:27832
ds_read_b64_tr_b16 a[242:243], v28 offset:32440
v_mfma_f32_16x16x32_bf16 v[44:47], a[220:223], v[204:207], v[44:47]
buffer_load_dwordx4 a[40:43], v32, s[24:27], s101 offen offset:1024 sc1
v_mfma_f32_16x16x32_bf16 v[48:51], a[224:227], v[200:203], v[48:51]
ds_read_b64_tr_b16 a[244:245], v28 offset:27864
ds_read_b64_tr_b16 a[246:247], v28 offset:32472
v_mfma_f32_16x16x32_bf16 v[52:55], a[224:227], v[204:207], v[52:55]
buffer_load_dwordx4 v25, s[20:23], s10 offen lds
v_mfma_f32_16x16x32_bf16 v[56:59], a[228:231], v[200:203], v[56:59]
ds_read_b64_tr_b16 a[248:249], v28 offset:27904
ds_read_b64_tr_b16 a[250:251], v28 offset:32512
v_mfma_f32_16x16x32_bf16 v[60:63], a[228:231], v[204:207], v[60:63]
s_waitcnt lgkmcnt(4)
v_mfma_f32_16x16x32_bf16 v[64:67], a[232:235], v[200:203], v[64:67]
ds_read_b64_tr_b16 a[252:253], v31 offset:27648
ds_read_b64_tr_b16 a[254:255], v31 offset:32256
v_mfma_f32_16x16x32_bf16 v[68:71], a[232:235], v[204:207], v[68:71]
buffer_load_dwordx4 a[44:47], v32, s[24:27], s101 offen offset:2048 sc1
v_mfma_f32_16x16x32_bf16 v[72:75], a[236:239], v[200:203], v[72:75]
s_waitcnt vmcnt(19)
s_barrier
v_mfma_f32_16x16x32_bf16 v[76:79], a[236:239], v[204:207], v[76:79]
ds_read_b64_tr_b16 a[192:193], v26 offset:0
ds_read_b64_tr_b16 a[194:195], v26 offset:4608
v_mfma_f32_16x16x32_bf16 v[80:83], a[240:243], v[200:203], v[80:83]
ds_read_b64_tr_b16 a[196:197], v26 offset:40
ds_read_b64_tr_b16 a[198:199], v26 offset:4648
v_mfma_f32_16x16x32_bf16 v[84:87], a[240:243], v[204:207], v[84:87]
s_add_u32 m0, s3, 92160
s_waitcnt lgkmcnt(4)
v_mfma_f32_16x16x32_bf16 v[88:91], a[244:247], v[200:203], v[88:91]
ds_read_b64_tr_b16 a[200:201], v26 offset:72
ds_read_b64_tr_b16 a[202:203], v26 offset:4680
v_mfma_f32_16x16x32_bf16 v[92:95], a[244:247], v[204:207], v[92:95]
buffer_load_dwordx4 v21, s[20:23], s68 offen offset:0 lds
v_mfma_f32_16x16x32_bf16 v[96:99], a[248:251], v[200:203], v[96:99]
ds_read_b64_tr_b16 a[204:205], v26 offset:112
ds_read_b64_tr_b16 a[206:207], v26 offset:4720
v_mfma_f32_16x16x32_bf16 v[100:103], a[248:251], v[204:207], v[100:103]
buffer_load_dwordx4 a[48:51], v32, s[24:27], s101 offen offset:3072 sc1
v_mfma_f32_16x16x32_bf16 v[104:107], a[252:255], v[200:203], v[104:107]
ds_read_b64_tr_b16 a[208:209], v26 offset:144
ds_read_b64_tr_b16 a[210:211], v26 offset:4752
v_mfma_f32_16x16x32_bf16 v[108:111], a[252:255], v[204:207], v[108:111]
s_add_u32 s101, s8, 4096
s_waitcnt lgkmcnt(4)
v_mfma_f32_16x16x32_bf16 v[40:43], a[192:195], v[208:211], v[40:43]
ds_read_b64_tr_b16 a[212:213], v26 offset:184
ds_read_b64_tr_b16 a[214:215], v26 offset:4792
v_mfma_f32_16x16x32_bf16 v[44:47], a[192:195], v[212:215], v[44:47]
buffer_load_dwordx4 v22, s[20:23], s68 offen offset:1024 lds
v_mfma_f32_16x16x32_bf16 v[48:51], a[196:199], v[208:211], v[48:51]
ds_read_b64_tr_b16 a[216:217], v26 offset:216
ds_read_b64_tr_b16 a[218:219], v26 offset:4824
v_mfma_f32_16x16x32_bf16 v[52:55], a[196:199], v[212:215], v[52:55]
buffer_load_dwordx4 a[52:55], v32, s[24:27], s101 offen offset:0 sc1
v_mfma_f32_16x16x32_bf16 v[56:59], a[200:203], v[208:211], v[56:59]
ds_read_b64_tr_b16 a[220:221], v26 offset:256
ds_read_b64_tr_b16 a[222:223], v26 offset:4864
v_mfma_f32_16x16x32_bf16 v[60:63], a[200:203], v[212:215], v[60:63]
s_waitcnt lgkmcnt(4)
v_mfma_f32_16x16x32_bf16 v[64:67], a[204:207], v[208:211], v[64:67]
ds_read_b64_tr_b16 a[224:225], v29 offset:0
ds_read_b64_tr_b16 a[226:227], v29 offset:4608
v_mfma_f32_16x16x32_bf16 v[68:71], a[204:207], v[212:215], v[68:71]
buffer_load_dwordx4 v23, s[20:23], s68 offen offset:2048 lds
v_mfma_f32_16x16x32_bf16 v[72:75], a[208:211], v[208:211], v[72:75]
ds_read_b64_tr_b16 a[228:229], v26 offset:9216
ds_read_b64_tr_b16 a[230:231], v26 offset:13824
v_mfma_f32_16x16x32_bf16 v[76:79], a[208:211], v[212:215], v[76:79]
buffer_load_dwordx4 a[56:59], v32, s[24:27], s101 offen offset:1024 sc1
v_mfma_f32_16x16x32_bf16 v[80:83], a[212:215], v[208:211], v[80:83]
ds_read_b64_tr_b16 a[232:233], v26 offset:9256
ds_read_b64_tr_b16 a[234:235], v26 offset:13864
v_mfma_f32_16x16x32_bf16 v[84:87], a[212:215], v[212:215], v[84:87]
s_waitcnt lgkmcnt(4)
v_mfma_f32_16x16x32_bf16 v[88:91], a[216:219], v[208:211], v[88:91]
ds_read_b64_tr_b16 a[236:237], v26 offset:9288
ds_read_b64_tr_b16 a[238:239], v26 offset:13896
v_mfma_f32_16x16x32_bf16 v[92:95], a[216:219], v[212:215], v[92:95]
buffer_load_dwordx4 v24, s[20:23], s68 offen offset:3072 lds
v_mfma_f32_16x16x32_bf16 v[96:99], a[220:223], v[208:211], v[96:99]
ds_read_b64_tr_b16 a[240:241], v26 offset:9328
ds_read_b64_tr_b16 a[242:243], v26 offset:13936
v_mfma_f32_16x16x32_bf16 v[100:103], a[220:223], v[212:215], v[100:103]
buffer_load_dwordx4 a[60:63], v32, s[24:27], s101 offen offset:2048 sc1
v_mfma_f32_16x16x32_bf16 v[104:107], a[224:227], v[208:211], v[104:107]
ds_read_b64_tr_b16 a[244:245], v26 offset:9360
ds_read_b64_tr_b16 a[246:247], v26 offset:13968
v_mfma_f32_16x16x32_bf16 v[108:111], a[224:227], v[212:215], v[108:111]
s_add_u32 m0, s3, 96256
s_waitcnt lgkmcnt(4)
v_mfma_f32_16x16x32_bf16 v[40:43], a[228:231], v[216:219], v[40:43]
ds_read_b64_tr_b16 a[248:249], v26 offset:9400
ds_read_b64_tr_b16 a[250:251], v26 offset:14008
v_mfma_f32_16x16x32_bf16 v[44:47], a[228:231], v[220:223], v[44:47]
buffer_load_dwordx4 a[64:67], v32, s[24:27], s101 offen offset:3072 sc1
v_mfma_f32_16x16x32_bf16 v[48:51], a[232:235], v[216:219], v[48:51]
ds_read_b64_tr_b16 a[252:253], v26 offset:9432
ds_read_b64_tr_b16 a[254:255], v26 offset:14040
v_mfma_f32_16x16x32_bf16 v[52:55], a[232:235], v[220:223], v[52:55]
buffer_load_dwordx4 v25, s[20:23], s68 offen lds
v_mfma_f32_16x16x32_bf16 v[56:59], a[236:239], v[216:219], v[56:59]
ds_read_b64_tr_b16 a[192:193], v26 offset:9472
ds_read_b64_tr_b16 a[194:195], v26 offset:14080
v_mfma_f32_16x16x32_bf16 v[60:63], a[236:239], v[220:223], v[60:63]
s_add_u32 s101, s8, 8192
s_waitcnt lgkmcnt(4)
v_mfma_f32_16x16x32_bf16 v[64:67], a[240:243], v[216:219], v[64:67]
ds_read_b64_tr_b16 a[196:197], v29 offset:9216
ds_read_b64_tr_b16 a[198:199], v29 offset:13824
v_mfma_f32_16x16x32_bf16 v[68:71], a[240:243], v[220:223], v[68:71]
buffer_load_dwordx4 a[68:71], v32, s[24:27], s101 offen offset:0 sc1
v_mfma_f32_16x16x32_bf16 v[72:75], a[244:247], v[216:219], v[72:75]
ds_read_b64_tr_b16 a[200:201], v26 offset:18432
ds_read_b64_tr_b16 a[202:203], v26 offset:23040
v_mfma_f32_16x16x32_bf16 v[76:79], a[244:247], v[220:223], v[76:79]
s_add_u32 m0, s3, 110592
v_mfma_f32_16x16x32_bf16 v[80:83], a[248:251], v[216:219], v[80:83]
ds_read_b64_tr_b16 a[204:205], v26 offset:18472
ds_read_b64_tr_b16 a[206:207], v26 offset:23080
v_mfma_f32_16x16x32_bf16 v[84:87], a[248:251], v[220:223], v[84:87]
s_waitcnt lgkmcnt(4)
v_mfma_f32_16x16x32_bf16 v[88:91], a[252:255], v[216:219], v[88:91]
ds_read_b64_tr_b16 a[208:209], v26 offset:18504
ds_read_b64_tr_b16 a[210:211], v26 offset:23112
v_mfma_f32_16x16x32_bf16 v[92:95], a[252:255], v[220:223], v[92:95]
buffer_load_dwordx4 v21, s[20:23], s69 offen offset:0 lds
v_mfma_f32_16x16x32_bf16 v[96:99], a[192:195], v[216:219], v[96:99]
ds_read_b64_tr_b16 a[212:213], v26 offset:18544
ds_read_b64_tr_b16 a[214:215], v26 offset:23152
v_mfma_f32_16x16x32_bf16 v[100:103], a[192:195], v[220:223], v[100:103]
v_mfma_f32_16x16x32_bf16 v[104:107], a[196:199], v[216:219], v[104:107]
ds_read_b64_tr_b16 a[216:217], v26 offset:18576
ds_read_b64_tr_b16 a[218:219], v26 offset:23184
v_mfma_f32_16x16x32_bf16 v[108:111], a[196:199], v[220:223], v[108:111]
s_waitcnt lgkmcnt(4)
v_mfma_f32_16x16x32_bf16 v[40:43], a[200:203], v[224:227], v[40:43]
ds_read_b64_tr_b16 a[220:221], v26 offset:18616
ds_read_b64_tr_b16 a[222:223], v26 offset:23224
v_mfma_f32_16x16x32_bf16 v[44:47], a[200:203], v[228:231], v[44:47]
buffer_load_dwordx4 v22, s[20:23], s69 offen offset:1024 lds
v_mfma_f32_16x16x32_bf16 v[48:51], a[204:207], v[224:227], v[48:51]
ds_read_b64_tr_b16 a[224:225], v26 offset:18648
ds_read_b64_tr_b16 a[226:227], v26 offset:23256
v_mfma_f32_16x16x32_bf16 v[52:55], a[204:207], v[228:231], v[52:55]
v_mfma_f32_16x16x32_bf16 v[56:59], a[208:211], v[224:227], v[56:59]
ds_read_b64_tr_b16 a[228:229], v26 offset:18688
ds_read_b64_tr_b16 a[230:231], v26 offset:23296
v_mfma_f32_16x16x32_bf16 v[60:63], a[208:211], v[228:231], v[60:63]
s_waitcnt lgkmcnt(4)
v_mfma_f32_16x16x32_bf16 v[64:67], a[212:215], v[224:227], v[64:67]
ds_read_b64_tr_b16 a[232:233], v29 offset:18432
ds_read_b64_tr_b16 a[234:235], v29 offset:23040
v_mfma_f32_16x16x32_bf16 v[68:71], a[212:215], v[228:231], v[68:71]
buffer_load_dwordx4 v23, s[20:23], s69 offen offset:2048 lds
v_mfma_f32_16x16x32_bf16 v[72:75], a[216:219], v[224:227], v[72:75]
ds_read_b64_tr_b16 a[236:237], v26 offset:27648
ds_read_b64_tr_b16 a[238:239], v26 offset:32256
v_mfma_f32_16x16x32_bf16 v[76:79], a[216:219], v[228:231], v[76:79]
v_mfma_f32_16x16x32_bf16 v[80:83], a[220:223], v[224:227], v[80:83]
ds_read_b64_tr_b16 a[240:241], v26 offset:27688
ds_read_b64_tr_b16 a[242:243], v26 offset:32296
v_mfma_f32_16x16x32_bf16 v[84:87], a[220:223], v[228:231], v[84:87]
s_waitcnt lgkmcnt(4)
v_mfma_f32_16x16x32_bf16 v[88:91], a[224:227], v[224:227], v[88:91]
ds_read_b64_tr_b16 a[244:245], v26 offset:27720
ds_read_b64_tr_b16 a[246:247], v26 offset:32328
v_mfma_f32_16x16x32_bf16 v[92:95], a[224:227], v[228:231], v[92:95]
buffer_load_dwordx4 v24, s[20:23], s69 offen offset:3072 lds
v_mfma_f32_16x16x32_bf16 v[96:99], a[228:231], v[224:227], v[96:99]
ds_read_b64_tr_b16 a[248:249], v26 offset:27760
ds_read_b64_tr_b16 a[250:251], v26 offset:32368
v_mfma_f32_16x16x32_bf16 v[100:103], a[228:231], v[228:231], v[100:103]
v_mfma_f32_16x16x32_bf16 v[104:107], a[232:235], v[224:227], v[104:107]
ds_read_b64_tr_b16 a[252:253], v26 offset:27792
ds_read_b64_tr_b16 a[254:255], v26 offset:32400
v_mfma_f32_16x16x32_bf16 v[108:111], a[232:235], v[228:231], v[108:111]
s_add_u32 m0, s3, 114688
s_waitcnt lgkmcnt(4)
v_mfma_f32_16x16x32_bf16 v[40:43], a[236:239], v[232:235], v[40:43]
ds_read_b64_tr_b16 a[192:193], v26 offset:27832
ds_read_b64_tr_b16 a[194:195], v26 offset:32440
v_mfma_f32_16x16x32_bf16 v[44:47], a[236:239], v[236:239], v[44:47]
v_mfma_f32_16x16x32_bf16 v[48:51], a[240:243], v[232:235], v[48:51]
ds_read_b64_tr_b16 a[196:197], v26 offset:27864
ds_read_b64_tr_b16 a[198:199], v26 offset:32472
v_mfma_f32_16x16x32_bf16 v[52:55], a[240:243], v[236:239], v[52:55]
buffer_load_dwordx4 v25, s[20:23], s69 offen lds
v_mfma_f32_16x16x32_bf16 v[56:59], a[244:247], v[232:235], v[56:59]
ds_read_b64_tr_b16 a[200:201], v26 offset:27904
ds_read_b64_tr_b16 a[202:203], v26 offset:32512
v_mfma_f32_16x16x32_bf16 v[60:63], a[244:247], v[236:239], v[60:63]
s_waitcnt lgkmcnt(4)
v_mfma_f32_16x16x32_bf16 v[64:67], a[248:251], v[232:235], v[64:67]
ds_read_b64_tr_b16 a[204:205], v29 offset:27648
ds_read_b64_tr_b16 a[206:207], v29 offset:32256
v_mfma_f32_16x16x32_bf16 v[68:71], a[248:251], v[236:239], v[68:71]
v_mfma_f32_16x16x32_bf16 v[72:75], a[252:255], v[232:235], v[72:75]
s_waitcnt vmcnt(30)
s_barrier
v_mfma_f32_16x16x32_bf16 v[76:79], a[252:255], v[236:239], v[76:79]
ds_read_b64_tr_b16 a[208:209], v26 offset:36864
ds_read_b64_tr_b16 a[210:211], v26 offset:41472
v_mfma_f32_16x16x32_bf16 v[80:83], a[192:195], v[232:235], v[80:83]
ds_read_b64_tr_b16 a[212:213], v26 offset:36904
ds_read_b64_tr_b16 a[214:215], v26 offset:41512
v_mfma_f32_16x16x32_bf16 v[84:87], a[192:195], v[236:239], v[84:87]
s_add_u32 m0, s3, 129024
s_waitcnt lgkmcnt(4)
v_mfma_f32_16x16x32_bf16 v[88:91], a[196:199], v[232:235], v[88:91]
ds_read_b64_tr_b16 a[216:217], v26 offset:36936
ds_read_b64_tr_b16 a[218:219], v26 offset:41544
v_mfma_f32_16x16x32_bf16 v[92:95], a[196:199], v[236:239], v[92:95]
buffer_load_dwordx4 v21, s[20:23], s70 offen offset:0 lds
v_mfma_f32_16x16x32_bf16 v[96:99], a[200:203], v[232:235], v[96:99]
ds_read_b64_tr_b16 a[220:221], v26 offset:36976
ds_read_b64_tr_b16 a[222:223], v26 offset:41584
v_mfma_f32_16x16x32_bf16 v[100:103], a[200:203], v[236:239], v[100:103]
buffer_load_dwordx4 v22, s[20:23], s70 offen offset:1024 lds
v_mfma_f32_16x16x32_bf16 v[104:107], a[204:207], v[232:235], v[104:107]
ds_read_b64_tr_b16 a[224:225], v26 offset:37008
ds_read_b64_tr_b16 a[226:227], v26 offset:41616
v_mfma_f32_16x16x32_bf16 v[108:111], a[204:207], v[236:239], v[108:111]
buffer_load_dword v33, v1, s[24:27], 0 offen sc1
s_waitcnt lgkmcnt(4)
v_mfma_f32_16x16x32_bf16 v[40:43], a[208:211], v[240:243], v[40:43]
ds_read_b64_tr_b16 a[228:229], v26 offset:37048
ds_read_b64_tr_b16 a[230:231], v26 offset:41656
v_mfma_f32_16x16x32_bf16 v[44:47], a[208:211], v[244:247], v[44:47]
buffer_load_dwordx4 v23, s[20:23], s70 offen offset:2048 lds
v_mfma_f32_16x16x32_bf16 v[48:51], a[212:215], v[240:243], v[48:51]
ds_read_b64_tr_b16 a[232:233], v26 offset:37080
ds_read_b64_tr_b16 a[234:235], v26 offset:41688
v_mfma_f32_16x16x32_bf16 v[52:55], a[212:215], v[244:247], v[52:55]
buffer_load_dwordx4 v24, s[20:23], s70 offen offset:3072 lds
v_mfma_f32_16x16x32_bf16 v[56:59], a[216:219], v[240:243], v[56:59]
ds_read_b64_tr_b16 a[236:237], v26 offset:37120
ds_read_b64_tr_b16 a[238:239], v26 offset:41728
v_mfma_f32_16x16x32_bf16 v[60:63], a[216:219], v[244:247], v[60:63]
s_waitcnt lgkmcnt(4)
v_mfma_f32_16x16x32_bf16 v[64:67], a[220:223], v[240:243], v[64:67]
ds_read_b64_tr_b16 a[240:241], v29 offset:36864
ds_read_b64_tr_b16 a[242:243], v29 offset:41472
v_mfma_f32_16x16x32_bf16 v[68:71], a[220:223], v[244:247], v[68:71]
s_add_u32 m0, s3, 133120
v_mfma_f32_16x16x32_bf16 v[72:75], a[224:227], v[240:243], v[72:75]
ds_read_b64_tr_b16 a[244:245], v26 offset:46080
ds_read_b64_tr_b16 a[246:247], v26 offset:50688
v_mfma_f32_16x16x32_bf16 v[76:79], a[224:227], v[244:247], v[76:79]
buffer_load_dwordx4 v25, s[20:23], s70 offen lds
v_mfma_f32_16x16x32_bf16 v[80:83], a[228:231], v[240:243], v[80:83]
ds_read_b64_tr_b16 a[248:249], v26 offset:46120
ds_read_b64_tr_b16 a[250:251], v26 offset:50728
v_mfma_f32_16x16x32_bf16 v[84:87], a[228:231], v[244:247], v[84:87]
s_waitcnt lgkmcnt(4)
v_mfma_f32_16x16x32_bf16 v[88:91], a[232:235], v[240:243], v[88:91]
ds_read_b64_tr_b16 a[252:253], v26 offset:46152
ds_read_b64_tr_b16 a[254:255], v26 offset:50760
v_mfma_f32_16x16x32_bf16 v[92:95], a[232:235], v[244:247], v[92:95]
s_add_u32 m0, s3, 0
v_mfma_f32_16x16x32_bf16 v[96:99], a[236:239], v[240:243], v[96:99]
ds_read_b64_tr_b16 a[192:193], v26 offset:46192
ds_read_b64_tr_b16 a[194:195], v26 offset:50800
v_mfma_f32_16x16x32_bf16 v[100:103], a[236:239], v[244:247], v[100:103]
s_add_u32 s10, s68, 82944
v_mfma_f32_16x16x32_bf16 v[104:107], a[240:243], v[240:243], v[104:107]
ds_read_b64_tr_b16 a[196:197], v26 offset:46224
ds_read_b64_tr_b16 a[198:199], v26 offset:50832
v_mfma_f32_16x16x32_bf16 v[108:111], a[240:243], v[244:247], v[108:111]
s_waitcnt lgkmcnt(4)
v_mfma_f32_16x16x32_bf16 v[40:43], a[244:247], v[248:251], v[40:43]
ds_read_b64_tr_b16 a[200:201], v26 offset:46264
ds_read_b64_tr_b16 a[202:203], v26 offset:50872
v_mfma_f32_16x16x32_bf16 v[44:47], a[244:247], v[252:255], v[44:47]
buffer_load_dwordx4 v21, s[20:23], s10 offen offset:0 lds
v_mfma_f32_16x16x32_bf16 v[48:51], a[248:251], v[248:251], v[48:51]
ds_read_b64_tr_b16 a[204:205], v26 offset:46296
ds_read_b64_tr_b16 a[206:207], v26 offset:50904
v_mfma_f32_16x16x32_bf16 v[52:55], a[248:251], v[252:255], v[52:55]
buffer_load_dwordx4 v22, s[20:23], s10 offen offset:1024 lds
v_mfma_f32_16x16x32_bf16 v[56:59], a[252:255], v[248:251], v[56:59]
ds_read_b64_tr_b16 a[208:209], v26 offset:46336
ds_read_b64_tr_b16 a[210:211], v26 offset:50944
v_mfma_f32_16x16x32_bf16 v[60:63], a[252:255], v[252:255], v[60:63]
s_waitcnt lgkmcnt(4)
v_mfma_f32_16x16x32_bf16 v[64:67], a[192:195], v[248:251], v[64:67]
ds_read_b64_tr_b16 a[212:213], v29 offset:46080
ds_read_b64_tr_b16 a[214:215], v29 offset:50688
v_mfma_f32_16x16x32_bf16 v[68:71], a[192:195], v[252:255], v[68:71]
buffer_load_dwordx4 v23, s[20:23], s10 offen offset:2048 lds
v_mfma_f32_16x16x32_bf16 v[72:75], a[196:199], v[248:251], v[72:75]
v_cvt_pk_bf16_f32 v112, v40, v41
v_cvt_pk_bf16_f32 v113, v42, v43
v_mfma_f32_16x16x32_bf16 v[76:79], a[196:199], v[252:255], v[76:79]
buffer_load_dwordx4 v24, s[20:23], s10 offen offset:3072 lds
v_cvt_pk_bf16_f32 v114, v44, v45
v_cvt_pk_bf16_f32 v115, v46, v47
v_mfma_f32_16x16x32_bf16 v[80:83], a[200:203], v[248:251], v[80:83]
v_cvt_pk_bf16_f32 v116, v48, v49
v_cvt_pk_bf16_f32 v117, v50, v51
v_mfma_f32_16x16x32_bf16 v[84:87], a[200:203], v[252:255], v[84:87]
v_cvt_pk_bf16_f32 v118, v52, v53
v_cvt_pk_bf16_f32 v119, v54, v55
s_waitcnt lgkmcnt(0)
v_mfma_f32_16x16x32_bf16 v[88:91], a[204:207], v[248:251], v[88:91]
s_add_u32 m0, s3, 4096
v_cvt_pk_bf16_f32 v120, v56, v57
v_cvt_pk_bf16_f32 v121, v58, v59
v_mfma_f32_16x16x32_bf16 v[92:95], a[204:207], v[252:255], v[92:95]
v_cvt_pk_bf16_f32 v122, v60, v61
v_cvt_pk_bf16_f32 v123, v62, v63
v_mfma_f32_16x16x32_bf16 v[96:99], a[208:211], v[248:251], v[96:99]
buffer_load_dwordx4 v25, s[20:23], s10 offen lds
v_cvt_pk_bf16_f32 v124, v64, v65
v_cvt_pk_bf16_f32 v125, v66, v67
v_mfma_f32_16x16x32_bf16 v[100:103], a[208:211], v[252:255], v[100:103]
v_cvt_pk_bf16_f32 v126, v68, v69
v_cvt_pk_bf16_f32 v127, v70, v71
v_mfma_f32_16x16x32_bf16 v[104:107], a[212:215], v[248:251], v[104:107]
v_cvt_pk_bf16_f32 v128, v72, v73
v_cvt_pk_bf16_f32 v129, v74, v75
v_mfma_f32_16x16x32_bf16 v[108:111], a[212:215], v[252:255], v[108:111]
v_cvt_pk_bf16_f32 v130, v76, v77
v_cvt_pk_bf16_f32 v131, v78, v79
v_cvt_pk_bf16_f32 v132, v80, v81
v_cvt_pk_bf16_f32 v133, v82, v83
v_cvt_pk_bf16_f32 v134, v84, v85
v_cvt_pk_bf16_f32 v135, v86, v87
v_cvt_pk_bf16_f32 v136, v88, v89
v_cvt_pk_bf16_f32 v137, v90, v91
v_cvt_pk_bf16_f32 v138, v92, v93
v_cvt_pk_bf16_f32 v139, v94, v95
v_cvt_pk_bf16_f32 v140, v96, v97
v_cvt_pk_bf16_f32 v141, v98, v99
v_cvt_pk_bf16_f32 v142, v100, v101
v_cvt_pk_bf16_f32 v143, v102, v103
v_cvt_pk_bf16_f32 v144, v104, v105
v_cvt_pk_bf16_f32 v145, v106, v107
v_cvt_pk_bf16_f32 v146, v108, v109
v_cvt_pk_bf16_f32 v147, v110, v111
v_mov_b32 v105, 0
v_mov_b32 v106, 0
v_mov_b32 v109, 0
v_mov_b32_e64 v110, 0
s_barrier
s_waitcnt vmcnt(8)
v_readfirstlane_b32 s11, v33
s_or_b32 s11, s11, s9
s_cmp_lt_u32 s11, 2
s_cbranch_scc1 L_hslowV
L_hbackV:
v_cndmask_b32 v104, 0, v144, s[50:51]
s_mov_b32 s96, 238609295
s_lshl_b32 s97, s49, 6
s_mov_b32 s98, 1152
v_add_u32 v34, s97, v0
v_cndmask_b32 v108, 0, v146, s[50:51]
s_add_u32 s97, s97, 64
v_mul_hi_u32 v35, v34, s96
s_add_u32 s101, s8, 9216
buffer_load_dwordx4 a[74:77], v32, s[24:27], s101 offen offset:0 sc1
v_mul_u32_u24 v36, 18, v35
v_sub_u32_e64 v34, v34, v36
v_cndmask_b32 v107, 0, v145, s[50:51]
v_lshlrev_b32 v34, 4, v34
v_lshrrev_b32 v36, 4, v35
v_xor_b32_e64 v36, s33, v36
v_mul_u32_u24 v36, 144, v36
v_cndmask_b32 v111, 0, v147, s[50:51]
buffer_load_dwordx4 a[82:85], v32, s[24:27], s101 offen offset:1024 sc1
v_bfe_u32 v37, v35, 2, 2
v_mad_u32_u24 v36, v37, 36, v36
v_and_b32_e64 v35, 3, v35
v_add3_u32 v35, v35, v36, 16
v_mfma_f32_16x16x16_bf16 v[148:151], a[0:1], v[112:113], v[4:7]
v_mad_u32_u24 v16, v35, s98, v34
v_add_u32 v34, s97, v0
s_add_u32 s97, s97, 64
buffer_load_dwordx4 a[90:93], v32, s[24:27], s101 offen offset:2048 sc1
v_mul_hi_u32 v35, v34, s96
v_mfma_f32_16x16x16_bf16 v[156:159], a[2:3], v[114:115], v[4:7]
v_mul_u32_u24 v36, 18, v35
v_sub_u32 v34, v34, v36
v_lshlrev_b32 v34, 4, v34
v_lshrrev_b32 v36, 4, v35
v_mfma_f32_16x16x16_bf16 v[164:167], a[4:5], v[116:117], v[4:7]
v_xor_b32_e64 v36, s33, v36
buffer_load_dwordx4 a[98:101], v32, s[24:27], s101 offen offset:3072 sc1
v_mul_u32_u24 v36, 144, v36
v_bfe_u32 v37, v35, 2, 2
v_mad_u32_u24 v36, v37, 36, v36
v_mfma_f32_16x16x16_bf16 v[172:175], a[6:7], v[118:119], v[4:7]
v_and_b32_e64 v35, 3, v35
v_add3_u32 v35, v35, v36, 16
v_mad_u32_u24 v17, v35, s98, v34
v_subrev_u32 v17, 1024, v17
s_add_u32 s101, s8, 13312
buffer_load_dwordx4 a[106:109], v32, s[24:27], s101 offen offset:0 sc1
v_mfma_f32_16x16x16_bf16 v[148:151], a[32:33], v[104:105], v[148:151]
v_add_u32 v34, s97, v0
s_add_u32 s97, s97, 64
v_mul_hi_u32 v35, v34, s96
v_mul_u32_u24_e64 v36, 18, v35
v_mfma_f32_16x16x16_bf16 v[156:159], a[34:35], v[108:109], v[156:159]
v_sub_u32 v34, v34, v36
v_lshlrev_b32 v34, 4, v34
buffer_load_dwordx4 a[114:117], v32, s[24:27], s101 offen offset:1024 sc1
v_lshrrev_b32 v36, 4, v35
v_xor_b32 v36, s33, v36
v_mfma_f32_16x16x16_bf16 v[164:167], a[32:33], v[106:107], v[164:167]
v_mul_u32_u24 v36, 144, v36
v_bfe_u32 v37, v35, 2, 2
v_mad_u32_u24 v36, v37, 36, v36
v_and_b32_e64 v35, 3, v35
v_mfma_f32_16x16x16_bf16 v[172:175], a[34:35], v[110:111], v[172:175]
buffer_load_dwordx4 a[122:125], v32, s[24:27], s101 offen offset:2048 sc1
v_add3_u32 v35, v35, v36, 16
v_mad_u32_u24 v18, v35, s98, v34
v_subrev_u32 v18, 2048, v18
v_add_u32_e64 v34, s97, v0
s_waitcnt vmcnt(23)
s_add_u32 s97, s97, 64
v_mul_hi_u32 v35, v34, s96
v_mul_u32_u24_e64 v36, 18, v35
buffer_load_dwordx4 a[130:133], v32, s[24:27], s101 offen offset:3072 sc1
v_sub_u32_e64 v34, v34, v36
v_mfma_f32_16x16x16_bf16 v[152:155], a[36:37], v[112:113], v[8:11]
v_lshlrev_b32 v34, 4, v34
v_lshrrev_b32 v36, 4, v35
v_xor_b32_e64 v36, s33, v36
v_mul_u32_u24 v36, 144, v36
v_mfma_f32_16x16x16_bf16 v[160:163], a[38:39], v[114:115], v[8:11]
v_bfe_u32 v37, v35, 2, 2
s_add_u32 s101, s8, 17408
buffer_load_dwordx4 a[138:141], v32, s[24:27], s101 offen offset:0 sc1
v_mad_u32_u24 v36, v37, 36, v36
v_and_b32_e64 v35, 3, v35
v_add3_u32 v35, v35, v36, 16
v_mfma_f32_16x16x16_bf16 v[168:171], a[40:41], v[116:117], v[8:11]
v_mad_u32_u24 v19, v35, s98, v34
v_subrev_u32 v19, 3072, v19
v_add_u32_e64 v34, s97, v0
v_mul_hi_u32 v35, v34, s96
v_mfma_f32_16x16x16_bf16 v[176:179], a[42:43], v[118:119], v[8:11]
v_mul_u32_u24 v36, 18, v35
v_sub_u32 v34, v34, v36
v_lshlrev_b32 v34, 4, v34
v_lshrrev_b32 v36, 4, v35
v_mfma_f32_16x16x16_bf16 v[152:155], a[68:69], v[104:105], v[152:155]
v_xor_b32_e64 v36, s33, v36
v_mul_u32_u24 v36, 144, v36
v_bfe_u32 v37, v35, 2, 2
v_mad_u32_u24 v36, v37, 36, v36
v_mfma_f32_16x16x16_bf16 v[160:163], a[70:71], v[108:109], v[160:163]
v_and_b32_e64 v35, 3, v35
v_add3_u32 v35, v35, v36, 16
v_mad_u32_u24 v20, v35, s98, v34
s_lshl_b32 s96, s34, 11
v_mfma_f32_16x16x16_bf16 v[168:171], a[68:69], v[106:107], v[168:171]
s_add_u32 s96, s96, 3697152
v_and_b32 v1, 3, v0
v_lshlrev_b32 v1, 7, v1
v_add_u32 v1, s96, v1
v_mfma_f32_16x16x16_bf16 v[176:179], a[70:71], v[110:111], v[176:179]
v_lshlrev_b32 v38, 3, v0
s_mov_b32 s43, s71
s_add_u32 s44, s71, 4096
s_add_u32 s45, s71, 8192
v_cndmask_b32 v104, 0, v144, s[52:53]
v_cndmask_b32 v108, 0, v146, s[52:53]
v_cndmask_b32 v107, 0, v145, s[52:53]
v_cndmask_b32 v111, 0, v147, s[52:53]
v_mfma_f32_16x16x16_bf16 v[180:183], a[8:9], v[120:121], v[4:7]
v_mfma_f32_16x16x16_bf16 v[188:191], a[10:11], v[122:123], v[4:7]
v_mfma_f32_16x16x16_bf16 v[196:199], a[12:13], v[124:125], v[4:7]
v_mfma_f32_16x16x16_bf16 v[204:207], a[14:15], v[126:127], v[4:7]
v_mfma_f32_16x16x16_bf16 v[180:183], a[32:33], v[104:105], v[180:183]
v_mfma_f32_16x16x16_bf16 v[188:191], a[34:35], v[108:109], v[188:191]
v_mfma_f32_16x16x16_bf16 v[196:199], a[32:33], v[106:107], v[196:199]
v_mfma_f32_16x16x16_bf16 v[204:207], a[34:35], v[110:111], v[204:207]
v_max_f32 v40, v152, v148
v_max_f32 v56, v168, v164
v_max_f32_e64 v48, v160, v156
v_mfma_f32_16x16x16_bf16 v[184:187], a[44:45], v[120:121], v[8:11]
v_max_f32 v64, v176, v172
v_max_f32 v41, v153, v149
v_max_f32_e64 v57, v169, v165
v_mfma_f32_16x16x16_bf16 v[192:195], a[46:47], v[122:123], v[8:11]
v_max_f32_e64 v49, v161, v157
s_add_u32 m0, s3, 18432
s_add_u32 s10, s69, 82944
buffer_load_dwordx4 v21, s[20:23], s10 offen offset:0 lds
v_max_f32 v65, v177, v173
v_max_f32 v42, v154, v150
v_mfma_f32_16x16x16_bf16 v[200:203], a[48:49], v[124:125], v[8:11]
v_max_f32 v58, v170, v166
v_max_f32 v50, v162, v158
v_max_f32_e64 v66, v178, v174
v_mfma_f32_16x16x16_bf16 v[208:211], a[50:51], v[126:127], v[8:11]
v_max_f32 v43, v155, v151
v_max_f32 v59, v171, v167
buffer_load_dwordx4 v22, s[20:23], s10 offen offset:1024 lds
v_max_f32_e64 v51, v163, v159
v_mfma_f32_16x16x16_bf16 v[184:187], a[68:69], v[104:105], v[184:187]
v_max_f32_e64 v67, v179, v175
v_max3_f32 v46, v40, v41, v42
v_max3_f32 v62, v56, v57, v58
v_mfma_f32_16x16x16_bf16 v[192:195], a[70:71], v[108:109], v[192:195]
v_max3_f32 v54, v48, v49, v50
v_max3_f32 v70, v64, v65, v66
v_max_f32_e64 v46, v46, v43
buffer_load_dwordx4 v23, s[20:23], s10 offen offset:2048 lds
v_mfma_f32_16x16x16_bf16 v[200:203], a[68:69], v[106:107], v[200:203]
v_max_f32 v62, v62, v59
v_max_f32 v54, v54, v51
v_max_f32_e64 v70, v70, v67
v_mfma_f32_16x16x16_bf16 v[208:211], a[70:71], v[110:111], v[208:211]
v_permlane32_swap_b32 v46, v54
v_permlane32_swap_b32 v62, v70
v_max_f32 v46, v46, v54
v_max_f32 v62, v62, v70
buffer_load_dwordx4 v24, s[20:23], s10 offen offset:3072 lds
v_mov_b32 v54, v46
v_mov_b32 v70, v62
s_nop 0
v_permlane16_swap_b32 v46, v54
v_permlane16_swap_b32 v62, v70
v_max_f32 v46, v46, v54
v_max_f32 v62, v62, v70
v_mul_f32 v46, s99, v46
v_mul_f32 v62, s99, v62
v_mov_b32 v54, v46
s_add_u32 m0, s3, 22528
s_nop 0
buffer_load_dwordx4 v25, s[20:23], s10 offen lds
v_mov_b32_e64 v70, v62
v_permlane32_swap_b32 v46, v54
s_nop 0
v_permlane32_swap_b32 v62, v70
v_fma_f32 v40, v40, s99, -v46
v_fma_f32 v56, v56, s99, -v62
v_fma_f32 v48, v48, s99, -v54
v_fma_f32 v64, v64, s99, -v70
v_fma_f32 v41, v41, s99, -v46
v_fma_f32 v57, v57, s99, -v62
s_add_u32 m0, s3, 36864
s_add_u32 s10, s70, 82944
buffer_load_dwordx4 v21, s[20:23], s10 offen offset:0 lds
v_fma_f32 v49, v49, s99, -v54
v_fma_f32 v65, v65, s99, -v70
v_fma_f32 v42, v42, s99, -v46
v_fma_f32 v58, v58, s99, -v62
v_fma_f32 v50, v50, s99, -v54
v_fma_f32 v66, v66, s99, -v70
v_fma_f32 v43, v43, s99, -v46
v_fma_f32 v59, v59, s99, -v62
v_fma_f32 v51, v51, s99, -v54
buffer_load_dwordx4 v22, s[20:23], s10 offen offset:1024 lds
v_fma_f32 v67, v67, s99, -v70
v_exp_f32 v40, v40
v_exp_f32 v56, v56
v_exp_f32 v48, v48
v_exp_f32 v64, v64
v_exp_f32 v41, v41
v_exp_f32 v57, v57
v_exp_f32 v49, v49
v_exp_f32 v65, v65
buffer_load_dwordx4 v23, s[20:23], s10 offen offset:2048 lds
v_exp_f32 v42, v42
v_exp_f32 v58, v58
v_exp_f32 v50, v50
v_exp_f32 v66, v66
v_exp_f32 v43, v43
v_exp_f32 v59, v59
v_exp_f32 v51, v51
v_exp_f32 v67, v67
v_cvt_pk_bf16_f32 v44, v40, v41
buffer_load_dwordx4 v24, s[20:23], s10 offen offset:3072 lds
v_cvt_pk_bf16_f32 v60, v56, v57
v_cvt_pk_bf16_f32 v52, v48, v49
v_cvt_pk_bf16_f32 v68, v64, v65
v_cvt_pk_bf16_f32 v45, v42, v43
v_cvt_pk_bf16_f32 v61, v58, v59
v_cvt_pk_bf16_f32 v53, v50, v51
v_cvt_pk_bf16_f32 v69, v66, v67
v_and_b32 v74, v14, v44
v_and_b32 v82, v14, v60
s_add_u32 m0, s3, 40960
s_nop 0
buffer_load_dwordx4 v25, s[20:23], s10 offen lds
v_and_b32 v76, v14, v52
v_and_b32 v84, v14, v68
v_and_b32 v75, v15, v45
v_and_b32 v83, v15, v61
v_and_b32 v77, v15, v53
v_and_b32 v85, v15, v69
v_and_b32 v72, v12, v44
v_and_b32 v80, v12, v60
v_and_b32 v78, v12, v52
v_and_b32 v86, v12, v68
v_and_b32 v73, v13, v45
v_and_b32 v81, v13, v61
v_and_b32 v79, v13, v53
v_and_b32 v87, v13, v69
s_waitcnt vmcnt(10)
v_mfma_f32_16x16x16_bf16 v[88:91], v[2:3], v[44:45], 0
v_mfma_f32_16x16x16_bf16 v[92:95], v[2:3], v[52:53], 0
v_mfma_f32_16x16x16_bf16 v[96:99], v[2:3], v[60:61], 0
v_mfma_f32_16x16x16_bf16 v[100:103], v[2:3], v[68:69], 0
v_mfma_f32_16x16x32_bf16 v[148:151], a[72:75], v[72:75], 0
v_mfma_f32_16x16x32_bf16 v[152:155], a[136:139], v[72:75], 0
v_mfma_f32_16x16x32_bf16 v[156:159], a[76:79], v[76:79], 0
v_mfma_f32_16x16x32_bf16 v[160:163], a[140:143], v[76:79], 0
v_mfma_f32_16x16x32_bf16 v[164:167], a[80:83], v[80:83], 0
v_mfma_f32_16x16x32_bf16 v[168:171], a[136:139], v[80:83], 0
v_mfma_f32_16x16x32_bf16 v[172:175], a[84:87], v[84:87], 0
v_mfma_f32_16x16x32_bf16 v[176:179], a[140:143], v[84:87], 0
v_max_f32 v40, v184, v180
v_max_f32 v56, v200, v196
v_max_f32 v48, v192, v188
v_max_f32 v64, v208, v204
v_max_f32 v41, v185, v181
v_max_f32 v57, v201, v197
v_max_f32 v49, v193, v189
v_max_f32 v65, v209, v205
v_max_f32 v42, v186, v182
v_max_f32 v58, v202, v198
v_max_f32 v50, v194, v190
v_max_f32 v66, v210, v206
v_max_f32 v43, v187, v183
v_max_f32 v59, v203, v199
v_max_f32 v51, v195, v191
v_max_f32 v67, v211, v207
v_max3_f32 v46, v40, v41, v42
v_rcp_f32_e64 v88, v88
v_max3_f32 v62, v56, v57, v58
v_rcp_f32_e64 v92, v92
v_max3_f32 v54, v48, v49, v50
v_rcp_f32_e64 v96, v96
v_max3_f32 v70, v64, v65, v66
v_rcp_f32 v100, v100
v_max_f32 v46, v46, v43
v_mul_f32 v148, v88, v148
v_max_f32 v62, v62, v59
v_mul_f32 v149, v88, v149
v_max_f32 v54, v54, v51
v_mul_f32 v150, v88, v150
v_max_f32 v70, v70, v67
v_mul_f32 v151, v88, v151
v_permlane32_swap_b32 v46, v54
v_mul_f32 v152, v88, v152
v_permlane32_swap_b32 v62, v70
v_mul_f32 v153, v88, v153
v_max_f32 v46, v46, v54
v_mul_f32 v156, v92, v156
v_max_f32 v62, v62, v70
v_mul_f32 v157, v92, v157
v_mov_b32 v54, v46
v_mul_f32 v158, v92, v158
v_mov_b32 v70, v62
v_mul_f32 v159, v92, v159
v_permlane16_swap_b32 v46, v54
v_mul_f32 v160, v92, v160
v_permlane16_swap_b32 v62, v70
v_mul_f32 v161, v92, v161
v_max_f32 v46, v46, v54
v_mul_f32 v164, v96, v164
v_max_f32 v62, v62, v70
v_mul_f32 v165, v96, v165
v_mul_f32 v46, s99, v46
v_mul_f32 v166, v96, v166
v_mul_f32 v62, s99, v62
v_mul_f32 v167, v96, v167
v_mov_b32 v54, v46
v_mul_f32 v170, v96, v170
v_mov_b32 v70, v62
v_mul_f32 v171, v96, v171
v_permlane32_swap_b32 v46, v54
v_mul_f32 v172, v100, v172
v_permlane32_swap_b32 v62, v70
v_mul_f32_e64 v173, v100, v173
v_fma_f32 v40, v40, s99, -v46
v_mul_f32_e64 v174, v100, v174
v_fma_f32 v56, v56, s99, -v62
v_mul_f32_e64 v175, v100, v175
v_fma_f32 v48, v48, s99, -v54
v_mul_f32_e64 v178, v100, v178
v_fma_f32 v64, v64, s99, -v70
v_mul_f32_e64 v179, v100, v179
v_fma_f32 v41, v41, s99, -v46
v_cvt_pk_bf16_f32 v212, v148, v149
v_fma_f32 v57, v57, s99, -v62
v_cvt_pk_bf16_f32 v213, v150, v151
v_fma_f32 v49, v49, s99, -v54
v_cvt_pk_bf16_f32 v228, v152, v153
v_fma_f32 v65, v65, s99, -v70
v_cvt_pk_bf16_f32 v232, v156, v157
v_fma_f32 v42, v42, s99, -v46
v_cvt_pk_bf16_f32 v233, v158, v159
v_fma_f32 v58, v58, s99, -v62
v_cvt_pk_bf16_f32 v248, v160, v161
v_fma_f32 v50, v50, s99, -v54
v_cvt_pk_bf16_f32 v214, v164, v165
v_fma_f32 v66, v66, s99, -v70
v_cvt_pk_bf16_f32 v215, v166, v167
v_fma_f32 v43, v43, s99, -v46
v_cvt_pk_bf16_f32 v229, v170, v171
v_fma_f32 v59, v59, s99, -v62
v_cvt_pk_bf16_f32 v234, v172, v173
v_fma_f32 v51, v51, s99, -v54
v_cvt_pk_bf16_f32 v235, v174, v175
v_fma_f32 v67, v67, s99, -v70
v_cvt_pk_bf16_f32 v249, v178, v179
v_exp_f32_e64 v40, v40
buffer_store_dwordx4 v[212:215], v32, s[24:27], s43 offen offset:0 sc1
v_exp_f32_e64 v56, v56
buffer_store_dwordx4 v[232:235], v32, s[24:27], s44 offen offset:0 sc1
v_exp_f32_e64 v48, v48
v_cndmask_b32 v104, 0, v144, s[54:55]
v_exp_f32_e64 v64, v64
v_cndmask_b32 v108, 0, v146, s[54:55]
v_exp_f32_e64 v41, v41
v_cndmask_b32 v107, 0, v145, s[54:55]
v_exp_f32_e64 v57, v57
v_cndmask_b32 v111, 0, v147, s[54:55]
v_exp_f32_e64 v49, v49
v_mfma_f32_16x16x16_bf16 v[148:151], a[16:17], v[128:129], v[4:7]
v_exp_f32_e64 v65, v65
v_mfma_f32_16x16x16_bf16 v[156:159], a[18:19], v[130:131], v[4:7]
v_exp_f32_e64 v42, v42
v_mfma_f32_16x16x16_bf16 v[164:167], a[20:21], v[132:133], v[4:7]
v_exp_f32_e64 v58, v58
v_mfma_f32_16x16x16_bf16 v[172:175], a[22:23], v[134:135], v[4:7]
v_exp_f32_e64 v50, v50
v_mfma_f32_16x16x16_bf16 v[148:151], a[32:33], v[104:105], v[148:151]
v_exp_f32_e64 v66, v66
v_mfma_f32_16x16x16_bf16 v[156:159], a[34:35], v[108:109], v[156:159]
v_exp_f32_e64 v43, v43
v_mfma_f32_16x16x16_bf16 v[164:167], a[32:33], v[106:107], v[164:167]
v_exp_f32_e64 v59, v59
v_mfma_f32_16x16x16_bf16 v[172:175], a[34:35], v[110:111], v[172:175]
v_exp_f32_e64 v51, v51
v_mfma_f32_16x16x16_bf16 v[152:155], a[52:53], v[128:129], v[8:11]
v_exp_f32_e64 v67, v67
v_mfma_f32_16x16x16_bf16 v[160:163], a[54:55], v[130:131], v[8:11]
v_cvt_pk_bf16_f32 v44, v40, v41
v_mfma_f32_16x16x16_bf16 v[168:171], a[56:57], v[132:133], v[8:11]
v_cvt_pk_bf16_f32 v60, v56, v57
v_mfma_f32_16x16x16_bf16 v[176:179], a[58:59], v[134:135], v[8:11]
v_cvt_pk_bf16_f32 v52, v48, v49
v_mfma_f32_16x16x16_bf16 v[152:155], a[68:69], v[104:105], v[152:155]
v_cvt_pk_bf16_f32 v68, v64, v65
v_mfma_f32_16x16x16_bf16 v[160:163], a[70:71], v[108:109], v[160:163]
v_cvt_pk_bf16_f32 v45, v42, v43
v_mfma_f32_16x16x16_bf16 v[168:171], a[68:69], v[106:107], v[168:171]
v_cvt_pk_bf16_f32 v61, v58, v59
v_mfma_f32_16x16x16_bf16 v[176:179], a[70:71], v[110:111], v[176:179]
v_cvt_pk_bf16_f32 v53, v50, v51
v_cvt_pk_bf16_f32 v69, v66, v67
v_and_b32 v74, v14, v44
v_and_b32 v82, v14, v60
v_and_b32 v76, v14, v52
v_and_b32 v84, v14, v68
v_and_b32 v75, v15, v45
v_and_b32 v83, v15, v61
v_and_b32 v77, v15, v53
v_and_b32 v85, v15, v69
v_and_b32 v72, v12, v44
v_and_b32 v80, v12, v60
v_and_b32 v78, v12, v52
v_and_b32 v86, v12, v68
v_and_b32 v73, v13, v45
v_and_b32 v81, v13, v61
v_and_b32 v79, v13, v53
v_and_b32 v87, v13, v69
v_mfma_f32_16x16x16_bf16 v[88:91], v[2:3], v[44:45], 0
v_mfma_f32_16x16x16_bf16 v[92:95], v[2:3], v[52:53], 0
v_mfma_f32_16x16x16_bf16 v[96:99], v[2:3], v[60:61], 0
v_mfma_f32_16x16x16_bf16 v[100:103], v[2:3], v[68:69], 0
v_mfma_f32_16x16x32_bf16 v[180:183], a[88:91], v[72:75], 0
v_mfma_f32_16x16x32_bf16 v[184:187], a[136:139], v[72:75], 0
v_mfma_f32_16x16x32_bf16 v[188:191], a[92:95], v[76:79], 0
v_mfma_f32_16x16x32_bf16 v[192:195], a[140:143], v[76:79], 0
v_mfma_f32_16x16x32_bf16 v[196:199], a[96:99], v[80:83], 0
v_mfma_f32_16x16x32_bf16 v[200:203], a[136:139], v[80:83], 0
v_mfma_f32_16x16x32_bf16 v[204:207], a[100:103], v[84:87], 0
v_mfma_f32_16x16x32_bf16 v[208:211], a[140:143], v[84:87], 0
v_max_f32 v40, v152, v148
v_max_f32 v56, v168, v164
v_max_f32 v48, v160, v156
v_max_f32 v64, v176, v172
v_max_f32 v41, v153, v149
v_max_f32 v57, v169, v165
v_max_f32 v49, v161, v157
v_max_f32 v65, v177, v173
v_max_f32 v42, v154, v150
v_max_f32 v58, v170, v166
v_max_f32 v50, v162, v158
v_max_f32 v66, v178, v174
v_max_f32 v43, v155, v151
v_max_f32 v59, v171, v167
v_max_f32 v51, v163, v159
v_max_f32 v67, v179, v175
v_max3_f32 v46, v40, v41, v42
v_rcp_f32_e64 v88, v88
v_max3_f32 v62, v56, v57, v58
v_rcp_f32_e64 v92, v92
v_max3_f32 v54, v48, v49, v50
v_rcp_f32_e64 v96, v96
v_max3_f32 v70, v64, v65, v66
v_rcp_f32 v100, v100
v_max_f32 v46, v46, v43
v_mul_f32 v180, v88, v180
v_max_f32 v62, v62, v59
v_mul_f32 v181, v88, v181
v_max_f32 v54, v54, v51
v_mul_f32 v182, v88, v182
v_max_f32 v70, v70, v67
v_mul_f32 v183, v88, v183
v_permlane32_swap_b32 v46, v54
v_mul_f32 v184, v88, v184
v_permlane32_swap_b32 v62, v70
v_mul_f32 v185, v88, v185
v_max_f32 v46, v46, v54
v_mul_f32 v188, v92, v188
v_max_f32 v62, v62, v70
v_mul_f32 v189, v92, v189
v_mov_b32 v54, v46
v_mul_f32 v190, v92, v190
v_mov_b32 v70, v62
v_mul_f32 v191, v92, v191
v_permlane16_swap_b32 v46, v54
v_mul_f32 v192, v92, v192
v_permlane16_swap_b32 v62, v70
v_mul_f32 v193, v92, v193
v_max_f32 v46, v46, v54
v_mul_f32 v196, v96, v196
v_max_f32 v62, v62, v70
v_mul_f32 v197, v96, v197
v_mul_f32 v46, s99, v46
v_mul_f32 v198, v96, v198
v_mul_f32 v62, s99, v62
v_mul_f32 v199, v96, v199
v_mov_b32 v54, v46
v_mul_f32 v202, v96, v202
v_mov_b32 v70, v62
v_mul_f32 v203, v96, v203
v_permlane32_swap_b32 v46, v54
v_mul_f32 v204, v100, v204
v_permlane32_swap_b32 v62, v70
v_mul_f32_e64 v205, v100, v205
v_fma_f32 v40, v40, s99, -v46
v_mul_f32_e64 v206, v100, v206
v_fma_f32 v56, v56, s99, -v62
v_mul_f32_e64 v207, v100, v207
v_fma_f32 v48, v48, s99, -v54
v_mul_f32_e64 v210, v100, v210
v_fma_f32 v64, v64, s99, -v70
v_mul_f32_e64 v211, v100, v211
v_fma_f32 v41, v41, s99, -v46
v_cvt_pk_bf16_f32 v216, v180, v181
v_fma_f32 v57, v57, s99, -v62
v_cvt_pk_bf16_f32 v217, v182, v183
v_fma_f32 v49, v49, s99, -v54
v_cvt_pk_bf16_f32 v184, v184, v185
v_fma_f32 v65, v65, s99, -v70
v_cvt_pk_bf16_f32 v236, v188, v189
v_fma_f32 v42, v42, s99, -v46
v_cvt_pk_bf16_f32 v237, v190, v191
v_fma_f32 v58, v58, s99, -v62
v_cvt_pk_bf16_f32 v192, v192, v193
v_fma_f32 v50, v50, s99, -v54
v_cvt_pk_bf16_f32 v218, v196, v197
v_fma_f32 v66, v66, s99, -v70
v_cvt_pk_bf16_f32 v219, v198, v199
v_fma_f32 v43, v43, s99, -v46
v_cvt_pk_bf16_f32 v200, v202, v203
v_fma_f32 v59, v59, s99, -v62
v_cvt_pk_bf16_f32 v238, v204, v205
v_fma_f32 v51, v51, s99, -v54
v_cvt_pk_bf16_f32 v239, v206, v207
v_fma_f32 v67, v67, s99, -v70
v_cvt_pk_bf16_f32 v208, v210, v211
v_exp_f32_e64 v40, v40
v_cndmask_b32 v228, v228, v184, s[52:53]
v_exp_f32_e64 v56, v56
v_cndmask_b32 v248, v248, v192, s[52:53]
v_exp_f32_e64 v48, v48
v_cndmask_b32 v229, v229, v200, s[52:53]
v_exp_f32_e64 v64, v64
v_cndmask_b32 v249, v249, v208, s[52:53]
v_exp_f32_e64 v41, v41
buffer_store_dwordx4 v[216:219], v32, s[24:27], s43 offen offset:1024 sc1
v_exp_f32_e64 v57, v57
buffer_store_dwordx4 v[236:239], v32, s[24:27], s44 offen offset:1024 sc1
v_exp_f32_e64 v49, v49
v_cndmask_b32 v104, 0, v144, s[56:57]
v_exp_f32_e64 v65, v65
v_cndmask_b32 v108, 0, v146, s[56:57]
v_exp_f32_e64 v42, v42
v_cndmask_b32 v107, 0, v145, s[56:57]
v_exp_f32_e64 v58, v58
v_cndmask_b32 v111, 0, v147, s[56:57]
v_exp_f32_e64 v50, v50
v_mfma_f32_16x16x16_bf16 v[180:183], a[24:25], v[136:137], v[4:7]
v_exp_f32_e64 v66, v66
v_mfma_f32_16x16x16_bf16 v[188:191], a[26:27], v[138:139], v[4:7]
v_exp_f32_e64 v43, v43
v_mfma_f32_16x16x16_bf16 v[196:199], a[28:29], v[140:141], v[4:7]
v_exp_f32_e64 v59, v59
v_mfma_f32_16x16x16_bf16 v[204:207], a[30:31], v[142:143], v[4:7]
v_exp_f32_e64 v51, v51
v_mfma_f32_16x16x16_bf16 v[180:183], a[32:33], v[104:105], v[180:183]
v_exp_f32_e64 v67, v67
v_mfma_f32_16x16x16_bf16 v[188:191], a[34:35], v[108:109], v[188:191]
v_cvt_pk_bf16_f32 v44, v40, v41
v_mfma_f32_16x16x16_bf16 v[196:199], a[32:33], v[106:107], v[196:199]
v_cvt_pk_bf16_f32 v60, v56, v57
v_mfma_f32_16x16x16_bf16 v[204:207], a[34:35], v[110:111], v[204:207]
v_cvt_pk_bf16_f32 v52, v48, v49
v_mfma_f32_16x16x16_bf16 v[184:187], a[60:61], v[136:137], v[8:11]
v_cvt_pk_bf16_f32 v68, v64, v65
v_mfma_f32_16x16x16_bf16 v[192:195], a[62:63], v[138:139], v[8:11]
v_cvt_pk_bf16_f32 v45, v42, v43
v_mfma_f32_16x16x16_bf16 v[200:203], a[64:65], v[140:141], v[8:11]
v_cvt_pk_bf16_f32 v61, v58, v59
v_mfma_f32_16x16x16_bf16 v[208:211], a[66:67], v[142:143], v[8:11]
v_cvt_pk_bf16_f32 v53, v50, v51
v_mfma_f32_16x16x16_bf16 v[184:187], a[68:69], v[104:105], v[184:187]
v_cvt_pk_bf16_f32 v69, v66, v67
v_mfma_f32_16x16x16_bf16 v[192:195], a[70:71], v[108:109], v[192:195]
v_and_b32_e64 v74, v14, v44
v_mfma_f32_16x16x16_bf16 v[200:203], a[68:69], v[106:107], v[200:203]
v_and_b32_e64 v82, v14, v60
v_mfma_f32_16x16x16_bf16 v[208:211], a[70:71], v[110:111], v[208:211]
v_and_b32 v76, v14, v52
v_and_b32 v84, v14, v68
v_and_b32 v75, v15, v45
v_and_b32 v83, v15, v61
v_and_b32 v77, v15, v53
v_and_b32 v85, v15, v69
v_and_b32 v72, v12, v44
v_and_b32 v80, v12, v60
v_and_b32 v78, v12, v52
v_and_b32 v86, v12, v68
v_and_b32 v73, v13, v45
v_and_b32 v81, v13, v61
v_and_b32 v79, v13, v53
v_and_b32 v87, v13, v69
v_mfma_f32_16x16x16_bf16 v[88:91], v[2:3], v[44:45], 0
v_mfma_f32_16x16x16_bf16 v[92:95], v[2:3], v[52:53], 0
v_mfma_f32_16x16x16_bf16 v[96:99], v[2:3], v[60:61], 0
v_mfma_f32_16x16x16_bf16 v[100:103], v[2:3], v[68:69], 0
v_mfma_f32_16x16x32_bf16 v[148:151], a[104:107], v[72:75], 0
v_mfma_f32_16x16x32_bf16 v[152:155], a[136:139], v[72:75], 0
v_mfma_f32_16x16x32_bf16 v[156:159], a[108:111], v[76:79], 0
v_mfma_f32_16x16x32_bf16 v[160:163], a[140:143], v[76:79], 0
v_mfma_f32_16x16x32_bf16 v[164:167], a[112:115], v[80:83], 0
v_mfma_f32_16x16x32_bf16 v[168:171], a[136:139], v[80:83], 0
v_mfma_f32_16x16x32_bf16 v[172:175], a[116:119], v[84:87], 0
v_mfma_f32_16x16x32_bf16 v[176:179], a[140:143], v[84:87], 0
v_max_f32 v40, v184, v180
v_max_f32 v56, v200, v196
v_max_f32 v48, v192, v188
v_max_f32 v64, v208, v204
v_max_f32 v41, v185, v181
v_max_f32 v57, v201, v197
v_max_f32 v49, v193, v189
v_max_f32 v65, v209, v205
v_max_f32 v42, v186, v182
v_max_f32 v58, v202, v198
v_max_f32 v50, v194, v190
v_max_f32 v66, v210, v206
v_max_f32 v43, v187, v183
v_max_f32 v59, v203, v199
v_max_f32 v51, v195, v191
v_max_f32 v67, v211, v207
v_max3_f32 v46, v40, v41, v42
v_rcp_f32_e64 v88, v88
v_max3_f32 v62, v56, v57, v58
v_rcp_f32_e64 v92, v92
v_max3_f32 v54, v48, v49, v50
v_rcp_f32_e64 v96, v96
v_max3_f32 v70, v64, v65, v66
v_rcp_f32 v100, v100
v_max_f32 v46, v46, v43
v_mul_f32 v148, v88, v148
v_max_f32 v62, v62, v59
v_mul_f32 v149, v88, v149
v_max_f32 v54, v54, v51
v_mul_f32 v150, v88, v150
v_max_f32 v70, v70, v67
v_mul_f32 v151, v88, v151
v_permlane32_swap_b32 v46, v54
v_mul_f32 v152, v88, v152
v_permlane32_swap_b32 v62, v70
v_mul_f32 v153, v88, v153
v_max_f32 v46, v46, v54
v_mul_f32 v156, v92, v156
v_max_f32 v62, v62, v70
v_mul_f32 v157, v92, v157
v_mov_b32 v54, v46
v_mul_f32 v158, v92, v158
v_mov_b32 v70, v62
v_mul_f32 v159, v92, v159
v_permlane16_swap_b32 v46, v54
v_mul_f32 v160, v92, v160
v_permlane16_swap_b32 v62, v70
v_mul_f32 v161, v92, v161
v_max_f32 v46, v46, v54
v_mul_f32 v164, v96, v164
v_max_f32 v62, v62, v70
v_mul_f32 v165, v96, v165
v_mul_f32 v46, s99, v46
v_mul_f32 v166, v96, v166
v_mul_f32 v62, s99, v62
v_mul_f32 v167, v96, v167
v_mov_b32 v54, v46
v_mul_f32 v170, v96, v170
v_mov_b32 v70, v62
v_mul_f32 v171, v96, v171
v_permlane32_swap_b32 v46, v54
v_mul_f32 v172, v100, v172
v_permlane32_swap_b32 v62, v70
v_mul_f32_e64 v173, v100, v173
v_fma_f32 v40, v40, s99, -v46
v_mul_f32_e64 v174, v100, v174
v_fma_f32 v56, v56, s99, -v62
v_mul_f32_e64 v175, v100, v175
v_fma_f32 v48, v48, s99, -v54
v_mul_f32_e64 v178, v100, v178
v_fma_f32 v64, v64, s99, -v70
v_mul_f32_e64 v179, v100, v179
v_fma_f32 v41, v41, s99, -v46
v_cvt_pk_bf16_f32 v220, v148, v149
v_fma_f32 v57, v57, s99, -v62
v_cvt_pk_bf16_f32 v221, v150, v151
v_fma_f32 v49, v49, s99, -v54
v_mov_b32 v33, 1
s_waitcnt vmcnt(0)
s_cmp_eq_u32 s46, 0
s_cbranch_scc1 L_orel0
buffer_store_dword v33, v39, s[24:27], s37 offen
L_orelb0:
v_cvt_pk_bf16_f32 v152, v152, v153
v_fma_f32 v65, v65, s99, -v70
v_cvt_pk_bf16_f32 v240, v156, v157
v_fma_f32 v42, v42, s99, -v46
v_cvt_pk_bf16_f32 v241, v158, v159
v_fma_f32 v58, v58, s99, -v62
v_cvt_pk_bf16_f32 v160, v160, v161
v_fma_f32 v50, v50, s99, -v54
v_cvt_pk_bf16_f32 v222, v164, v165
v_fma_f32 v66, v66, s99, -v70
v_cvt_pk_bf16_f32 v223, v166, v167
v_fma_f32 v43, v43, s99, -v46
v_cvt_pk_bf16_f32 v168, v170, v171
v_fma_f32 v59, v59, s99, -v62
v_cvt_pk_bf16_f32 v242, v172, v173
v_fma_f32 v51, v51, s99, -v54
v_cvt_pk_bf16_f32 v243, v174, v175
v_fma_f32 v67, v67, s99, -v70
v_cvt_pk_bf16_f32 v176, v178, v179
v_exp_f32_e64 v40, v40
v_cndmask_b32 v228, v228, v152, s[54:55]
v_exp_f32_e64 v56, v56
v_cndmask_b32 v248, v248, v160, s[54:55]
v_exp_f32_e64 v48, v48
v_cndmask_b32 v229, v229, v168, s[54:55]
v_exp_f32_e64 v64, v64
v_cndmask_b32 v249, v249, v176, s[54:55]
v_exp_f32 v41, v41
v_exp_f32 v57, v57
v_exp_f32 v49, v49
v_exp_f32 v65, v65
v_exp_f32 v42, v42
v_exp_f32 v58, v58
v_exp_f32 v50, v50
v_exp_f32 v66, v66
v_exp_f32 v43, v43
v_exp_f32 v59, v59
v_exp_f32 v51, v51
v_exp_f32 v67, v67
v_cvt_pk_bf16_f32 v44, v40, v41
v_cvt_pk_bf16_f32 v60, v56, v57
v_cvt_pk_bf16_f32 v52, v48, v49
v_cvt_pk_bf16_f32 v68, v64, v65
v_cvt_pk_bf16_f32 v45, v42, v43
v_cvt_pk_bf16_f32 v61, v58, v59
v_cvt_pk_bf16_f32 v53, v50, v51
v_cvt_pk_bf16_f32 v69, v66, v67
v_and_b32 v74, v14, v44
v_and_b32 v82, v14, v60
v_and_b32 v76, v14, v52
v_and_b32 v84, v14, v68
v_and_b32 v75, v15, v45
v_and_b32 v83, v15, v61
v_and_b32 v77, v15, v53
v_and_b32 v85, v15, v69
v_and_b32 v72, v12, v44
v_and_b32 v80, v12, v60
v_and_b32 v78, v12, v52
v_and_b32 v86, v12, v68
v_and_b32 v73, v13, v45
v_and_b32 v81, v13, v61
v_and_b32 v79, v13, v53
v_and_b32 v87, v13, v69
buffer_load_dword v34, v1, s[24:27], 0 offen sc1
v_mfma_f32_16x16x16_bf16 v[88:91], v[2:3], v[44:45], 0
v_mfma_f32_16x16x16_bf16 v[92:95], v[2:3], v[52:53], 0
v_mfma_f32_16x16x16_bf16 v[96:99], v[2:3], v[60:61], 0
v_mfma_f32_16x16x16_bf16 v[100:103], v[2:3], v[68:69], 0
v_mfma_f32_16x16x32_bf16 v[180:183], a[120:123], v[72:75], 0
v_mfma_f32_16x16x32_bf16 v[184:187], a[136:139], v[72:75], 0
v_mfma_f32_16x16x32_bf16 v[188:191], a[124:127], v[76:79], 0
v_mfma_f32_16x16x32_bf16 v[192:195], a[140:143], v[76:79], 0
v_mfma_f32_16x16x32_bf16 v[196:199], a[128:131], v[80:83], 0
v_mfma_f32_16x16x32_bf16 v[200:203], a[136:139], v[80:83], 0
v_mfma_f32_16x16x32_bf16 v[204:207], a[132:135], v[84:87], 0
v_mfma_f32_16x16x32_bf16 v[208:211], a[140:143], v[84:87], 0
s_waitcnt vmcnt(6)
s_barrier
ds_read_b64_tr_b16 a[192:193], v27 offset:0
ds_read_b64_tr_b16 a[194:195], v27 offset:4608
ds_read_b64_tr_b16 a[196:197], v27 offset:32
ds_read_b64_tr_b16 a[198:199], v27 offset:4640
ds_read_b64_tr_b16 a[200:201], v27 offset:64
ds_read_b64_tr_b16 a[202:203], v27 offset:4672
ds_read_b64_tr_b16 a[204:205], v27 offset:96
ds_read_b64_tr_b16 a[206:207], v27 offset:4704
ds_read_b64_tr_b16 a[208:209], v27 offset:128
ds_read_b64_tr_b16 a[210:211], v27 offset:4736
v_rcp_f32 v88, v88
v_rcp_f32 v92, v92
v_rcp_f32 v96, v96
v_rcp_f32 v100, v100
v_mul_f32 v180, v88, v180
v_mul_f32 v181, v88, v181
v_mul_f32 v182, v88, v182
v_mul_f32 v183, v88, v183
v_mul_f32 v184, v88, v184
v_mul_f32 v185, v88, v185
v_mul_f32 v188, v92, v188
v_mul_f32 v189, v92, v189
v_mul_f32 v190, v92, v190
v_mul_f32 v191, v92, v191
v_mul_f32 v192, v92, v192
v_mul_f32 v193, v92, v193
v_mul_f32 v196, v96, v196
v_mul_f32 v197, v96, v197
v_mul_f32 v198, v96, v198
v_mul_f32 v199, v96, v199
v_mul_f32 v202, v96, v202
v_mul_f32 v203, v96, v203
v_mul_f32 v204, v100, v204
v_mul_f32 v205, v100, v205
v_mul_f32 v206, v100, v206
v_mul_f32 v207, v100, v207
v_mul_f32 v210, v100, v210
v_mul_f32 v211, v100, v211
v_cvt_pk_bf16_f32 v224, v180, v181
v_cvt_pk_bf16_f32 v225, v182, v183
s_waitcnt vmcnt(0)
v_cmp_ge_u32 vcc, 0, v34
v_cvt_pk_bf16_f32 v184, v184, v185
v_cvt_pk_bf16_f32 v244, v188, v189
v_cvt_pk_bf16_f32 v245, v190, v191
v_cvt_pk_bf16_f32 v192, v192, v193
v_cvt_pk_bf16_f32 v226, v196, v197
v_cvt_pk_bf16_f32 v227, v198, v199
v_cvt_pk_bf16_f32 v200, v202, v203
v_cvt_pk_bf16_f32 v246, v204, v205
v_cvt_pk_bf16_f32 v247, v206, v207
v_cvt_pk_bf16_f32 v208, v210, v211
v_cndmask_b32 v228, v228, v184, s[56:57]
v_cndmask_b32 v248, v248, v192, s[56:57]
v_cndmask_b32 v229, v229, v200, s[56:57]
v_cndmask_b32 v249, v249, v208, s[56:57]
s_cbranch_vccnz L_oslow0
L_oback0:
s_add_u32 s47, s72, 4096
buffer_load_dwordx4 a[144:147], v32, s[24:27], s72 offen offset:0 sc1
buffer_load_dwordx4 a[148:151], v32, s[24:27], s47 offen offset:0 sc1
buffer_load_dwordx4 a[152:155], v32, s[24:27], s72 offen offset:1024 sc1
buffer_load_dwordx4 a[156:159], v32, s[24:27], s47 offen offset:1024 sc1
s_waitcnt lgkmcnt(4)
v_mfma_f32_16x16x32_bf16 v[40:43], a[192:195], v[212:215], 0
ds_read_b64_tr_b16 a[212:213], v27 offset:160
ds_read_b64_tr_b16 a[214:215], v27 offset:4768
v_mfma_f32_16x16x32_bf16 v[44:47], a[192:195], v[232:235], 0
buffer_store_dwordx4 v[220:223], v32, s[24:27], s43 offen offset:2048 sc1
v_mfma_f32_16x16x32_bf16 v[48:51], a[196:199], v[212:215], 0
ds_read_b64_tr_b16 a[216:217], v27 offset:192
ds_read_b64_tr_b16 a[218:219], v27 offset:4800
v_mfma_f32_16x16x32_bf16 v[52:55], a[196:199], v[232:235], 0
buffer_store_dwordx4 v[240:243], v32, s[24:27], s44 offen offset:2048 sc1
v_mfma_f32_16x16x32_bf16 v[56:59], a[200:203], v[212:215], 0
ds_read_b64_tr_b16 a[220:221], v27 offset:224
ds_read_b64_tr_b16 a[222:223], v27 offset:4832
v_mfma_f32_16x16x32_bf16 v[60:63], a[200:203], v[232:235], 0
s_waitcnt lgkmcnt(4)
v_mfma_f32_16x16x32_bf16 v[64:67], a[204:207], v[212:215], 0
ds_read_b64_tr_b16 a[224:225], v27 offset:256
ds_read_b64_tr_b16 a[226:227], v27 offset:4864
v_mfma_f32_16x16x32_bf16 v[68:71], a[204:207], v[232:235], 0
buffer_store_dwordx4 v[224:227], v32, s[24:27], s43 offen offset:3072 sc1
v_mfma_f32_16x16x32_bf16 v[72:75], a[208:211], v[212:215], 0
ds_read_b64_tr_b16 a[228:229], v27 offset:9216
ds_read_b64_tr_b16 a[230:231], v27 offset:13824
v_mfma_f32_16x16x32_bf16 v[76:79], a[208:211], v[232:235], 0
buffer_store_dwordx4 v[244:247], v32, s[24:27], s44 offen offset:3072 sc1
v_mfma_f32_16x16x32_bf16 v[80:83], a[212:215], v[212:215], 0
ds_read_b64_tr_b16 a[232:233], v27 offset:9248
ds_read_b64_tr_b16 a[234:235], v27 offset:13856
v_mfma_f32_16x16x32_bf16 v[84:87], a[212:215], v[232:235], 0
s_waitcnt lgkmcnt(4)
v_mfma_f32_16x16x32_bf16 v[88:91], a[216:219], v[212:215], 0
ds_read_b64_tr_b16 a[236:237], v27 offset:9280
ds_read_b64_tr_b16 a[238:239], v27 offset:13888
v_mfma_f32_16x16x32_bf16 v[92:95], a[216:219], v[232:235], 0
buffer_store_dwordx2 v[228:229], v38, s[24:27], s45 offen sc1
v_mfma_f32_16x16x32_bf16 v[96:99], a[220:223], v[212:215], 0
ds_read_b64_tr_b16 a[240:241], v27 offset:9312
ds_read_b64_tr_b16 a[242:243], v27 offset:13920
v_mfma_f32_16x16x32_bf16 v[100:103], a[220:223], v[232:235], 0
buffer_store_dwordx2 v[248:249], v38, s[24:27], s45 offen offset:512 sc1
v_mfma_f32_16x16x32_bf16 v[104:107], a[224:227], v[212:215], 0
ds_read_b64_tr_b16 a[244:245], v27 offset:9344
ds_read_b64_tr_b16 a[246:247], v27 offset:13952
v_mfma_f32_16x16x32_bf16 v[108:111], a[224:227], v[232:235], 0
s_add_u32 s47, s73, 4096
s_waitcnt lgkmcnt(4)
v_mfma_f32_16x16x32_bf16 v[40:43], a[228:231], v[216:219], v[40:43]
ds_read_b64_tr_b16 a[248:249], v27 offset:9376
ds_read_b64_tr_b16 a[250:251], v27 offset:13984
v_mfma_f32_16x16x32_bf16 v[44:47], a[228:231], v[236:239], v[44:47]
buffer_load_dwordx4 a[160:163], v32, s[24:27], s73 offen offset:0 sc1
v_mfma_f32_16x16x32_bf16 v[48:51], a[232:235], v[216:219], v[48:51]
ds_read_b64_tr_b16 a[252:253], v27 offset:9408
ds_read_b64_tr_b16 a[254:255], v27 offset:14016
v_mfma_f32_16x16x32_bf16 v[52:55], a[232:235], v[236:239], v[52:55]
buffer_load_dwordx4 a[164:167], v32, s[24:27], s47 offen offset:0 sc1
v_mfma_f32_16x16x32_bf16 v[56:59], a[236:239], v[216:219], v[56:59]
ds_read_b64_tr_b16 a[192:193], v27 offset:9440
ds_read_b64_tr_b16 a[194:195], v27 offset:14048
v_mfma_f32_16x16x32_bf16 v[60:63], a[236:239], v[236:239], v[60:63]
s_waitcnt lgkmcnt(4)
v_mfma_f32_16x16x32_bf16 v[64:67], a[240:243], v[216:219], v[64:67]
ds_read_b64_tr_b16 a[196:197], v27 offset:9472
ds_read_b64_tr_b16 a[198:199], v27 offset:14080
v_mfma_f32_16x16x32_bf16 v[68:71], a[240:243], v[236:239], v[68:71]
buffer_load_dwordx4 a[168:171], v32, s[24:27], s73 offen offset:1024 sc1
v_mfma_f32_16x16x32_bf16 v[72:75], a[244:247], v[216:219], v[72:75]
ds_read_b64_tr_b16 a[200:201], v27 offset:18432
ds_read_b64_tr_b16 a[202:203], v27 offset:23040
v_mfma_f32_16x16x32_bf16 v[76:79], a[244:247], v[236:239], v[76:79]
buffer_load_dwordx4 a[172:175], v32, s[24:27], s47 offen offset:1024 sc1
v_mfma_f32_16x16x32_bf16 v[80:83], a[248:251], v[216:219], v[80:83]
ds_read_b64_tr_b16 a[204:205], v27 offset:18464
ds_read_b64_tr_b16 a[206:207], v27 offset:23072
v_mfma_f32_16x16x32_bf16 v[84:87], a[248:251], v[236:239], v[84:87]
s_add_u32 s47, s74, 4096
s_waitcnt lgkmcnt(4)
v_mfma_f32_16x16x32_bf16 v[88:91], a[252:255], v[216:219], v[88:91]
ds_read_b64_tr_b16 a[208:209], v27 offset:18496
ds_read_b64_tr_b16 a[210:211], v27 offset:23104
v_mfma_f32_16x16x32_bf16 v[92:95], a[252:255], v[236:239], v[92:95]
buffer_load_dwordx4 a[176:179], v32, s[24:27], s74 offen offset:0 sc1
v_mfma_f32_16x16x32_bf16 v[96:99], a[192:195], v[216:219], v[96:99]
ds_read_b64_tr_b16 a[212:213], v27 offset:18528
ds_read_b64_tr_b16 a[214:215], v27 offset:23136
v_mfma_f32_16x16x32_bf16 v[100:103], a[192:195], v[236:239], v[100:103]
buffer_load_dwordx4 a[180:183], v32, s[24:27], s47 offen offset:0 sc1
v_mfma_f32_16x16x32_bf16 v[104:107], a[196:199], v[216:219], v[104:107]
ds_read_b64_tr_b16 a[216:217], v27 offset:18560
ds_read_b64_tr_b16 a[218:219], v27 offset:23168
v_mfma_f32_16x16x32_bf16 v[108:111], a[196:199], v[236:239], v[108:111]
s_waitcnt lgkmcnt(4)
v_mfma_f32_16x16x32_bf16 v[40:43], a[200:203], v[220:223], v[40:43]
ds_read_b64_tr_b16 a[220:221], v27 offset:18592
ds_read_b64_tr_b16 a[222:223], v27 offset:23200
v_mfma_f32_16x16x32_bf16 v[44:47], a[200:203], v[240:243], v[44:47]
buffer_load_dwordx4 a[184:187], v32, s[24:27], s74 offen offset:1024 sc1
v_mfma_f32_16x16x32_bf16 v[48:51], a[204:207], v[220:223], v[48:51]
ds_read_b64_tr_b16 a[224:225], v27 offset:18624
ds_read_b64_tr_b16 a[226:227], v27 offset:23232
v_mfma_f32_16x16x32_bf16 v[52:55], a[204:207], v[240:243], v[52:55]
buffer_load_dwordx4 a[188:191], v32, s[24:27], s47 offen offset:1024 sc1
v_mfma_f32_16x16x32_bf16 v[56:59], a[208:211], v[220:223], v[56:59]
ds_read_b64_tr_b16 a[228:229], v27 offset:18656
ds_read_b64_tr_b16 a[230:231], v27 offset:23264
v_mfma_f32_16x16x32_bf16 v[60:63], a[208:211], v[240:243], v[60:63]
s_waitcnt lgkmcnt(4)
v_mfma_f32_16x16x32_bf16 v[64:67], a[212:215], v[220:223], v[64:67]
ds_read_b64_tr_b16 a[232:233], v27 offset:18688
ds_read_b64_tr_b16 a[234:235], v27 offset:23296
v_mfma_f32_16x16x32_bf16 v[68:71], a[212:215], v[240:243], v[68:71]
v_mfma_f32_16x16x32_bf16 v[72:75], a[216:219], v[220:223], v[72:75]
ds_read_b64_tr_b16 a[236:237], v27 offset:27648
ds_read_b64_tr_b16 a[238:239], v27 offset:32256
v_mfma_f32_16x16x32_bf16 v[76:79], a[216:219], v[240:243], v[76:79]
v_mfma_f32_16x16x32_bf16 v[80:83], a[220:223], v[220:223], v[80:83]
ds_read_b64_tr_b16 a[240:241], v27 offset:27680
ds_read_b64_tr_b16 a[242:243], v27 offset:32288
v_mfma_f32_16x16x32_bf16 v[84:87], a[220:223], v[240:243], v[84:87]
s_waitcnt lgkmcnt(4)
v_mfma_f32_16x16x32_bf16 v[88:91], a[224:227], v[220:223], v[88:91]
ds_read_b64_tr_b16 a[244:245], v27 offset:27712
ds_read_b64_tr_b16 a[246:247], v27 offset:32320
v_mfma_f32_16x16x32_bf16 v[92:95], a[224:227], v[240:243], v[92:95]
v_mfma_f32_16x16x32_bf16 v[96:99], a[228:231], v[220:223], v[96:99]
ds_read_b64_tr_b16 a[248:249], v27 offset:27744
ds_read_b64_tr_b16 a[250:251], v27 offset:32352
v_mfma_f32_16x16x32_bf16 v[100:103], a[228:231], v[240:243], v[100:103]
v_mfma_f32_16x16x32_bf16 v[104:107], a[232:235], v[220:223], v[104:107]
ds_read_b64_tr_b16 a[252:253], v27 offset:27776
ds_read_b64_tr_b16 a[254:255], v27 offset:32384
v_mfma_f32_16x16x32_bf16 v[108:111], a[232:235], v[240:243], v[108:111]
s_waitcnt lgkmcnt(4)
v_mfma_f32_16x16x32_bf16 v[40:43], a[236:239], v[224:227], v[40:43]
ds_read_b64_tr_b16 a[192:193], v27 offset:27808
ds_read_b64_tr_b16 a[194:195], v27 offset:32416
v_mfma_f32_16x16x32_bf16 v[44:47], a[236:239], v[244:247], v[44:47]
v_mfma_f32_16x16x32_bf16 v[48:51], a[240:243], v[224:227], v[48:51]
ds_read_b64_tr_b16 a[196:197], v27 offset:27840
ds_read_b64_tr_b16 a[198:199], v27 offset:32448
v_mfma_f32_16x16x32_bf16 v[52:55], a[240:243], v[244:247], v[52:55]
v_mfma_f32_16x16x32_bf16 v[56:59], a[244:247], v[224:227], v[56:59]
ds_read_b64_tr_b16 a[200:201], v27 offset:27872
ds_read_b64_tr_b16 a[202:203], v27 offset:32480
v_mfma_f32_16x16x32_bf16 v[60:63], a[244:247], v[244:247], v[60:63]
s_waitcnt lgkmcnt(4)
v_mfma_f32_16x16x32_bf16 v[64:67], a[248:251], v[224:227], v[64:67]
ds_read_b64_tr_b16 a[204:205], v27 offset:27904
ds_read_b64_tr_b16 a[206:207], v27 offset:32512
v_mfma_f32_16x16x32_bf16 v[68:71], a[248:251], v[244:247], v[68:71]
v_mfma_f32_16x16x32_bf16 v[72:75], a[252:255], v[224:227], v[72:75]
ds_read_b64_tr_b16 a[208:209], v27 offset:36864
ds_read_b64_tr_b16 a[210:211], v27 offset:41472
v_mfma_f32_16x16x32_bf16 v[76:79], a[252:255], v[244:247], v[76:79]
v_mfma_f32_16x16x32_bf16 v[80:83], a[192:195], v[224:227], v[80:83]
ds_read_b64_tr_b16 a[212:213], v27 offset:36896
ds_read_b64_tr_b16 a[214:215], v27 offset:41504
v_mfma_f32_16x16x32_bf16 v[84:87], a[192:195], v[244:247], v[84:87]
s_waitcnt lgkmcnt(4)
v_mfma_f32_16x16x32_bf16 v[88:91], a[196:199], v[224:227], v[88:91]
ds_read_b64_tr_b16 a[216:217], v27 offset:36928
ds_read_b64_tr_b16 a[218:219], v27 offset:41536
v_mfma_f32_16x16x32_bf16 v[92:95], a[196:199], v[244:247], v[92:95]
v_mfma_f32_16x16x32_bf16 v[96:99], a[200:203], v[224:227], v[96:99]
ds_read_b64_tr_b16 a[220:221], v27 offset:36960
ds_read_b64_tr_b16 a[222:223], v27 offset:41568
v_mfma_f32_16x16x32_bf16 v[100:103], a[200:203], v[244:247], v[100:103]
v_mfma_f32_16x16x32_bf16 v[104:107], a[204:207], v[224:227], v[104:107]
ds_read_b64_tr_b16 a[224:225], v27 offset:36992
ds_read_b64_tr_b16 a[226:227], v27 offset:41600
v_mfma_f32_16x16x32_bf16 v[108:111], a[204:207], v[244:247], v[108:111]
s_waitcnt lgkmcnt(4)
s_waitcnt vmcnt(16)
v_mfma_f32_16x16x32_bf16 v[40:43], a[208:211], a[144:147], v[40:43]
ds_read_b64_tr_b16 a[228:229], v27 offset:37024
ds_read_b64_tr_b16 a[230:231], v27 offset:41632
v_mfma_f32_16x16x32_bf16 v[44:47], a[208:211], a[148:151], v[44:47]
v_mov_b32_e64 v33, 2
s_waitcnt vmcnt(8)
s_cmp_eq_u32 s46, 0
s_cbranch_scc1 L_orel1
buffer_store_dword v33, v39, s[24:27], s37 offen
L_orelb1:
v_mfma_f32_16x16x32_bf16 v[48:51], a[212:215], a[144:147], v[48:51]
ds_read_b64_tr_b16 a[232:233], v27 offset:37056
ds_read_b64_tr_b16 a[234:235], v27 offset:41664
v_mfma_f32_16x16x32_bf16 v[52:55], a[212:215], a[148:151], v[52:55]
v_mfma_f32_16x16x32_bf16 v[56:59], a[216:219], a[144:147], v[56:59]
ds_read_b64_tr_b16 a[236:237], v27 offset:37088
ds_read_b64_tr_b16 a[238:239], v27 offset:41696
v_mfma_f32_16x16x32_bf16 v[60:63], a[216:219], a[148:151], v[60:63]
s_waitcnt lgkmcnt(4)
v_mfma_f32_16x16x32_bf16 v[64:67], a[220:223], a[144:147], v[64:67]
ds_read_b64_tr_b16 a[240:241], v27 offset:37120
ds_read_b64_tr_b16 a[242:243], v27 offset:41728
v_mfma_f32_16x16x32_bf16 v[68:71], a[220:223], a[148:151], v[68:71]
v_mfma_f32_16x16x32_bf16 v[72:75], a[224:227], a[144:147], v[72:75]
ds_read_b64_tr_b16 a[244:245], v27 offset:46080
ds_read_b64_tr_b16 a[246:247], v27 offset:50688
v_mfma_f32_16x16x32_bf16 v[76:79], a[224:227], a[148:151], v[76:79]
v_mfma_f32_16x16x32_bf16 v[80:83], a[228:231], a[144:147], v[80:83]
ds_read_b64_tr_b16 a[248:249], v27 offset:46112
ds_read_b64_tr_b16 a[250:251], v27 offset:50720
v_mfma_f32_16x16x32_bf16 v[84:87], a[228:231], a[148:151], v[84:87]
s_waitcnt lgkmcnt(4)
v_mfma_f32_16x16x32_bf16 v[88:91], a[232:235], a[144:147], v[88:91]
ds_read_b64_tr_b16 a[252:253], v27 offset:46144
ds_read_b64_tr_b16 a[254:255], v27 offset:50752
v_mfma_f32_16x16x32_bf16 v[92:95], a[232:235], a[148:151], v[92:95]
v_mfma_f32_16x16x32_bf16 v[96:99], a[236:239], a[144:147], v[96:99]
ds_read_b64_tr_b16 a[192:193], v27 offset:46176
ds_read_b64_tr_b16 a[194:195], v27 offset:50784
v_mfma_f32_16x16x32_bf16 v[100:103], a[236:239], a[148:151], v[100:103]
v_mfma_f32_16x16x32_bf16 v[104:107], a[240:243], a[144:147], v[104:107]
ds_read_b64_tr_b16 a[196:197], v27 offset:46208
ds_read_b64_tr_b16 a[198:199], v27 offset:50816
v_mfma_f32_16x16x32_bf16 v[108:111], a[240:243], a[148:151], v[108:111]
s_waitcnt lgkmcnt(4)
s_waitcnt vmcnt(15)
v_mfma_f32_16x16x32_bf16 v[40:43], a[244:247], a[152:155], v[40:43]
ds_read_b64_tr_b16 a[200:201], v27 offset:46240
ds_read_b64_tr_b16 a[202:203], v27 offset:50848
v_mfma_f32_16x16x32_bf16 v[44:47], a[244:247], a[156:159], v[44:47]
v_mfma_f32_16x16x32_bf16 v[48:51], a[248:251], a[152:155], v[48:51]
ds_read_b64_tr_b16 a[204:205], v27 offset:46272
ds_read_b64_tr_b16 a[206:207], v27 offset:50880
v_mfma_f32_16x16x32_bf16 v[52:55], a[248:251], a[156:159], v[52:55]
v_mfma_f32_16x16x32_bf16 v[56:59], a[252:255], a[152:155], v[56:59]
ds_read_b64_tr_b16 a[208:209], v27 offset:46304
ds_read_b64_tr_b16 a[210:211], v27 offset:50912
v_mfma_f32_16x16x32_bf16 v[60:63], a[252:255], a[156:159], v[60:63]
s_waitcnt lgkmcnt(4)
v_mfma_f32_16x16x32_bf16 v[64:67], a[192:195], a[152:155], v[64:67]
ds_read_b64_tr_b16 a[212:213], v27 offset:46336
ds_read_b64_tr_b16 a[214:215], v27 offset:50944
v_mfma_f32_16x16x32_bf16 v[68:71], a[192:195], a[156:159], v[68:71]
v_mfma_f32_16x16x32_bf16 v[72:75], a[196:199], a[152:155], v[72:75]
s_barrier
v_mfma_f32_16x16x32_bf16 v[76:79], a[196:199], a[156:159], v[76:79]
ds_read_b64_tr_b16 a[216:217], v28 offset:0
ds_read_b64_tr_b16 a[218:219], v28 offset:4608
v_mfma_f32_16x16x32_bf16 v[80:83], a[200:203], a[152:155], v[80:83]
ds_read_b64_tr_b16 a[220:221], v28 offset:32
ds_read_b64_tr_b16 a[222:223], v28 offset:4640
v_mfma_f32_16x16x32_bf16 v[84:87], a[200:203], a[156:159], v[84:87]
buffer_load_dword v34, v1, s[24:27], 0 offen sc1
s_waitcnt lgkmcnt(4)
v_mfma_f32_16x16x32_bf16 v[88:91], a[204:207], a[152:155], v[88:91]
ds_read_b64_tr_b16 a[224:225], v28 offset:64
ds_read_b64_tr_b16 a[226:227], v28 offset:4672
v_mfma_f32_16x16x32_bf16 v[92:95], a[204:207], a[156:159], v[92:95]
v_mfma_f32_16x16x32_bf16 v[96:99], a[208:211], a[152:155], v[96:99]
ds_read_b64_tr_b16 a[228:229], v28 offset:96
ds_read_b64_tr_b16 a[230:231], v28 offset:4704
v_mfma_f32_16x16x32_bf16 v[100:103], a[208:211], a[156:159], v[100:103]
v_mfma_f32_16x16x32_bf16 v[104:107], a[212:215], a[152:155], v[104:107]
ds_read_b64_tr_b16 a[232:233], v28 offset:128
ds_read_b64_tr_b16 a[234:235], v28 offset:4736
v_mfma_f32_16x16x32_bf16 v[108:111], a[212:215], a[156:159], v[108:111]
s_waitcnt lgkmcnt(4)
s_waitcnt vmcnt(8)
v_mfma_f32_16x16x32_bf16 v[40:43], a[216:219], a[160:163], v[40:43]
ds_read_b64_tr_b16 a[236:237], v28 offset:160
ds_read_b64_tr_b16 a[238:239], v28 offset:4768
v_mfma_f32_16x16x32_bf16 v[44:47], a[216:219], a[164:167], v[44:47]
v_mfma_f32_16x16x32_bf16 v[48:51], a[220:223], a[160:163], v[48:51]
ds_read_b64_tr_b16 a[240:241], v28 offset:192
ds_read_b64_tr_b16 a[242:243], v28 offset:4800
v_mfma_f32_16x16x32_bf16 v[52:55], a[220:223], a[164:167], v[52:55]
v_mfma_f32_16x16x32_bf16 v[56:59], a[224:227], a[160:163], v[56:59]
ds_read_b64_tr_b16 a[244:245], v28 offset:224
ds_read_b64_tr_b16 a[246:247], v28 offset:4832
v_mfma_f32_16x16x32_bf16 v[60:63], a[224:227], a[164:167], v[60:63]
s_waitcnt lgkmcnt(4)
v_mfma_f32_16x16x32_bf16 v[64:67], a[228:231], a[160:163], v[64:67]
ds_read_b64_tr_b16 a[248:249], v28 offset:256
ds_read_b64_tr_b16 a[250:251], v28 offset:4864
v_mfma_f32_16x16x32_bf16 v[68:71], a[228:231], a[164:167], v[68:71]
v_mfma_f32_16x16x32_bf16 v[72:75], a[232:235], a[160:163], v[72:75]
ds_read_b64_tr_b16 a[252:253], v28 offset:9216
ds_read_b64_tr_b16 a[254:255], v28 offset:13824
v_mfma_f32_16x16x32_bf16 v[76:79], a[232:235], a[164:167], v[76:79]
v_mfma_f32_16x16x32_bf16 v[80:83], a[236:239], a[160:163], v[80:83]
ds_read_b64_tr_b16 a[192:193], v28 offset:9248
ds_read_b64_tr_b16 a[194:195], v28 offset:13856
v_mfma_f32_16x16x32_bf16 v[84:87], a[236:239], a[164:167], v[84:87]
s_waitcnt lgkmcnt(4)
v_mfma_f32_16x16x32_bf16 v[88:91], a[240:243], a[160:163], v[88:91]
ds_read_b64_tr_b16 a[196:197], v28 offset:9280
ds_read_b64_tr_b16 a[198:199], v28 offset:13888
v_mfma_f32_16x16x32_bf16 v[92:95], a[240:243], a[164:167], v[92:95]
s_waitcnt vmcnt(0)
v_cmp_ge_u32_e64 vcc, 1, v34
v_mfma_f32_16x16x32_bf16 v[96:99], a[244:247], a[160:163], v[96:99]
ds_read_b64_tr_b16 a[200:201], v28 offset:9312
ds_read_b64_tr_b16 a[202:203], v28 offset:13920
v_mfma_f32_16x16x32_bf16 v[100:103], a[244:247], a[164:167], v[100:103]
s_cbranch_vccnz L_oslow1
L_oback1:
v_mfma_f32_16x16x32_bf16 v[104:107], a[248:251], a[160:163], v[104:107]
ds_read_b64_tr_b16 a[204:205], v28 offset:9344
ds_read_b64_tr_b16 a[206:207], v28 offset:13952
v_mfma_f32_16x16x32_bf16 v[108:111], a[248:251], a[164:167], v[108:111]
s_waitcnt lgkmcnt(4)
s_waitcnt vmcnt(6)
v_mfma_f32_16x16x32_bf16 v[40:43], a[252:255], a[168:171], v[40:43]
ds_read_b64_tr_b16 a[208:209], v28 offset:9376
ds_read_b64_tr_b16 a[210:211], v28 offset:13984
v_mfma_f32_16x16x32_bf16 v[44:47], a[252:255], a[172:175], v[44:47]
s_add_u32 s47, s72, 4096
v_mfma_f32_16x16x32_bf16 v[48:51], a[192:195], a[168:171], v[48:51]
ds_read_b64_tr_b16 a[212:213], v28 offset:9408
ds_read_b64_tr_b16 a[214:215], v28 offset:14016
v_mfma_f32_16x16x32_bf16 v[52:55], a[192:195], a[172:175], v[52:55]
buffer_load_dwordx4 a[0:3], v32, s[24:27], s72 offen offset:2048 sc1
v_mfma_f32_16x16x32_bf16 v[56:59], a[196:199], a[168:171], v[56:59]
ds_read_b64_tr_b16 a[216:217], v28 offset:9440
ds_read_b64_tr_b16 a[218:219], v28 offset:14048
v_mfma_f32_16x16x32_bf16 v[60:63], a[196:199], a[172:175], v[60:63]
s_waitcnt lgkmcnt(4)
v_mfma_f32_16x16x32_bf16 v[64:67], a[200:203], a[168:171], v[64:67]
ds_read_b64_tr_b16 a[220:221], v28 offset:9472
ds_read_b64_tr_b16 a[222:223], v28 offset:14080
v_mfma_f32_16x16x32_bf16 v[68:71], a[200:203], a[172:175], v[68:71]
buffer_load_dwordx4 a[4:7], v32, s[24:27], s47 offen offset:2048 sc1
v_mfma_f32_16x16x32_bf16 v[72:75], a[204:207], a[168:171], v[72:75]
ds_read_b64_tr_b16 a[224:225], v28 offset:18432
ds_read_b64_tr_b16 a[226:227], v28 offset:23040
v_mfma_f32_16x16x32_bf16 v[76:79], a[204:207], a[172:175], v[76:79]
buffer_load_dwordx4 a[8:11], v32, s[24:27], s72 offen offset:3072 sc1
v_mfma_f32_16x16x32_bf16 v[80:83], a[208:211], a[168:171], v[80:83]
ds_read_b64_tr_b16 a[228:229], v28 offset:18464
ds_read_b64_tr_b16 a[230:231], v28 offset:23072
v_mfma_f32_16x16x32_bf16 v[84:87], a[208:211], a[172:175], v[84:87]
s_waitcnt lgkmcnt(4)
v_mfma_f32_16x16x32_bf16 v[88:91], a[212:215], a[168:171], v[88:91]
ds_read_b64_tr_b16 a[232:233], v28 offset:18496
ds_read_b64_tr_b16 a[234:235], v28 offset:23104
v_mfma_f32_16x16x32_bf16 v[92:95], a[212:215], a[172:175], v[92:95]
buffer_load_dwordx4 a[12:15], v32, s[24:27], s47 offen offset:3072 sc1
v_mfma_f32_16x16x32_bf16 v[96:99], a[216:219], a[168:171], v[96:99]
ds_read_b64_tr_b16 a[236:237], v28 offset:18528
ds_read_b64_tr_b16 a[238:239], v28 offset:23136
v_mfma_f32_16x16x32_bf16 v[100:103], a[216:219], a[172:175], v[100:103]
s_add_u32 s47, s73, 4096
v_mfma_f32_16x16x32_bf16 v[104:107], a[220:223], a[168:171], v[104:107]
ds_read_b64_tr_b16 a[240:241], v28 offset:18560
ds_read_b64_tr_b16 a[242:243], v28 offset:23168
v_mfma_f32_16x16x32_bf16 v[108:111], a[220:223], a[172:175], v[108:111]
s_waitcnt lgkmcnt(4)
s_waitcnt vmcnt(8)
v_mfma_f32_16x16x32_bf16 v[40:43], a[224:227], a[176:179], v[40:43]
ds_read_b64_tr_b16 a[244:245], v28 offset:18592
ds_read_b64_tr_b16 a[246:247], v28 offset:23200
v_mfma_f32_16x16x32_bf16 v[44:47], a[224:227], a[180:183], v[44:47]
buffer_load_dwordx4 a[16:19], v32, s[24:27], s73 offen offset:2048 sc1
v_mfma_f32_16x16x32_bf16 v[48:51], a[228:231], a[176:179], v[48:51]
ds_read_b64_tr_b16 a[248:249], v28 offset:18624
ds_read_b64_tr_b16 a[250:251], v28 offset:23232
v_mfma_f32_16x16x32_bf16 v[52:55], a[228:231], a[180:183], v[52:55]
buffer_load_dwordx4 a[20:23], v32, s[24:27], s47 offen offset:2048 sc1
v_mfma_f32_16x16x32_bf16 v[56:59], a[232:235], a[176:179], v[56:59]
ds_read_b64_tr_b16 a[252:253], v28 offset:18656
ds_read_b64_tr_b16 a[254:255], v28 offset:23264
v_mfma_f32_16x16x32_bf16 v[60:63], a[232:235], a[180:183], v[60:63]
s_waitcnt lgkmcnt(4)
v_mfma_f32_16x16x32_bf16 v[64:67], a[236:239], a[176:179], v[64:67]
ds_read_b64_tr_b16 a[192:193], v28 offset:18688
ds_read_b64_tr_b16 a[194:195], v28 offset:23296
v_mfma_f32_16x16x32_bf16 v[68:71], a[236:239], a[180:183], v[68:71]
buffer_load_dwordx4 a[24:27], v32, s[24:27], s73 offen offset:3072 sc1
v_mfma_f32_16x16x32_bf16 v[72:75], a[240:243], a[176:179], v[72:75]
ds_read_b64_tr_b16 a[196:197], v28 offset:27648
ds_read_b64_tr_b16 a[198:199], v28 offset:32256
v_mfma_f32_16x16x32_bf16 v[76:79], a[240:243], a[180:183], v[76:79]
buffer_load_dwordx4 a[28:31], v32, s[24:27], s47 offen offset:3072 sc1
v_mfma_f32_16x16x32_bf16 v[80:83], a[244:247], a[176:179], v[80:83]
ds_read_b64_tr_b16 a[200:201], v28 offset:27680
ds_read_b64_tr_b16 a[202:203], v28 offset:32288
v_mfma_f32_16x16x32_bf16 v[84:87], a[244:247], a[180:183], v[84:87]
s_add_u32 s47, s74, 4096
s_waitcnt lgkmcnt(4)
v_mfma_f32_16x16x32_bf16 v[88:91], a[248:251], a[176:179], v[88:91]
ds_read_b64_tr_b16 a[204:205], v28 offset:27712
ds_read_b64_tr_b16 a[206:207], v28 offset:32320
v_mfma_f32_16x16x32_bf16 v[92:95], a[248:251], a[180:183], v[92:95]
buffer_load_dwordx4 a[32:35], v32, s[24:27], s74 offen offset:2048 sc1
v_mfma_f32_16x16x32_bf16 v[96:99], a[252:255], a[176:179], v[96:99]
ds_read_b64_tr_b16 a[208:209], v28 offset:27744
ds_read_b64_tr_b16 a[210:211], v28 offset:32352
v_mfma_f32_16x16x32_bf16 v[100:103], a[252:255], a[180:183], v[100:103]
buffer_load_dwordx4 a[36:39], v32, s[24:27], s47 offen offset:2048 sc1
v_mfma_f32_16x16x32_bf16 v[104:107], a[192:195], a[176:179], v[104:107]
ds_read_b64_tr_b16 a[212:213], v28 offset:27776
ds_read_b64_tr_b16 a[214:215], v28 offset:32384
v_mfma_f32_16x16x32_bf16 v[108:111], a[192:195], a[180:183], v[108:111]
s_waitcnt lgkmcnt(4)
s_waitcnt vmcnt(12)
v_mfma_f32_16x16x32_bf16 v[40:43], a[196:199], a[184:187], v[40:43]
ds_read_b64_tr_b16 a[216:217], v28 offset:27808
ds_read_b64_tr_b16 a[218:219], v28 offset:32416
v_mfma_f32_16x16x32_bf16 v[44:47], a[196:199], a[188:191], v[44:47]
buffer_load_dwordx4 a[40:43], v32, s[24:27], s74 offen offset:3072 sc1
v_mfma_f32_16x16x32_bf16 v[48:51], a[200:203], a[184:187], v[48:51]
ds_read_b64_tr_b16 a[220:221], v28 offset:27840
ds_read_b64_tr_b16 a[222:223], v28 offset:32448
v_mfma_f32_16x16x32_bf16 v[52:55], a[200:203], a[188:191], v[52:55]
buffer_load_dwordx4 a[44:47], v32, s[24:27], s47 offen offset:3072 sc1
v_mfma_f32_16x16x32_bf16 v[56:59], a[204:207], a[184:187], v[56:59]
ds_read_b64_tr_b16 a[224:225], v28 offset:27872
ds_read_b64_tr_b16 a[226:227], v28 offset:32480
v_mfma_f32_16x16x32_bf16 v[60:63], a[204:207], a[188:191], v[60:63]
s_add_u32 s44, s72, 8192
s_waitcnt lgkmcnt(4)
v_mfma_f32_16x16x32_bf16 v[64:67], a[208:211], a[184:187], v[64:67]
ds_read_b64_tr_b16 a[228:229], v28 offset:27904
ds_read_b64_tr_b16 a[230:231], v28 offset:32512
v_mfma_f32_16x16x32_bf16 v[68:71], a[208:211], a[188:191], v[68:71]
buffer_load_dwordx2 v[230:231], v38, s[24:27], s44 offen offset:0 sc1
v_mfma_f32_16x16x32_bf16 v[72:75], a[212:215], a[184:187], v[72:75]
ds_read_b64_tr_b16 a[232:233], v26 offset:0
ds_read_b64_tr_b16 a[234:235], v26 offset:4608
v_mfma_f32_16x16x32_bf16 v[76:79], a[212:215], a[188:191], v[76:79]
buffer_load_dwordx2 v[250:251], v38, s[24:27], s44 offen offset:512 sc1
v_mfma_f32_16x16x32_bf16 v[80:83], a[216:219], a[184:187], v[80:83]
ds_read_b64_tr_b16 a[236:237], v26 offset:32
ds_read_b64_tr_b16 a[238:239], v26 offset:4640
v_mfma_f32_16x16x32_bf16 v[84:87], a[216:219], a[188:191], v[84:87]
s_add_u32 s44, s73, 8192
s_waitcnt lgkmcnt(4)
v_mfma_f32_16x16x32_bf16 v[88:91], a[220:223], a[184:187], v[88:91]
ds_read_b64_tr_b16 a[240:241], v26 offset:64
ds_read_b64_tr_b16 a[242:243], v26 offset:4672
v_mfma_f32_16x16x32_bf16 v[92:95], a[220:223], a[188:191], v[92:95]
buffer_load_dwordx2 a[96:97], v38, s[24:27], s44 offen offset:0 sc1
v_mfma_f32_16x16x32_bf16 v[96:99], a[224:227], a[184:187], v[96:99]
ds_read_b64_tr_b16 a[244:245], v26 offset:96
ds_read_b64_tr_b16 a[246:247], v26 offset:4704
v_mfma_f32_16x16x32_bf16 v[100:103], a[224:227], a[188:191], v[100:103]
buffer_load_dwordx2 a[100:101], v38, s[24:27], s44 offen offset:512 sc1
v_mfma_f32_16x16x32_bf16 v[104:107], a[228:231], a[184:187], v[104:107]
ds_read_b64_tr_b16 a[248:249], v26 offset:128
ds_read_b64_tr_b16 a[250:251], v26 offset:4736
v_mfma_f32_16x16x32_bf16 v[108:111], a[228:231], a[188:191], v[108:111]
s_waitcnt lgkmcnt(4)
s_waitcnt vmcnt(14)
v_mfma_f32_16x16x32_bf16 v[40:43], a[232:235], a[0:3], v[40:43]
ds_read_b64_tr_b16 a[252:253], v26 offset:160
ds_read_b64_tr_b16 a[254:255], v26 offset:4768
v_mfma_f32_16x16x32_bf16 v[44:47], a[232:235], a[4:7], v[44:47]
s_add_u32 s44, s74, 8192
v_mfma_f32_16x16x32_bf16 v[48:51], a[236:239], a[0:3], v[48:51]
ds_read_b64_tr_b16 a[192:193], v26 offset:192
ds_read_b64_tr_b16 a[194:195], v26 offset:4800
v_mfma_f32_16x16x32_bf16 v[52:55], a[236:239], a[4:7], v[52:55]
buffer_load_dwordx2 a[98:99], v38, s[24:27], s44 offen offset:0 sc1
v_mfma_f32_16x16x32_bf16 v[56:59], a[240:243], a[0:3], v[56:59]
ds_read_b64_tr_b16 a[196:197], v26 offset:224
ds_read_b64_tr_b16 a[198:199], v26 offset:4832
v_mfma_f32_16x16x32_bf16 v[60:63], a[240:243], a[4:7], v[60:63]
s_waitcnt lgkmcnt(4)
v_mfma_f32_16x16x32_bf16 v[64:67], a[244:247], a[0:3], v[64:67]
ds_read_b64_tr_b16 a[200:201], v26 offset:256
ds_read_b64_tr_b16 a[202:203], v26 offset:4864
v_mfma_f32_16x16x32_bf16 v[68:71], a[244:247], a[4:7], v[68:71]
buffer_load_dwordx2 a[102:103], v38, s[24:27], s44 offen offset:512 sc1
v_mfma_f32_16x16x32_bf16 v[72:75], a[248:251], a[0:3], v[72:75]
ds_read_b64_tr_b16 a[204:205], v26 offset:9216
ds_read_b64_tr_b16 a[206:207], v26 offset:13824
v_mfma_f32_16x16x32_bf16 v[76:79], a[248:251], a[4:7], v[76:79]
s_add_u32 m0, s3, 55296
v_mfma_f32_16x16x32_bf16 v[80:83], a[252:255], a[0:3], v[80:83]
ds_read_b64_tr_b16 a[208:209], v26 offset:9248
ds_read_b64_tr_b16 a[210:211], v26 offset:13856
v_mfma_f32_16x16x32_bf16 v[84:87], a[252:255], a[4:7], v[84:87]
s_waitcnt lgkmcnt(4)
v_mfma_f32_16x16x32_bf16 v[88:91], a[192:195], a[0:3], v[88:91]
ds_read_b64_tr_b16 a[212:213], v26 offset:9280
ds_read_b64_tr_b16 a[214:215], v26 offset:13888
v_mfma_f32_16x16x32_bf16 v[92:95], a[192:195], a[4:7], v[92:95]
buffer_load_dwordx4 v16, s[20:23], s41 offen offset:0 lds
v_mfma_f32_16x16x32_bf16 v[96:99], a[196:199], a[0:3], v[96:99]
ds_read_b64_tr_b16 a[216:217], v26 offset:9312
ds_read_b64_tr_b16 a[218:219], v26 offset:13920
v_mfma_f32_16x16x32_bf16 v[100:103], a[196:199], a[4:7], v[100:103]
buffer_load_dwordx4 v17, s[20:23], s41 offen offset:1024 lds
v_mfma_f32_16x16x32_bf16 v[104:107], a[200:203], a[0:3], v[104:107]
ds_read_b64_tr_b16 a[220:221], v26 offset:9344
ds_read_b64_tr_b16 a[222:223], v26 offset:13952
v_mfma_f32_16x16x32_bf16 v[108:111], a[200:203], a[4:7], v[108:111]
s_waitcnt lgkmcnt(4)
s_waitcnt vmcnt(16)
v_mfma_f32_16x16x32_bf16 v[40:43], a[204:207], a[8:11], v[40:43]
ds_read_b64_tr_b16 a[224:225], v26 offset:9376
ds_read_b64_tr_b16 a[226:227], v26 offset:13984
v_mfma_f32_16x16x32_bf16 v[44:47], a[204:207], a[12:15], v[44:47]
buffer_load_dwordx4 v18, s[20:23], s41 offen offset:2048 lds
v_mfma_f32_16x16x32_bf16 v[48:51], a[208:211], a[8:11], v[48:51]
ds_read_b64_tr_b16 a[228:229], v26 offset:9408
ds_read_b64_tr_b16 a[230:231], v26 offset:14016
v_mfma_f32_16x16x32_bf16 v[52:55], a[208:211], a[12:15], v[52:55]
buffer_load_dwordx4 v19, s[20:23], s41 offen offset:3072 lds
v_mfma_f32_16x16x32_bf16 v[56:59], a[212:215], a[8:11], v[56:59]
ds_read_b64_tr_b16 a[232:233], v26 offset:9440
ds_read_b64_tr_b16 a[234:235], v26 offset:14048
v_mfma_f32_16x16x32_bf16 v[60:63], a[212:215], a[12:15], v[60:63]
s_add_u32 m0, s3, 59392
s_waitcnt lgkmcnt(4)
v_mfma_f32_16x16x32_bf16 v[64:67], a[216:219], a[8:11], v[64:67]
ds_read_b64_tr_b16 a[236:237], v26 offset:9472
ds_read_b64_tr_b16 a[238:239], v26 offset:14080
v_mfma_f32_16x16x32_bf16 v[68:71], a[216:219], a[12:15], v[68:71]
buffer_load_dwordx4 v20, s[20:23], s41 offen lds
v_mfma_f32_16x16x32_bf16 v[72:75], a[220:223], a[8:11], v[72:75]
ds_read_b64_tr_b16 a[240:241], v26 offset:18432
ds_read_b64_tr_b16 a[242:243], v26 offset:23040
v_mfma_f32_16x16x32_bf16 v[76:79], a[220:223], a[12:15], v[76:79]
v_mfma_f32_16x16x32_bf16 v[80:83], a[224:227], a[8:11], v[80:83]
ds_read_b64_tr_b16 a[244:245], v26 offset:18464
ds_read_b64_tr_b16 a[246:247], v26 offset:23072
v_mfma_f32_16x16x32_bf16 v[84:87], a[224:227], a[12:15], v[84:87]
s_waitcnt lgkmcnt(4)
v_mfma_f32_16x16x32_bf16 v[88:91], a[228:231], a[8:11], v[88:91]
ds_read_b64_tr_b16 a[248:249], v26 offset:18496
ds_read_b64_tr_b16 a[250:251], v26 offset:23104
v_mfma_f32_16x16x32_bf16 v[92:95], a[228:231], a[12:15], v[92:95]
v_mfma_f32_16x16x32_bf16 v[96:99], a[232:235], a[8:11], v[96:99]
ds_read_b64_tr_b16 a[252:253], v26 offset:18528
ds_read_b64_tr_b16 a[254:255], v26 offset:23136
v_mfma_f32_16x16x32_bf16 v[100:103], a[232:235], a[12:15], v[100:103]
v_mfma_f32_16x16x32_bf16 v[104:107], a[236:239], a[8:11], v[104:107]
ds_read_b64_tr_b16 a[192:193], v26 offset:18560
ds_read_b64_tr_b16 a[194:195], v26 offset:23168
v_mfma_f32_16x16x32_bf16 v[108:111], a[236:239], a[12:15], v[108:111]
s_waitcnt lgkmcnt(4)
s_waitcnt vmcnt(17)
v_mfma_f32_16x16x32_bf16 v[40:43], a[240:243], a[16:19], v[40:43]
ds_read_b64_tr_b16 a[196:197], v26 offset:18592
ds_read_b64_tr_b16 a[198:199], v26 offset:23200
v_mfma_f32_16x16x32_bf16 v[44:47], a[240:243], a[20:23], v[44:47]
v_mfma_f32_16x16x32_bf16 v[48:51], a[244:247], a[16:19], v[48:51]
ds_read_b64_tr_b16 a[200:201], v26 offset:18624
ds_read_b64_tr_b16 a[202:203], v26 offset:23232
v_mfma_f32_16x16x32_bf16 v[52:55], a[244:247], a[20:23], v[52:55]
v_mfma_f32_16x16x32_bf16 v[56:59], a[248:251], a[16:19], v[56:59]
ds_read_b64_tr_b16 a[204:205], v26 offset:18656
ds_read_b64_tr_b16 a[206:207], v26 offset:23264
v_mfma_f32_16x16x32_bf16 v[60:63], a[248:251], a[20:23], v[60:63]
s_waitcnt lgkmcnt(4)
v_mfma_f32_16x16x32_bf16 v[64:67], a[252:255], a[16:19], v[64:67]
ds_read_b64_tr_b16 a[208:209], v26 offset:18688
ds_read_b64_tr_b16 a[210:211], v26 offset:23296
v_mfma_f32_16x16x32_bf16 v[68:71], a[252:255], a[20:23], v[68:71]
v_mfma_f32_16x16x32_bf16 v[72:75], a[192:195], a[16:19], v[72:75]
ds_read_b64_tr_b16 a[212:213], v26 offset:27648
ds_read_b64_tr_b16 a[214:215], v26 offset:32256
v_mfma_f32_16x16x32_bf16 v[76:79], a[192:195], a[20:23], v[76:79]
v_mfma_f32_16x16x32_bf16 v[80:83], a[196:199], a[16:19], v[80:83]
ds_read_b64_tr_b16 a[216:217], v26 offset:27680
ds_read_b64_tr_b16 a[218:219], v26 offset:32288
v_mfma_f32_16x16x32_bf16 v[84:87], a[196:199], a[20:23], v[84:87]
s_waitcnt lgkmcnt(4)
v_mfma_f32_16x16x32_bf16 v[88:91], a[200:203], a[16:19], v[88:91]
ds_read_b64_tr_b16 a[220:221], v26 offset:27712
ds_read_b64_tr_b16 a[222:223], v26 offset:32320
v_mfma_f32_16x16x32_bf16 v[92:95], a[200:203], a[20:23], v[92:95]
v_mfma_f32_16x16x32_bf16 v[96:99], a[204:207], a[16:19], v[96:99]
ds_read_b64_tr_b16 a[224:225], v26 offset:27744
ds_read_b64_tr_b16 a[226:227], v26 offset:32352
v_mfma_f32_16x16x32_bf16 v[100:103], a[204:207], a[20:23], v[100:103]
v_mfma_f32_16x16x32_bf16 v[104:107], a[208:211], a[16:19], v[104:107]
ds_read_b64_tr_b16 a[228:229], v26 offset:27776
ds_read_b64_tr_b16 a[230:231], v26 offset:32384
v_mfma_f32_16x16x32_bf16 v[108:111], a[208:211], a[20:23], v[108:111]
s_waitcnt lgkmcnt(4)
s_waitcnt vmcnt(15)
v_mfma_f32_16x16x32_bf16 v[40:43], a[212:215], a[24:27], v[40:43]
ds_read_b64_tr_b16 a[232:233], v26 offset:27808
ds_read_b64_tr_b16 a[234:235], v26 offset:32416
v_mfma_f32_16x16x32_bf16 v[44:47], a[212:215], a[28:31], v[44:47]
v_mfma_f32_16x16x32_bf16 v[48:51], a[216:219], a[24:27], v[48:51]
ds_read_b64_tr_b16 a[236:237], v26 offset:27840
ds_read_b64_tr_b16 a[238:239], v26 offset:32448
v_mfma_f32_16x16x32_bf16 v[52:55], a[216:219], a[28:31], v[52:55]
v_mfma_f32_16x16x32_bf16 v[56:59], a[220:223], a[24:27], v[56:59]
ds_read_b64_tr_b16 a[240:241], v26 offset:27872
ds_read_b64_tr_b16 a[242:243], v26 offset:32480
v_mfma_f32_16x16x32_bf16 v[60:63], a[220:223], a[28:31], v[60:63]
s_waitcnt lgkmcnt(4)
v_mfma_f32_16x16x32_bf16 v[64:67], a[224:227], a[24:27], v[64:67]
ds_read_b64_tr_b16 a[244:245], v26 offset:27904
ds_read_b64_tr_b16 a[246:247], v26 offset:32512
v_mfma_f32_16x16x32_bf16 v[68:71], a[224:227], a[28:31], v[68:71]
v_mfma_f32_16x16x32_bf16 v[72:75], a[228:231], a[24:27], v[72:75]
ds_read_b64_tr_b16 a[248:249], v26 offset:36864
ds_read_b64_tr_b16 a[250:251], v26 offset:41472
v_mfma_f32_16x16x32_bf16 v[76:79], a[228:231], a[28:31], v[76:79]
v_mfma_f32_16x16x32_bf16 v[80:83], a[232:235], a[24:27], v[80:83]
ds_read_b64_tr_b16 a[252:253], v26 offset:36896
ds_read_b64_tr_b16 a[254:255], v26 offset:41504
v_mfma_f32_16x16x32_bf16 v[84:87], a[232:235], a[28:31], v[84:87]
s_waitcnt lgkmcnt(4)
v_mfma_f32_16x16x32_bf16 v[88:91], a[236:239], a[24:27], v[88:91]
ds_read_b64_tr_b16 a[192:193], v26 offset:36928
ds_read_b64_tr_b16 a[194:195], v26 offset:41536
v_mfma_f32_16x16x32_bf16 v[92:95], a[236:239], a[28:31], v[92:95]
v_mfma_f32_16x16x32_bf16 v[96:99], a[240:243], a[24:27], v[96:99]
ds_read_b64_tr_b16 a[196:197], v26 offset:36960
ds_read_b64_tr_b16 a[198:199], v26 offset:41568
v_mfma_f32_16x16x32_bf16 v[100:103], a[240:243], a[28:31], v[100:103]
v_mfma_f32_16x16x32_bf16 v[104:107], a[244:247], a[24:27], v[104:107]
ds_read_b64_tr_b16 a[200:201], v26 offset:36992
ds_read_b64_tr_b16 a[202:203], v26 offset:41600
v_mfma_f32_16x16x32_bf16 v[108:111], a[244:247], a[28:31], v[108:111]
s_waitcnt lgkmcnt(4)
s_waitcnt vmcnt(13)
v_mfma_f32_16x16x32_bf16 v[40:43], a[248:251], a[32:35], v[40:43]
ds_read_b64_tr_b16 a[204:205], v26 offset:37024
ds_read_b64_tr_b16 a[206:207], v26 offset:41632
v_mfma_f32_16x16x32_bf16 v[44:47], a[248:251], a[36:39], v[44:47]
v_mfma_f32_16x16x32_bf16 v[48:51], a[252:255], a[32:35], v[48:51]
ds_read_b64_tr_b16 a[208:209], v26 offset:37056
ds_read_b64_tr_b16 a[210:211], v26 offset:41664
v_mfma_f32_16x16x32_bf16 v[52:55], a[252:255], a[36:39], v[52:55]
v_mfma_f32_16x16x32_bf16 v[56:59], a[192:195], a[32:35], v[56:59]
ds_read_b64_tr_b16 a[212:213], v26 offset:37088
ds_read_b64_tr_b16 a[214:215], v26 offset:41696
v_mfma_f32_16x16x32_bf16 v[60:63], a[192:195], a[36:39], v[60:63]
s_waitcnt lgkmcnt(4)
v_mfma_f32_16x16x32_bf16 v[64:67], a[196:199], a[32:35], v[64:67]
ds_read_b64_tr_b16 a[216:217], v26 offset:37120
ds_read_b64_tr_b16 a[218:219], v26 offset:41728
v_mfma_f32_16x16x32_bf16 v[68:71], a[196:199], a[36:39], v[68:71]
v_mfma_f32_16x16x32_bf16 v[72:75], a[200:203], a[32:35], v[72:75]
ds_read_b64_tr_b16 a[220:221], v26 offset:46080
ds_read_b64_tr_b16 a[222:223], v26 offset:50688
v_mfma_f32_16x16x32_bf16 v[76:79], a[200:203], a[36:39], v[76:79]
v_mfma_f32_16x16x32_bf16 v[80:83], a[204:207], a[32:35], v[80:83]
ds_read_b64_tr_b16 a[224:225], v26 offset:46112
ds_read_b64_tr_b16 a[226:227], v26 offset:50720
v_mfma_f32_16x16x32_bf16 v[84:87], a[204:207], a[36:39], v[84:87]
s_waitcnt lgkmcnt(4)
v_mfma_f32_16x16x32_bf16 v[88:91], a[208:211], a[32:35], v[88:91]
ds_read_b64_tr_b16 a[228:229], v26 offset:46144
ds_read_b64_tr_b16 a[230:231], v26 offset:50752
v_mfma_f32_16x16x32_bf16 v[92:95], a[208:211], a[36:39], v[92:95]
v_mfma_f32_16x16x32_bf16 v[96:99], a[212:215], a[32:35], v[96:99]
ds_read_b64_tr_b16 a[232:233], v26 offset:46176
ds_read_b64_tr_b16 a[234:235], v26 offset:50784
v_mfma_f32_16x16x32_bf16 v[100:103], a[212:215], a[36:39], v[100:103]
v_mfma_f32_16x16x32_bf16 v[104:107], a[216:219], a[32:35], v[104:107]
ds_read_b64_tr_b16 a[236:237], v26 offset:46208
ds_read_b64_tr_b16 a[238:239], v26 offset:50816
v_mfma_f32_16x16x32_bf16 v[108:111], a[216:219], a[36:39], v[108:111]
s_waitcnt lgkmcnt(4)
s_waitcnt vmcnt(11)
v_mfma_f32_16x16x32_bf16 v[40:43], a[220:223], a[40:43], v[40:43]
ds_read_b64_tr_b16 a[240:241], v26 offset:46240
ds_read_b64_tr_b16 a[242:243], v26 offset:50848
v_mfma_f32_16x16x32_bf16 v[44:47], a[220:223], a[44:47], v[44:47]
v_mfma_f32_16x16x32_bf16 v[48:51], a[224:227], a[40:43], v[48:51]
ds_read_b64_tr_b16 a[244:245], v26 offset:46272
ds_read_b64_tr_b16 a[246:247], v26 offset:50880
v_mfma_f32_16x16x32_bf16 v[52:55], a[224:227], a[44:47], v[52:55]
v_mfma_f32_16x16x32_bf16 v[56:59], a[228:231], a[40:43], v[56:59]
ds_read_b64_tr_b16 a[248:249], v26 offset:46304
ds_read_b64_tr_b16 a[250:251], v26 offset:50912
v_mfma_f32_16x16x32_bf16 v[60:63], a[228:231], a[44:47], v[60:63]
s_waitcnt lgkmcnt(4)
v_mfma_f32_16x16x32_bf16 v[64:67], a[232:235], a[40:43], v[64:67]
ds_read_b64_tr_b16 a[252:253], v26 offset:46336
ds_read_b64_tr_b16 a[254:255], v26 offset:50944
v_mfma_f32_16x16x32_bf16 v[68:71], a[232:235], a[44:47], v[68:71]
v_mfma_f32_16x16x32_bf16 v[72:75], a[236:239], a[40:43], v[72:75]
s_waitcnt vmcnt(0)
s_barrier
v_mfma_f32_16x16x32_bf16 v[76:79], a[236:239], a[44:47], v[76:79]
ds_read_b64_tr_b16 a[192:193], v27 offset:0
ds_read_b64_tr_b16 a[194:195], v27 offset:4608
v_mfma_f32_16x16x32_bf16 v[80:83], a[240:243], a[40:43], v[80:83]
ds_read_b64_tr_b16 a[196:197], v27 offset:32
ds_read_b64_tr_b16 a[198:199], v27 offset:4640
v_mfma_f32_16x16x32_bf16 v[84:87], a[240:243], a[44:47], v[84:87]
s_add_u32 s41, s40, 18432
s_waitcnt lgkmcnt(4)
v_mfma_f32_16x16x32_bf16 v[88:91], a[244:247], a[40:43], v[88:91]
ds_read_b64_tr_b16 a[200:201], v27 offset:64
ds_read_b64_tr_b16 a[202:203], v27 offset:4672
v_mfma_f32_16x16x32_bf16 v[92:95], a[244:247], a[44:47], v[92:95]
s_add_u32 s43, s40, 4096
s_add_u32 s44, s41, 4096
v_mfma_f32_16x16x32_bf16 v[96:99], a[248:251], a[40:43], v[96:99]
ds_read_b64_tr_b16 a[204:205], v27 offset:96
ds_read_b64_tr_b16 a[206:207], v27 offset:4704
v_mfma_f32_16x16x32_bf16 v[100:103], a[248:251], a[44:47], v[100:103]
v_mfma_f32_16x16x32_bf16 v[104:107], a[252:255], a[40:43], v[104:107]
ds_read_b64_tr_b16 a[208:209], v27 offset:128
ds_read_b64_tr_b16 a[210:211], v27 offset:4736
v_mfma_f32_16x16x32_bf16 v[108:111], a[252:255], a[44:47], v[108:111]
s_waitcnt lgkmcnt(4)
s_waitcnt vmcnt(9)
v_mfma_f32_16x16x32_bf16 v[40:43], a[192:195], v[228:231], v[40:43]
ds_read_b64_tr_b16 a[212:213], v27 offset:160
ds_read_b64_tr_b16 a[214:215], v27 offset:4768
v_mfma_f32_16x16x32_bf16 v[44:47], a[192:195], v[248:251], v[44:47]
v_mfma_f32_16x16x32_bf16 v[48:51], a[196:199], v[228:231], v[48:51]
ds_read_b64_tr_b16 a[216:217], v27 offset:192
ds_read_b64_tr_b16 a[218:219], v27 offset:4800
v_mfma_f32_16x16x32_bf16 v[52:55], a[196:199], v[248:251], v[52:55]
v_mfma_f32_16x16x32_bf16 v[56:59], a[200:203], v[228:231], v[56:59]
ds_read_b64_tr_b16 a[220:221], v27 offset:224
ds_read_b64_tr_b16 a[222:223], v27 offset:4832
v_mfma_f32_16x16x32_bf16 v[60:63], a[200:203], v[248:251], v[60:63]
s_waitcnt lgkmcnt(4)
v_mfma_f32_16x16x32_bf16 v[64:67], a[204:207], v[228:231], v[64:67]
ds_read_b64_tr_b16 a[224:225], v27 offset:256
ds_read_b64_tr_b16 a[226:227], v27 offset:4864
v_mfma_f32_16x16x32_bf16 v[68:71], a[204:207], v[248:251], v[68:71]
v_mfma_f32_16x16x32_bf16 v[72:75], a[208:211], v[228:231], v[72:75]
ds_read_b64_tr_b16 a[228:229], v27 offset:9216
ds_read_b64_tr_b16 a[230:231], v27 offset:13824
v_mfma_f32_16x16x32_bf16 v[76:79], a[208:211], v[248:251], v[76:79]
v_mfma_f32_16x16x32_bf16 v[80:83], a[212:215], v[228:231], v[80:83]
ds_read_b64_tr_b16 a[232:233], v27 offset:9248
ds_read_b64_tr_b16 a[234:235], v27 offset:13856
v_mfma_f32_16x16x32_bf16 v[84:87], a[212:215], v[248:251], v[84:87]
s_waitcnt lgkmcnt(4)
v_mfma_f32_16x16x32_bf16 v[88:91], a[216:219], v[228:231], v[88:91]
ds_read_b64_tr_b16 a[236:237], v27 offset:9280
ds_read_b64_tr_b16 a[238:239], v27 offset:13888
v_mfma_f32_16x16x32_bf16 v[92:95], a[216:219], v[248:251], v[92:95]
v_mfma_f32_16x16x32_bf16 v[96:99], a[220:223], v[228:231], v[96:99]
ds_read_b64_tr_b16 a[240:241], v27 offset:9312
ds_read_b64_tr_b16 a[242:243], v27 offset:13920
v_mfma_f32_16x16x32_bf16 v[100:103], a[220:223], v[248:251], v[100:103]
v_mfma_f32_16x16x32_bf16 v[104:107], a[224:227], v[228:231], v[104:107]
ds_read_b64_tr_b16 a[244:245], v27 offset:9344
ds_read_b64_tr_b16 a[246:247], v27 offset:13952
v_mfma_f32_16x16x32_bf16 v[108:111], a[224:227], v[248:251], v[108:111]
s_waitcnt lgkmcnt(4)
s_waitcnt vmcnt(5)
v_mfma_f32_16x16x32_bf16 v[40:43], a[228:231], a[96:99], v[40:43]
ds_read_b64_tr_b16 a[248:249], v27 offset:9376
ds_read_b64_tr_b16 a[250:251], v27 offset:13984
v_mfma_f32_16x16x32_bf16 v[44:47], a[228:231], a[100:103], v[44:47]
v_mfma_f32_16x16x32_bf16 v[48:51], a[232:235], a[96:99], v[48:51]
ds_read_b64_tr_b16 a[252:253], v27 offset:9408
ds_read_b64_tr_b16 a[254:255], v27 offset:14016
v_mfma_f32_16x16x32_bf16 v[52:55], a[232:235], a[100:103], v[52:55]
v_mfma_f32_16x16x32_bf16 v[56:59], a[236:239], a[96:99], v[56:59]
ds_read_b64_tr_b16 a[192:193], v27 offset:9440
ds_read_b64_tr_b16 a[194:195], v27 offset:14048
v_mfma_f32_16x16x32_bf16 v[60:63], a[236:239], a[100:103], v[60:63]
s_waitcnt lgkmcnt(4)
v_mfma_f32_16x16x32_bf16 v[64:67], a[240:243], a[96:99], v[64:67]
ds_read_b64_tr_b16 a[196:197], v27 offset:9472
ds_read_b64_tr_b16 a[198:199], v27 offset:14080
v_mfma_f32_16x16x32_bf16 v[68:71], a[240:243], a[100:103], v[68:71]
v_mfma_f32_16x16x32_bf16 v[72:75], a[244:247], a[96:99], v[72:75]
v_cvt_pk_bf16_f32 v112, v40, v41
v_cvt_pk_bf16_f32 v113, v42, v43
v_cvt_pk_bf16_f32 v114, v44, v45
v_mfma_f32_16x16x32_bf16 v[76:79], a[244:247], a[100:103], v[76:79]
v_cvt_pk_bf16_f32 v115, v46, v47
buffer_store_dwordx2 v[112:113], v38, s[24:27], s40 offen offset:0 sc1
buffer_store_dwordx2 v[114:115], v38, s[24:27], s41 offen offset:0 sc1
v_mfma_f32_16x16x32_bf16 v[80:83], a[248:251], a[96:99], v[80:83]
v_cvt_pk_bf16_f32 v116, v48, v49
v_cvt_pk_bf16_f32 v117, v50, v51
v_cvt_pk_bf16_f32 v118, v52, v53
v_mfma_f32_16x16x32_bf16 v[84:87], a[248:251], a[100:103], v[84:87]
v_cvt_pk_bf16_f32 v119, v54, v55
buffer_store_dwordx2 v[116:117], v38, s[24:27], s40 offen offset:512 sc1
buffer_store_dwordx2 v[118:119], v38, s[24:27], s41 offen offset:512 sc1
s_waitcnt lgkmcnt(0)
v_mfma_f32_16x16x32_bf16 v[88:91], a[252:255], a[96:99], v[88:91]
v_cvt_pk_bf16_f32 v120, v56, v57
v_cvt_pk_bf16_f32 v121, v58, v59
v_cvt_pk_bf16_f32 v122, v60, v61
v_mfma_f32_16x16x32_bf16 v[92:95], a[252:255], a[100:103], v[92:95]
v_cvt_pk_bf16_f32 v123, v62, v63
buffer_store_dwordx2 v[120:121], v38, s[24:27], s40 offen offset:1024 sc1
buffer_store_dwordx2 v[122:123], v38, s[24:27], s41 offen offset:1024 sc1
v_mfma_f32_16x16x32_bf16 v[96:99], a[192:195], a[96:99], v[96:99]
v_cvt_pk_bf16_f32 v124, v64, v65
v_cvt_pk_bf16_f32 v125, v66, v67
v_cvt_pk_bf16_f32 v126, v68, v69
v_mfma_f32_16x16x32_bf16 v[100:103], a[192:195], a[100:103], v[100:103]
v_cvt_pk_bf16_f32 v127, v70, v71
buffer_store_dwordx2 v[124:125], v38, s[24:27], s40 offen offset:1536 sc1
buffer_store_dwordx2 v[126:127], v38, s[24:27], s41 offen offset:1536 sc1
v_mfma_f32_16x16x32_bf16 v[104:107], a[196:199], a[96:99], v[104:107]
v_cvt_pk_bf16_f32 v128, v72, v73
v_cvt_pk_bf16_f32 v129, v74, v75
v_cvt_pk_bf16_f32 v130, v76, v77
v_mfma_f32_16x16x32_bf16 v[108:111], a[196:199], a[100:103], v[108:111]
v_cvt_pk_bf16_f32 v131, v78, v79
buffer_store_dwordx2 v[128:129], v38, s[24:27], s40 offen offset:2048 sc1
buffer_store_dwordx2 v[130:131], v38, s[24:27], s41 offen offset:2048 sc1
v_cvt_pk_bf16_f32 v132, v80, v81
v_cvt_pk_bf16_f32 v133, v82, v83
v_cvt_pk_bf16_f32 v134, v84, v85
v_cvt_pk_bf16_f32 v135, v86, v87
buffer_store_dwordx2 v[132:133], v38, s[24:27], s40 offen offset:2560 sc1
buffer_store_dwordx2 v[134:135], v38, s[24:27], s41 offen offset:2560 sc1
v_cvt_pk_bf16_f32 v136, v88, v89
v_cvt_pk_bf16_f32 v137, v90, v91
v_cvt_pk_bf16_f32 v138, v92, v93
v_cvt_pk_bf16_f32 v139, v94, v95
buffer_store_dwordx2 v[136:137], v38, s[24:27], s40 offen offset:3072 sc1
buffer_store_dwordx2 v[138:139], v38, s[24:27], s41 offen offset:3072 sc1
v_cvt_pk_bf16_f32 v140, v96, v97
v_cvt_pk_bf16_f32 v141, v98, v99
v_cvt_pk_bf16_f32 v142, v100, v101
v_cvt_pk_bf16_f32 v143, v102, v103
buffer_store_dwordx2 v[140:141], v38, s[24:27], s40 offen offset:3584 sc1
buffer_store_dwordx2 v[142:143], v38, s[24:27], s41 offen offset:3584 sc1
v_cvt_pk_bf16_f32 v144, v104, v105
v_cvt_pk_bf16_f32 v145, v106, v107
v_cvt_pk_bf16_f32 v146, v108, v109
v_cvt_pk_bf16_f32 v147, v110, v111
buffer_store_dwordx2 v[144:145], v38, s[24:27], s43 offen offset:0 sc1
buffer_store_dwordx2 v[146:147], v38, s[24:27], s44 offen offset:0 sc1
v_mov_b32_e64 v2, 15
s_waitcnt vmcnt(0)
buffer_store_dword v2, v39, s[24:27], 0 offen sc1
s_endpgm
L_aslowH:
s_mov_b32 s97, 0
L_aspinH:
buffer_load_dword v7, v6, s[28:31], 0 offen sc1
s_waitcnt vmcnt(0)
v_and_b32 v5, 0xff, v7
v_cmp_le_u32 vcc, 4, v5
s_and_b32 s96, vcc_lo, 0xff
s_cmp_eq_u32 s96, 0xff
s_cbranch_scc1 L_abackH
s_sleep 1
s_add_u32 s97, s97, 1
s_cmp_lt_u32 s97, 0x80000
s_cbranch_scc1 L_aspinH
s_branch L_abackH
L_hslowK:
s_mov_b32 s42, 0
L_hspinK:
buffer_load_dword v33, v1, s[24:27], 0 offen sc1
s_waitcnt vmcnt(0)
v_readfirstlane_b32 s11, v33
s_add_u32 s42, s42, 1
s_cmp_ge_u32 s11, 1
s_cbranch_scc1 L_hbackK
s_sleep 1
s_cmp_lt_u32 s42, 0x80000
s_cbranch_scc1 L_hspinK
s_branch L_hbackK
L_hslowV:
s_mov_b32 s42, 0
L_hspinV:
buffer_load_dword v33, v1, s[24:27], 0 offen sc1
s_waitcnt vmcnt(0)
v_readfirstlane_b32 s11, v33
s_add_u32 s42, s42, 1
s_cmp_ge_u32 s11, 2
s_cbranch_scc1 L_hbackV
s_sleep 1
s_cmp_lt_u32 s42, 0x80000
s_cbranch_scc1 L_hspinV
s_branch L_hbackV
L_orel0:
buffer_store_dword v33, v39, s[24:27], s37 offen sc1
s_branch L_orelb0
L_oslow0:
s_mov_b32 s97, 0
L_ospin0:
buffer_load_dword v34, v1, s[24:27], 0 offen sc1
s_waitcnt vmcnt(0)
v_cmp_ge_u32 vcc, 0, v34
s_add_u32 s97, s97, 1
s_nop 4
s_cbranch_vccz L_oback0
s_cmp_lt_u32 s97, 0x80000
s_cbranch_scc1 L_ospin0
s_branch L_oback0
L_orel1:
buffer_store_dword v33, v39, s[24:27], s37 offen sc1
s_branch L_orelb1
L_oslow1:
s_mov_b32 s97, 0
L_ospin1:
buffer_load_dword v34, v1, s[24:27], 0 offen sc1
s_waitcnt vmcnt(0)
v_cmp_ge_u32_e64 vcc, 1, v34
s_add_u32 s97, s97, 1
s_nop 4
s_cbranch_vccz L_oback1
s_cmp_lt_u32 s97, 0x80000
s_cbranch_scc1 L_ospin1
s_branch L_oback1
L_exit:
s_endpgm
L_main_end:
.section .rodata,"a"
.p2align 6
.amdhsa_kernel recurrent_scan__sliding_local_dilated__dense_activation_silu__prompt_kernel
  .amdhsa_next_free_vgpr 512
  .amdhsa_next_free_sgpr 102
  .amdhsa_accum_offset 256
  .amdhsa_group_segment_fixed_size 0
  .amdhsa_kernarg_size 72
  .amdhsa_user_sgpr_count 2
  .amdhsa_user_sgpr_kernarg_segment_ptr 1
  .amdhsa_system_sgpr_workgroup_id_x 1
  .amdhsa_float_denorm_mode_32 3
.end_amdhsa_kernel
```
